```python
import torch

def _softmax(x, axis=-1):
    return torch.softmax(x, dim=axis)
def _gelu(x):
    return torch.nn.functional.gelu(x, approximate="tanh")
def _silu(x):
    return torch.nn.functional.silu(x)
def _sigmoid(x):
    return torch.sigmoid(x)
def _layernorm(x, axis=-1, eps=1e-5):
    m = x.mean(dim=axis, keepdim=True)
    v = x.var(dim=axis, keepdim=True, unbiased=False)
    return (x - m) / torch.sqrt(v + eps)
def _scatter_add(tgt, idx, src, axis=0):
    return tgt.clone().index_add_(axis, idx, src)
def _segment_sum(src, seg, n):
    out = torch.zeros((n,) + src.shape[1:], dtype=src.dtype)
    return out.index_add_(0, seg, src)
def _pad(x, pw):
    flat = tuple(v for pair in reversed(pw) for v in pair)
    return torch.nn.functional.pad(x, flat)

kernel_name = 'recurrent_scan__gqa_block_cached__mixer_channel_mlp__prompt'

def setup_inputs():

    _w = (lambda a: (lambda t: t.to(torch.bfloat16) if t.is_floating_point() else t)(torch.as_tensor(a)))
    def _A_setup():
        B, Sq, D = 1, 2048, 448
        Hq, Hkv, Sk, Dh = 16, 8, 2048, 256
        assert Hq % Hkv == 0, (Hq, Hkv)
        return {
            "x": _w((lambda *s: torch.randn(*s, dtype=torch.bfloat16) * 0.05)(B, Sq, D)),
            "k_cache": _w((lambda *s: torch.randn(*s, dtype=torch.bfloat16) * 1.6)(B, Hkv, Sk, Dh)),
            "v_cache": _w((lambda *s: torch.randn(*s, dtype=torch.bfloat16) * 0.8)(B, Hkv, Sk, Dh)),
            "wq": _w((lambda *s: torch.randn(*s, dtype=torch.bfloat16) * 1.6)(D, Hq * Dh) * (D ** -0.5)),
            "wo": _w((lambda *s: torch.randn(*s, dtype=torch.bfloat16) * 0.8)(Hq * Dh, D) * ((Hq * Dh) ** -0.5)),
        }
    _A_in = _A_setup()

    def _B_setup():
        B, S, D, F = 1, 2048, 448, 1792
        return {
            "x": _w((lambda *s: torch.randn(*s, dtype=torch.bfloat16) * 0.05)(B, S, D)),
            "w1": _w((lambda *s: torch.randn(*s, dtype=torch.bfloat16) * 1.6)(D, F) * (D ** -0.5)),
            "b1": _w((lambda *s: torch.randn(*s, dtype=torch.bfloat16) * 0.8)(F)),
            "w2": _w((lambda *s: torch.randn(*s, dtype=torch.bfloat16) * 0.2)(F, D) * (F ** -0.5)),
            "b2": _w((lambda *s: torch.randn(*s, dtype=torch.bfloat16) * 0.2)(D)),
        }
    _B_in = _B_setup()

    return {
        "A_x": _A_in["x"],
        "A_k_cache": _A_in["k_cache"],
        "A_v_cache": _A_in["v_cache"],
        "A_wq": _A_in["wq"],
        "A_wo": _A_in["wo"],
        "B_x": _B_in["x"],
        "B_w1": _B_in["w1"],
        "B_b1": _B_in["b1"],
        "B_w2": _B_in["w2"],
        "B_b2": _B_in["b2"],
    }

def reference(A_x, A_k_cache, A_v_cache, A_wq, A_wo, B_x, B_w1, B_b1, B_w2, B_b2):
    def _A_ref(x, k_cache, v_cache, wq, wo):
        B, Sq, D = x.shape
        Hq, Dh = 16, 256
        Hkv = k_cache.shape[1]
        rep = Hq // Hkv
        q = (lambda x, *d: x.permute(*d))((x @ wq).reshape(B, Sq, Hq, Dh), 0, 2, 1, 3)
        k = (lambda x, n, axis: torch.repeat_interleave(x, n, dim=axis))(k_cache, rep, axis=1)
        v = (lambda x, n, axis: torch.repeat_interleave(x, n, dim=axis))(v_cache, rep, axis=1)
        scores = torch.einsum("bhqd,bhkd->bhqk", q, k) * (Dh ** -0.5)
        p = _softmax(scores, axis=-1)
        o = torch.einsum("bhqk,bhkd->bhqd", p, v)
        return (lambda x, *d: x.permute(*d))(o, 0, 2, 1, 3).reshape(B, Sq, Hq * Dh) @ wo

    def _B_ref(x, w1, b1, w2, b2):
        y = _layernorm(x, axis=-1)
        h = _gelu(torch.einsum("bsd,df->bsf", y, w1) + b1)
        return torch.einsum("bsf,fd->bsd", h, w2) + b2

    x = A_x
    xn = _layernorm(x, axis=-1)
    s = _A_ref(xn, A_k_cache, A_v_cache, A_wq, A_wo)
    g = _silu(_B_ref(xn, B_w1, B_b1, B_w2, B_b2))
    return x + s * g
```

```asm
; @launch grid=(256,1,1) block=(256,1,1) lds=163840
.amdgcn_target "amdgcn-amd-amdhsa--gfx950"
.text
.globl recurrent_scan__gqa_block_cached__mixer_channel_mlp__prompt_kernel
.p2align 8
.type recurrent_scan__gqa_block_cached__mixer_channel_mlp__prompt_kernel,@function
recurrent_scan__gqa_block_cached__mixer_channel_mlp__prompt_kernel:
    s_cmp_ge_u32 s2, 256
    s_cbranch_scc1 L_end
    s_load_dwordx2 s[16:17], s[0:1], 0
    v_lshrrev_b32 v232, 6, v0
    v_and_b32 v251, 63, v0
    v_readfirstlane_b32 s3, v232
    v_and_b32 v233, 15, v251
    v_lshrrev_b32 v234, 4, v251
    s_lshr_b32 s45, s2, 3
    v_mul_u32_u24 v235, 896, v233
    s_lshl_b32 s55, s45, 2
    s_add_u32 s55, s55, s3
    v_lshl_add_u32 v235, v234, 4, v235
    s_mul_i32 s55, s55, 14336
    s_mov_b32 s18, 1835008
    s_mov_b32 s19, 0x20000
    s_waitcnt lgkmcnt(0)
    buffer_load_dwordx4 v[0:3], v235, s[16:19], s55 offen offset:0
    buffer_load_dwordx4 v[4:7], v235, s[16:19], s55 offen offset:64
    buffer_load_dwordx4 v[8:11], v235, s[16:19], s55 offen offset:128
    buffer_load_dwordx4 v[12:15], v235, s[16:19], s55 offen offset:192
    buffer_load_dwordx4 v[16:19], v235, s[16:19], s55 offen offset:256
    buffer_load_dwordx4 v[20:23], v235, s[16:19], s55 offen offset:320
    buffer_load_dwordx4 v[24:27], v235, s[16:19], s55 offen offset:384
    buffer_load_dwordx4 v[28:31], v235, s[16:19], s55 offen offset:448
    buffer_load_dwordx4 v[32:35], v235, s[16:19], s55 offen offset:512
    buffer_load_dwordx4 v[36:39], v235, s[16:19], s55 offen offset:576
    buffer_load_dwordx4 v[40:43], v235, s[16:19], s55 offen offset:640
    buffer_load_dwordx4 v[44:47], v235, s[16:19], s55 offen offset:704
    buffer_load_dwordx4 v[48:51], v235, s[16:19], s55 offen offset:768
    buffer_load_dwordx4 v[52:55], v235, s[16:19], s55 offen offset:832
    s_load_dwordx16 s[68:83], s[0:1], 0
    s_load_dwordx2 s[84:85], s[0:1], 64
    s_load_dwordx2 s[4:5], s[0:1], 96
    s_load_dwordx4 s[92:95], s[0:1], 72
    s_load_dwordx2 s[96:97], s[0:1], 88
    s_getpc_b64 s[6:7]
L_pc0:
    s_sub_u32 s6, s6, L_pc0-recurrent_scan__gqa_block_cached__mixer_channel_mlp__prompt_kernel
    s_subb_u32 s7, s7, 0
    s_lshl_b32 s56, s45, 11
    v_lshlrev_b32 v236, 9, v232
    v_and_b32 v237, 3, v251
    v_lshl_add_u32 v236, v237, 7, v236
    v_add_u32 v236, s56, v236
    global_load_dword a255, v236, s[6:7]
    global_load_dword a255, v236, s[6:7] offset:64
    s_and_b32 s44, s2, 7
    s_waitcnt lgkmcnt(0)
    s_cmp_lg_u32 s3, 0
    s_cbranch_scc1 L_nonce
    s_memrealtime s[6:7]
    s_mov_b32 s40, s96
    s_mov_b32 s41, s97
    s_mov_b32 s42, 256
    s_mov_b32 s43, 0x20000
    s_lshl_b32 s100, s45, 2
    s_add_u32 s100, s100, 128
    s_waitcnt lgkmcnt(0)
    s_or_b32 s59, s6, 1
    s_mov_b64 exec, 1
    v_mov_b32 v96, s59
    v_mov_b32 v97, 0
    v_mov_b32 v98, 0
    buffer_atomic_cmpswap v[96:97], v98, s[40:43], s100 offen sc0
    s_mov_b64 exec, -1
L_nonce:
    s_lshl_b32 s55, s44, 20
    s_add_u32 s8, s70, s55
    s_addc_u32 s9, s71, 0
    s_mov_b32 s10, 0x100000
    s_mov_b32 s11, 0x20000
    s_add_u32 s12, s72, s55
    s_addc_u32 s13, s73, 0
    s_mov_b32 s14, 0x100000
    s_mov_b32 s15, 0x20000
    s_mov_b32 s20, s74
    s_mov_b32 s21, s75
    s_mov_b32 s22, 3670016
    s_mov_b32 s23, 0x20000
    s_mov_b32 s24, s76
    s_mov_b32 s25, s77
    s_mov_b32 s26, 3670016
    s_mov_b32 s27, 0x20000
    s_mov_b32 s28, s80
    s_mov_b32 s29, s81
    s_mov_b32 s30, 1605632
    s_mov_b32 s31, 0x20000
    s_mov_b32 s32, s84
    s_mov_b32 s33, s85
    s_mov_b32 s34, 1605632
    s_mov_b32 s35, 0x20000
    s_mov_b32 s36, s4
    s_mov_b32 s37, s5
    s_mov_b32 s38, 134217728
    s_mov_b32 s39, 0x20000
    s_mov_b32 s40, s82
    s_mov_b32 s41, s83
    s_mov_b32 s42, 3584
    s_mov_b32 s43, 0x20000
    s_lshr_b32 s53, s3, 1
    s_and_b32 s54, s3, 1
    s_mul_i32 s55, s53, 16896
    s_mul_i32 s56, s54, 8448
    s_add_u32 s46, s55, s56
    s_add_u32 s64, s46, 0
    s_add_u32 s65, s46, 33792
    s_add_u32 s66, s46, 67584
    s_add_u32 s67, s46, 101376
    s_lshl_b32 s55, s53, 14
    s_lshl_b32 s56, s54, 12
    s_add_u32 s47, s55, s56
    s_sub_u32 s48, s47, 0x8000
    s_sub_u32 s49, s47, 0x8000
    s_lshl_b32 s55, s53, 5
    s_lshl_b32 s56, s54, 4
    s_add_u32 s55, s55, s56
    s_mul_i32 s60, s55, 3584
    s_mul_i32 s56, s44, 448
    s_add_u32 s60, s60, s56
    s_lshl_b32 s55, s54, 17
    s_lshl_b32 s56, s44, 10
    s_add_u32 s55, s55, s56
    s_lshl_b32 s56, s53, 9
    s_add_u32 s61, s55, s56
    s_mul_i32 s55, s44, 224
    s_lshl_b32 s56, s54, 3
    s_add_u32 s55, s55, s56
    s_mul_i32 s62, s55, 896
    s_mul_i32 s57, s53, 448
    s_add_u32 s62, s62, s57
    s_lshl_b32 s55, s44, 9
    s_add_u32 s55, s55, s56
    s_mul_i32 s63, s55, 896
    s_add_u32 s63, s63, s57
    s_mov_b32 s52, 1333788672
    v_lshrrev_b32 v236, 5, v251
    v_and_b32 v237, 31, v251
    v_lshlrev_b32 v237, 4, v237
    v_mul_u32_u24 v254, 14336, v236
    v_add_u32 v254, v254, v237
    v_lshl_add_u32 v255, v236, 15, v237
    v_lshl_add_u32 v250, v236, 13, v237
    v_mul_u32_u24 v247, 14336, v236
    v_add_u32 v247, v247, v237
    v_cmp_lt_u32 vcc, 432, v237
    v_mov_b32 v238, 0x40000000
    s_nop 1
    v_cndmask_b32 v247, v247, v238, vcc
    v_bfe_u32 v244, v251, 2, 2
    v_lshrrev_b32 v245, 4, v251
    v_lshl_add_u32 v244, v245, 2, v244
    v_mul_u32_u24 v244, 1056, v244
    v_and_b32 v245, 3, v251
    s_waitcnt vmcnt(2)
    v_lshlrev_b32 v112, 16, v0
    v_and_b32 v113, 0xffff0000, v0
    v_lshlrev_b32 v114, 16, v1
    v_and_b32 v115, 0xffff0000, v1
    v_lshlrev_b32 v116, 16, v2
    v_and_b32 v117, 0xffff0000, v2
    v_lshlrev_b32 v118, 16, v3
    v_and_b32 v119, 0xffff0000, v3
    v_lshlrev_b32 v120, 16, v4
    v_and_b32 v121, 0xffff0000, v4
    v_lshlrev_b32 v122, 16, v5
    v_and_b32 v123, 0xffff0000, v5
    v_lshlrev_b32 v124, 16, v6
    v_and_b32 v125, 0xffff0000, v6
    v_lshlrev_b32 v126, 16, v7
    v_and_b32 v127, 0xffff0000, v7
    v_lshlrev_b32 v128, 16, v8
    v_and_b32 v129, 0xffff0000, v8
    v_lshlrev_b32 v130, 16, v9
    v_and_b32 v131, 0xffff0000, v9
    v_lshlrev_b32 v132, 16, v10
    v_and_b32 v133, 0xffff0000, v10
    v_lshlrev_b32 v134, 16, v11
    v_and_b32 v135, 0xffff0000, v11
    v_lshlrev_b32 v136, 16, v12
    v_and_b32 v137, 0xffff0000, v12
    v_lshlrev_b32 v138, 16, v13
    v_and_b32 v139, 0xffff0000, v13
    v_lshlrev_b32 v140, 16, v14
    v_and_b32 v141, 0xffff0000, v14
    v_lshlrev_b32 v142, 16, v15
    v_and_b32 v143, 0xffff0000, v15
    v_lshlrev_b32 v144, 16, v16
    v_and_b32 v145, 0xffff0000, v16
    v_lshlrev_b32 v146, 16, v17
    v_and_b32 v147, 0xffff0000, v17
    v_lshlrev_b32 v148, 16, v18
    v_and_b32 v149, 0xffff0000, v18
    v_lshlrev_b32 v150, 16, v19
    v_and_b32 v151, 0xffff0000, v19
    v_lshlrev_b32 v152, 16, v20
    v_and_b32 v153, 0xffff0000, v20
    v_lshlrev_b32 v154, 16, v21
    v_and_b32 v155, 0xffff0000, v21
    v_lshlrev_b32 v156, 16, v22
    v_and_b32 v157, 0xffff0000, v22
    v_lshlrev_b32 v158, 16, v23
    v_and_b32 v159, 0xffff0000, v23
    v_lshlrev_b32 v160, 16, v24
    v_and_b32 v161, 0xffff0000, v24
    v_lshlrev_b32 v162, 16, v25
    v_and_b32 v163, 0xffff0000, v25
    v_lshlrev_b32 v164, 16, v26
    v_and_b32 v165, 0xffff0000, v26
    v_lshlrev_b32 v166, 16, v27
    v_and_b32 v167, 0xffff0000, v27
    v_lshlrev_b32 v168, 16, v28
    v_and_b32 v169, 0xffff0000, v28
    v_lshlrev_b32 v170, 16, v29
    v_and_b32 v171, 0xffff0000, v29
    v_lshlrev_b32 v172, 16, v30
    v_and_b32 v173, 0xffff0000, v30
    v_lshlrev_b32 v174, 16, v31
    v_and_b32 v175, 0xffff0000, v31
    v_lshlrev_b32 v176, 16, v32
    v_and_b32 v177, 0xffff0000, v32
    v_lshlrev_b32 v178, 16, v33
    v_and_b32 v179, 0xffff0000, v33
    v_lshlrev_b32 v180, 16, v34
    v_and_b32 v181, 0xffff0000, v34
    v_lshlrev_b32 v182, 16, v35
    v_and_b32 v183, 0xffff0000, v35
    v_lshlrev_b32 v184, 16, v36
    v_and_b32 v185, 0xffff0000, v36
    v_lshlrev_b32 v186, 16, v37
    v_and_b32 v187, 0xffff0000, v37
    v_lshlrev_b32 v188, 16, v38
    v_and_b32 v189, 0xffff0000, v38
    v_lshlrev_b32 v190, 16, v39
    v_and_b32 v191, 0xffff0000, v39
    v_lshlrev_b32 v192, 16, v40
    v_and_b32 v193, 0xffff0000, v40
    v_lshlrev_b32 v194, 16, v41
    v_and_b32 v195, 0xffff0000, v41
    v_lshlrev_b32 v196, 16, v42
    v_and_b32 v197, 0xffff0000, v42
    v_lshlrev_b32 v198, 16, v43
    v_and_b32 v199, 0xffff0000, v43
    v_lshlrev_b32 v200, 16, v44
    v_and_b32 v201, 0xffff0000, v44
    v_lshlrev_b32 v202, 16, v45
    v_and_b32 v203, 0xffff0000, v45
    v_lshlrev_b32 v204, 16, v46
    v_and_b32 v205, 0xffff0000, v46
    v_lshlrev_b32 v206, 16, v47
    v_and_b32 v207, 0xffff0000, v47
    v_lshlrev_b32 v208, 16, v48
    v_and_b32 v209, 0xffff0000, v48
    v_lshlrev_b32 v210, 16, v49
    v_and_b32 v211, 0xffff0000, v49
    v_lshlrev_b32 v212, 16, v50
    v_and_b32 v213, 0xffff0000, v50
    v_lshlrev_b32 v214, 16, v51
    v_and_b32 v215, 0xffff0000, v51
    v_lshlrev_b32 v216, 16, v52
    v_and_b32 v217, 0xffff0000, v52
    v_lshlrev_b32 v218, 16, v53
    v_and_b32 v219, 0xffff0000, v53
    v_lshlrev_b32 v220, 16, v54
    v_and_b32 v221, 0xffff0000, v54
    v_lshlrev_b32 v222, 16, v55
    v_and_b32 v223, 0xffff0000, v55
    s_add_u32 s50, s60, 0
    s_add_u32 m0, s64, 0
    s_nop 0
    buffer_load_dwordx4 v254, s[28:31], s50 offen lds
    s_add_u32 s50, s60, 3584
    s_add_u32 m0, s64, 1056
    s_nop 0
    buffer_load_dwordx4 v254, s[28:31], s50 offen lds
    s_add_u32 s50, s60, 7168
    s_add_u32 m0, s64, 2112
    s_nop 0
    buffer_load_dwordx4 v254, s[28:31], s50 offen lds
    s_add_u32 s50, s60, 10752
    s_add_u32 m0, s64, 3168
    s_nop 0
    buffer_load_dwordx4 v254, s[28:31], s50 offen lds
    s_add_u32 s50, s60, 28672
    s_add_u32 m0, s64, 4224
    s_nop 0
    buffer_load_dwordx4 v254, s[28:31], s50 offen lds
    s_add_u32 s50, s60, 32256
    s_add_u32 m0, s64, 5280
    s_nop 0
    buffer_load_dwordx4 v254, s[28:31], s50 offen lds
    s_add_u32 s50, s60, 35840
    s_add_u32 m0, s64, 6336
    s_nop 0
    buffer_load_dwordx4 v254, s[28:31], s50 offen lds
    s_add_u32 s50, s60, 39424
    s_add_u32 m0, s64, 7392
    s_nop 0
    buffer_load_dwordx4 v254, s[28:31], s50 offen lds
    v_pk_add_f32 v[56:57], v[112:113], v[114:115]
    v_pk_add_f32 v[58:59], v[116:117], v[118:119]
    v_pk_add_f32 v[60:61], v[120:121], v[122:123]
    v_pk_add_f32 v[62:63], v[124:125], v[126:127]
    v_pk_add_f32 v[56:57], v[56:57], v[128:129]
    v_pk_add_f32 v[58:59], v[58:59], v[130:131]
    v_pk_add_f32 v[60:61], v[60:61], v[132:133]
    v_pk_add_f32 v[62:63], v[62:63], v[134:135]
    v_pk_add_f32 v[56:57], v[56:57], v[136:137]
    v_pk_add_f32 v[58:59], v[58:59], v[138:139]
    v_pk_add_f32 v[60:61], v[60:61], v[140:141]
    v_pk_add_f32 v[62:63], v[62:63], v[142:143]
    v_pk_add_f32 v[56:57], v[56:57], v[144:145]
    v_pk_add_f32 v[58:59], v[58:59], v[146:147]
    v_pk_add_f32 v[60:61], v[60:61], v[148:149]
    v_pk_add_f32 v[62:63], v[62:63], v[150:151]
    v_pk_add_f32 v[56:57], v[56:57], v[152:153]
    v_pk_add_f32 v[58:59], v[58:59], v[154:155]
    v_pk_add_f32 v[60:61], v[60:61], v[156:157]
    v_pk_add_f32 v[62:63], v[62:63], v[158:159]
    v_pk_add_f32 v[56:57], v[56:57], v[160:161]
    v_pk_add_f32 v[58:59], v[58:59], v[162:163]
    v_pk_add_f32 v[60:61], v[60:61], v[164:165]
    v_pk_add_f32 v[62:63], v[62:63], v[166:167]
    v_pk_add_f32 v[56:57], v[56:57], v[168:169]
    v_pk_add_f32 v[58:59], v[58:59], v[170:171]
    v_pk_add_f32 v[60:61], v[60:61], v[172:173]
    v_pk_add_f32 v[62:63], v[62:63], v[174:175]
    v_pk_add_f32 v[56:57], v[56:57], v[176:177]
    v_pk_add_f32 v[58:59], v[58:59], v[178:179]
    v_pk_add_f32 v[60:61], v[60:61], v[180:181]
    v_pk_add_f32 v[62:63], v[62:63], v[182:183]
    v_pk_add_f32 v[56:57], v[56:57], v[184:185]
    v_pk_add_f32 v[58:59], v[58:59], v[186:187]
    v_pk_add_f32 v[60:61], v[60:61], v[188:189]
    v_pk_add_f32 v[62:63], v[62:63], v[190:191]
    v_pk_add_f32 v[56:57], v[56:57], v[192:193]
    v_pk_add_f32 v[58:59], v[58:59], v[194:195]
    v_pk_add_f32 v[60:61], v[60:61], v[196:197]
    v_pk_add_f32 v[62:63], v[62:63], v[198:199]
    v_pk_add_f32 v[56:57], v[56:57], v[200:201]
    v_pk_add_f32 v[58:59], v[58:59], v[202:203]
    v_pk_add_f32 v[60:61], v[60:61], v[204:205]
    v_pk_add_f32 v[62:63], v[62:63], v[206:207]
    v_pk_add_f32 v[56:57], v[56:57], v[208:209]
    v_pk_add_f32 v[58:59], v[58:59], v[210:211]
    v_pk_add_f32 v[60:61], v[60:61], v[212:213]
    v_pk_add_f32 v[62:63], v[62:63], v[214:215]
    v_pk_add_f32 v[56:57], v[56:57], v[216:217]
    v_pk_add_f32 v[58:59], v[58:59], v[218:219]
    v_pk_add_f32 v[60:61], v[60:61], v[220:221]
    v_pk_add_f32 v[62:63], v[62:63], v[222:223]
    v_pk_add_f32 v[56:57], v[56:57], v[58:59]
    v_pk_add_f32 v[60:61], v[60:61], v[62:63]
    v_pk_add_f32 v[56:57], v[56:57], v[60:61]
    v_add_f32 v56, v56, v57
    v_mov_b32 v57, v56
    s_nop 1
    v_permlane16_swap_b32 v56, v57
    s_nop 1
    v_add_f32 v56, v56, v57
    v_mov_b32 v57, v56
    s_nop 1
    v_permlane32_swap_b32 v56, v57
    s_nop 1
    v_add_f32 v56, v56, v57
    v_mul_f32 v60, 0x3b124925, v56
    v_mov_b32 v61, v60
    s_add_u32 s50, s60, 229376
    s_add_u32 m0, s65, 0
    s_nop 0
    buffer_load_dwordx4 v254, s[28:31], s50 offen lds
    s_add_u32 s50, s60, 232960
    s_add_u32 m0, s65, 1056
    s_nop 0
    buffer_load_dwordx4 v254, s[28:31], s50 offen lds
    s_add_u32 s50, s60, 236544
    s_add_u32 m0, s65, 2112
    s_nop 0
    buffer_load_dwordx4 v254, s[28:31], s50 offen lds
    s_add_u32 s50, s60, 240128
    s_add_u32 m0, s65, 3168
    s_nop 0
    buffer_load_dwordx4 v254, s[28:31], s50 offen lds
    s_add_u32 s50, s60, 258048
    s_add_u32 m0, s65, 4224
    s_nop 0
    buffer_load_dwordx4 v254, s[28:31], s50 offen lds
    s_add_u32 s50, s60, 261632
    s_add_u32 m0, s65, 5280
    s_nop 0
    buffer_load_dwordx4 v254, s[28:31], s50 offen lds
    s_add_u32 s50, s60, 265216
    s_add_u32 m0, s65, 6336
    s_nop 0
    buffer_load_dwordx4 v254, s[28:31], s50 offen lds
    s_add_u32 s50, s60, 268800
    s_add_u32 m0, s65, 7392
    s_nop 0
    buffer_load_dwordx4 v254, s[28:31], s50 offen lds
    v_lshlrev_b32 v238, 4, v251
    s_lshl_b32 s55, s3, 10
    s_add_u32 s55, s55, 67584
    v_add_u32 v238, s55, v238
    v_pk_add_f32 v[112:113], v[112:113], v[60:61] neg_lo:[0,1] neg_hi:[0,1]
    v_pk_add_f32 v[114:115], v[114:115], v[60:61] neg_lo:[0,1] neg_hi:[0,1]
    v_pk_add_f32 v[116:117], v[116:117], v[60:61] neg_lo:[0,1] neg_hi:[0,1]
    v_pk_add_f32 v[118:119], v[118:119], v[60:61] neg_lo:[0,1] neg_hi:[0,1]
    v_pk_mul_f32 v[64:65], v[112:113], v[112:113]
    v_pk_mul_f32 v[66:67], v[114:115], v[114:115]
    v_pk_mul_f32 v[68:69], v[116:117], v[116:117]
    v_pk_mul_f32 v[70:71], v[118:119], v[118:119]
    v_pk_add_f32 v[120:121], v[120:121], v[60:61] neg_lo:[0,1] neg_hi:[0,1]
    v_pk_add_f32 v[122:123], v[122:123], v[60:61] neg_lo:[0,1] neg_hi:[0,1]
    v_pk_add_f32 v[124:125], v[124:125], v[60:61] neg_lo:[0,1] neg_hi:[0,1]
    v_pk_add_f32 v[126:127], v[126:127], v[60:61] neg_lo:[0,1] neg_hi:[0,1]
    v_pk_fma_f32 v[64:65], v[120:121], v[120:121], v[64:65]
    v_pk_fma_f32 v[66:67], v[122:123], v[122:123], v[66:67]
    v_pk_fma_f32 v[68:69], v[124:125], v[124:125], v[68:69]
    v_pk_fma_f32 v[70:71], v[126:127], v[126:127], v[70:71]
    v_pk_add_f32 v[128:129], v[128:129], v[60:61] neg_lo:[0,1] neg_hi:[0,1]
    v_pk_add_f32 v[130:131], v[130:131], v[60:61] neg_lo:[0,1] neg_hi:[0,1]
    v_pk_add_f32 v[132:133], v[132:133], v[60:61] neg_lo:[0,1] neg_hi:[0,1]
    v_pk_add_f32 v[134:135], v[134:135], v[60:61] neg_lo:[0,1] neg_hi:[0,1]
    v_pk_fma_f32 v[64:65], v[128:129], v[128:129], v[64:65]
    v_pk_fma_f32 v[66:67], v[130:131], v[130:131], v[66:67]
    v_pk_fma_f32 v[68:69], v[132:133], v[132:133], v[68:69]
    v_pk_fma_f32 v[70:71], v[134:135], v[134:135], v[70:71]
    v_pk_add_f32 v[136:137], v[136:137], v[60:61] neg_lo:[0,1] neg_hi:[0,1]
    v_pk_add_f32 v[138:139], v[138:139], v[60:61] neg_lo:[0,1] neg_hi:[0,1]
    v_pk_add_f32 v[140:141], v[140:141], v[60:61] neg_lo:[0,1] neg_hi:[0,1]
    v_pk_add_f32 v[142:143], v[142:143], v[60:61] neg_lo:[0,1] neg_hi:[0,1]
    v_pk_fma_f32 v[64:65], v[136:137], v[136:137], v[64:65]
    v_pk_fma_f32 v[66:67], v[138:139], v[138:139], v[66:67]
    v_pk_fma_f32 v[68:69], v[140:141], v[140:141], v[68:69]
    v_pk_fma_f32 v[70:71], v[142:143], v[142:143], v[70:71]
    v_pk_add_f32 v[144:145], v[144:145], v[60:61] neg_lo:[0,1] neg_hi:[0,1]
    v_pk_add_f32 v[146:147], v[146:147], v[60:61] neg_lo:[0,1] neg_hi:[0,1]
    v_pk_add_f32 v[148:149], v[148:149], v[60:61] neg_lo:[0,1] neg_hi:[0,1]
    v_pk_add_f32 v[150:151], v[150:151], v[60:61] neg_lo:[0,1] neg_hi:[0,1]
    v_pk_fma_f32 v[64:65], v[144:145], v[144:145], v[64:65]
    v_pk_fma_f32 v[66:67], v[146:147], v[146:147], v[66:67]
    v_pk_fma_f32 v[68:69], v[148:149], v[148:149], v[68:69]
    v_pk_fma_f32 v[70:71], v[150:151], v[150:151], v[70:71]
    v_pk_add_f32 v[152:153], v[152:153], v[60:61] neg_lo:[0,1] neg_hi:[0,1]
    v_pk_add_f32 v[154:155], v[154:155], v[60:61] neg_lo:[0,1] neg_hi:[0,1]
    v_pk_add_f32 v[156:157], v[156:157], v[60:61] neg_lo:[0,1] neg_hi:[0,1]
    v_pk_add_f32 v[158:159], v[158:159], v[60:61] neg_lo:[0,1] neg_hi:[0,1]
    v_pk_fma_f32 v[64:65], v[152:153], v[152:153], v[64:65]
    v_pk_fma_f32 v[66:67], v[154:155], v[154:155], v[66:67]
    v_pk_fma_f32 v[68:69], v[156:157], v[156:157], v[68:69]
    v_pk_fma_f32 v[70:71], v[158:159], v[158:159], v[70:71]
    v_pk_add_f32 v[160:161], v[160:161], v[60:61] neg_lo:[0,1] neg_hi:[0,1]
    v_pk_add_f32 v[162:163], v[162:163], v[60:61] neg_lo:[0,1] neg_hi:[0,1]
    v_pk_add_f32 v[164:165], v[164:165], v[60:61] neg_lo:[0,1] neg_hi:[0,1]
    v_pk_add_f32 v[166:167], v[166:167], v[60:61] neg_lo:[0,1] neg_hi:[0,1]
    v_pk_fma_f32 v[64:65], v[160:161], v[160:161], v[64:65]
    v_pk_fma_f32 v[66:67], v[162:163], v[162:163], v[66:67]
    v_pk_fma_f32 v[68:69], v[164:165], v[164:165], v[68:69]
    v_pk_fma_f32 v[70:71], v[166:167], v[166:167], v[70:71]
    v_pk_add_f32 v[168:169], v[168:169], v[60:61] neg_lo:[0,1] neg_hi:[0,1]
    v_pk_add_f32 v[170:171], v[170:171], v[60:61] neg_lo:[0,1] neg_hi:[0,1]
    v_pk_add_f32 v[172:173], v[172:173], v[60:61] neg_lo:[0,1] neg_hi:[0,1]
    v_pk_add_f32 v[174:175], v[174:175], v[60:61] neg_lo:[0,1] neg_hi:[0,1]
    v_pk_fma_f32 v[64:65], v[168:169], v[168:169], v[64:65]
    v_pk_fma_f32 v[66:67], v[170:171], v[170:171], v[66:67]
    v_pk_fma_f32 v[68:69], v[172:173], v[172:173], v[68:69]
    v_pk_fma_f32 v[70:71], v[174:175], v[174:175], v[70:71]
    v_pk_add_f32 v[176:177], v[176:177], v[60:61] neg_lo:[0,1] neg_hi:[0,1]
    v_pk_add_f32 v[178:179], v[178:179], v[60:61] neg_lo:[0,1] neg_hi:[0,1]
    v_pk_add_f32 v[180:181], v[180:181], v[60:61] neg_lo:[0,1] neg_hi:[0,1]
    v_pk_add_f32 v[182:183], v[182:183], v[60:61] neg_lo:[0,1] neg_hi:[0,1]
    v_pk_fma_f32 v[64:65], v[176:177], v[176:177], v[64:65]
    v_pk_fma_f32 v[66:67], v[178:179], v[178:179], v[66:67]
    v_pk_fma_f32 v[68:69], v[180:181], v[180:181], v[68:69]
    v_pk_fma_f32 v[70:71], v[182:183], v[182:183], v[70:71]
    v_pk_add_f32 v[184:185], v[184:185], v[60:61] neg_lo:[0,1] neg_hi:[0,1]
    v_pk_add_f32 v[186:187], v[186:187], v[60:61] neg_lo:[0,1] neg_hi:[0,1]
    v_pk_add_f32 v[188:189], v[188:189], v[60:61] neg_lo:[0,1] neg_hi:[0,1]
    v_pk_add_f32 v[190:191], v[190:191], v[60:61] neg_lo:[0,1] neg_hi:[0,1]
    v_pk_fma_f32 v[64:65], v[184:185], v[184:185], v[64:65]
    v_pk_fma_f32 v[66:67], v[186:187], v[186:187], v[66:67]
    v_pk_fma_f32 v[68:69], v[188:189], v[188:189], v[68:69]
    v_pk_fma_f32 v[70:71], v[190:191], v[190:191], v[70:71]
    v_pk_add_f32 v[192:193], v[192:193], v[60:61] neg_lo:[0,1] neg_hi:[0,1]
    v_pk_add_f32 v[194:195], v[194:195], v[60:61] neg_lo:[0,1] neg_hi:[0,1]
    v_pk_add_f32 v[196:197], v[196:197], v[60:61] neg_lo:[0,1] neg_hi:[0,1]
    v_pk_add_f32 v[198:199], v[198:199], v[60:61] neg_lo:[0,1] neg_hi:[0,1]
    v_pk_fma_f32 v[64:65], v[192:193], v[192:193], v[64:65]
    v_pk_fma_f32 v[66:67], v[194:195], v[194:195], v[66:67]
    v_pk_fma_f32 v[68:69], v[196:197], v[196:197], v[68:69]
    v_pk_fma_f32 v[70:71], v[198:199], v[198:199], v[70:71]
    v_pk_add_f32 v[200:201], v[200:201], v[60:61] neg_lo:[0,1] neg_hi:[0,1]
    v_pk_add_f32 v[202:203], v[202:203], v[60:61] neg_lo:[0,1] neg_hi:[0,1]
    v_pk_add_f32 v[204:205], v[204:205], v[60:61] neg_lo:[0,1] neg_hi:[0,1]
    v_pk_add_f32 v[206:207], v[206:207], v[60:61] neg_lo:[0,1] neg_hi:[0,1]
    v_pk_fma_f32 v[64:65], v[200:201], v[200:201], v[64:65]
    v_pk_fma_f32 v[66:67], v[202:203], v[202:203], v[66:67]
    v_pk_fma_f32 v[68:69], v[204:205], v[204:205], v[68:69]
    v_pk_fma_f32 v[70:71], v[206:207], v[206:207], v[70:71]
    v_pk_add_f32 v[208:209], v[208:209], v[60:61] neg_lo:[0,1] neg_hi:[0,1]
    v_pk_add_f32 v[210:211], v[210:211], v[60:61] neg_lo:[0,1] neg_hi:[0,1]
    v_pk_add_f32 v[212:213], v[212:213], v[60:61] neg_lo:[0,1] neg_hi:[0,1]
    v_pk_add_f32 v[214:215], v[214:215], v[60:61] neg_lo:[0,1] neg_hi:[0,1]
    v_pk_fma_f32 v[64:65], v[208:209], v[208:209], v[64:65]
    v_pk_fma_f32 v[66:67], v[210:211], v[210:211], v[66:67]
    v_pk_fma_f32 v[68:69], v[212:213], v[212:213], v[68:69]
    v_pk_fma_f32 v[70:71], v[214:215], v[214:215], v[70:71]
    v_pk_add_f32 v[216:217], v[216:217], v[60:61] neg_lo:[0,1] neg_hi:[0,1]
    v_pk_add_f32 v[218:219], v[218:219], v[60:61] neg_lo:[0,1] neg_hi:[0,1]
    v_pk_add_f32 v[220:221], v[220:221], v[60:61] neg_lo:[0,1] neg_hi:[0,1]
    v_pk_add_f32 v[222:223], v[222:223], v[60:61] neg_lo:[0,1] neg_hi:[0,1]
    v_pk_fma_f32 v[64:65], v[216:217], v[216:217], v[64:65]
    v_pk_fma_f32 v[66:67], v[218:219], v[218:219], v[66:67]
    v_pk_fma_f32 v[68:69], v[220:221], v[220:221], v[68:69]
    v_pk_fma_f32 v[70:71], v[222:223], v[222:223], v[70:71]
    v_lshlrev_b32 v236, 3, v234
    s_mul_i32 s55, s44, 448
    s_lshl_b32 s56, s3, 7
    s_add_u32 s55, s55, s56
    buffer_load_dwordx2 a[224:225], v236, s[40:43], s55 offen offset:0
    buffer_load_dwordx2 a[226:227], v236, s[40:43], s55 offen offset:32
    buffer_load_dwordx2 a[228:229], v236, s[40:43], s55 offen offset:64
    buffer_load_dwordx2 a[230:231], v236, s[40:43], s55 offen offset:96
    s_lshl_b32 s55, s45, 2
    s_add_u32 s55, s55, s3
    s_mul_i32 s55, s55, 28
    v_add_u32 v236, s55, v251
    v_lshrrev_b32 v237, 3, v236
    v_and_b32 v236, 7, v236
    v_mul_u32_u24 v236, 64, v236
    s_mov_b32 s56, 3584
    v_mad_u32_u24 v236, v237, s56, v236
    v_cmp_lt_u32 vcc, 27, v251
    v_mov_b32 v237, 0x40000000
    s_nop 1
    v_cndmask_b32 v236, v236, v237, vcc
    s_mul_i32 s56, s44, 448
    buffer_load_dword a255, v236, s[28:31], s56 offen
    s_lshl_b32 s55, s45, 2
    s_add_u32 s55, s55, s3
    s_mul_i32 s55, s55, 28
    v_add_u32 v236, s55, v251
    v_lshrrev_b32 v237, 3, v236
    v_and_b32 v236, 7, v236
    v_mul_u32_u24 v236, 128, v236
    s_mov_b32 s56, 8192
    v_mad_u32_u24 v236, v237, s56, v236
    v_cmp_lt_u32 vcc, 27, v251
    v_mov_b32 v237, 0x40000000
    s_nop 1
    v_cndmask_b32 v236, v236, v237, vcc
    s_mul_i32 s56, s44, 1024
    buffer_load_dword a255, v236, s[20:23], s56 offen
    s_lshl_b32 s55, s45, 2
    s_add_u32 s55, s55, s3
    s_mul_i32 s55, s55, 1664
    s_mul_i32 s56, s44, 200704
    s_add_u32 s55, s55, s56
    v_lshlrev_b32 v236, 7, v251
    v_cmp_lt_u32 vcc, 12, v251
    v_mov_b32 v237, 0x40000000
    s_nop 1
    v_cndmask_b32 v236, v236, v237, vcc
    buffer_load_dword a255, v236, s[32:35], s55 offen
    v_pk_add_f32 v[64:65], v[64:65], v[66:67]
    v_pk_add_f32 v[68:69], v[68:69], v[70:71]
    v_pk_add_f32 v[64:65], v[64:65], v[68:69]
    v_add_f32 v64, v64, v65
    v_mov_b32 v65, v64
    s_nop 1
    v_permlane16_swap_b32 v64, v65
    s_nop 1
    v_add_f32 v64, v64, v65
    v_mov_b32 v65, v64
    s_nop 1
    v_permlane32_swap_b32 v64, v65
    s_nop 1
    v_add_f32 v64, v64, v65
    v_mul_f32 v64, 0x3b124925, v64
    v_mov_b32 v68, v64
    v_cvt_pk_bf16_f32 v65, v68, v68
    v_lshlrev_b32 v68, 16, v65
    v_add_f32 v68, 0x3727c5ac, v68
    v_cvt_pk_bf16_f32 v65, v68, v68
    v_lshlrev_b32 v68, 16, v65
    v_sqrt_f32 v68, v68
    s_nop 0
    v_cvt_pk_bf16_f32 v65, v68, v68
    v_lshlrev_b32 v68, 16, v65
    v_rcp_f32 v69, v68
    s_nop 0
    v_mul_f32 v66, 0x3db8aa3b, v69
    v_mov_b32 v67, v66
    v_pk_mul_f32 v[112:113], v[112:113], v[66:67]
    v_pk_mul_f32 v[114:115], v[114:115], v[66:67]
    v_pk_mul_f32 v[116:117], v[116:117], v[66:67]
    v_pk_mul_f32 v[118:119], v[118:119], v[66:67]
    v_cvt_pk_bf16_f32 v0, v112, v113
    v_cvt_pk_bf16_f32 v1, v114, v115
    v_cvt_pk_bf16_f32 v2, v116, v117
    v_cvt_pk_bf16_f32 v3, v118, v119
    ds_write_b128 v238, v[0:3] offset:0
    v_pk_mul_f32 v[120:121], v[120:121], v[66:67]
    v_pk_mul_f32 v[122:123], v[122:123], v[66:67]
    v_pk_mul_f32 v[124:125], v[124:125], v[66:67]
    v_pk_mul_f32 v[126:127], v[126:127], v[66:67]
    v_cvt_pk_bf16_f32 v4, v120, v121
    v_cvt_pk_bf16_f32 v5, v122, v123
    v_cvt_pk_bf16_f32 v6, v124, v125
    v_cvt_pk_bf16_f32 v7, v126, v127
    ds_write_b128 v238, v[4:7] offset:4096
    v_pk_mul_f32 v[128:129], v[128:129], v[66:67]
    v_pk_mul_f32 v[130:131], v[130:131], v[66:67]
    v_pk_mul_f32 v[132:133], v[132:133], v[66:67]
    v_pk_mul_f32 v[134:135], v[134:135], v[66:67]
    v_cvt_pk_bf16_f32 v8, v128, v129
    v_cvt_pk_bf16_f32 v9, v130, v131
    v_cvt_pk_bf16_f32 v10, v132, v133
    v_cvt_pk_bf16_f32 v11, v134, v135
    ds_write_b128 v238, v[8:11] offset:8192
    v_pk_mul_f32 v[136:137], v[136:137], v[66:67]
    v_pk_mul_f32 v[138:139], v[138:139], v[66:67]
    v_pk_mul_f32 v[140:141], v[140:141], v[66:67]
    v_pk_mul_f32 v[142:143], v[142:143], v[66:67]
    v_cvt_pk_bf16_f32 v12, v136, v137
    v_cvt_pk_bf16_f32 v13, v138, v139
    v_cvt_pk_bf16_f32 v14, v140, v141
    v_cvt_pk_bf16_f32 v15, v142, v143
    ds_write_b128 v238, v[12:15] offset:12288
    v_pk_mul_f32 v[144:145], v[144:145], v[66:67]
    v_pk_mul_f32 v[146:147], v[146:147], v[66:67]
    v_pk_mul_f32 v[148:149], v[148:149], v[66:67]
    v_pk_mul_f32 v[150:151], v[150:151], v[66:67]
    v_cvt_pk_bf16_f32 v16, v144, v145
    v_cvt_pk_bf16_f32 v17, v146, v147
    v_cvt_pk_bf16_f32 v18, v148, v149
    v_cvt_pk_bf16_f32 v19, v150, v151
    ds_write_b128 v238, v[16:19] offset:16384
    v_pk_mul_f32 v[152:153], v[152:153], v[66:67]
    v_pk_mul_f32 v[154:155], v[154:155], v[66:67]
    v_pk_mul_f32 v[156:157], v[156:157], v[66:67]
    v_pk_mul_f32 v[158:159], v[158:159], v[66:67]
    v_cvt_pk_bf16_f32 v20, v152, v153
    v_cvt_pk_bf16_f32 v21, v154, v155
    v_cvt_pk_bf16_f32 v22, v156, v157
    v_cvt_pk_bf16_f32 v23, v158, v159
    ds_write_b128 v238, v[20:23] offset:20480
    v_pk_mul_f32 v[160:161], v[160:161], v[66:67]
    v_pk_mul_f32 v[162:163], v[162:163], v[66:67]
    v_pk_mul_f32 v[164:165], v[164:165], v[66:67]
    v_pk_mul_f32 v[166:167], v[166:167], v[66:67]
    v_cvt_pk_bf16_f32 v24, v160, v161
    v_cvt_pk_bf16_f32 v25, v162, v163
    v_cvt_pk_bf16_f32 v26, v164, v165
    v_cvt_pk_bf16_f32 v27, v166, v167
    ds_write_b128 v238, v[24:27] offset:24576
    v_pk_mul_f32 v[168:169], v[168:169], v[66:67]
    v_pk_mul_f32 v[170:171], v[170:171], v[66:67]
    v_pk_mul_f32 v[172:173], v[172:173], v[66:67]
    v_pk_mul_f32 v[174:175], v[174:175], v[66:67]
    v_cvt_pk_bf16_f32 v28, v168, v169
    v_cvt_pk_bf16_f32 v29, v170, v171
    v_cvt_pk_bf16_f32 v30, v172, v173
    v_cvt_pk_bf16_f32 v31, v174, v175
    ds_write_b128 v238, v[28:31] offset:28672
    v_pk_mul_f32 v[176:177], v[176:177], v[66:67]
    v_pk_mul_f32 v[178:179], v[178:179], v[66:67]
    v_pk_mul_f32 v[180:181], v[180:181], v[66:67]
    v_pk_mul_f32 v[182:183], v[182:183], v[66:67]
    v_cvt_pk_bf16_f32 v32, v176, v177
    v_cvt_pk_bf16_f32 v33, v178, v179
    v_cvt_pk_bf16_f32 v34, v180, v181
    v_cvt_pk_bf16_f32 v35, v182, v183
    ds_write_b128 v238, v[32:35] offset:32768
    v_pk_mul_f32 v[184:185], v[184:185], v[66:67]
    v_pk_mul_f32 v[186:187], v[186:187], v[66:67]
    v_pk_mul_f32 v[188:189], v[188:189], v[66:67]
    v_pk_mul_f32 v[190:191], v[190:191], v[66:67]
    v_cvt_pk_bf16_f32 v36, v184, v185
    v_cvt_pk_bf16_f32 v37, v186, v187
    v_cvt_pk_bf16_f32 v38, v188, v189
    v_cvt_pk_bf16_f32 v39, v190, v191
    ds_write_b128 v238, v[36:39] offset:36864
    v_pk_mul_f32 v[192:193], v[192:193], v[66:67]
    v_pk_mul_f32 v[194:195], v[194:195], v[66:67]
    v_pk_mul_f32 v[196:197], v[196:197], v[66:67]
    v_pk_mul_f32 v[198:199], v[198:199], v[66:67]
    v_cvt_pk_bf16_f32 v40, v192, v193
    v_cvt_pk_bf16_f32 v41, v194, v195
    v_cvt_pk_bf16_f32 v42, v196, v197
    v_cvt_pk_bf16_f32 v43, v198, v199
    ds_write_b128 v238, v[40:43] offset:40960
    v_pk_mul_f32 v[200:201], v[200:201], v[66:67]
    v_pk_mul_f32 v[202:203], v[202:203], v[66:67]
    v_pk_mul_f32 v[204:205], v[204:205], v[66:67]
    v_pk_mul_f32 v[206:207], v[206:207], v[66:67]
    v_cvt_pk_bf16_f32 v44, v200, v201
    v_cvt_pk_bf16_f32 v45, v202, v203
    v_cvt_pk_bf16_f32 v46, v204, v205
    v_cvt_pk_bf16_f32 v47, v206, v207
    ds_write_b128 v238, v[44:47] offset:45056
    v_pk_mul_f32 v[208:209], v[208:209], v[66:67]
    v_pk_mul_f32 v[210:211], v[210:211], v[66:67]
    v_pk_mul_f32 v[212:213], v[212:213], v[66:67]
    v_pk_mul_f32 v[214:215], v[214:215], v[66:67]
    v_cvt_pk_bf16_f32 v48, v208, v209
    v_cvt_pk_bf16_f32 v49, v210, v211
    v_cvt_pk_bf16_f32 v50, v212, v213
    v_cvt_pk_bf16_f32 v51, v214, v215
    ds_write_b128 v238, v[48:51] offset:49152
    v_pk_mul_f32 v[216:217], v[216:217], v[66:67]
    v_pk_mul_f32 v[218:219], v[218:219], v[66:67]
    v_pk_mul_f32 v[220:221], v[220:221], v[66:67]
    v_pk_mul_f32 v[222:223], v[222:223], v[66:67]
    v_cvt_pk_bf16_f32 v52, v216, v217
    v_cvt_pk_bf16_f32 v53, v218, v219
    v_cvt_pk_bf16_f32 v54, v220, v221
    v_cvt_pk_bf16_f32 v55, v222, v223
    ds_write_b128 v238, v[52:55] offset:53248
    v_mul_f32 v70, v69, v69
    v_mul_f32 v70, v70, v64
    v_cvt_pk_bf16_f32 v71, v70, v70
    v_lshlrev_b32 v70, 16, v71
    v_add_f32 v70, 0x3727c5ac, v70
    v_cvt_pk_bf16_f32 v71, v70, v70
    v_lshlrev_b32 v70, 16, v71
    v_sqrt_f32 v70, v70
    s_nop 0
    v_cvt_pk_bf16_f32 v71, v70, v70
    v_lshlrev_b32 v70, 16, v71
    v_rcp_f32 v70, v70
    s_nop 0
    v_mul_f32 v70, 0x41317218, v70
    s_lshl_b32 s55, s3, 6
    s_add_u32 s55, s55, 135168
    v_lshlrev_b32 v237, 2, v233
    v_add_u32 v237, s55, v237
    ds_write_b32 v237, v70
    v_lshlrev_b32 v238, 4, v251
    v_add_u32 v238, 67584, v238
    v_lshlrev_b32 v239, 2, v233
    v_add_u32 v239, 135168, v239
    s_lshl_b32 s55, s3, 7
    v_lshl_add_u32 v252, v245, 3, v244
    v_add_u32 v252, s55, v252
    v_add_u32 v253, 67584, v252
    s_cmp_lg_u32 s3, 0
    s_cbranch_scc1 L_nonce2
    s_waitcnt vmcnt(23)
    v_readfirstlane_b32 s55, v96
    s_cmp_eq_u32 s55, 0
    s_cselect_b32 s59, s59, s55
    v_mov_b32 v97, s59
    v_mov_b32 v98, 135680
    ds_write_b32 v98, v97
L_nonce2:
    s_waitcnt lgkmcnt(0)
    s_barrier
    v_mov_b32 v98, 135680
    ds_read_b32 v97, v98
    ds_read_b128 a[0:3], v238 offset:0
    ds_read_b128 a[4:7], v238 offset:1024
    ds_read_b128 a[8:11], v238 offset:2048
    ds_read_b128 a[12:15], v238 offset:3072
    ds_read_b128 a[16:19], v238 offset:4096
    ds_read_b128 a[20:23], v238 offset:5120
    ds_read_b128 a[24:27], v238 offset:6144
    ds_read_b128 a[28:31], v238 offset:7168
    ds_read_b128 a[32:35], v238 offset:8192
    ds_read_b128 a[36:39], v238 offset:9216
    ds_read_b128 a[40:43], v238 offset:10240
    ds_read_b128 a[44:47], v238 offset:11264
    s_waitcnt lgkmcnt(4)
    ds_read_b128 a[48:51], v238 offset:12288
    ds_read_b128 a[52:55], v238 offset:13312
    ds_read_b128 a[56:59], v238 offset:14336
    ds_read_b128 a[60:63], v238 offset:15360
    ds_read_b128 a[64:67], v238 offset:16384
    ds_read_b128 a[68:71], v238 offset:17408
    ds_read_b128 a[72:75], v238 offset:18432
    ds_read_b128 a[76:79], v238 offset:19456
    ds_read_b128 a[80:83], v238 offset:20480
    ds_read_b128 a[84:87], v238 offset:21504
    ds_read_b128 a[88:91], v238 offset:22528
    ds_read_b128 a[92:95], v238 offset:23552
    s_waitcnt lgkmcnt(4)
    ds_read_b128 a[96:99], v238 offset:24576
    ds_read_b128 a[100:103], v238 offset:25600
    ds_read_b128 a[104:107], v238 offset:26624
    ds_read_b128 a[108:111], v238 offset:27648
    ds_read_b128 a[112:115], v238 offset:28672
    ds_read_b128 a[116:119], v238 offset:29696
    ds_read_b128 a[120:123], v238 offset:30720
    ds_read_b128 a[124:127], v238 offset:31744
    ds_read_b128 a[128:131], v238 offset:32768
    ds_read_b128 a[132:135], v238 offset:33792
    ds_read_b128 a[136:139], v238 offset:34816
    ds_read_b128 a[140:143], v238 offset:35840
    s_waitcnt lgkmcnt(4)
    ds_read_b128 a[144:147], v238 offset:36864
    ds_read_b128 a[148:151], v238 offset:37888
    ds_read_b128 a[152:155], v238 offset:38912
    ds_read_b128 a[156:159], v238 offset:39936
    ds_read_b128 a[160:163], v238 offset:40960
    ds_read_b128 a[164:167], v238 offset:41984
    ds_read_b128 a[168:171], v238 offset:43008
    ds_read_b128 a[172:175], v238 offset:44032
    ds_read_b128 a[176:179], v238 offset:45056
    ds_read_b128 a[180:183], v238 offset:46080
    ds_read_b128 a[184:187], v238 offset:47104
    ds_read_b128 a[188:191], v238 offset:48128
    s_waitcnt lgkmcnt(4)
    ds_read_b128 a[192:195], v238 offset:49152
    ds_read_b128 a[196:199], v238 offset:50176
    ds_read_b128 a[200:203], v238 offset:51200
    ds_read_b128 a[204:207], v238 offset:52224
    ds_read_b128 a[208:211], v238 offset:53248
    ds_read_b128 a[212:215], v238 offset:54272
    ds_read_b128 a[216:219], v238 offset:55296
    ds_read_b128 a[220:223], v238 offset:56320
    ds_read_b32 v225, v239 offset:0
    ds_read_b32 v227, v239 offset:64
    ds_read_b32 v229, v239 offset:128
    ds_read_b32 v231, v239 offset:192
    s_waitcnt lgkmcnt(0)
    v_readfirstlane_b32 s59, v97
    s_waitcnt vmcnt(7)
    s_barrier
    s_add_u32 s50, s60, 458752
    s_add_u32 m0, s66, 0
    s_nop 0
    buffer_load_dwordx4 v254, s[28:31], s50 offen lds
    s_add_u32 s50, s60, 462336
    s_add_u32 m0, s66, 1056
    s_nop 0
    buffer_load_dwordx4 v254, s[28:31], s50 offen lds
    s_add_u32 s50, s60, 465920
    s_add_u32 m0, s66, 2112
    s_nop 0
    buffer_load_dwordx4 v254, s[28:31], s50 offen lds
    s_add_u32 s50, s60, 469504
    s_add_u32 m0, s66, 3168
    s_nop 0
    buffer_load_dwordx4 v254, s[28:31], s50 offen lds
    s_add_u32 s50, s60, 487424
    s_add_u32 m0, s66, 4224
    s_nop 0
    buffer_load_dwordx4 v254, s[28:31], s50 offen lds
    s_add_u32 s50, s60, 491008
    s_add_u32 m0, s66, 5280
    s_nop 0
    buffer_load_dwordx4 v254, s[28:31], s50 offen lds
    s_add_u32 s50, s60, 494592
    s_add_u32 m0, s66, 6336
    s_nop 0
    buffer_load_dwordx4 v254, s[28:31], s50 offen lds
    s_add_u32 s50, s60, 498176
    s_add_u32 m0, s66, 7392
    s_nop 0
    buffer_load_dwordx4 v254, s[28:31], s50 offen lds
    s_add_u32 s50, s60, 688128
    s_add_u32 m0, s67, 0
    s_nop 0
    buffer_load_dwordx4 v254, s[28:31], s50 offen lds
    s_add_u32 s50, s60, 691712
    s_add_u32 m0, s67, 1056
    s_nop 0
    buffer_load_dwordx4 v254, s[28:31], s50 offen lds
    s_add_u32 s50, s60, 695296
    s_add_u32 m0, s67, 2112
    s_nop 0
    buffer_load_dwordx4 v254, s[28:31], s50 offen lds
    s_add_u32 s50, s60, 698880
    s_add_u32 m0, s67, 3168
    s_nop 0
    buffer_load_dwordx4 v254, s[28:31], s50 offen lds
    s_add_u32 s50, s60, 716800
    s_add_u32 m0, s67, 4224
    s_nop 0
    buffer_load_dwordx4 v254, s[28:31], s50 offen lds
    s_add_u32 s50, s60, 720384
    s_add_u32 m0, s67, 5280
    s_nop 0
    buffer_load_dwordx4 v254, s[28:31], s50 offen lds
    s_add_u32 s50, s60, 723968
    s_add_u32 m0, s67, 6336
    s_nop 0
    buffer_load_dwordx4 v254, s[28:31], s50 offen lds
    s_add_u32 s50, s60, 727552
    s_add_u32 m0, s67, 7392
    s_nop 0
    buffer_load_dwordx4 v254, s[28:31], s50 offen lds
    s_lshl_b32 s55, s45, 2
    s_add_u32 s55, s55, s3
    s_mul_i32 s55, s55, 1536
    v_lshlrev_b32 v236, 7, v251
    v_cmp_lt_u32 vcc, 11, v251
    v_mov_b32 v237, 0x40000000
    s_nop 1
    v_cndmask_b32 v236, v236, v237, vcc
    buffer_load_dword a255, v236, s[8:11], s55 offen
    s_lshl_b32 s55, s45, 2
    s_add_u32 s55, s55, s3
    s_mul_i32 s55, s55, 1536
    v_lshlrev_b32 v236, 7, v251
    v_cmp_lt_u32 vcc, 11, v251
    v_mov_b32 v237, 0x40000000
    s_nop 1
    v_cndmask_b32 v236, v236, v237, vcc
    buffer_load_dword a255, v236, s[12:15], s55 offen
    s_mul_i32 s55, s53, 16896
    s_lshl_b32 s56, s54, 8
    s_add_u32 s55, s55, s56
    v_lshl_add_u32 v248, v245, 4, v244
    v_add_u32 v248, s55, v248
    v_add_u32 v249, 67584, v248
    ds_read_b64_tr_b16 a[236:237], v252 offset:0
    ds_read_b64_tr_b16 a[238:239], v252 offset:512
    ds_read_b64_tr_b16 a[240:241], v252 offset:32
    ds_read_b64_tr_b16 a[242:243], v252 offset:544
    ds_read_b64_tr_b16 a[244:245], v252 offset:64
    ds_read_b64_tr_b16 a[246:247], v252 offset:576
    s_waitcnt lgkmcnt(2)
    v_mfma_f32_16x16x32_bf16 v[0:3], a[236:239], a[0:3], 0
    ds_read_b64_tr_b16 a[248:249], v252 offset:96
    ds_read_b64_tr_b16 a[250:251], v252 offset:608
    v_mfma_f32_16x16x32_bf16 v[4:7], a[236:239], a[4:7], 0
    v_mfma_f32_16x16x32_bf16 v[8:11], a[236:239], a[8:11], 0
    v_mfma_f32_16x16x32_bf16 v[12:15], a[236:239], a[12:15], 0
    v_mfma_f32_16x16x32_bf16 v[16:19], a[240:243], a[0:3], 0
    ds_read_b64_tr_b16 a[236:237], v252 offset:16896
    ds_read_b64_tr_b16 a[238:239], v252 offset:17408
    v_mfma_f32_16x16x32_bf16 v[20:23], a[240:243], a[4:7], 0
    v_mfma_f32_16x16x32_bf16 v[24:27], a[240:243], a[8:11], 0
    v_mfma_f32_16x16x32_bf16 v[28:31], a[240:243], a[12:15], 0
    s_waitcnt lgkmcnt(2)
    v_mfma_f32_16x16x32_bf16 v[32:35], a[244:247], a[0:3], 0
    ds_read_b64_tr_b16 a[240:241], v252 offset:16928
    ds_read_b64_tr_b16 a[242:243], v252 offset:17440
    v_mfma_f32_16x16x32_bf16 v[36:39], a[244:247], a[4:7], 0
    v_mfma_f32_16x16x32_bf16 v[40:43], a[244:247], a[8:11], 0
    v_mfma_f32_16x16x32_bf16 v[44:47], a[244:247], a[12:15], 0
    v_mfma_f32_16x16x32_bf16 v[48:51], a[248:251], a[0:3], 0
    ds_read_b64_tr_b16 a[244:245], v252 offset:16960
    ds_read_b64_tr_b16 a[246:247], v252 offset:17472
    v_mfma_f32_16x16x32_bf16 v[52:55], a[248:251], a[4:7], 0
    v_mfma_f32_16x16x32_bf16 v[56:59], a[248:251], a[8:11], 0
    v_mfma_f32_16x16x32_bf16 v[60:63], a[248:251], a[12:15], 0
    s_waitcnt lgkmcnt(2)
    v_mfma_f32_16x16x32_bf16 v[0:3], a[236:239], a[16:19], v[0:3]
    ds_read_b64_tr_b16 a[248:249], v252 offset:16992
    ds_read_b64_tr_b16 a[250:251], v252 offset:17504
    v_mfma_f32_16x16x32_bf16 v[4:7], a[236:239], a[20:23], v[4:7]
    v_mfma_f32_16x16x32_bf16 v[8:11], a[236:239], a[24:27], v[8:11]
    v_mfma_f32_16x16x32_bf16 v[12:15], a[236:239], a[28:31], v[12:15]
    v_mfma_f32_16x16x32_bf16 v[16:19], a[240:243], a[16:19], v[16:19]
    ds_read_b64_tr_b16 a[236:237], v252 offset:33792
    ds_read_b64_tr_b16 a[238:239], v252 offset:34304
    v_mfma_f32_16x16x32_bf16 v[20:23], a[240:243], a[20:23], v[20:23]
    v_mfma_f32_16x16x32_bf16 v[24:27], a[240:243], a[24:27], v[24:27]
    v_mfma_f32_16x16x32_bf16 v[28:31], a[240:243], a[28:31], v[28:31]
    s_waitcnt lgkmcnt(2)
    v_mfma_f32_16x16x32_bf16 v[32:35], a[244:247], a[16:19], v[32:35]
    ds_read_b64_tr_b16 a[240:241], v252 offset:33824
    ds_read_b64_tr_b16 a[242:243], v252 offset:34336
    v_mfma_f32_16x16x32_bf16 v[36:39], a[244:247], a[20:23], v[36:39]
    v_mfma_f32_16x16x32_bf16 v[40:43], a[244:247], a[24:27], v[40:43]
    v_mfma_f32_16x16x32_bf16 v[44:47], a[244:247], a[28:31], v[44:47]
    v_mfma_f32_16x16x32_bf16 v[48:51], a[248:251], a[16:19], v[48:51]
    ds_read_b64_tr_b16 a[244:245], v252 offset:33856
    ds_read_b64_tr_b16 a[246:247], v252 offset:34368
    v_mfma_f32_16x16x32_bf16 v[52:55], a[248:251], a[20:23], v[52:55]
    v_mfma_f32_16x16x32_bf16 v[56:59], a[248:251], a[24:27], v[56:59]
    v_mfma_f32_16x16x32_bf16 v[60:63], a[248:251], a[28:31], v[60:63]
    s_waitcnt vmcnt(10)
    s_barrier
    s_waitcnt lgkmcnt(2)
    v_mfma_f32_16x16x32_bf16 v[0:3], a[236:239], a[32:35], v[0:3]
    s_add_u32 s50, s60, 917504
    s_add_u32 m0, s64, 0
    ds_read_b64_tr_b16 a[248:249], v252 offset:33888
    ds_read_b64_tr_b16 a[250:251], v252 offset:34400
    v_mfma_f32_16x16x32_bf16 v[4:7], a[236:239], a[36:39], v[4:7]
    buffer_load_dwordx4 v254, s[28:31], s50 offen lds
    v_mfma_f32_16x16x32_bf16 v[8:11], a[236:239], a[40:43], v[8:11]
    v_mfma_f32_16x16x32_bf16 v[12:15], a[236:239], a[44:47], v[12:15]
    v_mfma_f32_16x16x32_bf16 v[16:19], a[240:243], a[32:35], v[16:19]
    s_add_u32 s50, s60, 921088
    s_add_u32 m0, s64, 1056
    ds_read_b64_tr_b16 a[236:237], v252 offset:50688
    ds_read_b64_tr_b16 a[238:239], v252 offset:51200
    v_mfma_f32_16x16x32_bf16 v[20:23], a[240:243], a[36:39], v[20:23]
    buffer_load_dwordx4 v254, s[28:31], s50 offen lds
    v_mfma_f32_16x16x32_bf16 v[24:27], a[240:243], a[40:43], v[24:27]
    v_mfma_f32_16x16x32_bf16 v[28:31], a[240:243], a[44:47], v[28:31]
    s_waitcnt lgkmcnt(2)
    v_mfma_f32_16x16x32_bf16 v[32:35], a[244:247], a[32:35], v[32:35]
    s_add_u32 s50, s60, 924672
    s_add_u32 m0, s64, 2112
    ds_read_b64_tr_b16 a[240:241], v252 offset:50720
    ds_read_b64_tr_b16 a[242:243], v252 offset:51232
    v_mfma_f32_16x16x32_bf16 v[36:39], a[244:247], a[36:39], v[36:39]
    buffer_load_dwordx4 v254, s[28:31], s50 offen lds
    v_mfma_f32_16x16x32_bf16 v[40:43], a[244:247], a[40:43], v[40:43]
    v_mfma_f32_16x16x32_bf16 v[44:47], a[244:247], a[44:47], v[44:47]
    v_mfma_f32_16x16x32_bf16 v[48:51], a[248:251], a[32:35], v[48:51]
    s_add_u32 s50, s60, 928256
    s_add_u32 m0, s64, 3168
    ds_read_b64_tr_b16 a[244:245], v252 offset:50752
    ds_read_b64_tr_b16 a[246:247], v252 offset:51264
    v_mfma_f32_16x16x32_bf16 v[52:55], a[248:251], a[36:39], v[52:55]
    buffer_load_dwordx4 v254, s[28:31], s50 offen lds
    v_mfma_f32_16x16x32_bf16 v[56:59], a[248:251], a[40:43], v[56:59]
    v_mfma_f32_16x16x32_bf16 v[60:63], a[248:251], a[44:47], v[60:63]
    s_waitcnt lgkmcnt(2)
    v_mfma_f32_16x16x32_bf16 v[0:3], a[236:239], a[48:51], v[0:3]
    s_add_u32 s50, s60, 946176
    s_add_u32 m0, s64, 4224
    ds_read_b64_tr_b16 a[248:249], v252 offset:50784
    ds_read_b64_tr_b16 a[250:251], v252 offset:51296
    v_mfma_f32_16x16x32_bf16 v[4:7], a[236:239], a[52:55], v[4:7]
    buffer_load_dwordx4 v254, s[28:31], s50 offen lds
    v_mfma_f32_16x16x32_bf16 v[8:11], a[236:239], a[56:59], v[8:11]
    v_mfma_f32_16x16x32_bf16 v[12:15], a[236:239], a[60:63], v[12:15]
    v_mfma_f32_16x16x32_bf16 v[16:19], a[240:243], a[48:51], v[16:19]
    s_add_u32 s50, s60, 949760
    s_add_u32 m0, s64, 5280
    ds_read_b64_tr_b16 a[236:237], v253 offset:0
    ds_read_b64_tr_b16 a[238:239], v253 offset:512
    v_mfma_f32_16x16x32_bf16 v[20:23], a[240:243], a[52:55], v[20:23]
    buffer_load_dwordx4 v254, s[28:31], s50 offen lds
    v_mfma_f32_16x16x32_bf16 v[24:27], a[240:243], a[56:59], v[24:27]
    v_mfma_f32_16x16x32_bf16 v[28:31], a[240:243], a[60:63], v[28:31]
    s_waitcnt lgkmcnt(2)
    v_mfma_f32_16x16x32_bf16 v[32:35], a[244:247], a[48:51], v[32:35]
    s_add_u32 s50, s60, 953344
    s_add_u32 m0, s64, 6336
    ds_read_b64_tr_b16 a[240:241], v253 offset:32
    ds_read_b64_tr_b16 a[242:243], v253 offset:544
    v_mfma_f32_16x16x32_bf16 v[36:39], a[244:247], a[52:55], v[36:39]
    buffer_load_dwordx4 v254, s[28:31], s50 offen lds
    v_mfma_f32_16x16x32_bf16 v[40:43], a[244:247], a[56:59], v[40:43]
    v_mfma_f32_16x16x32_bf16 v[44:47], a[244:247], a[60:63], v[44:47]
    v_mfma_f32_16x16x32_bf16 v[48:51], a[248:251], a[48:51], v[48:51]
    s_add_u32 s50, s60, 956928
    s_add_u32 m0, s64, 7392
    ds_read_b64_tr_b16 a[244:245], v253 offset:64
    ds_read_b64_tr_b16 a[246:247], v253 offset:576
    v_mfma_f32_16x16x32_bf16 v[52:55], a[248:251], a[52:55], v[52:55]
    buffer_load_dwordx4 v254, s[28:31], s50 offen lds
    v_mfma_f32_16x16x32_bf16 v[56:59], a[248:251], a[56:59], v[56:59]
    v_mfma_f32_16x16x32_bf16 v[60:63], a[248:251], a[60:63], v[60:63]
    s_waitcnt vmcnt(10)
    s_barrier
    s_waitcnt lgkmcnt(2)
    v_mfma_f32_16x16x32_bf16 v[0:3], a[236:239], a[64:67], v[0:3]
    s_add_u32 s50, s60, 1146880
    s_add_u32 m0, s65, 0
    ds_read_b64_tr_b16 a[248:249], v253 offset:96
    ds_read_b64_tr_b16 a[250:251], v253 offset:608
    v_mfma_f32_16x16x32_bf16 v[4:7], a[236:239], a[68:71], v[4:7]
    buffer_load_dwordx4 v254, s[28:31], s50 offen lds
    v_mfma_f32_16x16x32_bf16 v[8:11], a[236:239], a[72:75], v[8:11]
    v_mfma_f32_16x16x32_bf16 v[12:15], a[236:239], a[76:79], v[12:15]
    v_mfma_f32_16x16x32_bf16 v[16:19], a[240:243], a[64:67], v[16:19]
    s_add_u32 s50, s60, 1150464
    s_add_u32 m0, s65, 1056
    ds_read_b64_tr_b16 a[236:237], v253 offset:16896
    ds_read_b64_tr_b16 a[238:239], v253 offset:17408
    v_mfma_f32_16x16x32_bf16 v[20:23], a[240:243], a[68:71], v[20:23]
    buffer_load_dwordx4 v254, s[28:31], s50 offen lds
    v_mfma_f32_16x16x32_bf16 v[24:27], a[240:243], a[72:75], v[24:27]
    v_mfma_f32_16x16x32_bf16 v[28:31], a[240:243], a[76:79], v[28:31]
    s_waitcnt lgkmcnt(2)
    v_mfma_f32_16x16x32_bf16 v[32:35], a[244:247], a[64:67], v[32:35]
    s_add_u32 s50, s60, 1154048
    s_add_u32 m0, s65, 2112
    ds_read_b64_tr_b16 a[240:241], v253 offset:16928
    ds_read_b64_tr_b16 a[242:243], v253 offset:17440
    v_mfma_f32_16x16x32_bf16 v[36:39], a[244:247], a[68:71], v[36:39]
    buffer_load_dwordx4 v254, s[28:31], s50 offen lds
    v_mfma_f32_16x16x32_bf16 v[40:43], a[244:247], a[72:75], v[40:43]
    v_mfma_f32_16x16x32_bf16 v[44:47], a[244:247], a[76:79], v[44:47]
    v_mfma_f32_16x16x32_bf16 v[48:51], a[248:251], a[64:67], v[48:51]
    s_add_u32 s50, s60, 1157632
    s_add_u32 m0, s65, 3168
    ds_read_b64_tr_b16 a[244:245], v253 offset:16960
    ds_read_b64_tr_b16 a[246:247], v253 offset:17472
    v_mfma_f32_16x16x32_bf16 v[52:55], a[248:251], a[68:71], v[52:55]
    buffer_load_dwordx4 v254, s[28:31], s50 offen lds
    v_mfma_f32_16x16x32_bf16 v[56:59], a[248:251], a[72:75], v[56:59]
    v_mfma_f32_16x16x32_bf16 v[60:63], a[248:251], a[76:79], v[60:63]
    s_waitcnt lgkmcnt(2)
    v_mfma_f32_16x16x32_bf16 v[0:3], a[236:239], a[80:83], v[0:3]
    s_add_u32 s50, s60, 1175552
    s_add_u32 m0, s65, 4224
    ds_read_b64_tr_b16 a[248:249], v253 offset:16992
    ds_read_b64_tr_b16 a[250:251], v253 offset:17504
    v_mfma_f32_16x16x32_bf16 v[4:7], a[236:239], a[84:87], v[4:7]
    buffer_load_dwordx4 v254, s[28:31], s50 offen lds
    v_mfma_f32_16x16x32_bf16 v[8:11], a[236:239], a[88:91], v[8:11]
    v_mfma_f32_16x16x32_bf16 v[12:15], a[236:239], a[92:95], v[12:15]
    v_mfma_f32_16x16x32_bf16 v[16:19], a[240:243], a[80:83], v[16:19]
    s_add_u32 s50, s60, 1179136
    s_add_u32 m0, s65, 5280
    ds_read_b64_tr_b16 a[236:237], v253 offset:33792
    ds_read_b64_tr_b16 a[238:239], v253 offset:34304
    v_mfma_f32_16x16x32_bf16 v[20:23], a[240:243], a[84:87], v[20:23]
    buffer_load_dwordx4 v254, s[28:31], s50 offen lds
    v_mfma_f32_16x16x32_bf16 v[24:27], a[240:243], a[88:91], v[24:27]
    v_mfma_f32_16x16x32_bf16 v[28:31], a[240:243], a[92:95], v[28:31]
    s_waitcnt lgkmcnt(2)
    v_mfma_f32_16x16x32_bf16 v[32:35], a[244:247], a[80:83], v[32:35]
    s_add_u32 s50, s60, 1182720
    s_add_u32 m0, s65, 6336
    ds_read_b64_tr_b16 a[240:241], v253 offset:33824
    ds_read_b64_tr_b16 a[242:243], v253 offset:34336
    v_mfma_f32_16x16x32_bf16 v[36:39], a[244:247], a[84:87], v[36:39]
    buffer_load_dwordx4 v254, s[28:31], s50 offen lds
    v_mfma_f32_16x16x32_bf16 v[40:43], a[244:247], a[88:91], v[40:43]
    v_mfma_f32_16x16x32_bf16 v[44:47], a[244:247], a[92:95], v[44:47]
    v_mfma_f32_16x16x32_bf16 v[48:51], a[248:251], a[80:83], v[48:51]
    s_add_u32 s50, s60, 1186304
    s_add_u32 m0, s65, 7392
    ds_read_b64_tr_b16 a[244:245], v253 offset:33856
    ds_read_b64_tr_b16 a[246:247], v253 offset:34368
    v_mfma_f32_16x16x32_bf16 v[52:55], a[248:251], a[84:87], v[52:55]
    buffer_load_dwordx4 v254, s[28:31], s50 offen lds
    v_mfma_f32_16x16x32_bf16 v[56:59], a[248:251], a[88:91], v[56:59]
    v_mfma_f32_16x16x32_bf16 v[60:63], a[248:251], a[92:95], v[60:63]
    s_waitcnt vmcnt(8)
    s_barrier
    s_waitcnt lgkmcnt(2)
    v_mfma_f32_16x16x32_bf16 v[0:3], a[236:239], a[96:99], v[0:3]
    s_add_u32 s50, s60, 1376256
    s_add_u32 m0, s66, 0
    ds_read_b64_tr_b16 a[248:249], v253 offset:33888
    ds_read_b64_tr_b16 a[250:251], v253 offset:34400
    v_mfma_f32_16x16x32_bf16 v[4:7], a[236:239], a[100:103], v[4:7]
    buffer_load_dwordx4 v254, s[28:31], s50 offen lds
    v_mfma_f32_16x16x32_bf16 v[8:11], a[236:239], a[104:107], v[8:11]
    v_mfma_f32_16x16x32_bf16 v[12:15], a[236:239], a[108:111], v[12:15]
    v_mfma_f32_16x16x32_bf16 v[16:19], a[240:243], a[96:99], v[16:19]
    s_add_u32 s50, s60, 1379840
    s_add_u32 m0, s66, 1056
    ds_read_b64_tr_b16 a[236:237], v253 offset:50688
    ds_read_b64_tr_b16 a[238:239], v253 offset:51200
    v_mfma_f32_16x16x32_bf16 v[20:23], a[240:243], a[100:103], v[20:23]
    buffer_load_dwordx4 v254, s[28:31], s50 offen lds
    v_mfma_f32_16x16x32_bf16 v[24:27], a[240:243], a[104:107], v[24:27]
    v_mfma_f32_16x16x32_bf16 v[28:31], a[240:243], a[108:111], v[28:31]
    s_waitcnt lgkmcnt(2)
    v_mfma_f32_16x16x32_bf16 v[32:35], a[244:247], a[96:99], v[32:35]
    s_add_u32 s50, s60, 1383424
    s_add_u32 m0, s66, 2112
    ds_read_b64_tr_b16 a[240:241], v253 offset:50720
    ds_read_b64_tr_b16 a[242:243], v253 offset:51232
    v_mfma_f32_16x16x32_bf16 v[36:39], a[244:247], a[100:103], v[36:39]
    buffer_load_dwordx4 v254, s[28:31], s50 offen lds
    v_mfma_f32_16x16x32_bf16 v[40:43], a[244:247], a[104:107], v[40:43]
    v_mfma_f32_16x16x32_bf16 v[44:47], a[244:247], a[108:111], v[44:47]
    v_mfma_f32_16x16x32_bf16 v[48:51], a[248:251], a[96:99], v[48:51]
    s_add_u32 s50, s60, 1387008
    s_add_u32 m0, s66, 3168
    ds_read_b64_tr_b16 a[244:245], v253 offset:50752
    ds_read_b64_tr_b16 a[246:247], v253 offset:51264
    v_mfma_f32_16x16x32_bf16 v[52:55], a[248:251], a[100:103], v[52:55]
    buffer_load_dwordx4 v254, s[28:31], s50 offen lds
    v_mfma_f32_16x16x32_bf16 v[56:59], a[248:251], a[104:107], v[56:59]
    v_mfma_f32_16x16x32_bf16 v[60:63], a[248:251], a[108:111], v[60:63]
    s_waitcnt lgkmcnt(2)
    v_mfma_f32_16x16x32_bf16 v[0:3], a[236:239], a[112:115], v[0:3]
    s_add_u32 s50, s60, 1404928
    s_add_u32 m0, s66, 4224
    ds_read_b64_tr_b16 a[248:249], v253 offset:50784
    ds_read_b64_tr_b16 a[250:251], v253 offset:51296
    v_mfma_f32_16x16x32_bf16 v[4:7], a[236:239], a[116:119], v[4:7]
    buffer_load_dwordx4 v254, s[28:31], s50 offen lds
    v_mfma_f32_16x16x32_bf16 v[8:11], a[236:239], a[120:123], v[8:11]
    v_mfma_f32_16x16x32_bf16 v[12:15], a[236:239], a[124:127], v[12:15]
    v_mfma_f32_16x16x32_bf16 v[16:19], a[240:243], a[112:115], v[16:19]
    s_add_u32 s50, s60, 1408512
    s_add_u32 m0, s66, 5280
    ds_read_b64_tr_b16 a[236:237], v252 offset:0
    ds_read_b64_tr_b16 a[238:239], v252 offset:512
    v_mfma_f32_16x16x32_bf16 v[20:23], a[240:243], a[116:119], v[20:23]
    buffer_load_dwordx4 v254, s[28:31], s50 offen lds
    v_mfma_f32_16x16x32_bf16 v[24:27], a[240:243], a[120:123], v[24:27]
    v_mfma_f32_16x16x32_bf16 v[28:31], a[240:243], a[124:127], v[28:31]
    s_waitcnt lgkmcnt(2)
    v_mfma_f32_16x16x32_bf16 v[32:35], a[244:247], a[112:115], v[32:35]
    s_add_u32 s50, s60, 1412096
    s_add_u32 m0, s66, 6336
    ds_read_b64_tr_b16 a[240:241], v252 offset:32
    ds_read_b64_tr_b16 a[242:243], v252 offset:544
    v_mfma_f32_16x16x32_bf16 v[36:39], a[244:247], a[116:119], v[36:39]
    buffer_load_dwordx4 v254, s[28:31], s50 offen lds
    v_mfma_f32_16x16x32_bf16 v[40:43], a[244:247], a[120:123], v[40:43]
    v_mfma_f32_16x16x32_bf16 v[44:47], a[244:247], a[124:127], v[44:47]
    v_mfma_f32_16x16x32_bf16 v[48:51], a[248:251], a[112:115], v[48:51]
    s_add_u32 s50, s60, 1415680
    s_add_u32 m0, s66, 7392
    ds_read_b64_tr_b16 a[244:245], v252 offset:64
    ds_read_b64_tr_b16 a[246:247], v252 offset:576
    v_mfma_f32_16x16x32_bf16 v[52:55], a[248:251], a[116:119], v[52:55]
    buffer_load_dwordx4 v254, s[28:31], s50 offen lds
    v_mfma_f32_16x16x32_bf16 v[56:59], a[248:251], a[120:123], v[56:59]
    v_mfma_f32_16x16x32_bf16 v[60:63], a[248:251], a[124:127], v[60:63]
    s_waitcnt vmcnt(8)
    s_barrier
    s_waitcnt lgkmcnt(2)
    v_mfma_f32_16x16x32_bf16 v[0:3], a[236:239], a[128:131], v[0:3]
    s_add_u32 s50, s61, 0
    s_add_u32 m0, s67, 0
    ds_read_b64_tr_b16 a[248:249], v252 offset:96
    ds_read_b64_tr_b16 a[250:251], v252 offset:608
    v_mfma_f32_16x16x32_bf16 v[4:7], a[236:239], a[132:135], v[4:7]
    buffer_load_dwordx4 v255, s[20:23], s50 offen lds
    v_mfma_f32_16x16x32_bf16 v[8:11], a[236:239], a[136:139], v[8:11]
    v_mfma_f32_16x16x32_bf16 v[12:15], a[236:239], a[140:143], v[12:15]
    v_mfma_f32_16x16x32_bf16 v[16:19], a[240:243], a[128:131], v[16:19]
    s_add_u32 s50, s61, 8192
    s_add_u32 m0, s67, 1056
    ds_read_b64_tr_b16 a[236:237], v252 offset:16896
    ds_read_b64_tr_b16 a[238:239], v252 offset:17408
    v_mfma_f32_16x16x32_bf16 v[20:23], a[240:243], a[132:135], v[20:23]
    buffer_load_dwordx4 v255, s[20:23], s50 offen lds
    v_mfma_f32_16x16x32_bf16 v[24:27], a[240:243], a[136:139], v[24:27]
    v_mfma_f32_16x16x32_bf16 v[28:31], a[240:243], a[140:143], v[28:31]
    s_waitcnt lgkmcnt(2)
    v_mfma_f32_16x16x32_bf16 v[32:35], a[244:247], a[128:131], v[32:35]
    s_add_u32 s50, s61, 16384
    s_add_u32 m0, s67, 2112
    ds_read_b64_tr_b16 a[240:241], v252 offset:16928
    ds_read_b64_tr_b16 a[242:243], v252 offset:17440
    v_mfma_f32_16x16x32_bf16 v[36:39], a[244:247], a[132:135], v[36:39]
    buffer_load_dwordx4 v255, s[20:23], s50 offen lds
    v_mfma_f32_16x16x32_bf16 v[40:43], a[244:247], a[136:139], v[40:43]
    v_mfma_f32_16x16x32_bf16 v[44:47], a[244:247], a[140:143], v[44:47]
    v_mfma_f32_16x16x32_bf16 v[48:51], a[248:251], a[128:131], v[48:51]
    s_add_u32 s50, s61, 24576
    s_add_u32 m0, s67, 3168
    ds_read_b64_tr_b16 a[244:245], v252 offset:16960
    ds_read_b64_tr_b16 a[246:247], v252 offset:17472
    v_mfma_f32_16x16x32_bf16 v[52:55], a[248:251], a[132:135], v[52:55]
    buffer_load_dwordx4 v255, s[20:23], s50 offen lds
    v_mfma_f32_16x16x32_bf16 v[56:59], a[248:251], a[136:139], v[56:59]
    v_mfma_f32_16x16x32_bf16 v[60:63], a[248:251], a[140:143], v[60:63]
    s_waitcnt lgkmcnt(2)
    v_mfma_f32_16x16x32_bf16 v[0:3], a[236:239], a[144:147], v[0:3]
    s_add_u32 s50, s61, 65536
    s_add_u32 m0, s67, 4224
    ds_read_b64_tr_b16 a[248:249], v252 offset:16992
    ds_read_b64_tr_b16 a[250:251], v252 offset:17504
    v_mfma_f32_16x16x32_bf16 v[4:7], a[236:239], a[148:151], v[4:7]
    buffer_load_dwordx4 v255, s[20:23], s50 offen lds
    v_mfma_f32_16x16x32_bf16 v[8:11], a[236:239], a[152:155], v[8:11]
    v_mfma_f32_16x16x32_bf16 v[12:15], a[236:239], a[156:159], v[12:15]
    v_mfma_f32_16x16x32_bf16 v[16:19], a[240:243], a[144:147], v[16:19]
    s_add_u32 s50, s61, 73728
    s_add_u32 m0, s67, 5280
    ds_read_b64_tr_b16 a[236:237], v252 offset:33792
    ds_read_b64_tr_b16 a[238:239], v252 offset:34304
    v_mfma_f32_16x16x32_bf16 v[20:23], a[240:243], a[148:151], v[20:23]
    buffer_load_dwordx4 v255, s[20:23], s50 offen lds
    v_mfma_f32_16x16x32_bf16 v[24:27], a[240:243], a[152:155], v[24:27]
    v_mfma_f32_16x16x32_bf16 v[28:31], a[240:243], a[156:159], v[28:31]
    s_waitcnt lgkmcnt(2)
    v_mfma_f32_16x16x32_bf16 v[32:35], a[244:247], a[144:147], v[32:35]
    s_add_u32 s50, s61, 81920
    s_add_u32 m0, s67, 6336
    ds_read_b64_tr_b16 a[240:241], v252 offset:33824
    ds_read_b64_tr_b16 a[242:243], v252 offset:34336
    v_mfma_f32_16x16x32_bf16 v[36:39], a[244:247], a[148:151], v[36:39]
    buffer_load_dwordx4 v255, s[20:23], s50 offen lds
    v_mfma_f32_16x16x32_bf16 v[40:43], a[244:247], a[152:155], v[40:43]
    v_mfma_f32_16x16x32_bf16 v[44:47], a[244:247], a[156:159], v[44:47]
    v_mfma_f32_16x16x32_bf16 v[48:51], a[248:251], a[144:147], v[48:51]
    s_add_u32 s50, s61, 90112
    s_add_u32 m0, s67, 7392
    ds_read_b64_tr_b16 a[244:245], v252 offset:33856
    ds_read_b64_tr_b16 a[246:247], v252 offset:34368
    v_mfma_f32_16x16x32_bf16 v[52:55], a[248:251], a[148:151], v[52:55]
    buffer_load_dwordx4 v255, s[20:23], s50 offen lds
    v_mfma_f32_16x16x32_bf16 v[56:59], a[248:251], a[152:155], v[56:59]
    v_mfma_f32_16x16x32_bf16 v[60:63], a[248:251], a[156:159], v[60:63]
    s_waitcnt vmcnt(8)
    s_barrier
    s_waitcnt lgkmcnt(2)
    v_mfma_f32_16x16x32_bf16 v[0:3], a[236:239], a[160:163], v[0:3]
    s_add_u32 s50, s61, 262144
    s_add_u32 m0, s64, 0
    ds_read_b64_tr_b16 a[248:249], v252 offset:33888
    ds_read_b64_tr_b16 a[250:251], v252 offset:34400
    v_mfma_f32_16x16x32_bf16 v[4:7], a[236:239], a[164:167], v[4:7]
    buffer_load_dwordx4 v255, s[20:23], s50 offen lds
    v_mfma_f32_16x16x32_bf16 v[8:11], a[236:239], a[168:171], v[8:11]
    v_mfma_f32_16x16x32_bf16 v[12:15], a[236:239], a[172:175], v[12:15]
    v_mfma_f32_16x16x32_bf16 v[16:19], a[240:243], a[160:163], v[16:19]
    s_add_u32 s50, s61, 270336
    s_add_u32 m0, s64, 1056
    ds_read_b64_tr_b16 a[236:237], v252 offset:50688
    ds_read_b64_tr_b16 a[238:239], v252 offset:51200
    v_mfma_f32_16x16x32_bf16 v[20:23], a[240:243], a[164:167], v[20:23]
    buffer_load_dwordx4 v255, s[20:23], s50 offen lds
    v_mfma_f32_16x16x32_bf16 v[24:27], a[240:243], a[168:171], v[24:27]
    v_mfma_f32_16x16x32_bf16 v[28:31], a[240:243], a[172:175], v[28:31]
    s_waitcnt lgkmcnt(2)
    v_mfma_f32_16x16x32_bf16 v[32:35], a[244:247], a[160:163], v[32:35]
    s_add_u32 s50, s61, 278528
    s_add_u32 m0, s64, 2112
    ds_read_b64_tr_b16 a[240:241], v252 offset:50720
    ds_read_b64_tr_b16 a[242:243], v252 offset:51232
    v_mfma_f32_16x16x32_bf16 v[36:39], a[244:247], a[164:167], v[36:39]
    buffer_load_dwordx4 v255, s[20:23], s50 offen lds
    v_mfma_f32_16x16x32_bf16 v[40:43], a[244:247], a[168:171], v[40:43]
    v_mfma_f32_16x16x32_bf16 v[44:47], a[244:247], a[172:175], v[44:47]
    v_mfma_f32_16x16x32_bf16 v[48:51], a[248:251], a[160:163], v[48:51]
    s_add_u32 s50, s61, 286720
    s_add_u32 m0, s64, 3168
    ds_read_b64_tr_b16 a[244:245], v252 offset:50752
    ds_read_b64_tr_b16 a[246:247], v252 offset:51264
    v_mfma_f32_16x16x32_bf16 v[52:55], a[248:251], a[164:167], v[52:55]
    buffer_load_dwordx4 v255, s[20:23], s50 offen lds
    v_mfma_f32_16x16x32_bf16 v[56:59], a[248:251], a[168:171], v[56:59]
    v_mfma_f32_16x16x32_bf16 v[60:63], a[248:251], a[172:175], v[60:63]
    s_waitcnt lgkmcnt(2)
    v_mfma_f32_16x16x32_bf16 v[0:3], a[236:239], a[176:179], v[0:3]
    s_add_u32 s50, s61, 327680
    s_add_u32 m0, s64, 4224
    ds_read_b64_tr_b16 a[248:249], v252 offset:50784
    ds_read_b64_tr_b16 a[250:251], v252 offset:51296
    v_mfma_f32_16x16x32_bf16 v[4:7], a[236:239], a[180:183], v[4:7]
    buffer_load_dwordx4 v255, s[20:23], s50 offen lds
    v_mfma_f32_16x16x32_bf16 v[8:11], a[236:239], a[184:187], v[8:11]
    v_mfma_f32_16x16x32_bf16 v[12:15], a[236:239], a[188:191], v[12:15]
    v_mfma_f32_16x16x32_bf16 v[16:19], a[240:243], a[176:179], v[16:19]
    s_add_u32 s50, s61, 335872
    s_add_u32 m0, s64, 5280
    ds_read_b64_tr_b16 a[236:237], v253 offset:0
    ds_read_b64_tr_b16 a[238:239], v253 offset:512
    v_mfma_f32_16x16x32_bf16 v[20:23], a[240:243], a[180:183], v[20:23]
    buffer_load_dwordx4 v255, s[20:23], s50 offen lds
    v_mfma_f32_16x16x32_bf16 v[24:27], a[240:243], a[184:187], v[24:27]
    v_mfma_f32_16x16x32_bf16 v[28:31], a[240:243], a[188:191], v[28:31]
    s_waitcnt lgkmcnt(2)
    v_mfma_f32_16x16x32_bf16 v[32:35], a[244:247], a[176:179], v[32:35]
    s_add_u32 s50, s61, 344064
    s_add_u32 m0, s64, 6336
    ds_read_b64_tr_b16 a[240:241], v253 offset:32
    ds_read_b64_tr_b16 a[242:243], v253 offset:544
    v_mfma_f32_16x16x32_bf16 v[36:39], a[244:247], a[180:183], v[36:39]
    buffer_load_dwordx4 v255, s[20:23], s50 offen lds
    v_mfma_f32_16x16x32_bf16 v[40:43], a[244:247], a[184:187], v[40:43]
    v_mfma_f32_16x16x32_bf16 v[44:47], a[244:247], a[188:191], v[44:47]
    v_mfma_f32_16x16x32_bf16 v[48:51], a[248:251], a[176:179], v[48:51]
    s_add_u32 s50, s61, 352256
    s_add_u32 m0, s64, 7392
    ds_read_b64_tr_b16 a[244:245], v253 offset:64
    ds_read_b64_tr_b16 a[246:247], v253 offset:576
    v_mfma_f32_16x16x32_bf16 v[52:55], a[248:251], a[180:183], v[52:55]
    buffer_load_dwordx4 v255, s[20:23], s50 offen lds
    v_mfma_f32_16x16x32_bf16 v[56:59], a[248:251], a[184:187], v[56:59]
    v_mfma_f32_16x16x32_bf16 v[60:63], a[248:251], a[188:191], v[60:63]
    s_waitcnt vmcnt(8)
    s_barrier
    s_waitcnt lgkmcnt(2)
    v_mfma_f32_16x16x32_bf16 v[0:3], a[236:239], a[192:195], v[0:3]
    s_add_u32 s50, s61, 524288
    s_add_u32 m0, s65, 0
    ds_read_b64_tr_b16 a[248:249], v253 offset:96
    ds_read_b64_tr_b16 a[250:251], v253 offset:608
    v_mfma_f32_16x16x32_bf16 v[4:7], a[236:239], a[196:199], v[4:7]
    buffer_load_dwordx4 v255, s[20:23], s50 offen lds
    v_mfma_f32_16x16x32_bf16 v[8:11], a[236:239], a[200:203], v[8:11]
    v_mfma_f32_16x16x32_bf16 v[12:15], a[236:239], a[204:207], v[12:15]
    v_mfma_f32_16x16x32_bf16 v[16:19], a[240:243], a[192:195], v[16:19]
    s_add_u32 s50, s61, 532480
    s_add_u32 m0, s65, 1056
    ds_read_b64_tr_b16 a[236:237], v253 offset:16896
    ds_read_b64_tr_b16 a[238:239], v253 offset:17408
    v_mfma_f32_16x16x32_bf16 v[20:23], a[240:243], a[196:199], v[20:23]
    buffer_load_dwordx4 v255, s[20:23], s50 offen lds
    v_mfma_f32_16x16x32_bf16 v[24:27], a[240:243], a[200:203], v[24:27]
    v_mfma_f32_16x16x32_bf16 v[28:31], a[240:243], a[204:207], v[28:31]
    s_waitcnt lgkmcnt(2)
    v_mfma_f32_16x16x32_bf16 v[32:35], a[244:247], a[192:195], v[32:35]
    s_add_u32 s50, s61, 540672
    s_add_u32 m0, s65, 2112
    ds_read_b64_tr_b16 a[240:241], v253 offset:16928
    ds_read_b64_tr_b16 a[242:243], v253 offset:17440
    v_mfma_f32_16x16x32_bf16 v[36:39], a[244:247], a[196:199], v[36:39]
    buffer_load_dwordx4 v255, s[20:23], s50 offen lds
    v_mfma_f32_16x16x32_bf16 v[40:43], a[244:247], a[200:203], v[40:43]
    v_mfma_f32_16x16x32_bf16 v[44:47], a[244:247], a[204:207], v[44:47]
    v_mfma_f32_16x16x32_bf16 v[48:51], a[248:251], a[192:195], v[48:51]
    s_add_u32 s50, s61, 548864
    s_add_u32 m0, s65, 3168
    ds_read_b64_tr_b16 a[244:245], v253 offset:16960
    ds_read_b64_tr_b16 a[246:247], v253 offset:17472
    v_mfma_f32_16x16x32_bf16 v[52:55], a[248:251], a[196:199], v[52:55]
    buffer_load_dwordx4 v255, s[20:23], s50 offen lds
    v_mfma_f32_16x16x32_bf16 v[56:59], a[248:251], a[200:203], v[56:59]
    v_mfma_f32_16x16x32_bf16 v[60:63], a[248:251], a[204:207], v[60:63]
    s_waitcnt lgkmcnt(2)
    v_mfma_f32_16x16x32_bf16 v[0:3], a[236:239], a[208:211], v[0:3]
    s_add_u32 s50, s61, 589824
    s_add_u32 m0, s65, 4224
    ds_read_b64_tr_b16 a[248:249], v253 offset:16992
    ds_read_b64_tr_b16 a[250:251], v253 offset:17504
    v_mfma_f32_16x16x32_bf16 v[4:7], a[236:239], a[212:215], v[4:7]
    buffer_load_dwordx4 v255, s[20:23], s50 offen lds
    v_mfma_f32_16x16x32_bf16 v[8:11], a[236:239], a[216:219], v[8:11]
    v_mfma_f32_16x16x32_bf16 v[12:15], a[236:239], a[220:223], v[12:15]
    v_mfma_f32_16x16x32_bf16 v[16:19], a[240:243], a[208:211], v[16:19]
    s_add_u32 s50, s61, 598016
    s_add_u32 m0, s65, 5280
    ds_read_b64_tr_b16 a[236:237], v249 offset:33792
    ds_read_b64_tr_b16 a[238:239], v249 offset:34304
    v_mfma_f32_16x16x32_bf16 v[20:23], a[240:243], a[212:215], v[20:23]
    buffer_load_dwordx4 v255, s[20:23], s50 offen lds
    v_mfma_f32_16x16x32_bf16 v[24:27], a[240:243], a[216:219], v[24:27]
    v_mfma_f32_16x16x32_bf16 v[28:31], a[240:243], a[220:223], v[28:31]
    s_waitcnt lgkmcnt(2)
    v_mfma_f32_16x16x32_bf16 v[32:35], a[244:247], a[208:211], v[32:35]
    s_add_u32 s50, s61, 606208
    s_add_u32 m0, s65, 6336
    ds_read_b64_tr_b16 a[240:241], v249 offset:33800
    ds_read_b64_tr_b16 a[242:243], v249 offset:34312
    v_mfma_f32_16x16x32_bf16 v[36:39], a[244:247], a[212:215], v[36:39]
    buffer_load_dwordx4 v255, s[20:23], s50 offen lds
    v_mfma_f32_16x16x32_bf16 v[40:43], a[244:247], a[216:219], v[40:43]
    v_mfma_f32_16x16x32_bf16 v[44:47], a[244:247], a[220:223], v[44:47]
    v_mfma_f32_16x16x32_bf16 v[48:51], a[248:251], a[208:211], v[48:51]
    s_add_u32 s50, s61, 614400
    s_add_u32 m0, s65, 7392
    ds_read_b64_tr_b16 a[244:245], v249 offset:33856
    ds_read_b64_tr_b16 a[246:247], v249 offset:34368
    v_mfma_f32_16x16x32_bf16 v[52:55], a[248:251], a[212:215], v[52:55]
    buffer_load_dwordx4 v255, s[20:23], s50 offen lds
    v_mfma_f32_16x16x32_bf16 v[56:59], a[248:251], a[216:219], v[56:59]
    v_mfma_f32_16x16x32_bf16 v[60:63], a[248:251], a[220:223], v[60:63]
    s_waitcnt vmcnt(8)
    s_barrier
    s_waitcnt lgkmcnt(2)
    v_mfma_f32_16x16x32_bf16 v[96:99], a[236:239], a[0:3], 0
    s_add_u32 s50, s61, 786432
    s_add_u32 m0, s66, 0
    ds_read_b64_tr_b16 a[248:249], v249 offset:33864
    ds_read_b64_tr_b16 a[250:251], v249 offset:34376
    v_mfma_f32_16x16x32_bf16 v[100:103], a[236:239], a[4:7], 0
    buffer_load_dwordx4 v255, s[20:23], s50 offen lds
    v_mfma_f32_16x16x32_bf16 v[104:107], a[236:239], a[8:11], 0
    v_mfma_f32_16x16x32_bf16 v[108:111], a[236:239], a[12:15], 0
    v_mfma_f32_16x16x32_bf16 v[112:115], a[240:243], a[0:3], 0
    s_add_u32 s50, s61, 794624
    s_add_u32 m0, s66, 1056
    ds_read_b64_tr_b16 a[236:237], v249 offset:33920
    ds_read_b64_tr_b16 a[238:239], v249 offset:34432
    v_mfma_f32_16x16x32_bf16 v[116:119], a[240:243], a[4:7], 0
    buffer_load_dwordx4 v255, s[20:23], s50 offen lds
    v_mfma_f32_16x16x32_bf16 v[120:123], a[240:243], a[8:11], 0
    v_mfma_f32_16x16x32_bf16 v[124:127], a[240:243], a[12:15], 0
    s_waitcnt lgkmcnt(2)
    v_mfma_f32_16x16x32_bf16 v[128:131], a[244:247], a[0:3], 0
    s_add_u32 s50, s61, 802816
    s_add_u32 m0, s66, 2112
    s_mov_b32 s100, 0xbdd2d3e8
    ds_read_b64_tr_b16 a[240:241], v249 offset:33928
    ds_read_b64_tr_b16 a[242:243], v249 offset:34440
    v_mov_b32 v239, 0xc0135761
    v_mfma_f32_16x16x32_bf16 v[132:135], a[244:247], a[4:7], 0
    buffer_load_dwordx4 v255, s[20:23], s50 offen lds
    v_accvgpr_read_b32 v232, a224
    v_mfma_f32_16x16x32_bf16 v[136:139], a[244:247], a[8:11], 0
    v_accvgpr_read_b32 v233, a225
    s_nop 0
    v_lshlrev_b32 v240, 16, v232
    v_and_b32 v241, 0xffff0000, v232
    v_mfma_f32_16x16x32_bf16 v[140:143], a[244:247], a[12:15], 0
    v_lshlrev_b32 v242, 16, v233
    v_and_b32 v243, 0xffff0000, v233
    v_fma_f32 v0, v0, v225, v240
    v_mfma_f32_16x16x32_bf16 v[144:147], a[248:251], a[0:3], 0
    s_add_u32 s50, s61, 811008
    s_add_u32 m0, s66, 3168
    ds_read_b64_tr_b16 a[244:245], v249 offset:33984
    ds_read_b64_tr_b16 a[246:247], v249 offset:34496
    v_fma_f32 v1, v1, v225, v241
    v_mfma_f32_16x16x32_bf16 v[148:151], a[248:251], a[4:7], 0
    buffer_load_dwordx4 v255, s[20:23], s50 offen lds
    v_fma_f32 v2, v2, v225, v242
    v_mfma_f32_16x16x32_bf16 v[152:155], a[248:251], a[8:11], 0
    v_fma_f32 v3, v3, v225, v243
    v_mul_f32 v232, v0, v0
    v_mul_f32 v233, v1, v1
    v_mfma_f32_16x16x32_bf16 v[156:159], a[248:251], a[12:15], 0
    s_waitcnt lgkmcnt(2)
    v_mul_f32 v234, v2, v2
    v_mul_f32 v235, v3, v3
    v_fma_f32 v232, v232, s100, v239
    v_mfma_f32_16x16x32_bf16 v[160:163], a[236:239], a[0:3], 0
    s_add_u32 s50, s61, 851968
    s_add_u32 m0, s66, 4224
    ds_read_b64_tr_b16 a[248:249], v249 offset:33992
    ds_read_b64_tr_b16 a[250:251], v249 offset:34504
    v_fma_f32 v233, v233, s100, v239
    v_mfma_f32_16x16x32_bf16 v[164:167], a[236:239], a[4:7], 0
    buffer_load_dwordx4 v255, s[20:23], s50 offen lds
    v_fma_f32 v234, v234, s100, v239
    v_mfma_f32_16x16x32_bf16 v[168:171], a[236:239], a[8:11], 0
    v_fma_f32 v235, v235, s100, v239
    v_mul_f32 v232, v232, v0
    v_mul_f32 v233, v233, v1
    v_mfma_f32_16x16x32_bf16 v[172:175], a[236:239], a[12:15], 0
    v_mul_f32 v234, v234, v2
    v_mul_f32 v235, v235, v3
    v_mfma_f32_16x16x32_bf16 v[176:179], a[240:243], a[0:3], 0
    s_add_u32 s50, s61, 860160
    s_add_u32 m0, s66, 5280
    ds_read_b64_tr_b16 a[236:237], v248 offset:0
    ds_read_b64_tr_b16 a[238:239], v248 offset:512
    v_mfma_f32_16x16x32_bf16 v[180:183], a[240:243], a[4:7], 0
    buffer_load_dwordx4 v255, s[20:23], s50 offen lds
    v_mfma_f32_16x16x32_bf16 v[184:187], a[240:243], a[8:11], 0
    v_exp_f32 v232, v232
    v_mfma_f32_16x16x32_bf16 v[188:191], a[240:243], a[12:15], 0
    s_waitcnt lgkmcnt(2)
    v_exp_f32 v233, v233
    v_mfma_f32_16x16x32_bf16 v[192:195], a[244:247], a[0:3], 0
    s_add_u32 s50, s61, 868352
    s_add_u32 m0, s66, 6336
    ds_read_b64_tr_b16 a[240:241], v248 offset:8
    ds_read_b64_tr_b16 a[242:243], v248 offset:520
    v_mfma_f32_16x16x32_bf16 v[196:199], a[244:247], a[4:7], 0
    buffer_load_dwordx4 v255, s[20:23], s50 offen lds
    v_mfma_f32_16x16x32_bf16 v[200:203], a[244:247], a[8:11], 0
    v_exp_f32 v234, v234
    v_mfma_f32_16x16x32_bf16 v[204:207], a[244:247], a[12:15], 0
    v_exp_f32 v235, v235
    v_add_f32 v232, 1.0, v232
    v_mfma_f32_16x16x32_bf16 v[208:211], a[248:251], a[0:3], 0
    s_add_u32 s50, s61, 876544
    s_add_u32 m0, s66, 7392
    ds_read_b64_tr_b16 a[244:245], v248 offset:64
    ds_read_b64_tr_b16 a[246:247], v248 offset:576
    v_add_f32 v233, 1.0, v233
    v_mfma_f32_16x16x32_bf16 v[212:215], a[248:251], a[4:7], 0
    buffer_load_dwordx4 v255, s[20:23], s50 offen lds
    v_add_f32 v234, 1.0, v234
    v_mfma_f32_16x16x32_bf16 v[216:219], a[248:251], a[8:11], 0
    v_add_f32 v235, 1.0, v235
    v_rcp_f32 v232, v232
    v_mfma_f32_16x16x32_bf16 v[220:223], a[248:251], a[12:15], 0
    v_rcp_f32 v233, v233
    s_waitcnt vmcnt(8)
    s_barrier
    s_waitcnt lgkmcnt(2)
    v_mfma_f32_16x16x32_bf16 v[96:99], a[236:239], a[16:19], v[96:99]
    s_add_u32 s50, s61, 1048576
    s_add_u32 m0, s67, 0
    ds_read_b64_tr_b16 a[248:249], v248 offset:72
    ds_read_b64_tr_b16 a[250:251], v248 offset:584
    v_mfma_f32_16x16x32_bf16 v[100:103], a[236:239], a[20:23], v[100:103]
    buffer_load_dwordx4 v255, s[20:23], s50 offen lds
    v_mfma_f32_16x16x32_bf16 v[104:107], a[236:239], a[24:27], v[104:107]
    v_rcp_f32 v234, v234
    v_mfma_f32_16x16x32_bf16 v[108:111], a[236:239], a[28:31], v[108:111]
    v_rcp_f32 v235, v235
    v_mul_f32 v0, v0, v232
    v_mfma_f32_16x16x32_bf16 v[112:115], a[240:243], a[16:19], v[112:115]
    s_add_u32 s50, s61, 1056768
    s_add_u32 m0, s67, 1056
    ds_read_b64_tr_b16 a[236:237], v248 offset:128
    ds_read_b64_tr_b16 a[238:239], v248 offset:640
    v_mul_f32 v1, v1, v233
    v_mfma_f32_16x16x32_bf16 v[116:119], a[240:243], a[20:23], v[116:119]
    buffer_load_dwordx4 v255, s[20:23], s50 offen lds
    v_mul_f32 v2, v2, v234
    v_mfma_f32_16x16x32_bf16 v[120:123], a[240:243], a[24:27], v[120:123]
    v_mul_f32 v3, v3, v235
    v_cvt_pk_bf16_f32 v64, v0, v1
    v_cvt_pk_bf16_f32 v65, v2, v3
    v_mfma_f32_16x16x32_bf16 v[124:127], a[240:243], a[28:31], v[124:127]
    s_waitcnt lgkmcnt(2)
    v_fma_f32 v4, v4, v227, v240
    v_fma_f32 v5, v5, v227, v241
    v_fma_f32 v6, v6, v227, v242
    v_mfma_f32_16x16x32_bf16 v[128:131], a[244:247], a[16:19], v[128:131]
    s_add_u32 s50, s61, 1064960
    s_add_u32 m0, s67, 2112
    ds_read_b64_tr_b16 a[240:241], v248 offset:136
    ds_read_b64_tr_b16 a[242:243], v248 offset:648
    v_fma_f32 v7, v7, v227, v243
    v_mfma_f32_16x16x32_bf16 v[132:135], a[244:247], a[20:23], v[132:135]
    buffer_load_dwordx4 v255, s[20:23], s50 offen lds
    v_mul_f32 v232, v4, v4
    v_mfma_f32_16x16x32_bf16 v[136:139], a[244:247], a[24:27], v[136:139]
    v_mul_f32 v233, v5, v5
    v_mul_f32 v234, v6, v6
    v_mul_f32 v235, v7, v7
    v_mfma_f32_16x16x32_bf16 v[140:143], a[244:247], a[28:31], v[140:143]
    v_fma_f32 v232, v232, s100, v239
    v_fma_f32 v233, v233, s100, v239
    v_fma_f32 v234, v234, s100, v239
    v_mfma_f32_16x16x32_bf16 v[144:147], a[248:251], a[16:19], v[144:147]
    s_add_u32 s50, s61, 1073152
    s_add_u32 m0, s67, 3168
    ds_read_b64_tr_b16 a[244:245], v248 offset:192
    ds_read_b64_tr_b16 a[246:247], v248 offset:704
    v_fma_f32 v235, v235, s100, v239
    v_mfma_f32_16x16x32_bf16 v[148:151], a[248:251], a[20:23], v[148:151]
    buffer_load_dwordx4 v255, s[20:23], s50 offen lds
    v_mul_f32 v232, v232, v4
    v_mfma_f32_16x16x32_bf16 v[152:155], a[248:251], a[24:27], v[152:155]
    v_mul_f32 v233, v233, v5
    v_mul_f32 v234, v234, v6
    v_mul_f32 v235, v235, v7
    v_mfma_f32_16x16x32_bf16 v[156:159], a[248:251], a[28:31], v[156:159]
    s_waitcnt lgkmcnt(2)
    v_exp_f32 v232, v232
    v_mfma_f32_16x16x32_bf16 v[160:163], a[236:239], a[16:19], v[160:163]
    s_add_u32 s50, s61, 1114112
    s_add_u32 m0, s67, 4224
    ds_read_b64_tr_b16 a[248:249], v248 offset:200
    ds_read_b64_tr_b16 a[250:251], v248 offset:712
    v_mfma_f32_16x16x32_bf16 v[164:167], a[236:239], a[20:23], v[164:167]
    buffer_load_dwordx4 v255, s[20:23], s50 offen lds
    v_mfma_f32_16x16x32_bf16 v[168:171], a[236:239], a[24:27], v[168:171]
    v_exp_f32 v233, v233
    v_mfma_f32_16x16x32_bf16 v[172:175], a[236:239], a[28:31], v[172:175]
    v_exp_f32 v234, v234
    v_mfma_f32_16x16x32_bf16 v[176:179], a[240:243], a[16:19], v[176:179]
    s_add_u32 s50, s61, 1122304
    s_add_u32 m0, s67, 5280
    ds_read_b64_tr_b16 a[236:237], v248 offset:33792
    ds_read_b64_tr_b16 a[238:239], v248 offset:34304
    v_mfma_f32_16x16x32_bf16 v[180:183], a[240:243], a[20:23], v[180:183]
    buffer_load_dwordx4 v255, s[20:23], s50 offen lds
    v_mfma_f32_16x16x32_bf16 v[184:187], a[240:243], a[24:27], v[184:187]
    v_exp_f32 v235, v235
    v_add_f32 v232, 1.0, v232
    v_mfma_f32_16x16x32_bf16 v[188:191], a[240:243], a[28:31], v[188:191]
    s_waitcnt lgkmcnt(2)
    v_add_f32 v233, 1.0, v233
    v_add_f32 v234, 1.0, v234
    v_add_f32 v235, 1.0, v235
    v_mfma_f32_16x16x32_bf16 v[192:195], a[244:247], a[16:19], v[192:195]
    s_add_u32 s50, s61, 1130496
    s_add_u32 m0, s67, 6336
    ds_read_b64_tr_b16 a[240:241], v248 offset:33800
    ds_read_b64_tr_b16 a[242:243], v248 offset:34312
    v_mfma_f32_16x16x32_bf16 v[196:199], a[244:247], a[20:23], v[196:199]
    buffer_load_dwordx4 v255, s[20:23], s50 offen lds
    v_mfma_f32_16x16x32_bf16 v[200:203], a[244:247], a[24:27], v[200:203]
    v_rcp_f32 v232, v232
    v_mfma_f32_16x16x32_bf16 v[204:207], a[244:247], a[28:31], v[204:207]
    v_rcp_f32 v233, v233
    v_mfma_f32_16x16x32_bf16 v[208:211], a[248:251], a[16:19], v[208:211]
    s_add_u32 s50, s61, 1138688
    s_add_u32 m0, s67, 7392
    ds_read_b64_tr_b16 a[244:245], v248 offset:33856
    ds_read_b64_tr_b16 a[246:247], v248 offset:34368
    v_mfma_f32_16x16x32_bf16 v[212:215], a[248:251], a[20:23], v[212:215]
    buffer_load_dwordx4 v255, s[20:23], s50 offen lds
    v_mfma_f32_16x16x32_bf16 v[216:219], a[248:251], a[24:27], v[216:219]
    v_rcp_f32 v234, v234
    v_mfma_f32_16x16x32_bf16 v[220:223], a[248:251], a[28:31], v[220:223]
    v_rcp_f32 v235, v235
    v_mul_f32 v4, v4, v232
    s_waitcnt vmcnt(8)
    s_barrier
    s_waitcnt lgkmcnt(2)
    v_mfma_f32_16x16x32_bf16 v[96:99], a[236:239], a[32:35], v[96:99]
    s_add_u32 s50, s61, 1310720
    s_add_u32 m0, s64, 0
    ds_read_b64_tr_b16 a[248:249], v248 offset:33864
    ds_read_b64_tr_b16 a[250:251], v248 offset:34376
    v_mul_f32 v5, v5, v233
    v_mfma_f32_16x16x32_bf16 v[100:103], a[236:239], a[36:39], v[100:103]
    buffer_load_dwordx4 v255, s[20:23], s50 offen lds
    v_mul_f32 v6, v6, v234
    v_mfma_f32_16x16x32_bf16 v[104:107], a[236:239], a[40:43], v[104:107]
    v_mul_f32 v7, v7, v235
    v_cvt_pk_bf16_f32 v68, v4, v5
    v_cvt_pk_bf16_f32 v69, v6, v7
    v_mfma_f32_16x16x32_bf16 v[108:111], a[236:239], a[44:47], v[108:111]
    v_fma_f32 v8, v8, v229, v240
    v_fma_f32 v9, v9, v229, v241
    v_fma_f32 v10, v10, v229, v242
    v_mfma_f32_16x16x32_bf16 v[112:115], a[240:243], a[32:35], v[112:115]
    s_add_u32 s50, s61, 1318912
    s_add_u32 m0, s64, 1056
    ds_read_b64_tr_b16 a[236:237], v248 offset:33920
    ds_read_b64_tr_b16 a[238:239], v248 offset:34432
    v_fma_f32 v11, v11, v229, v243
    v_mfma_f32_16x16x32_bf16 v[116:119], a[240:243], a[36:39], v[116:119]
    buffer_load_dwordx4 v255, s[20:23], s50 offen lds
    v_mul_f32 v232, v8, v8
    v_mfma_f32_16x16x32_bf16 v[120:123], a[240:243], a[40:43], v[120:123]
    v_mul_f32 v233, v9, v9
    v_mul_f32 v234, v10, v10
    v_mul_f32 v235, v11, v11
    v_mfma_f32_16x16x32_bf16 v[124:127], a[240:243], a[44:47], v[124:127]
    s_waitcnt lgkmcnt(2)
    v_fma_f32 v232, v232, s100, v239
    v_fma_f32 v233, v233, s100, v239
    v_fma_f32 v234, v234, s100, v239
    v_mfma_f32_16x16x32_bf16 v[128:131], a[244:247], a[32:35], v[128:131]
    s_add_u32 s50, s61, 1327104
    s_add_u32 m0, s64, 2112
    ds_read_b64_tr_b16 a[240:241], v248 offset:33928
    ds_read_b64_tr_b16 a[242:243], v248 offset:34440
    v_fma_f32 v235, v235, s100, v239
    v_mfma_f32_16x16x32_bf16 v[132:135], a[244:247], a[36:39], v[132:135]
    buffer_load_dwordx4 v255, s[20:23], s50 offen lds
    v_mul_f32 v232, v232, v8
    v_mfma_f32_16x16x32_bf16 v[136:139], a[244:247], a[40:43], v[136:139]
    v_mul_f32 v233, v233, v9
    v_mul_f32 v234, v234, v10
    v_mul_f32 v235, v235, v11
    v_mfma_f32_16x16x32_bf16 v[140:143], a[244:247], a[44:47], v[140:143]
    v_exp_f32 v232, v232
    v_mfma_f32_16x16x32_bf16 v[144:147], a[248:251], a[32:35], v[144:147]
    s_add_u32 s50, s61, 1335296
    s_add_u32 m0, s64, 3168
    ds_read_b64_tr_b16 a[244:245], v248 offset:33984
    ds_read_b64_tr_b16 a[246:247], v248 offset:34496
    v_mfma_f32_16x16x32_bf16 v[148:151], a[248:251], a[36:39], v[148:151]
    buffer_load_dwordx4 v255, s[20:23], s50 offen lds
    v_mfma_f32_16x16x32_bf16 v[152:155], a[248:251], a[40:43], v[152:155]
    v_exp_f32 v233, v233
    v_mfma_f32_16x16x32_bf16 v[156:159], a[248:251], a[44:47], v[156:159]
    s_waitcnt lgkmcnt(2)
    v_exp_f32 v234, v234
    v_mfma_f32_16x16x32_bf16 v[160:163], a[236:239], a[32:35], v[160:163]
    s_add_u32 s50, s61, 1376256
    s_add_u32 m0, s64, 4224
    ds_read_b64_tr_b16 a[248:249], v248 offset:33992
    ds_read_b64_tr_b16 a[250:251], v248 offset:34504
    v_mfma_f32_16x16x32_bf16 v[164:167], a[236:239], a[36:39], v[164:167]
    buffer_load_dwordx4 v255, s[20:23], s50 offen lds
    v_mfma_f32_16x16x32_bf16 v[168:171], a[236:239], a[40:43], v[168:171]
    v_exp_f32 v235, v235
    v_add_f32 v232, 1.0, v232
    v_mfma_f32_16x16x32_bf16 v[172:175], a[236:239], a[44:47], v[172:175]
    v_add_f32 v233, 1.0, v233
    v_add_f32 v234, 1.0, v234
    v_add_f32 v235, 1.0, v235
    v_mfma_f32_16x16x32_bf16 v[176:179], a[240:243], a[32:35], v[176:179]
    s_add_u32 s50, s61, 1384448
    s_add_u32 m0, s64, 5280
    ds_read_b64_tr_b16 a[236:237], v249 offset:0
    ds_read_b64_tr_b16 a[238:239], v249 offset:512
    v_mfma_f32_16x16x32_bf16 v[180:183], a[240:243], a[36:39], v[180:183]
    buffer_load_dwordx4 v255, s[20:23], s50 offen lds
    v_mfma_f32_16x16x32_bf16 v[184:187], a[240:243], a[40:43], v[184:187]
    v_rcp_f32 v232, v232
    v_mfma_f32_16x16x32_bf16 v[188:191], a[240:243], a[44:47], v[188:191]
    s_waitcnt lgkmcnt(2)
    v_rcp_f32 v233, v233
    v_mfma_f32_16x16x32_bf16 v[192:195], a[244:247], a[32:35], v[192:195]
    s_add_u32 s50, s61, 1392640
    s_add_u32 m0, s64, 6336
    ds_read_b64_tr_b16 a[240:241], v249 offset:8
    ds_read_b64_tr_b16 a[242:243], v249 offset:520
    v_mfma_f32_16x16x32_bf16 v[196:199], a[244:247], a[36:39], v[196:199]
    buffer_load_dwordx4 v255, s[20:23], s50 offen lds
    v_mfma_f32_16x16x32_bf16 v[200:203], a[244:247], a[40:43], v[200:203]
    v_rcp_f32 v234, v234
    v_mfma_f32_16x16x32_bf16 v[204:207], a[244:247], a[44:47], v[204:207]
    v_rcp_f32 v235, v235
    v_mul_f32 v8, v8, v232
    v_mfma_f32_16x16x32_bf16 v[208:211], a[248:251], a[32:35], v[208:211]
    s_add_u32 s50, s61, 1400832
    s_add_u32 m0, s64, 7392
    ds_read_b64_tr_b16 a[244:245], v249 offset:64
    ds_read_b64_tr_b16 a[246:247], v249 offset:576
    v_mul_f32 v9, v9, v233
    v_mfma_f32_16x16x32_bf16 v[212:215], a[248:251], a[36:39], v[212:215]
    buffer_load_dwordx4 v255, s[20:23], s50 offen lds
    v_mul_f32 v10, v10, v234
    v_mfma_f32_16x16x32_bf16 v[216:219], a[248:251], a[40:43], v[216:219]
    v_mul_f32 v11, v11, v235
    v_cvt_pk_bf16_f32 v72, v8, v9
    v_cvt_pk_bf16_f32 v73, v10, v11
    v_mfma_f32_16x16x32_bf16 v[220:223], a[248:251], a[44:47], v[220:223]
    v_fma_f32 v12, v12, v231, v240
    v_fma_f32 v13, v13, v231, v241
    v_fma_f32 v14, v14, v231, v242
    s_waitcnt vmcnt(8)
    s_barrier
    s_waitcnt lgkmcnt(2)
    v_mfma_f32_16x16x32_bf16 v[96:99], a[236:239], a[48:51], v[96:99]
    s_add_u32 s50, s61, 1572864
    s_add_u32 m0, s65, 0
    ds_read_b64_tr_b16 a[248:249], v249 offset:72
    ds_read_b64_tr_b16 a[250:251], v249 offset:584
    v_fma_f32 v15, v15, v231, v243
    v_mfma_f32_16x16x32_bf16 v[100:103], a[236:239], a[52:55], v[100:103]
    buffer_load_dwordx4 v255, s[20:23], s50 offen lds
    v_mul_f32 v232, v12, v12
    v_mfma_f32_16x16x32_bf16 v[104:107], a[236:239], a[56:59], v[104:107]
    v_mul_f32 v233, v13, v13
    v_mul_f32 v234, v14, v14
    v_mul_f32 v235, v15, v15
    v_mfma_f32_16x16x32_bf16 v[108:111], a[236:239], a[60:63], v[108:111]
    v_fma_f32 v232, v232, s100, v239
    v_fma_f32 v233, v233, s100, v239
    v_fma_f32 v234, v234, s100, v239
    v_mfma_f32_16x16x32_bf16 v[112:115], a[240:243], a[48:51], v[112:115]
    s_add_u32 s50, s61, 1581056
    s_add_u32 m0, s65, 1056
    ds_read_b64_tr_b16 a[236:237], v249 offset:128
    ds_read_b64_tr_b16 a[238:239], v249 offset:640
    v_fma_f32 v235, v235, s100, v239
    v_mfma_f32_16x16x32_bf16 v[116:119], a[240:243], a[52:55], v[116:119]
    buffer_load_dwordx4 v255, s[20:23], s50 offen lds
    v_mul_f32 v232, v232, v12
    v_mfma_f32_16x16x32_bf16 v[120:123], a[240:243], a[56:59], v[120:123]
    v_mul_f32 v233, v233, v13
    v_mul_f32 v234, v234, v14
    v_mul_f32 v235, v235, v15
    v_mfma_f32_16x16x32_bf16 v[124:127], a[240:243], a[60:63], v[124:127]
    s_waitcnt lgkmcnt(2)
    v_exp_f32 v232, v232
    v_mfma_f32_16x16x32_bf16 v[128:131], a[244:247], a[48:51], v[128:131]
    s_add_u32 s50, s61, 1589248
    s_add_u32 m0, s65, 2112
    ds_read_b64_tr_b16 a[240:241], v249 offset:136
    ds_read_b64_tr_b16 a[242:243], v249 offset:648
    v_mfma_f32_16x16x32_bf16 v[132:135], a[244:247], a[52:55], v[132:135]
    buffer_load_dwordx4 v255, s[20:23], s50 offen lds
    v_mfma_f32_16x16x32_bf16 v[136:139], a[244:247], a[56:59], v[136:139]
    v_exp_f32 v233, v233
    v_mfma_f32_16x16x32_bf16 v[140:143], a[244:247], a[60:63], v[140:143]
    v_exp_f32 v234, v234
    v_mfma_f32_16x16x32_bf16 v[144:147], a[248:251], a[48:51], v[144:147]
    s_add_u32 s50, s61, 1597440
    s_add_u32 m0, s65, 3168
    ds_read_b64_tr_b16 a[244:245], v249 offset:192
    ds_read_b64_tr_b16 a[246:247], v249 offset:704
    v_mfma_f32_16x16x32_bf16 v[148:151], a[248:251], a[52:55], v[148:151]
    buffer_load_dwordx4 v255, s[20:23], s50 offen lds
    v_mfma_f32_16x16x32_bf16 v[152:155], a[248:251], a[56:59], v[152:155]
    v_exp_f32 v235, v235
    v_add_f32 v232, 1.0, v232
    v_mfma_f32_16x16x32_bf16 v[156:159], a[248:251], a[60:63], v[156:159]
    s_waitcnt lgkmcnt(2)
    v_add_f32 v233, 1.0, v233
    v_add_f32 v234, 1.0, v234
    v_add_f32 v235, 1.0, v235
    v_mfma_f32_16x16x32_bf16 v[160:163], a[236:239], a[48:51], v[160:163]
    s_add_u32 s50, s61, 1638400
    s_add_u32 m0, s65, 4224
    ds_read_b64_tr_b16 a[248:249], v249 offset:200
    ds_read_b64_tr_b16 a[250:251], v249 offset:712
    v_mfma_f32_16x16x32_bf16 v[164:167], a[236:239], a[52:55], v[164:167]
    buffer_load_dwordx4 v255, s[20:23], s50 offen lds
    v_mfma_f32_16x16x32_bf16 v[168:171], a[236:239], a[56:59], v[168:171]
    v_rcp_f32 v232, v232
    v_mfma_f32_16x16x32_bf16 v[172:175], a[236:239], a[60:63], v[172:175]
    v_rcp_f32 v233, v233
    v_mfma_f32_16x16x32_bf16 v[176:179], a[240:243], a[48:51], v[176:179]
    s_add_u32 s50, s61, 1646592
    s_add_u32 m0, s65, 5280
    ds_read_b64_tr_b16 a[236:237], v249 offset:33792
    ds_read_b64_tr_b16 a[238:239], v249 offset:34304
    v_mfma_f32_16x16x32_bf16 v[180:183], a[240:243], a[52:55], v[180:183]
    buffer_load_dwordx4 v255, s[20:23], s50 offen lds
    v_mfma_f32_16x16x32_bf16 v[184:187], a[240:243], a[56:59], v[184:187]
    v_rcp_f32 v234, v234
    v_mfma_f32_16x16x32_bf16 v[188:191], a[240:243], a[60:63], v[188:191]
    s_waitcnt lgkmcnt(2)
    v_rcp_f32 v235, v235
    v_mul_f32 v12, v12, v232
    v_mfma_f32_16x16x32_bf16 v[192:195], a[244:247], a[48:51], v[192:195]
    s_add_u32 s50, s61, 1654784
    s_add_u32 m0, s65, 6336
    ds_read_b64_tr_b16 a[240:241], v249 offset:33800
    ds_read_b64_tr_b16 a[242:243], v249 offset:34312
    v_mul_f32 v13, v13, v233
    v_mfma_f32_16x16x32_bf16 v[196:199], a[244:247], a[52:55], v[196:199]
    buffer_load_dwordx4 v255, s[20:23], s50 offen lds
    v_mul_f32 v14, v14, v234
    v_mfma_f32_16x16x32_bf16 v[200:203], a[244:247], a[56:59], v[200:203]
    v_mul_f32 v15, v15, v235
    v_cvt_pk_bf16_f32 v76, v12, v13
    v_cvt_pk_bf16_f32 v77, v14, v15
    v_mfma_f32_16x16x32_bf16 v[204:207], a[244:247], a[60:63], v[204:207]
    v_accvgpr_read_b32 v232, a226
    v_accvgpr_read_b32 v233, a227
    s_nop 0
    v_lshlrev_b32 v240, 16, v232
    v_mfma_f32_16x16x32_bf16 v[208:211], a[248:251], a[48:51], v[208:211]
    s_add_u32 s50, s61, 1662976
    s_add_u32 m0, s65, 7392
    ds_read_b64_tr_b16 a[244:245], v249 offset:33856
    ds_read_b64_tr_b16 a[246:247], v249 offset:34368
    v_and_b32 v241, 0xffff0000, v232
    v_mfma_f32_16x16x32_bf16 v[212:215], a[248:251], a[52:55], v[212:215]
    buffer_load_dwordx4 v255, s[20:23], s50 offen lds
    v_lshlrev_b32 v242, 16, v233
    v_mfma_f32_16x16x32_bf16 v[216:219], a[248:251], a[56:59], v[216:219]
    v_and_b32 v243, 0xffff0000, v233
    v_fma_f32 v16, v16, v225, v240
    v_fma_f32 v17, v17, v225, v241
    v_mfma_f32_16x16x32_bf16 v[220:223], a[248:251], a[60:63], v[220:223]
    v_fma_f32 v18, v18, v225, v242
    v_fma_f32 v19, v19, v225, v243
    v_mul_f32 v232, v16, v16
    s_waitcnt vmcnt(8)
    s_barrier
    s_waitcnt lgkmcnt(2)
    v_mfma_f32_16x16x32_bf16 v[96:99], a[236:239], a[64:67], v[96:99]
    s_add_u32 s50, s61, 1835008
    s_add_u32 m0, s66, 0
    ds_read_b64_tr_b16 a[248:249], v249 offset:33864
    ds_read_b64_tr_b16 a[250:251], v249 offset:34376
    v_mul_f32 v233, v17, v17
    v_mfma_f32_16x16x32_bf16 v[100:103], a[236:239], a[68:71], v[100:103]
    buffer_load_dwordx4 v255, s[20:23], s50 offen lds
    v_mul_f32 v234, v18, v18
    v_mfma_f32_16x16x32_bf16 v[104:107], a[236:239], a[72:75], v[104:107]
    v_mul_f32 v235, v19, v19
    v_fma_f32 v232, v232, s100, v239
    v_fma_f32 v233, v233, s100, v239
    v_mfma_f32_16x16x32_bf16 v[108:111], a[236:239], a[76:79], v[108:111]
    v_fma_f32 v234, v234, s100, v239
    v_fma_f32 v235, v235, s100, v239
    v_mul_f32 v232, v232, v16
    v_mfma_f32_16x16x32_bf16 v[112:115], a[240:243], a[64:67], v[112:115]
    s_add_u32 s50, s61, 1843200
    s_add_u32 m0, s66, 1056
    ds_read_b64_tr_b16 a[236:237], v249 offset:33920
    ds_read_b64_tr_b16 a[238:239], v249 offset:34432
    v_mul_f32 v233, v233, v17
    v_mfma_f32_16x16x32_bf16 v[116:119], a[240:243], a[68:71], v[116:119]
    buffer_load_dwordx4 v255, s[20:23], s50 offen lds
    v_mul_f32 v234, v234, v18
    v_mfma_f32_16x16x32_bf16 v[120:123], a[240:243], a[72:75], v[120:123]
    v_mul_f32 v235, v235, v19
    v_exp_f32 v232, v232
    v_mfma_f32_16x16x32_bf16 v[124:127], a[240:243], a[76:79], v[124:127]
    s_waitcnt lgkmcnt(2)
    v_exp_f32 v233, v233
    v_mfma_f32_16x16x32_bf16 v[128:131], a[244:247], a[64:67], v[128:131]
    s_add_u32 s50, s61, 1851392
    s_add_u32 m0, s66, 2112
    ds_read_b64_tr_b16 a[240:241], v249 offset:33928
    ds_read_b64_tr_b16 a[242:243], v249 offset:34440
    v_mfma_f32_16x16x32_bf16 v[132:135], a[244:247], a[68:71], v[132:135]
    buffer_load_dwordx4 v255, s[20:23], s50 offen lds
    v_mfma_f32_16x16x32_bf16 v[136:139], a[244:247], a[72:75], v[136:139]
    v_exp_f32 v234, v234
    v_mfma_f32_16x16x32_bf16 v[140:143], a[244:247], a[76:79], v[140:143]
    v_exp_f32 v235, v235
    v_add_f32 v232, 1.0, v232
    v_mfma_f32_16x16x32_bf16 v[144:147], a[248:251], a[64:67], v[144:147]
    s_add_u32 s50, s61, 1859584
    s_add_u32 m0, s66, 3168
    ds_read_b64_tr_b16 a[244:245], v249 offset:33984
    ds_read_b64_tr_b16 a[246:247], v249 offset:34496
    v_add_f32 v233, 1.0, v233
    v_mfma_f32_16x16x32_bf16 v[148:151], a[248:251], a[68:71], v[148:151]
    buffer_load_dwordx4 v255, s[20:23], s50 offen lds
    v_add_f32 v234, 1.0, v234
    v_mfma_f32_16x16x32_bf16 v[152:155], a[248:251], a[72:75], v[152:155]
    v_add_f32 v235, 1.0, v235
    v_rcp_f32 v232, v232
    v_mfma_f32_16x16x32_bf16 v[156:159], a[248:251], a[76:79], v[156:159]
    s_waitcnt lgkmcnt(2)
    v_rcp_f32 v233, v233
    v_mfma_f32_16x16x32_bf16 v[160:163], a[236:239], a[64:67], v[160:163]
    s_add_u32 s50, s61, 1900544
    s_add_u32 m0, s66, 4224
    ds_read_b64_tr_b16 a[248:249], v249 offset:33992
    ds_read_b64_tr_b16 a[250:251], v249 offset:34504
    v_mfma_f32_16x16x32_bf16 v[164:167], a[236:239], a[68:71], v[164:167]
    buffer_load_dwordx4 v255, s[20:23], s50 offen lds
    v_mfma_f32_16x16x32_bf16 v[168:171], a[236:239], a[72:75], v[168:171]
    v_rcp_f32 v234, v234
    v_mfma_f32_16x16x32_bf16 v[172:175], a[236:239], a[76:79], v[172:175]
    v_rcp_f32 v235, v235
    v_mul_f32 v16, v16, v232
    v_mfma_f32_16x16x32_bf16 v[176:179], a[240:243], a[64:67], v[176:179]
    s_add_u32 s50, s61, 1908736
    s_add_u32 m0, s66, 5280
    ds_read_b64_tr_b16 a[236:237], v248 offset:0
    ds_read_b64_tr_b16 a[238:239], v248 offset:512
    v_mul_f32 v17, v17, v233
    v_mfma_f32_16x16x32_bf16 v[180:183], a[240:243], a[68:71], v[180:183]
    buffer_load_dwordx4 v255, s[20:23], s50 offen lds
    v_mul_f32 v18, v18, v234
    v_mfma_f32_16x16x32_bf16 v[184:187], a[240:243], a[72:75], v[184:187]
    v_mul_f32 v19, v19, v235
    v_cvt_pk_bf16_f32 v66, v16, v17
    v_cvt_pk_bf16_f32 v67, v18, v19
    v_mfma_f32_16x16x32_bf16 v[188:191], a[240:243], a[76:79], v[188:191]
    s_waitcnt lgkmcnt(2)
    v_fma_f32 v20, v20, v227, v240
    v_fma_f32 v21, v21, v227, v241
    v_fma_f32 v22, v22, v227, v242
    v_mfma_f32_16x16x32_bf16 v[192:195], a[244:247], a[64:67], v[192:195]
    s_add_u32 s50, s61, 1916928
    s_add_u32 m0, s66, 6336
    ds_read_b64_tr_b16 a[240:241], v248 offset:8
    ds_read_b64_tr_b16 a[242:243], v248 offset:520
    v_fma_f32 v23, v23, v227, v243
    v_mfma_f32_16x16x32_bf16 v[196:199], a[244:247], a[68:71], v[196:199]
    buffer_load_dwordx4 v255, s[20:23], s50 offen lds
    v_mul_f32 v232, v20, v20
    v_mfma_f32_16x16x32_bf16 v[200:203], a[244:247], a[72:75], v[200:203]
    v_mul_f32 v233, v21, v21
    v_mul_f32 v234, v22, v22
    v_mul_f32 v235, v23, v23
    v_mfma_f32_16x16x32_bf16 v[204:207], a[244:247], a[76:79], v[204:207]
    v_fma_f32 v232, v232, s100, v239
    v_fma_f32 v233, v233, s100, v239
    v_fma_f32 v234, v234, s100, v239
    v_mfma_f32_16x16x32_bf16 v[208:211], a[248:251], a[64:67], v[208:211]
    s_add_u32 s50, s61, 1925120
    s_add_u32 m0, s66, 7392
    ds_read_b64_tr_b16 a[244:245], v248 offset:64
    ds_read_b64_tr_b16 a[246:247], v248 offset:576
    v_fma_f32 v235, v235, s100, v239
    v_mfma_f32_16x16x32_bf16 v[212:215], a[248:251], a[68:71], v[212:215]
    buffer_load_dwordx4 v255, s[20:23], s50 offen lds
    v_mul_f32 v232, v232, v20
    v_mfma_f32_16x16x32_bf16 v[216:219], a[248:251], a[72:75], v[216:219]
    v_mul_f32 v233, v233, v21
    v_mul_f32 v234, v234, v22
    v_mul_f32 v235, v235, v23
    v_mfma_f32_16x16x32_bf16 v[220:223], a[248:251], a[76:79], v[220:223]
    v_exp_f32 v232, v232
    s_waitcnt vmcnt(8)
    s_barrier
    s_waitcnt lgkmcnt(2)
    v_mfma_f32_16x16x32_bf16 v[96:99], a[236:239], a[80:83], v[96:99]
    s_add_u32 s50, s61, 2097152
    s_add_u32 m0, s67, 0
    ds_read_b64_tr_b16 a[248:249], v248 offset:72
    ds_read_b64_tr_b16 a[250:251], v248 offset:584
    v_mfma_f32_16x16x32_bf16 v[100:103], a[236:239], a[84:87], v[100:103]
    buffer_load_dwordx4 v255, s[20:23], s50 offen lds
    v_mfma_f32_16x16x32_bf16 v[104:107], a[236:239], a[88:91], v[104:107]
    v_exp_f32 v233, v233
    v_mfma_f32_16x16x32_bf16 v[108:111], a[236:239], a[92:95], v[108:111]
    v_exp_f32 v234, v234
    v_mfma_f32_16x16x32_bf16 v[112:115], a[240:243], a[80:83], v[112:115]
    s_add_u32 s50, s61, 2105344
    s_add_u32 m0, s67, 1056
    ds_read_b64_tr_b16 a[236:237], v248 offset:128
    ds_read_b64_tr_b16 a[238:239], v248 offset:640
    v_mfma_f32_16x16x32_bf16 v[116:119], a[240:243], a[84:87], v[116:119]
    buffer_load_dwordx4 v255, s[20:23], s50 offen lds
    v_mfma_f32_16x16x32_bf16 v[120:123], a[240:243], a[88:91], v[120:123]
    v_exp_f32 v235, v235
    v_add_f32 v232, 1.0, v232
    v_mfma_f32_16x16x32_bf16 v[124:127], a[240:243], a[92:95], v[124:127]
    s_waitcnt lgkmcnt(2)
    v_add_f32 v233, 1.0, v233
    v_add_f32 v234, 1.0, v234
    v_add_f32 v235, 1.0, v235
    v_mfma_f32_16x16x32_bf16 v[128:131], a[244:247], a[80:83], v[128:131]
    s_add_u32 s50, s61, 2113536
    s_add_u32 m0, s67, 2112
    ds_read_b64_tr_b16 a[240:241], v248 offset:136
    ds_read_b64_tr_b16 a[242:243], v248 offset:648
    v_mfma_f32_16x16x32_bf16 v[132:135], a[244:247], a[84:87], v[132:135]
    buffer_load_dwordx4 v255, s[20:23], s50 offen lds
    v_mfma_f32_16x16x32_bf16 v[136:139], a[244:247], a[88:91], v[136:139]
    v_rcp_f32 v232, v232
    v_mfma_f32_16x16x32_bf16 v[140:143], a[244:247], a[92:95], v[140:143]
    v_rcp_f32 v233, v233
    v_mfma_f32_16x16x32_bf16 v[144:147], a[248:251], a[80:83], v[144:147]
    s_add_u32 s50, s61, 2121728
    s_add_u32 m0, s67, 3168
    ds_read_b64_tr_b16 a[244:245], v248 offset:192
    ds_read_b64_tr_b16 a[246:247], v248 offset:704
    v_mfma_f32_16x16x32_bf16 v[148:151], a[248:251], a[84:87], v[148:151]
    buffer_load_dwordx4 v255, s[20:23], s50 offen lds
    v_mfma_f32_16x16x32_bf16 v[152:155], a[248:251], a[88:91], v[152:155]
    v_rcp_f32 v234, v234
    v_mfma_f32_16x16x32_bf16 v[156:159], a[248:251], a[92:95], v[156:159]
    s_waitcnt lgkmcnt(2)
    v_rcp_f32 v235, v235
    v_mul_f32 v20, v20, v232
    v_mfma_f32_16x16x32_bf16 v[160:163], a[236:239], a[80:83], v[160:163]
    s_add_u32 s50, s61, 2162688
    s_add_u32 m0, s67, 4224
    ds_read_b64_tr_b16 a[248:249], v248 offset:200
    ds_read_b64_tr_b16 a[250:251], v248 offset:712
    v_mul_f32 v21, v21, v233
    v_mfma_f32_16x16x32_bf16 v[164:167], a[236:239], a[84:87], v[164:167]
    buffer_load_dwordx4 v255, s[20:23], s50 offen lds
    v_mul_f32 v22, v22, v234
    v_mfma_f32_16x16x32_bf16 v[168:171], a[236:239], a[88:91], v[168:171]
    v_mul_f32 v23, v23, v235
    v_cvt_pk_bf16_f32 v70, v20, v21
    v_cvt_pk_bf16_f32 v71, v22, v23
    v_mfma_f32_16x16x32_bf16 v[172:175], a[236:239], a[92:95], v[172:175]
    v_fma_f32 v24, v24, v229, v240
    v_fma_f32 v25, v25, v229, v241
    v_fma_f32 v26, v26, v229, v242
    v_mfma_f32_16x16x32_bf16 v[176:179], a[240:243], a[80:83], v[176:179]
    s_add_u32 s50, s61, 2170880
    s_add_u32 m0, s67, 5280
    ds_read_b64_tr_b16 a[236:237], v248 offset:33792
    ds_read_b64_tr_b16 a[238:239], v248 offset:34304
    v_fma_f32 v27, v27, v229, v243
    v_mfma_f32_16x16x32_bf16 v[180:183], a[240:243], a[84:87], v[180:183]
    buffer_load_dwordx4 v255, s[20:23], s50 offen lds
    v_mul_f32 v232, v24, v24
    v_mfma_f32_16x16x32_bf16 v[184:187], a[240:243], a[88:91], v[184:187]
    v_mul_f32 v233, v25, v25
    v_mul_f32 v234, v26, v26
    v_mul_f32 v235, v27, v27
    v_mfma_f32_16x16x32_bf16 v[188:191], a[240:243], a[92:95], v[188:191]
    s_waitcnt lgkmcnt(2)
    v_fma_f32 v232, v232, s100, v239
    v_fma_f32 v233, v233, s100, v239
    v_fma_f32 v234, v234, s100, v239
    v_mfma_f32_16x16x32_bf16 v[192:195], a[244:247], a[80:83], v[192:195]
    s_add_u32 s50, s61, 2179072
    s_add_u32 m0, s67, 6336
    ds_read_b64_tr_b16 a[240:241], v248 offset:33800
    ds_read_b64_tr_b16 a[242:243], v248 offset:34312
    v_fma_f32 v235, v235, s100, v239
    v_mfma_f32_16x16x32_bf16 v[196:199], a[244:247], a[84:87], v[196:199]
    buffer_load_dwordx4 v255, s[20:23], s50 offen lds
    v_mul_f32 v232, v232, v24
    v_mfma_f32_16x16x32_bf16 v[200:203], a[244:247], a[88:91], v[200:203]
    v_mul_f32 v233, v233, v25
    v_mul_f32 v234, v234, v26
    v_mul_f32 v235, v235, v27
    v_mfma_f32_16x16x32_bf16 v[204:207], a[244:247], a[92:95], v[204:207]
    v_exp_f32 v232, v232
    v_mfma_f32_16x16x32_bf16 v[208:211], a[248:251], a[80:83], v[208:211]
    s_add_u32 s50, s61, 2187264
    s_add_u32 m0, s67, 7392
    ds_read_b64_tr_b16 a[244:245], v248 offset:33856
    ds_read_b64_tr_b16 a[246:247], v248 offset:34368
    v_mfma_f32_16x16x32_bf16 v[212:215], a[248:251], a[84:87], v[212:215]
    buffer_load_dwordx4 v255, s[20:23], s50 offen lds
    v_mfma_f32_16x16x32_bf16 v[216:219], a[248:251], a[88:91], v[216:219]
    v_exp_f32 v233, v233
    v_mfma_f32_16x16x32_bf16 v[220:223], a[248:251], a[92:95], v[220:223]
    v_exp_f32 v234, v234
    s_waitcnt vmcnt(8)
    s_barrier
    s_waitcnt lgkmcnt(2)
    v_mfma_f32_16x16x32_bf16 v[96:99], a[236:239], a[96:99], v[96:99]
    s_add_u32 s50, s61, 2359296
    s_add_u32 m0, s64, 0
    ds_read_b64_tr_b16 a[248:249], v248 offset:33864
    ds_read_b64_tr_b16 a[250:251], v248 offset:34376
    v_mfma_f32_16x16x32_bf16 v[100:103], a[236:239], a[100:103], v[100:103]
    buffer_load_dwordx4 v255, s[20:23], s50 offen lds
    v_mfma_f32_16x16x32_bf16 v[104:107], a[236:239], a[104:107], v[104:107]
    v_exp_f32 v235, v235
    v_add_f32 v232, 1.0, v232
    v_mfma_f32_16x16x32_bf16 v[108:111], a[236:239], a[108:111], v[108:111]
    v_add_f32 v233, 1.0, v233
    v_add_f32 v234, 1.0, v234
    v_add_f32 v235, 1.0, v235
    v_mfma_f32_16x16x32_bf16 v[112:115], a[240:243], a[96:99], v[112:115]
    s_add_u32 s50, s61, 2367488
    s_add_u32 m0, s64, 1056
    ds_read_b64_tr_b16 a[236:237], v248 offset:33920
    ds_read_b64_tr_b16 a[238:239], v248 offset:34432
    v_mfma_f32_16x16x32_bf16 v[116:119], a[240:243], a[100:103], v[116:119]
    buffer_load_dwordx4 v255, s[20:23], s50 offen lds
    v_mfma_f32_16x16x32_bf16 v[120:123], a[240:243], a[104:107], v[120:123]
    v_rcp_f32 v232, v232
    v_mfma_f32_16x16x32_bf16 v[124:127], a[240:243], a[108:111], v[124:127]
    s_waitcnt lgkmcnt(2)
    v_rcp_f32 v233, v233
    v_mfma_f32_16x16x32_bf16 v[128:131], a[244:247], a[96:99], v[128:131]
    s_add_u32 s50, s61, 2375680
    s_add_u32 m0, s64, 2112
    ds_read_b64_tr_b16 a[240:241], v248 offset:33928
    ds_read_b64_tr_b16 a[242:243], v248 offset:34440
    v_mfma_f32_16x16x32_bf16 v[132:135], a[244:247], a[100:103], v[132:135]
    buffer_load_dwordx4 v255, s[20:23], s50 offen lds
    v_mfma_f32_16x16x32_bf16 v[136:139], a[244:247], a[104:107], v[136:139]
    v_rcp_f32 v234, v234
    v_mfma_f32_16x16x32_bf16 v[140:143], a[244:247], a[108:111], v[140:143]
    v_rcp_f32 v235, v235
    v_mul_f32 v24, v24, v232
    v_mfma_f32_16x16x32_bf16 v[144:147], a[248:251], a[96:99], v[144:147]
    s_add_u32 s50, s61, 2383872
    s_add_u32 m0, s64, 3168
    ds_read_b64_tr_b16 a[244:245], v248 offset:33984
    ds_read_b64_tr_b16 a[246:247], v248 offset:34496
    v_mul_f32 v25, v25, v233
    v_mfma_f32_16x16x32_bf16 v[148:151], a[248:251], a[100:103], v[148:151]
    buffer_load_dwordx4 v255, s[20:23], s50 offen lds
    v_mul_f32 v26, v26, v234
    v_mfma_f32_16x16x32_bf16 v[152:155], a[248:251], a[104:107], v[152:155]
    v_mul_f32 v27, v27, v235
    v_cvt_pk_bf16_f32 v74, v24, v25
    v_cvt_pk_bf16_f32 v75, v26, v27
    v_mfma_f32_16x16x32_bf16 v[156:159], a[248:251], a[108:111], v[156:159]
    s_waitcnt lgkmcnt(2)
    v_fma_f32 v28, v28, v231, v240
    v_fma_f32 v29, v29, v231, v241
    v_fma_f32 v30, v30, v231, v242
    v_mfma_f32_16x16x32_bf16 v[160:163], a[236:239], a[96:99], v[160:163]
    s_add_u32 s50, s61, 2424832
    s_add_u32 m0, s64, 4224
    ds_read_b64_tr_b16 a[248:249], v248 offset:33992
    ds_read_b64_tr_b16 a[250:251], v248 offset:34504
    v_fma_f32 v31, v31, v231, v243
    v_mfma_f32_16x16x32_bf16 v[164:167], a[236:239], a[100:103], v[164:167]
    buffer_load_dwordx4 v255, s[20:23], s50 offen lds
    v_mul_f32 v232, v28, v28
    v_mfma_f32_16x16x32_bf16 v[168:171], a[236:239], a[104:107], v[168:171]
    v_mul_f32 v233, v29, v29
    v_mul_f32 v234, v30, v30
    v_mul_f32 v235, v31, v31
    v_mfma_f32_16x16x32_bf16 v[172:175], a[236:239], a[108:111], v[172:175]
    v_fma_f32 v232, v232, s100, v239
    v_fma_f32 v233, v233, s100, v239
    v_fma_f32 v234, v234, s100, v239
    v_mfma_f32_16x16x32_bf16 v[176:179], a[240:243], a[96:99], v[176:179]
    s_add_u32 s50, s61, 2433024
    s_add_u32 m0, s64, 5280
    ds_read_b64_tr_b16 a[236:237], v249 offset:0
    ds_read_b64_tr_b16 a[238:239], v249 offset:512
    v_fma_f32 v235, v235, s100, v239
    v_mfma_f32_16x16x32_bf16 v[180:183], a[240:243], a[100:103], v[180:183]
    buffer_load_dwordx4 v255, s[20:23], s50 offen lds
    v_mul_f32 v232, v232, v28
    v_mfma_f32_16x16x32_bf16 v[184:187], a[240:243], a[104:107], v[184:187]
    v_mul_f32 v233, v233, v29
    v_mul_f32 v234, v234, v30
    v_mul_f32 v235, v235, v31
    v_mfma_f32_16x16x32_bf16 v[188:191], a[240:243], a[108:111], v[188:191]
    s_waitcnt lgkmcnt(2)
    v_exp_f32 v232, v232
    v_mfma_f32_16x16x32_bf16 v[192:195], a[244:247], a[96:99], v[192:195]
    s_add_u32 s50, s61, 2441216
    s_add_u32 m0, s64, 6336
    ds_read_b64_tr_b16 a[240:241], v249 offset:8
    ds_read_b64_tr_b16 a[242:243], v249 offset:520
    v_mfma_f32_16x16x32_bf16 v[196:199], a[244:247], a[100:103], v[196:199]
    buffer_load_dwordx4 v255, s[20:23], s50 offen lds
    v_mfma_f32_16x16x32_bf16 v[200:203], a[244:247], a[104:107], v[200:203]
    v_exp_f32 v233, v233
    v_mfma_f32_16x16x32_bf16 v[204:207], a[244:247], a[108:111], v[204:207]
    v_exp_f32 v234, v234
    v_mfma_f32_16x16x32_bf16 v[208:211], a[248:251], a[96:99], v[208:211]
    s_add_u32 s50, s61, 2449408
    s_add_u32 m0, s64, 7392
    ds_read_b64_tr_b16 a[244:245], v249 offset:64
    ds_read_b64_tr_b16 a[246:247], v249 offset:576
    v_mfma_f32_16x16x32_bf16 v[212:215], a[248:251], a[100:103], v[212:215]
    buffer_load_dwordx4 v255, s[20:23], s50 offen lds
    v_mfma_f32_16x16x32_bf16 v[216:219], a[248:251], a[104:107], v[216:219]
    v_exp_f32 v235, v235
    v_add_f32 v232, 1.0, v232
    v_mfma_f32_16x16x32_bf16 v[220:223], a[248:251], a[108:111], v[220:223]
    v_add_f32 v233, 1.0, v233
    v_add_f32 v234, 1.0, v234
    v_add_f32 v235, 1.0, v235
    s_waitcnt vmcnt(8)
    s_barrier
    s_waitcnt lgkmcnt(2)
    v_mfma_f32_16x16x32_bf16 v[96:99], a[236:239], a[112:115], v[96:99]
    s_add_u32 s50, s61, 2621440
    s_add_u32 m0, s65, 0
    ds_read_b64_tr_b16 a[248:249], v249 offset:72
    ds_read_b64_tr_b16 a[250:251], v249 offset:584
    v_mfma_f32_16x16x32_bf16 v[100:103], a[236:239], a[116:119], v[100:103]
    buffer_load_dwordx4 v255, s[20:23], s50 offen lds
    v_mfma_f32_16x16x32_bf16 v[104:107], a[236:239], a[120:123], v[104:107]
    v_rcp_f32 v232, v232
    v_mfma_f32_16x16x32_bf16 v[108:111], a[236:239], a[124:127], v[108:111]
    v_rcp_f32 v233, v233
    v_mfma_f32_16x16x32_bf16 v[112:115], a[240:243], a[112:115], v[112:115]
    s_add_u32 s50, s61, 2629632
    s_add_u32 m0, s65, 1056
    ds_read_b64_tr_b16 a[236:237], v249 offset:128
    ds_read_b64_tr_b16 a[238:239], v249 offset:640
    v_mfma_f32_16x16x32_bf16 v[116:119], a[240:243], a[116:119], v[116:119]
    buffer_load_dwordx4 v255, s[20:23], s50 offen lds
    v_mfma_f32_16x16x32_bf16 v[120:123], a[240:243], a[120:123], v[120:123]
    v_rcp_f32 v234, v234
    v_mfma_f32_16x16x32_bf16 v[124:127], a[240:243], a[124:127], v[124:127]
    s_waitcnt lgkmcnt(2)
    v_rcp_f32 v235, v235
    v_mul_f32 v28, v28, v232
    v_mfma_f32_16x16x32_bf16 v[128:131], a[244:247], a[112:115], v[128:131]
    s_add_u32 s50, s61, 2637824
    s_add_u32 m0, s65, 2112
    ds_read_b64_tr_b16 a[240:241], v249 offset:136
    ds_read_b64_tr_b16 a[242:243], v249 offset:648
    v_mul_f32 v29, v29, v233
    v_mfma_f32_16x16x32_bf16 v[132:135], a[244:247], a[116:119], v[132:135]
    buffer_load_dwordx4 v255, s[20:23], s50 offen lds
    v_mul_f32 v30, v30, v234
    v_mfma_f32_16x16x32_bf16 v[136:139], a[244:247], a[120:123], v[136:139]
    v_mul_f32 v31, v31, v235
    v_cvt_pk_bf16_f32 v78, v28, v29
    v_cvt_pk_bf16_f32 v79, v30, v31
    v_mfma_f32_16x16x32_bf16 v[140:143], a[244:247], a[124:127], v[140:143]
    v_accvgpr_read_b32 v232, a228
    v_accvgpr_read_b32 v233, a229
    s_nop 0
    v_lshlrev_b32 v240, 16, v232
    v_mfma_f32_16x16x32_bf16 v[144:147], a[248:251], a[112:115], v[144:147]
    s_add_u32 s50, s61, 2646016
    s_add_u32 m0, s65, 3168
    ds_read_b64_tr_b16 a[244:245], v249 offset:192
    ds_read_b64_tr_b16 a[246:247], v249 offset:704
    v_and_b32 v241, 0xffff0000, v232
    v_mfma_f32_16x16x32_bf16 v[148:151], a[248:251], a[116:119], v[148:151]
    buffer_load_dwordx4 v255, s[20:23], s50 offen lds
    v_lshlrev_b32 v242, 16, v233
    v_mfma_f32_16x16x32_bf16 v[152:155], a[248:251], a[120:123], v[152:155]
    v_and_b32 v243, 0xffff0000, v233
    v_fma_f32 v32, v32, v225, v240
    v_fma_f32 v33, v33, v225, v241
    v_mfma_f32_16x16x32_bf16 v[156:159], a[248:251], a[124:127], v[156:159]
    s_waitcnt lgkmcnt(2)
    v_fma_f32 v34, v34, v225, v242
    v_fma_f32 v35, v35, v225, v243
    v_mul_f32 v232, v32, v32
    v_mfma_f32_16x16x32_bf16 v[160:163], a[236:239], a[112:115], v[160:163]
    s_add_u32 s50, s61, 2686976
    s_add_u32 m0, s65, 4224
    ds_read_b64_tr_b16 a[248:249], v249 offset:200
    ds_read_b64_tr_b16 a[250:251], v249 offset:712
    v_mul_f32 v233, v33, v33
    v_mfma_f32_16x16x32_bf16 v[164:167], a[236:239], a[116:119], v[164:167]
    buffer_load_dwordx4 v255, s[20:23], s50 offen lds
    v_mul_f32 v234, v34, v34
    v_mfma_f32_16x16x32_bf16 v[168:171], a[236:239], a[120:123], v[168:171]
    v_mul_f32 v235, v35, v35
    v_fma_f32 v232, v232, s100, v239
    v_fma_f32 v233, v233, s100, v239
    v_mfma_f32_16x16x32_bf16 v[172:175], a[236:239], a[124:127], v[172:175]
    v_fma_f32 v234, v234, s100, v239
    v_fma_f32 v235, v235, s100, v239
    v_mul_f32 v232, v232, v32
    v_mfma_f32_16x16x32_bf16 v[176:179], a[240:243], a[112:115], v[176:179]
    s_add_u32 s50, s61, 2695168
    s_add_u32 m0, s65, 5280
    ds_read_b64_tr_b16 a[236:237], v249 offset:33792
    ds_read_b64_tr_b16 a[238:239], v249 offset:34304
    v_mul_f32 v233, v233, v33
    v_mfma_f32_16x16x32_bf16 v[180:183], a[240:243], a[116:119], v[180:183]
    buffer_load_dwordx4 v255, s[20:23], s50 offen lds
    v_mul_f32 v234, v234, v34
    v_mfma_f32_16x16x32_bf16 v[184:187], a[240:243], a[120:123], v[184:187]
    v_mul_f32 v235, v235, v35
    v_exp_f32 v232, v232
    v_mfma_f32_16x16x32_bf16 v[188:191], a[240:243], a[124:127], v[188:191]
    s_waitcnt lgkmcnt(2)
    v_exp_f32 v233, v233
    v_mfma_f32_16x16x32_bf16 v[192:195], a[244:247], a[112:115], v[192:195]
    s_add_u32 s50, s61, 2703360
    s_add_u32 m0, s65, 6336
    ds_read_b64_tr_b16 a[240:241], v249 offset:33800
    ds_read_b64_tr_b16 a[242:243], v249 offset:34312
    v_mfma_f32_16x16x32_bf16 v[196:199], a[244:247], a[116:119], v[196:199]
    buffer_load_dwordx4 v255, s[20:23], s50 offen lds
    v_mfma_f32_16x16x32_bf16 v[200:203], a[244:247], a[120:123], v[200:203]
    v_exp_f32 v234, v234
    v_mfma_f32_16x16x32_bf16 v[204:207], a[244:247], a[124:127], v[204:207]
    v_exp_f32 v235, v235
    v_add_f32 v232, 1.0, v232
    v_mfma_f32_16x16x32_bf16 v[208:211], a[248:251], a[112:115], v[208:211]
    s_add_u32 s50, s61, 2711552
    s_add_u32 m0, s65, 7392
    ds_read_b64_tr_b16 a[244:245], v249 offset:33856
    ds_read_b64_tr_b16 a[246:247], v249 offset:34368
    v_add_f32 v233, 1.0, v233
    v_mfma_f32_16x16x32_bf16 v[212:215], a[248:251], a[116:119], v[212:215]
    buffer_load_dwordx4 v255, s[20:23], s50 offen lds
    v_add_f32 v234, 1.0, v234
    v_mfma_f32_16x16x32_bf16 v[216:219], a[248:251], a[120:123], v[216:219]
    v_add_f32 v235, 1.0, v235
    v_rcp_f32 v232, v232
    v_mfma_f32_16x16x32_bf16 v[220:223], a[248:251], a[124:127], v[220:223]
    v_rcp_f32 v233, v233
    s_waitcnt vmcnt(8)
    s_barrier
    s_waitcnt lgkmcnt(2)
    v_mfma_f32_16x16x32_bf16 v[96:99], a[236:239], a[128:131], v[96:99]
    s_add_u32 s50, s61, 2883584
    s_add_u32 m0, s66, 0
    ds_read_b64_tr_b16 a[248:249], v249 offset:33864
    ds_read_b64_tr_b16 a[250:251], v249 offset:34376
    v_mfma_f32_16x16x32_bf16 v[100:103], a[236:239], a[132:135], v[100:103]
    buffer_load_dwordx4 v255, s[20:23], s50 offen lds
    v_mfma_f32_16x16x32_bf16 v[104:107], a[236:239], a[136:139], v[104:107]
    v_rcp_f32 v234, v234
    v_mfma_f32_16x16x32_bf16 v[108:111], a[236:239], a[140:143], v[108:111]
    v_rcp_f32 v235, v235
    v_mul_f32 v32, v32, v232
    v_mfma_f32_16x16x32_bf16 v[112:115], a[240:243], a[128:131], v[112:115]
    s_add_u32 s50, s61, 2891776
    s_add_u32 m0, s66, 1056
    ds_read_b64_tr_b16 a[236:237], v249 offset:33920
    ds_read_b64_tr_b16 a[238:239], v249 offset:34432
    v_mul_f32 v33, v33, v233
    v_mfma_f32_16x16x32_bf16 v[116:119], a[240:243], a[132:135], v[116:119]
    buffer_load_dwordx4 v255, s[20:23], s50 offen lds
    v_mul_f32 v34, v34, v234
    v_mfma_f32_16x16x32_bf16 v[120:123], a[240:243], a[136:139], v[120:123]
    v_mul_f32 v35, v35, v235
    v_cvt_pk_bf16_f32 v80, v32, v33
    v_cvt_pk_bf16_f32 v81, v34, v35
    v_mfma_f32_16x16x32_bf16 v[124:127], a[240:243], a[140:143], v[124:127]
    s_waitcnt lgkmcnt(2)
    v_fma_f32 v36, v36, v227, v240
    v_fma_f32 v37, v37, v227, v241
    v_fma_f32 v38, v38, v227, v242
    v_mfma_f32_16x16x32_bf16 v[128:131], a[244:247], a[128:131], v[128:131]
    s_add_u32 s50, s61, 2899968
    s_add_u32 m0, s66, 2112
    ds_read_b64_tr_b16 a[240:241], v249 offset:33928
    ds_read_b64_tr_b16 a[242:243], v249 offset:34440
    v_fma_f32 v39, v39, v227, v243
    v_mfma_f32_16x16x32_bf16 v[132:135], a[244:247], a[132:135], v[132:135]
    buffer_load_dwordx4 v255, s[20:23], s50 offen lds
    v_mul_f32 v232, v36, v36
    v_mfma_f32_16x16x32_bf16 v[136:139], a[244:247], a[136:139], v[136:139]
    v_mul_f32 v233, v37, v37
    v_mul_f32 v234, v38, v38
    v_mul_f32 v235, v39, v39
    v_mfma_f32_16x16x32_bf16 v[140:143], a[244:247], a[140:143], v[140:143]
    v_fma_f32 v232, v232, s100, v239
    v_fma_f32 v233, v233, s100, v239
    v_fma_f32 v234, v234, s100, v239
    v_mfma_f32_16x16x32_bf16 v[144:147], a[248:251], a[128:131], v[144:147]
    s_add_u32 s50, s61, 2908160
    s_add_u32 m0, s66, 3168
    ds_read_b64_tr_b16 a[244:245], v249 offset:33984
    ds_read_b64_tr_b16 a[246:247], v249 offset:34496
    v_fma_f32 v235, v235, s100, v239
    v_mfma_f32_16x16x32_bf16 v[148:151], a[248:251], a[132:135], v[148:151]
    buffer_load_dwordx4 v255, s[20:23], s50 offen lds
    v_mul_f32 v232, v232, v36
    v_mfma_f32_16x16x32_bf16 v[152:155], a[248:251], a[136:139], v[152:155]
    v_mul_f32 v233, v233, v37
    v_mul_f32 v234, v234, v38
    v_mul_f32 v235, v235, v39
    v_mfma_f32_16x16x32_bf16 v[156:159], a[248:251], a[140:143], v[156:159]
    s_waitcnt lgkmcnt(2)
    v_exp_f32 v232, v232
    v_mfma_f32_16x16x32_bf16 v[160:163], a[236:239], a[128:131], v[160:163]
    s_add_u32 s50, s61, 2949120
    s_add_u32 m0, s66, 4224
    ds_read_b64_tr_b16 a[248:249], v249 offset:33992
    ds_read_b64_tr_b16 a[250:251], v249 offset:34504
    v_mfma_f32_16x16x32_bf16 v[164:167], a[236:239], a[132:135], v[164:167]
    buffer_load_dwordx4 v255, s[20:23], s50 offen lds
    v_mfma_f32_16x16x32_bf16 v[168:171], a[236:239], a[136:139], v[168:171]
    v_exp_f32 v233, v233
    v_mfma_f32_16x16x32_bf16 v[172:175], a[236:239], a[140:143], v[172:175]
    v_exp_f32 v234, v234
    v_mfma_f32_16x16x32_bf16 v[176:179], a[240:243], a[128:131], v[176:179]
    s_add_u32 s50, s61, 2957312
    s_add_u32 m0, s66, 5280
    ds_read_b64_tr_b16 a[236:237], v248 offset:0
    ds_read_b64_tr_b16 a[238:239], v248 offset:512
    v_mfma_f32_16x16x32_bf16 v[180:183], a[240:243], a[132:135], v[180:183]
    buffer_load_dwordx4 v255, s[20:23], s50 offen lds
    v_mfma_f32_16x16x32_bf16 v[184:187], a[240:243], a[136:139], v[184:187]
    v_exp_f32 v235, v235
    v_add_f32 v232, 1.0, v232
    v_mfma_f32_16x16x32_bf16 v[188:191], a[240:243], a[140:143], v[188:191]
    s_waitcnt lgkmcnt(2)
    v_add_f32 v233, 1.0, v233
    v_add_f32 v234, 1.0, v234
    v_add_f32 v235, 1.0, v235
    v_mfma_f32_16x16x32_bf16 v[192:195], a[244:247], a[128:131], v[192:195]
    s_add_u32 s50, s61, 2965504
    s_add_u32 m0, s66, 6336
    ds_read_b64_tr_b16 a[240:241], v248 offset:8
    ds_read_b64_tr_b16 a[242:243], v248 offset:520
    v_mfma_f32_16x16x32_bf16 v[196:199], a[244:247], a[132:135], v[196:199]
    buffer_load_dwordx4 v255, s[20:23], s50 offen lds
    v_mfma_f32_16x16x32_bf16 v[200:203], a[244:247], a[136:139], v[200:203]
    v_rcp_f32 v232, v232
    v_mfma_f32_16x16x32_bf16 v[204:207], a[244:247], a[140:143], v[204:207]
    v_rcp_f32 v233, v233
    v_mfma_f32_16x16x32_bf16 v[208:211], a[248:251], a[128:131], v[208:211]
    s_add_u32 s50, s61, 2973696
    s_add_u32 m0, s66, 7392
    ds_read_b64_tr_b16 a[244:245], v248 offset:64
    ds_read_b64_tr_b16 a[246:247], v248 offset:576
    v_mfma_f32_16x16x32_bf16 v[212:215], a[248:251], a[132:135], v[212:215]
    buffer_load_dwordx4 v255, s[20:23], s50 offen lds
    v_mfma_f32_16x16x32_bf16 v[216:219], a[248:251], a[136:139], v[216:219]
    v_rcp_f32 v234, v234
    v_mfma_f32_16x16x32_bf16 v[220:223], a[248:251], a[140:143], v[220:223]
    v_rcp_f32 v235, v235
    v_mul_f32 v36, v36, v232
    s_waitcnt vmcnt(8)
    s_barrier
    s_waitcnt lgkmcnt(2)
    v_mfma_f32_16x16x32_bf16 v[96:99], a[236:239], a[144:147], v[96:99]
    s_add_u32 s50, s61, 3145728
    s_add_u32 m0, s67, 0
    ds_read_b64_tr_b16 a[248:249], v248 offset:72
    ds_read_b64_tr_b16 a[250:251], v248 offset:584
    v_mul_f32 v37, v37, v233
    v_mfma_f32_16x16x32_bf16 v[100:103], a[236:239], a[148:151], v[100:103]
    buffer_load_dwordx4 v255, s[20:23], s50 offen lds
    v_mul_f32 v38, v38, v234
    v_mfma_f32_16x16x32_bf16 v[104:107], a[236:239], a[152:155], v[104:107]
    v_mul_f32 v39, v39, v235
    v_cvt_pk_bf16_f32 v84, v36, v37
    v_cvt_pk_bf16_f32 v85, v38, v39
    v_mfma_f32_16x16x32_bf16 v[108:111], a[236:239], a[156:159], v[108:111]
    v_fma_f32 v40, v40, v229, v240
    v_fma_f32 v41, v41, v229, v241
    v_fma_f32 v42, v42, v229, v242
    v_mfma_f32_16x16x32_bf16 v[112:115], a[240:243], a[144:147], v[112:115]
    s_add_u32 s50, s61, 3153920
    s_add_u32 m0, s67, 1056
    ds_read_b64_tr_b16 a[236:237], v248 offset:128
    ds_read_b64_tr_b16 a[238:239], v248 offset:640
    v_fma_f32 v43, v43, v229, v243
    v_mfma_f32_16x16x32_bf16 v[116:119], a[240:243], a[148:151], v[116:119]
    buffer_load_dwordx4 v255, s[20:23], s50 offen lds
    v_mul_f32 v232, v40, v40
    v_mfma_f32_16x16x32_bf16 v[120:123], a[240:243], a[152:155], v[120:123]
    v_mul_f32 v233, v41, v41
    v_mul_f32 v234, v42, v42
    v_mul_f32 v235, v43, v43
    v_mfma_f32_16x16x32_bf16 v[124:127], a[240:243], a[156:159], v[124:127]
    s_waitcnt lgkmcnt(2)
    v_fma_f32 v232, v232, s100, v239
    v_fma_f32 v233, v233, s100, v239
    v_fma_f32 v234, v234, s100, v239
    v_mfma_f32_16x16x32_bf16 v[128:131], a[244:247], a[144:147], v[128:131]
    s_add_u32 s50, s61, 3162112
    s_add_u32 m0, s67, 2112
    ds_read_b64_tr_b16 a[240:241], v248 offset:136
    ds_read_b64_tr_b16 a[242:243], v248 offset:648
    v_fma_f32 v235, v235, s100, v239
    v_mfma_f32_16x16x32_bf16 v[132:135], a[244:247], a[148:151], v[132:135]
    buffer_load_dwordx4 v255, s[20:23], s50 offen lds
    v_mul_f32 v232, v232, v40
    v_mfma_f32_16x16x32_bf16 v[136:139], a[244:247], a[152:155], v[136:139]
    v_mul_f32 v233, v233, v41
    v_mul_f32 v234, v234, v42
    v_mul_f32 v235, v235, v43
    v_mfma_f32_16x16x32_bf16 v[140:143], a[244:247], a[156:159], v[140:143]
    v_exp_f32 v232, v232
    v_mfma_f32_16x16x32_bf16 v[144:147], a[248:251], a[144:147], v[144:147]
    s_add_u32 s50, s61, 3170304
    s_add_u32 m0, s67, 3168
    ds_read_b64_tr_b16 a[244:245], v248 offset:192
    ds_read_b64_tr_b16 a[246:247], v248 offset:704
    v_mfma_f32_16x16x32_bf16 v[148:151], a[248:251], a[148:151], v[148:151]
    buffer_load_dwordx4 v255, s[20:23], s50 offen lds
    v_mfma_f32_16x16x32_bf16 v[152:155], a[248:251], a[152:155], v[152:155]
    v_exp_f32 v233, v233
    v_mfma_f32_16x16x32_bf16 v[156:159], a[248:251], a[156:159], v[156:159]
    s_waitcnt lgkmcnt(2)
    v_exp_f32 v234, v234
    v_mfma_f32_16x16x32_bf16 v[160:163], a[236:239], a[144:147], v[160:163]
    s_add_u32 s50, s61, 3211264
    s_add_u32 m0, s67, 4224
    ds_read_b64_tr_b16 a[248:249], v248 offset:200
    ds_read_b64_tr_b16 a[250:251], v248 offset:712
    v_mfma_f32_16x16x32_bf16 v[164:167], a[236:239], a[148:151], v[164:167]
    buffer_load_dwordx4 v255, s[20:23], s50 offen lds
    v_mfma_f32_16x16x32_bf16 v[168:171], a[236:239], a[152:155], v[168:171]
    v_exp_f32 v235, v235
    v_add_f32 v232, 1.0, v232
    v_mfma_f32_16x16x32_bf16 v[172:175], a[236:239], a[156:159], v[172:175]
    v_add_f32 v233, 1.0, v233
    v_add_f32 v234, 1.0, v234
    v_add_f32 v235, 1.0, v235
    v_mfma_f32_16x16x32_bf16 v[176:179], a[240:243], a[144:147], v[176:179]
    s_add_u32 s50, s61, 3219456
    s_add_u32 m0, s67, 5280
    ds_read_b64_tr_b16 a[236:237], v248 offset:33792
    ds_read_b64_tr_b16 a[238:239], v248 offset:34304
    v_mfma_f32_16x16x32_bf16 v[180:183], a[240:243], a[148:151], v[180:183]
    buffer_load_dwordx4 v255, s[20:23], s50 offen lds
    v_mfma_f32_16x16x32_bf16 v[184:187], a[240:243], a[152:155], v[184:187]
    v_rcp_f32 v232, v232
    v_mfma_f32_16x16x32_bf16 v[188:191], a[240:243], a[156:159], v[188:191]
    s_waitcnt lgkmcnt(2)
    v_rcp_f32 v233, v233
    v_mfma_f32_16x16x32_bf16 v[192:195], a[244:247], a[144:147], v[192:195]
    s_add_u32 s50, s61, 3227648
    s_add_u32 m0, s67, 6336
    ds_read_b64_tr_b16 a[240:241], v248 offset:33800
    ds_read_b64_tr_b16 a[242:243], v248 offset:34312
    v_mfma_f32_16x16x32_bf16 v[196:199], a[244:247], a[148:151], v[196:199]
    buffer_load_dwordx4 v255, s[20:23], s50 offen lds
    v_mfma_f32_16x16x32_bf16 v[200:203], a[244:247], a[152:155], v[200:203]
    v_rcp_f32 v234, v234
    v_mfma_f32_16x16x32_bf16 v[204:207], a[244:247], a[156:159], v[204:207]
    v_rcp_f32 v235, v235
    v_mul_f32 v40, v40, v232
    v_mfma_f32_16x16x32_bf16 v[208:211], a[248:251], a[144:147], v[208:211]
    s_add_u32 s50, s61, 3235840
    s_add_u32 m0, s67, 7392
    ds_read_b64_tr_b16 a[244:245], v248 offset:33856
    ds_read_b64_tr_b16 a[246:247], v248 offset:34368
    v_mul_f32 v41, v41, v233
    v_mfma_f32_16x16x32_bf16 v[212:215], a[248:251], a[148:151], v[212:215]
    buffer_load_dwordx4 v255, s[20:23], s50 offen lds
    v_mul_f32 v42, v42, v234
    v_mfma_f32_16x16x32_bf16 v[216:219], a[248:251], a[152:155], v[216:219]
    v_mul_f32 v43, v43, v235
    v_cvt_pk_bf16_f32 v88, v40, v41
    v_cvt_pk_bf16_f32 v89, v42, v43
    v_mfma_f32_16x16x32_bf16 v[220:223], a[248:251], a[156:159], v[220:223]
    v_fma_f32 v44, v44, v231, v240
    v_fma_f32 v45, v45, v231, v241
    v_fma_f32 v46, v46, v231, v242
    s_waitcnt vmcnt(8)
    s_barrier
    s_waitcnt lgkmcnt(2)
    v_mfma_f32_16x16x32_bf16 v[96:99], a[236:239], a[160:163], v[96:99]
    s_add_u32 s50, s61, 3407872
    s_add_u32 m0, s64, 0
    ds_read_b64_tr_b16 a[248:249], v248 offset:33864
    ds_read_b64_tr_b16 a[250:251], v248 offset:34376
    v_fma_f32 v47, v47, v231, v243
    v_mfma_f32_16x16x32_bf16 v[100:103], a[236:239], a[164:167], v[100:103]
    buffer_load_dwordx4 v255, s[20:23], s50 offen lds
    v_mul_f32 v232, v44, v44
    v_mfma_f32_16x16x32_bf16 v[104:107], a[236:239], a[168:171], v[104:107]
    v_mul_f32 v233, v45, v45
    v_mul_f32 v234, v46, v46
    v_mul_f32 v235, v47, v47
    v_mfma_f32_16x16x32_bf16 v[108:111], a[236:239], a[172:175], v[108:111]
    v_fma_f32 v232, v232, s100, v239
    v_fma_f32 v233, v233, s100, v239
    v_fma_f32 v234, v234, s100, v239
    v_mfma_f32_16x16x32_bf16 v[112:115], a[240:243], a[160:163], v[112:115]
    s_add_u32 s50, s61, 3416064
    s_add_u32 m0, s64, 1056
    ds_read_b64_tr_b16 a[236:237], v248 offset:33920
    ds_read_b64_tr_b16 a[238:239], v248 offset:34432
    v_fma_f32 v235, v235, s100, v239
    v_mfma_f32_16x16x32_bf16 v[116:119], a[240:243], a[164:167], v[116:119]
    buffer_load_dwordx4 v255, s[20:23], s50 offen lds
    v_mul_f32 v232, v232, v44
    v_mfma_f32_16x16x32_bf16 v[120:123], a[240:243], a[168:171], v[120:123]
    v_mul_f32 v233, v233, v45
    v_mul_f32 v234, v234, v46
    v_mul_f32 v235, v235, v47
    v_mfma_f32_16x16x32_bf16 v[124:127], a[240:243], a[172:175], v[124:127]
    s_waitcnt lgkmcnt(2)
    v_exp_f32 v232, v232
    v_mfma_f32_16x16x32_bf16 v[128:131], a[244:247], a[160:163], v[128:131]
    s_add_u32 s50, s61, 3424256
    s_add_u32 m0, s64, 2112
    ds_read_b64_tr_b16 a[240:241], v248 offset:33928
    ds_read_b64_tr_b16 a[242:243], v248 offset:34440
    v_mfma_f32_16x16x32_bf16 v[132:135], a[244:247], a[164:167], v[132:135]
    buffer_load_dwordx4 v255, s[20:23], s50 offen lds
    v_mfma_f32_16x16x32_bf16 v[136:139], a[244:247], a[168:171], v[136:139]
    v_exp_f32 v233, v233
    v_mfma_f32_16x16x32_bf16 v[140:143], a[244:247], a[172:175], v[140:143]
    v_exp_f32 v234, v234
    v_mfma_f32_16x16x32_bf16 v[144:147], a[248:251], a[160:163], v[144:147]
    s_add_u32 s50, s61, 3432448
    s_add_u32 m0, s64, 3168
    ds_read_b64_tr_b16 a[244:245], v248 offset:33984
    ds_read_b64_tr_b16 a[246:247], v248 offset:34496
    v_mfma_f32_16x16x32_bf16 v[148:151], a[248:251], a[164:167], v[148:151]
    buffer_load_dwordx4 v255, s[20:23], s50 offen lds
    v_mfma_f32_16x16x32_bf16 v[152:155], a[248:251], a[168:171], v[152:155]
    v_exp_f32 v235, v235
    v_add_f32 v232, 1.0, v232
    v_mfma_f32_16x16x32_bf16 v[156:159], a[248:251], a[172:175], v[156:159]
    s_waitcnt lgkmcnt(2)
    v_add_f32 v233, 1.0, v233
    v_add_f32 v234, 1.0, v234
    v_add_f32 v235, 1.0, v235
    v_mfma_f32_16x16x32_bf16 v[160:163], a[236:239], a[160:163], v[160:163]
    s_add_u32 s50, s61, 3473408
    s_add_u32 m0, s64, 4224
    ds_read_b64_tr_b16 a[248:249], v248 offset:33992
    ds_read_b64_tr_b16 a[250:251], v248 offset:34504
    v_mfma_f32_16x16x32_bf16 v[164:167], a[236:239], a[164:167], v[164:167]
    buffer_load_dwordx4 v255, s[20:23], s50 offen lds
    v_mfma_f32_16x16x32_bf16 v[168:171], a[236:239], a[168:171], v[168:171]
    v_rcp_f32 v232, v232
    v_mfma_f32_16x16x32_bf16 v[172:175], a[236:239], a[172:175], v[172:175]
    v_rcp_f32 v233, v233
    v_mfma_f32_16x16x32_bf16 v[176:179], a[240:243], a[160:163], v[176:179]
    s_add_u32 s50, s61, 3481600
    s_add_u32 m0, s64, 5280
    ds_read_b64_tr_b16 a[236:237], v249 offset:0
    ds_read_b64_tr_b16 a[238:239], v249 offset:512
    v_mfma_f32_16x16x32_bf16 v[180:183], a[240:243], a[164:167], v[180:183]
    buffer_load_dwordx4 v255, s[20:23], s50 offen lds
    v_mfma_f32_16x16x32_bf16 v[184:187], a[240:243], a[168:171], v[184:187]
    v_rcp_f32 v234, v234
    v_mfma_f32_16x16x32_bf16 v[188:191], a[240:243], a[172:175], v[188:191]
    s_waitcnt lgkmcnt(2)
    v_rcp_f32 v235, v235
    v_mul_f32 v44, v44, v232
    v_mfma_f32_16x16x32_bf16 v[192:195], a[244:247], a[160:163], v[192:195]
    s_add_u32 s50, s61, 3489792
    s_add_u32 m0, s64, 6336
    ds_read_b64_tr_b16 a[240:241], v249 offset:8
    ds_read_b64_tr_b16 a[242:243], v249 offset:520
    v_mul_f32 v45, v45, v233
    v_mfma_f32_16x16x32_bf16 v[196:199], a[244:247], a[164:167], v[196:199]
    buffer_load_dwordx4 v255, s[20:23], s50 offen lds
    v_mul_f32 v46, v46, v234
    v_mfma_f32_16x16x32_bf16 v[200:203], a[244:247], a[168:171], v[200:203]
    v_mul_f32 v47, v47, v235
    v_cvt_pk_bf16_f32 v92, v44, v45
    v_cvt_pk_bf16_f32 v93, v46, v47
    v_mfma_f32_16x16x32_bf16 v[204:207], a[244:247], a[172:175], v[204:207]
    v_accvgpr_read_b32 v232, a230
    v_accvgpr_read_b32 v233, a231
    s_nop 0
    v_lshlrev_b32 v240, 16, v232
    v_mfma_f32_16x16x32_bf16 v[208:211], a[248:251], a[160:163], v[208:211]
    s_add_u32 s50, s61, 3497984
    s_add_u32 m0, s64, 7392
    ds_read_b64_tr_b16 a[244:245], v249 offset:64
    ds_read_b64_tr_b16 a[246:247], v249 offset:576
    v_and_b32 v241, 0xffff0000, v232
    v_mfma_f32_16x16x32_bf16 v[212:215], a[248:251], a[164:167], v[212:215]
    buffer_load_dwordx4 v255, s[20:23], s50 offen lds
    v_lshlrev_b32 v242, 16, v233
    v_mfma_f32_16x16x32_bf16 v[216:219], a[248:251], a[168:171], v[216:219]
    v_and_b32 v243, 0xffff0000, v233
    v_fma_f32 v48, v48, v225, v240
    v_fma_f32 v49, v49, v225, v241
    v_mfma_f32_16x16x32_bf16 v[220:223], a[248:251], a[172:175], v[220:223]
    v_fma_f32 v50, v50, v225, v242
    v_fma_f32 v51, v51, v225, v243
    v_mul_f32 v232, v48, v48
    v_mul_f32 v233, v49, v49
    v_mul_f32 v234, v50, v50
    v_mul_f32 v235, v51, v51
    v_fma_f32 v232, v232, s100, v239
    v_fma_f32 v233, v233, s100, v239
    v_fma_f32 v234, v234, s100, v239
    v_fma_f32 v235, v235, s100, v239
    v_mul_f32 v232, v232, v48
    v_mul_f32 v233, v233, v49
    v_mul_f32 v234, v234, v50
    v_mul_f32 v235, v235, v51
    v_exp_f32 v232, v232
    v_exp_f32 v233, v233
    v_exp_f32 v234, v234
    v_exp_f32 v235, v235
    v_add_f32 v232, 1.0, v232
    v_add_f32 v233, 1.0, v233
    v_add_f32 v234, 1.0, v234
    v_add_f32 v235, 1.0, v235
    v_rcp_f32 v232, v232
    v_rcp_f32 v233, v233
    v_rcp_f32 v234, v234
    v_rcp_f32 v235, v235
    v_mul_f32 v48, v48, v232
    v_mul_f32 v49, v49, v233
    v_mul_f32 v50, v50, v234
    v_mul_f32 v51, v51, v235
    v_cvt_pk_bf16_f32 v82, v48, v49
    v_cvt_pk_bf16_f32 v83, v50, v51
    v_fma_f32 v52, v52, v227, v240
    v_fma_f32 v53, v53, v227, v241
    v_fma_f32 v54, v54, v227, v242
    v_fma_f32 v55, v55, v227, v243
    v_mul_f32 v232, v52, v52
    v_mul_f32 v233, v53, v53
    v_mul_f32 v234, v54, v54
    v_mul_f32 v235, v55, v55
    v_fma_f32 v232, v232, s100, v239
    v_fma_f32 v233, v233, s100, v239
    v_fma_f32 v234, v234, s100, v239
    v_fma_f32 v235, v235, s100, v239
    v_mul_f32 v232, v232, v52
    v_mul_f32 v233, v233, v53
    v_mul_f32 v234, v234, v54
    v_mul_f32 v235, v235, v55
    v_exp_f32 v232, v232
    v_exp_f32 v233, v233
    v_exp_f32 v234, v234
    v_exp_f32 v235, v235
    v_add_f32 v232, 1.0, v232
    v_add_f32 v233, 1.0, v233
    v_add_f32 v234, 1.0, v234
    v_add_f32 v235, 1.0, v235
    v_rcp_f32 v232, v232
    v_rcp_f32 v233, v233
    v_rcp_f32 v234, v234
    v_rcp_f32 v235, v235
    v_mul_f32 v52, v52, v232
    v_mul_f32 v53, v53, v233
    v_mul_f32 v54, v54, v234
    v_mul_f32 v55, v55, v235
    v_cvt_pk_bf16_f32 v86, v52, v53
    v_cvt_pk_bf16_f32 v87, v54, v55
    v_fma_f32 v56, v56, v229, v240
    v_fma_f32 v57, v57, v229, v241
    v_fma_f32 v58, v58, v229, v242
    v_fma_f32 v59, v59, v229, v243
    v_mul_f32 v232, v56, v56
    v_mul_f32 v233, v57, v57
    v_mul_f32 v234, v58, v58
    v_mul_f32 v235, v59, v59
    v_fma_f32 v232, v232, s100, v239
    v_fma_f32 v233, v233, s100, v239
    v_fma_f32 v234, v234, s100, v239
    v_fma_f32 v235, v235, s100, v239
    v_mul_f32 v232, v232, v56
    v_mul_f32 v233, v233, v57
    v_mul_f32 v234, v234, v58
    v_mul_f32 v235, v235, v59
    v_exp_f32 v232, v232
    v_exp_f32 v233, v233
    v_exp_f32 v234, v234
    v_exp_f32 v235, v235
    v_add_f32 v232, 1.0, v232
    v_add_f32 v233, 1.0, v233
    v_add_f32 v234, 1.0, v234
    v_add_f32 v235, 1.0, v235
    v_rcp_f32 v232, v232
    v_rcp_f32 v233, v233
    v_rcp_f32 v234, v234
    v_rcp_f32 v235, v235
    v_mul_f32 v56, v56, v232
    v_mul_f32 v57, v57, v233
    v_mul_f32 v58, v58, v234
    v_mul_f32 v59, v59, v235
    v_cvt_pk_bf16_f32 v90, v56, v57
    v_cvt_pk_bf16_f32 v91, v58, v59
    v_fma_f32 v60, v60, v231, v240
    v_fma_f32 v61, v61, v231, v241
    v_fma_f32 v62, v62, v231, v242
    v_fma_f32 v63, v63, v231, v243
    v_mul_f32 v232, v60, v60
    v_mul_f32 v233, v61, v61
    v_mul_f32 v234, v62, v62
    v_mul_f32 v235, v63, v63
    v_fma_f32 v232, v232, s100, v239
    v_fma_f32 v233, v233, s100, v239
    v_fma_f32 v234, v234, s100, v239
    v_fma_f32 v235, v235, s100, v239
    v_mul_f32 v232, v232, v60
    v_mul_f32 v233, v233, v61
    v_mul_f32 v234, v234, v62
    v_mul_f32 v235, v235, v63
    v_exp_f32 v232, v232
    v_exp_f32 v233, v233
    v_exp_f32 v234, v234
    v_exp_f32 v235, v235
    v_add_f32 v232, 1.0, v232
    v_add_f32 v233, 1.0, v233
    v_add_f32 v234, 1.0, v234
    v_add_f32 v235, 1.0, v235
    v_rcp_f32 v232, v232
    v_rcp_f32 v233, v233
    v_rcp_f32 v234, v234
    v_rcp_f32 v235, v235
    v_mul_f32 v60, v60, v232
    v_mul_f32 v61, v61, v233
    v_mul_f32 v62, v62, v234
    v_mul_f32 v63, v63, v235
    v_cvt_pk_bf16_f32 v94, v60, v61
    v_cvt_pk_bf16_f32 v95, v62, v63
    s_lshl_b32 s100, s3, 1
    s_add_u32 s101, s100, 1
    s_min_u32 s101, s101, 6
    s_lshl_b32 s100, s100, 12
    s_lshl_b32 s101, s101, 12
    v_lshlrev_b32 v238, 4, v251
    v_add_u32 v238, 135168, v238
    v_add_u32 v237, s101, v238
    v_add_u32 v236, s100, v238
    ds_write_b128 v237, v[80:83] offset:0
    ds_write_b128 v237, v[84:87] offset:1024
    ds_write_b128 v237, v[88:91] offset:2048
    ds_write_b128 v237, v[92:95] offset:3072
    ds_write_b128 v236, v[64:67] offset:0
    ds_write_b128 v236, v[68:71] offset:1024
    ds_write_b128 v236, v[72:75] offset:2048
    ds_write_b128 v236, v[76:79] offset:3072
    s_waitcnt lgkmcnt(0)
    s_waitcnt vmcnt(8)
    s_barrier
    v_mfma_f32_16x16x32_bf16 v[96:99], a[236:239], a[176:179], v[96:99]
    s_add_u32 s50, s62, 0
    s_add_u32 m0, s65, 0
    ds_read_b64_tr_b16 a[248:249], v249 offset:72
    ds_read_b64_tr_b16 a[250:251], v249 offset:584
    v_mfma_f32_16x16x32_bf16 v[100:103], a[236:239], a[180:183], v[100:103]
    buffer_load_dwordx4 v247, s[32:35], s50 offen offset:0 lds
    v_mfma_f32_16x16x32_bf16 v[104:107], a[236:239], a[184:187], v[104:107]
    v_mfma_f32_16x16x32_bf16 v[108:111], a[236:239], a[188:191], v[108:111]
    v_mfma_f32_16x16x32_bf16 v[112:115], a[240:243], a[176:179], v[112:115]
    s_add_u32 m0, s65, 160
    ds_read_b64_tr_b16 a[236:237], v249 offset:128
    ds_read_b64_tr_b16 a[238:239], v249 offset:640
    v_mfma_f32_16x16x32_bf16 v[116:119], a[240:243], a[180:183], v[116:119]
    buffer_load_dwordx4 v247, s[32:35], s50 offen offset:896 lds
    v_mfma_f32_16x16x32_bf16 v[120:123], a[240:243], a[184:187], v[120:123]
    v_mfma_f32_16x16x32_bf16 v[124:127], a[240:243], a[188:191], v[124:127]
    s_waitcnt lgkmcnt(2)
    v_mfma_f32_16x16x32_bf16 v[128:131], a[244:247], a[176:179], v[128:131]
    s_add_u32 m0, s65, 320
    ds_read_b64_tr_b16 a[240:241], v249 offset:136
    ds_read_b64_tr_b16 a[242:243], v249 offset:648
    v_mfma_f32_16x16x32_bf16 v[132:135], a[244:247], a[180:183], v[132:135]
    buffer_load_dwordx4 v247, s[32:35], s50 offen offset:1792 lds
    v_mfma_f32_16x16x32_bf16 v[136:139], a[244:247], a[184:187], v[136:139]
    v_mfma_f32_16x16x32_bf16 v[140:143], a[244:247], a[188:191], v[140:143]
    v_mfma_f32_16x16x32_bf16 v[144:147], a[248:251], a[176:179], v[144:147]
    s_add_u32 m0, s65, 480
    ds_read_b64_tr_b16 a[244:245], v249 offset:192
    ds_read_b64_tr_b16 a[246:247], v249 offset:704
    v_mfma_f32_16x16x32_bf16 v[148:151], a[248:251], a[180:183], v[148:151]
    buffer_load_dwordx4 v247, s[32:35], s50 offen offset:2688 lds
    v_mfma_f32_16x16x32_bf16 v[152:155], a[248:251], a[184:187], v[152:155]
    v_mfma_f32_16x16x32_bf16 v[156:159], a[248:251], a[188:191], v[156:159]
    s_waitcnt lgkmcnt(2)
    v_mfma_f32_16x16x32_bf16 v[160:163], a[236:239], a[176:179], v[160:163]
    s_add_u32 s50, s62, 3584
    s_add_u32 m0, s65, 4224
    ds_read_b64_tr_b16 a[248:249], v249 offset:200
    ds_read_b64_tr_b16 a[250:251], v249 offset:712
    v_mfma_f32_16x16x32_bf16 v[164:167], a[236:239], a[180:183], v[164:167]
    buffer_load_dwordx4 v247, s[32:35], s50 offen offset:0 lds
    v_mfma_f32_16x16x32_bf16 v[168:171], a[236:239], a[184:187], v[168:171]
    v_mfma_f32_16x16x32_bf16 v[172:175], a[236:239], a[188:191], v[172:175]
    v_mfma_f32_16x16x32_bf16 v[176:179], a[240:243], a[176:179], v[176:179]
    s_add_u32 m0, s65, 4384
    ds_read_b64_tr_b16 a[236:237], v249 offset:33792
    ds_read_b64_tr_b16 a[238:239], v249 offset:34304
    v_mfma_f32_16x16x32_bf16 v[180:183], a[240:243], a[180:183], v[180:183]
    buffer_load_dwordx4 v247, s[32:35], s50 offen offset:896 lds
    v_mfma_f32_16x16x32_bf16 v[184:187], a[240:243], a[184:187], v[184:187]
    v_mfma_f32_16x16x32_bf16 v[188:191], a[240:243], a[188:191], v[188:191]
    s_waitcnt lgkmcnt(2)
    v_mfma_f32_16x16x32_bf16 v[192:195], a[244:247], a[176:179], v[192:195]
    s_add_u32 m0, s65, 4544
    ds_read_b64_tr_b16 a[240:241], v249 offset:33800
    ds_read_b64_tr_b16 a[242:243], v249 offset:34312
    v_mfma_f32_16x16x32_bf16 v[196:199], a[244:247], a[180:183], v[196:199]
    buffer_load_dwordx4 v247, s[32:35], s50 offen offset:1792 lds
    v_mfma_f32_16x16x32_bf16 v[200:203], a[244:247], a[184:187], v[200:203]
    v_mfma_f32_16x16x32_bf16 v[204:207], a[244:247], a[188:191], v[204:207]
    v_mfma_f32_16x16x32_bf16 v[208:211], a[248:251], a[176:179], v[208:211]
    s_add_u32 m0, s65, 4704
    ds_read_b64_tr_b16 a[244:245], v249 offset:33856
    ds_read_b64_tr_b16 a[246:247], v249 offset:34368
    v_mfma_f32_16x16x32_bf16 v[212:215], a[248:251], a[180:183], v[212:215]
    buffer_load_dwordx4 v247, s[32:35], s50 offen offset:2688 lds
    v_mfma_f32_16x16x32_bf16 v[216:219], a[248:251], a[184:187], v[216:219]
    v_mfma_f32_16x16x32_bf16 v[220:223], a[248:251], a[188:191], v[220:223]
    s_waitcnt vmcnt(8)
    s_barrier
    s_waitcnt lgkmcnt(2)
    v_mfma_f32_16x16x32_bf16 v[96:99], a[236:239], a[192:195], v[96:99]
    s_add_u32 s50, s62, 28672
    s_add_u32 m0, s66, 0
    s_mul_i32 s100, s53, 16896
    s_mul_i32 s101, s54, 224
    s_add_u32 s100, s100, s101
    ds_read_b64_tr_b16 a[248:249], v249 offset:33864
    ds_read_b64_tr_b16 a[250:251], v249 offset:34376
    v_lshl_add_u32 v252, v245, 3, v244
    v_mfma_f32_16x16x32_bf16 v[100:103], a[236:239], a[196:199], v[100:103]
    buffer_load_dwordx4 v247, s[32:35], s50 offen offset:0 lds
    v_mfma_f32_16x16x32_bf16 v[104:107], a[236:239], a[200:203], v[104:107]
    v_add_u32 v252, s100, v252
    v_mfma_f32_16x16x32_bf16 v[108:111], a[236:239], a[204:207], v[108:111]
    v_add_u32 v253, 67584, v252
    v_mfma_f32_16x16x32_bf16 v[112:115], a[240:243], a[192:195], v[112:115]
    s_add_u32 m0, s66, 160
    ds_read_b64_tr_b16 a[236:237], v249 offset:33920
    ds_read_b64_tr_b16 a[238:239], v249 offset:34432
    v_mfma_f32_16x16x32_bf16 v[116:119], a[240:243], a[196:199], v[116:119]
    buffer_load_dwordx4 v247, s[32:35], s50 offen offset:896 lds
    v_mfma_f32_16x16x32_bf16 v[120:123], a[240:243], a[200:203], v[120:123]
    ds_read_b128 a[0:3], v238 offset:0
    v_mfma_f32_16x16x32_bf16 v[124:127], a[240:243], a[204:207], v[124:127]
    s_waitcnt lgkmcnt(3)
    ds_read_b128 a[4:7], v238 offset:1024
    v_mfma_f32_16x16x32_bf16 v[128:131], a[244:247], a[192:195], v[128:131]
    s_add_u32 m0, s66, 320
    ds_read_b64_tr_b16 a[240:241], v249 offset:33928
    ds_read_b64_tr_b16 a[242:243], v249 offset:34440
    v_mfma_f32_16x16x32_bf16 v[132:135], a[244:247], a[196:199], v[132:135]
    buffer_load_dwordx4 v247, s[32:35], s50 offen offset:1792 lds
    v_mfma_f32_16x16x32_bf16 v[136:139], a[244:247], a[200:203], v[136:139]
    ds_read_b128 a[8:11], v238 offset:2048
    v_mfma_f32_16x16x32_bf16 v[140:143], a[244:247], a[204:207], v[140:143]
    ds_read_b128 a[12:15], v238 offset:3072
    v_mfma_f32_16x16x32_bf16 v[144:147], a[248:251], a[192:195], v[144:147]
    s_add_u32 m0, s66, 480
    ds_read_b64_tr_b16 a[244:245], v249 offset:33984
    ds_read_b64_tr_b16 a[246:247], v249 offset:34496
    v_mfma_f32_16x16x32_bf16 v[148:151], a[248:251], a[196:199], v[148:151]
    buffer_load_dwordx4 v247, s[32:35], s50 offen offset:2688 lds
    v_mfma_f32_16x16x32_bf16 v[152:155], a[248:251], a[200:203], v[152:155]
    ds_read_b128 a[16:19], v238 offset:4096
    v_mfma_f32_16x16x32_bf16 v[156:159], a[248:251], a[204:207], v[156:159]
    s_waitcnt lgkmcnt(5)
    ds_read_b128 a[20:23], v238 offset:5120
    v_mfma_f32_16x16x32_bf16 v[160:163], a[236:239], a[192:195], v[160:163]
    s_add_u32 s50, s62, 32256
    s_add_u32 m0, s66, 4224
    ds_read_b64_tr_b16 a[248:249], v249 offset:33992
    ds_read_b64_tr_b16 a[250:251], v249 offset:34504
    v_mfma_f32_16x16x32_bf16 v[164:167], a[236:239], a[196:199], v[164:167]
    buffer_load_dwordx4 v247, s[32:35], s50 offen offset:0 lds
    v_mfma_f32_16x16x32_bf16 v[168:171], a[236:239], a[200:203], v[168:171]
    ds_read_b128 a[24:27], v238 offset:6144
    v_mfma_f32_16x16x32_bf16 v[172:175], a[236:239], a[204:207], v[172:175]
    ds_read_b128 a[28:31], v238 offset:7168
    v_mfma_f32_16x16x32_bf16 v[176:179], a[240:243], a[192:195], v[176:179]
    s_add_u32 m0, s66, 4384
    ds_read_b64_tr_b16 a[236:237], v248 offset:0
    ds_read_b64_tr_b16 a[238:239], v248 offset:512
    v_mfma_f32_16x16x32_bf16 v[180:183], a[240:243], a[196:199], v[180:183]
    buffer_load_dwordx4 v247, s[32:35], s50 offen offset:896 lds
    v_mfma_f32_16x16x32_bf16 v[184:187], a[240:243], a[200:203], v[184:187]
    ds_read_b128 a[32:35], v238 offset:8192
    v_mfma_f32_16x16x32_bf16 v[188:191], a[240:243], a[204:207], v[188:191]
    s_waitcnt lgkmcnt(5)
    ds_read_b128 a[36:39], v238 offset:9216
    v_mfma_f32_16x16x32_bf16 v[192:195], a[244:247], a[192:195], v[192:195]
    s_add_u32 m0, s66, 4544
    ds_read_b64_tr_b16 a[240:241], v248 offset:8
    ds_read_b64_tr_b16 a[242:243], v248 offset:520
    v_mfma_f32_16x16x32_bf16 v[196:199], a[244:247], a[196:199], v[196:199]
    buffer_load_dwordx4 v247, s[32:35], s50 offen offset:1792 lds
    v_mfma_f32_16x16x32_bf16 v[200:203], a[244:247], a[200:203], v[200:203]
    ds_read_b128 a[40:43], v238 offset:10240
    v_mfma_f32_16x16x32_bf16 v[204:207], a[244:247], a[204:207], v[204:207]
    ds_read_b128 a[44:47], v238 offset:11264
    v_mfma_f32_16x16x32_bf16 v[208:211], a[248:251], a[192:195], v[208:211]
    s_add_u32 m0, s66, 4704
    ds_read_b64_tr_b16 a[244:245], v248 offset:64
    ds_read_b64_tr_b16 a[246:247], v248 offset:576
    v_mfma_f32_16x16x32_bf16 v[212:215], a[248:251], a[196:199], v[212:215]
    buffer_load_dwordx4 v247, s[32:35], s50 offen offset:2688 lds
    v_mfma_f32_16x16x32_bf16 v[216:219], a[248:251], a[200:203], v[216:219]
    ds_read_b128 a[48:51], v238 offset:12288
    v_mfma_f32_16x16x32_bf16 v[220:223], a[248:251], a[204:207], v[220:223]
    ds_read_b128 a[52:55], v238 offset:13312
    s_waitcnt vmcnt(8)
    s_barrier
    s_waitcnt lgkmcnt(6)
    v_mfma_f32_16x16x32_bf16 v[96:99], a[236:239], a[208:211], v[96:99]
    s_add_u32 s50, s62, 57344
    s_add_u32 m0, s67, 0
    ds_read_b64_tr_b16 a[248:249], v248 offset:72
    ds_read_b64_tr_b16 a[250:251], v248 offset:584
    v_mfma_f32_16x16x32_bf16 v[100:103], a[236:239], a[212:215], v[100:103]
    buffer_load_dwordx4 v247, s[32:35], s50 offen offset:0 lds
    ds_read_b128 a[56:59], v238 offset:14336
    v_mfma_f32_16x16x32_bf16 v[104:107], a[236:239], a[216:219], v[104:107]
    v_mfma_f32_16x16x32_bf16 v[108:111], a[236:239], a[220:223], v[108:111]
    ds_read_b128 a[60:63], v238 offset:15360
    v_mfma_f32_16x16x32_bf16 v[112:115], a[240:243], a[208:211], v[112:115]
    s_add_u32 m0, s67, 160
    ds_read_b64_tr_b16 a[236:237], v248 offset:128
    ds_read_b64_tr_b16 a[238:239], v248 offset:640
    v_mfma_f32_16x16x32_bf16 v[116:119], a[240:243], a[212:215], v[116:119]
    buffer_load_dwordx4 v247, s[32:35], s50 offen offset:896 lds
    ds_read_b128 a[64:67], v238 offset:16384
    v_mfma_f32_16x16x32_bf16 v[120:123], a[240:243], a[216:219], v[120:123]
    v_mfma_f32_16x16x32_bf16 v[124:127], a[240:243], a[220:223], v[124:127]
    s_waitcnt lgkmcnt(5)
    ds_read_b128 a[68:71], v238 offset:17408
    v_mfma_f32_16x16x32_bf16 v[128:131], a[244:247], a[208:211], v[128:131]
    s_add_u32 m0, s67, 320
    ds_read_b64_tr_b16 a[240:241], v248 offset:136
    ds_read_b64_tr_b16 a[242:243], v248 offset:648
    v_mfma_f32_16x16x32_bf16 v[132:135], a[244:247], a[212:215], v[132:135]
    buffer_load_dwordx4 v247, s[32:35], s50 offen offset:1792 lds
    ds_read_b128 a[72:75], v238 offset:18432
    v_mfma_f32_16x16x32_bf16 v[136:139], a[244:247], a[216:219], v[136:139]
    v_mfma_f32_16x16x32_bf16 v[140:143], a[244:247], a[220:223], v[140:143]
    ds_read_b128 a[76:79], v238 offset:19456
    v_mfma_f32_16x16x32_bf16 v[144:147], a[248:251], a[208:211], v[144:147]
    s_add_u32 m0, s67, 480
    ds_read_b64_tr_b16 a[244:245], v248 offset:192
    ds_read_b64_tr_b16 a[246:247], v248 offset:704
    v_mfma_f32_16x16x32_bf16 v[148:151], a[248:251], a[212:215], v[148:151]
    buffer_load_dwordx4 v247, s[32:35], s50 offen offset:2688 lds
    ds_read_b128 a[80:83], v238 offset:20480
    v_mfma_f32_16x16x32_bf16 v[152:155], a[248:251], a[216:219], v[152:155]
    ds_read_b128 a[84:87], v238 offset:21504
    v_mfma_f32_16x16x32_bf16 v[156:159], a[248:251], a[220:223], v[156:159]
    s_waitcnt lgkmcnt(6)
    v_mfma_f32_16x16x32_bf16 v[160:163], a[236:239], a[208:211], v[160:163]
    s_add_u32 s50, s62, 60928
    s_add_u32 m0, s67, 4224
    ds_read_b64_tr_b16 a[248:249], v248 offset:200
    ds_read_b64_tr_b16 a[250:251], v248 offset:712
    ds_read_b128 a[88:91], v238 offset:22528
    v_mfma_f32_16x16x32_bf16 v[164:167], a[236:239], a[212:215], v[164:167]
    buffer_load_dwordx4 v247, s[32:35], s50 offen offset:0 lds
    v_mfma_f32_16x16x32_bf16 v[168:171], a[236:239], a[216:219], v[168:171]
    ds_read_b128 a[92:95], v238 offset:23552
    v_mfma_f32_16x16x32_bf16 v[172:175], a[236:239], a[220:223], v[172:175]
    v_mfma_f32_16x16x32_bf16 v[176:179], a[240:243], a[208:211], v[176:179]
    s_add_u32 m0, s67, 4384
    ds_read_b64_tr_b16 a[236:237], v252 offset:33792
    ds_read_b64_tr_b16 a[238:239], v252 offset:34304
    ds_read_b128 a[96:99], v238 offset:24576
    v_mfma_f32_16x16x32_bf16 v[180:183], a[240:243], a[212:215], v[180:183]
    buffer_load_dwordx4 v247, s[32:35], s50 offen offset:896 lds
    v_mfma_f32_16x16x32_bf16 v[184:187], a[240:243], a[216:219], v[184:187]
    ds_read_b128 a[100:103], v238 offset:25600
    v_mfma_f32_16x16x32_bf16 v[188:191], a[240:243], a[220:223], v[188:191]
    s_waitcnt lgkmcnt(6)
    v_mfma_f32_16x16x32_bf16 v[192:195], a[244:247], a[208:211], v[192:195]
    s_add_u32 m0, s67, 4544
    ds_read_b64_tr_b16 a[240:241], v252 offset:33824
    ds_read_b64_tr_b16 a[242:243], v252 offset:34336
    ds_read_b128 a[104:107], v238 offset:26624
    v_mfma_f32_16x16x32_bf16 v[196:199], a[244:247], a[212:215], v[196:199]
    buffer_load_dwordx4 v247, s[32:35], s50 offen offset:1792 lds
    v_mfma_f32_16x16x32_bf16 v[200:203], a[244:247], a[216:219], v[200:203]
    ds_read_b128 a[108:111], v238 offset:27648
    s_waitcnt lgkmcnt(0)
    v_mfma_f32_16x16x32_bf16 v[204:207], a[244:247], a[220:223], v[204:207]
    v_mfma_f32_16x16x32_bf16 v[208:211], a[248:251], a[208:211], v[208:211]
    s_add_u32 m0, s67, 4704
    ds_read_b64_tr_b16 a[244:245], v252 offset:33856
    ds_read_b64_tr_b16 a[246:247], v252 offset:34368
    v_mfma_f32_16x16x32_bf16 v[212:215], a[248:251], a[212:215], v[212:215]
    buffer_load_dwordx4 v247, s[32:35], s50 offen offset:2688 lds
    v_mfma_f32_16x16x32_bf16 v[216:219], a[248:251], a[216:219], v[216:219]
    v_mfma_f32_16x16x32_bf16 v[220:223], a[248:251], a[220:223], v[220:223]
    s_waitcnt vmcnt(8)
    s_barrier
    v_mfma_f32_16x16x32_bf16 a[112:115], a[236:239], a[0:3], 0
    s_add_u32 s50, s62, 86016
    s_add_u32 m0, s64, 0
    ds_read_b64_tr_b16 a[248:249], v252 offset:33888
    ds_read_b64_tr_b16 a[250:251], v252 offset:34400
    v_mfma_f32_16x16x32_bf16 a[116:119], a[236:239], a[4:7], 0
    buffer_load_dwordx4 v247, s[32:35], s50 offen offset:0 lds
    v_mfma_f32_16x16x32_bf16 a[120:123], a[236:239], a[8:11], 0
    v_mfma_f32_16x16x32_bf16 a[124:127], a[236:239], a[12:15], 0
    v_mfma_f32_16x16x32_bf16 a[128:131], a[240:243], a[0:3], 0
    s_add_u32 m0, s64, 160
    ds_read_b64_tr_b16 a[236:237], v252 offset:33920
    ds_read_b64_tr_b16 a[238:239], v252 offset:34432
    v_mfma_f32_16x16x32_bf16 a[132:135], a[240:243], a[4:7], 0
    buffer_load_dwordx4 v247, s[32:35], s50 offen offset:896 lds
    v_mfma_f32_16x16x32_bf16 a[136:139], a[240:243], a[8:11], 0
    s_mul_i32 s100, s3, 7168
    s_xor_b32 s101, s3, 1
    s_mul_i32 s101, s101, 7168
    v_lshlrev_b32 v238, 4, v251
    v_add_u32 v238, 135168, v238
    v_add_u32 v237, s100, v238
    v_mfma_f32_16x16x32_bf16 a[140:143], a[240:243], a[12:15], 0
    s_waitcnt lgkmcnt(2)
    v_add_u32 v236, s101, v238
    v_cvt_pk_bf16_f32 v0, v96, v97
    v_cvt_pk_bf16_f32 v1, v98, v99
    v_mfma_f32_16x16x32_bf16 a[144:147], a[244:247], a[0:3], 0
    s_add_u32 m0, s64, 320
    ds_read_b64_tr_b16 a[240:241], v252 offset:33952
    ds_read_b64_tr_b16 a[242:243], v252 offset:34464
    v_cvt_pk_bf16_f32 v2, v112, v113
    v_mfma_f32_16x16x32_bf16 a[148:151], a[244:247], a[4:7], 0
    buffer_load_dwordx4 v247, s[32:35], s50 offen offset:1792 lds
    v_cvt_pk_bf16_f32 v3, v114, v115
    v_mfma_f32_16x16x32_bf16 a[152:155], a[244:247], a[8:11], 0
    v_cvt_pk_bf16_f32 v4, v100, v101
    v_cvt_pk_bf16_f32 v5, v102, v103
    v_cvt_pk_bf16_f32 v6, v116, v117
    v_mfma_f32_16x16x32_bf16 a[156:159], a[244:247], a[12:15], 0
    v_cvt_pk_bf16_f32 v7, v118, v119
    v_cvt_pk_bf16_f32 v8, v104, v105
    v_cvt_pk_bf16_f32 v9, v106, v107
    v_mfma_f32_16x16x32_bf16 a[160:163], a[248:251], a[0:3], 0
    s_add_u32 m0, s64, 480
    ds_read_b64_tr_b16 a[244:245], v252 offset:33984
    ds_read_b64_tr_b16 a[246:247], v252 offset:34496
    v_cvt_pk_bf16_f32 v10, v120, v121
    v_mfma_f32_16x16x32_bf16 a[164:167], a[248:251], a[4:7], 0
    buffer_load_dwordx4 v247, s[32:35], s50 offen offset:2688 lds
    s_add_u32 s50, s62, 89600
    s_add_u32 m0, s64, 4224
    v_cvt_pk_bf16_f32 v11, v122, v123
    v_mfma_f32_16x16x32_bf16 a[168:171], a[248:251], a[8:11], 0
    buffer_load_dwordx4 v247, s[32:35], s50 offen offset:0 lds
    v_cvt_pk_bf16_f32 v12, v108, v109
    v_mfma_f32_16x16x32_bf16 a[172:175], a[248:251], a[12:15], 0
    s_waitcnt lgkmcnt(2)
    v_cvt_pk_bf16_f32 v13, v110, v111
    v_cvt_pk_bf16_f32 v14, v124, v125
    v_cvt_pk_bf16_f32 v15, v126, v127
    v_mfma_f32_16x16x32_bf16 a[176:179], a[236:239], a[0:3], 0
    s_add_u32 m0, s64, 4384
    ds_read_b64_tr_b16 a[248:249], v253 offset:0
    ds_read_b64_tr_b16 a[250:251], v253 offset:512
    v_cvt_pk_bf16_f32 v16, v128, v129
    v_mfma_f32_16x16x32_bf16 a[180:183], a[236:239], a[4:7], 0
    buffer_load_dwordx4 v247, s[32:35], s50 offen offset:896 lds
    v_cvt_pk_bf16_f32 v17, v130, v131
    v_mfma_f32_16x16x32_bf16 a[184:187], a[236:239], a[8:11], 0
    v_cvt_pk_bf16_f32 v18, v144, v145
    v_cvt_pk_bf16_f32 v19, v146, v147
    v_cvt_pk_bf16_f32 v20, v132, v133
    v_mfma_f32_16x16x32_bf16 a[188:191], a[236:239], a[12:15], 0
    v_cvt_pk_bf16_f32 v21, v134, v135
    v_cvt_pk_bf16_f32 v22, v148, v149
    v_cvt_pk_bf16_f32 v23, v150, v151
    v_mfma_f32_16x16x32_bf16 a[192:195], a[240:243], a[0:3], 0
    s_add_u32 m0, s64, 4544
    ds_read_b64_tr_b16 a[236:237], v253 offset:32
    ds_read_b64_tr_b16 a[238:239], v253 offset:544
    v_cvt_pk_bf16_f32 v24, v136, v137
    v_mfma_f32_16x16x32_bf16 a[196:199], a[240:243], a[4:7], 0
    buffer_load_dwordx4 v247, s[32:35], s50 offen offset:1792 lds
    v_cvt_pk_bf16_f32 v25, v138, v139
    v_mfma_f32_16x16x32_bf16 a[200:203], a[240:243], a[8:11], 0
    v_cvt_pk_bf16_f32 v26, v152, v153
    v_cvt_pk_bf16_f32 v27, v154, v155
    v_mfma_f32_16x16x32_bf16 a[204:207], a[240:243], a[12:15], 0
    s_waitcnt lgkmcnt(4)
    ds_write_b128 v237, v[0:3] offset:0
    v_mfma_f32_16x16x32_bf16 a[208:211], a[244:247], a[0:3], 0
    s_add_u32 m0, s64, 4704
    ds_read_b64_tr_b16 a[240:241], v253 offset:64
    ds_read_b64_tr_b16 a[242:243], v253 offset:576
    v_mfma_f32_16x16x32_bf16 a[212:215], a[244:247], a[4:7], 0
    buffer_load_dwordx4 v247, s[32:35], s50 offen offset:2688 lds
    v_mfma_f32_16x16x32_bf16 a[216:219], a[244:247], a[8:11], 0
    ds_write_b128 v237, v[4:7] offset:1024
    v_mfma_f32_16x16x32_bf16 a[220:223], a[244:247], a[12:15], 0
    ds_write_b128 v237, v[8:11] offset:2048
    ds_write_b128 v237, v[12:15] offset:3072
    ds_write_b128 v237, v[16:19] offset:4096
    ds_write_b128 v237, v[20:23] offset:5120
    ds_write_b128 v237, v[24:27] offset:6144
    s_waitcnt lgkmcnt(0)
    s_waitcnt vmcnt(8)
    s_barrier
    v_mfma_f32_16x16x32_bf16 a[112:115], a[248:251], a[16:19], a[112:115]
    s_add_u32 s50, s62, 114688
    s_add_u32 m0, s65, 0
    ds_read_b64_tr_b16 a[244:245], v253 offset:96
    ds_read_b64_tr_b16 a[246:247], v253 offset:608
    v_mfma_f32_16x16x32_bf16 a[116:119], a[248:251], a[20:23], a[116:119]
    buffer_load_dwordx4 v247, s[32:35], s50 offen offset:0 lds
    ds_read_b128 v[64:67], v236 offset:0
    v_mfma_f32_16x16x32_bf16 a[120:123], a[248:251], a[24:27], a[120:123]
    ds_read_b128 v[68:71], v236 offset:1024
    v_mfma_f32_16x16x32_bf16 a[124:127], a[248:251], a[28:31], a[124:127]
    ds_read_b128 v[72:75], v236 offset:2048
    ds_read_b128 v[76:79], v236 offset:3072
    v_mfma_f32_16x16x32_bf16 a[128:131], a[236:239], a[16:19], a[128:131]
    s_add_u32 m0, s65, 160
    ds_read_b64_tr_b16 a[248:249], v253 offset:128
    ds_read_b64_tr_b16 a[250:251], v253 offset:640
    v_mfma_f32_16x16x32_bf16 a[132:135], a[236:239], a[20:23], a[132:135]
    buffer_load_dwordx4 v247, s[32:35], s50 offen offset:896 lds
    v_mfma_f32_16x16x32_bf16 a[136:139], a[236:239], a[24:27], a[136:139]
    ds_read_b128 v[80:83], v236 offset:4096
    ds_read_b128 v[84:87], v236 offset:5120
    v_mfma_f32_16x16x32_bf16 a[140:143], a[236:239], a[28:31], a[140:143]
    ds_read_b128 v[88:91], v236 offset:6144
    s_waitcnt lgkmcnt(0)
    v_mfma_f32_16x16x32_bf16 a[144:147], a[240:243], a[16:19], a[144:147]
    s_add_u32 m0, s65, 320
    ds_read_b64_tr_b16 a[236:237], v253 offset:160
    ds_read_b64_tr_b16 a[238:239], v253 offset:672
    v_mfma_f32_16x16x32_bf16 a[148:151], a[240:243], a[20:23], a[148:151]
    buffer_load_dwordx4 v247, s[32:35], s50 offen offset:1792 lds
    v_cvt_pk_bf16_f32 v28, v140, v141
    v_mfma_f32_16x16x32_bf16 a[152:155], a[240:243], a[24:27], a[152:155]
    v_cvt_pk_bf16_f32 v29, v142, v143
    v_mfma_f32_16x16x32_bf16 a[156:159], a[240:243], a[28:31], a[156:159]
    v_cvt_pk_bf16_f32 v30, v156, v157
    v_mfma_f32_16x16x32_bf16 a[160:163], a[244:247], a[16:19], a[160:163]
    s_add_u32 m0, s65, 480
    ds_read_b64_tr_b16 a[240:241], v253 offset:192
    ds_read_b64_tr_b16 a[242:243], v253 offset:704
    v_cvt_pk_bf16_f32 v31, v158, v159
    v_mfma_f32_16x16x32_bf16 a[164:167], a[244:247], a[20:23], a[164:167]
    buffer_load_dwordx4 v247, s[32:35], s50 offen offset:2688 lds
    s_add_u32 s50, s62, 118272
    s_add_u32 m0, s65, 4224
    v_mfma_f32_16x16x32_bf16 a[168:171], a[244:247], a[24:27], a[168:171]
    buffer_load_dwordx4 v247, s[32:35], s50 offen offset:0 lds
    v_cvt_pk_bf16_f32 v32, v160, v161
    v_mfma_f32_16x16x32_bf16 a[172:175], a[244:247], a[28:31], a[172:175]
    v_cvt_pk_bf16_f32 v33, v162, v163
    v_mfma_f32_16x16x32_bf16 a[176:179], a[248:251], a[16:19], a[176:179]
    s_add_u32 m0, s65, 4384
    ds_read_b64_tr_b16 a[244:245], v253 offset:33792
    ds_read_b64_tr_b16 a[246:247], v253 offset:34304
    v_cvt_pk_bf16_f32 v34, v176, v177
    v_mfma_f32_16x16x32_bf16 a[180:183], a[248:251], a[20:23], a[180:183]
    buffer_load_dwordx4 v247, s[32:35], s50 offen offset:896 lds
    v_mfma_f32_16x16x32_bf16 a[184:187], a[248:251], a[24:27], a[184:187]
    v_cvt_pk_bf16_f32 v35, v178, v179
    v_mfma_f32_16x16x32_bf16 a[188:191], a[248:251], a[28:31], a[188:191]
    s_waitcnt lgkmcnt(2)
    v_cvt_pk_bf16_f32 v36, v164, v165
    v_cvt_pk_bf16_f32 v37, v166, v167
    v_mfma_f32_16x16x32_bf16 a[192:195], a[236:239], a[16:19], a[192:195]
    s_add_u32 m0, s65, 4544
    ds_read_b64_tr_b16 a[248:249], v253 offset:33824
    ds_read_b64_tr_b16 a[250:251], v253 offset:34336
    v_mfma_f32_16x16x32_bf16 a[196:199], a[236:239], a[20:23], a[196:199]
    buffer_load_dwordx4 v247, s[32:35], s50 offen offset:1792 lds
    v_mfma_f32_16x16x32_bf16 a[200:203], a[236:239], a[24:27], a[200:203]
    v_cvt_pk_bf16_f32 v38, v180, v181
    v_cvt_pk_bf16_f32 v39, v182, v183
    v_mfma_f32_16x16x32_bf16 a[204:207], a[236:239], a[28:31], a[204:207]
    v_cvt_pk_bf16_f32 v40, v168, v169
    v_mfma_f32_16x16x32_bf16 a[208:211], a[240:243], a[16:19], a[208:211]
    s_add_u32 m0, s65, 4704
    ds_read_b64_tr_b16 a[236:237], v253 offset:33856
    ds_read_b64_tr_b16 a[238:239], v253 offset:34368
    v_mfma_f32_16x16x32_bf16 a[212:215], a[240:243], a[20:23], a[212:215]
    buffer_load_dwordx4 v247, s[32:35], s50 offen offset:2688 lds
    v_cvt_pk_bf16_f32 v41, v170, v171
    v_mfma_f32_16x16x32_bf16 a[216:219], a[240:243], a[24:27], a[216:219]
    v_cvt_pk_bf16_f32 v42, v184, v185
    v_mfma_f32_16x16x32_bf16 a[220:223], a[240:243], a[28:31], a[220:223]
    v_cvt_pk_bf16_f32 v43, v186, v187
    s_waitcnt vmcnt(8)
    s_barrier
    s_waitcnt lgkmcnt(2)
    v_mfma_f32_16x16x32_bf16 a[112:115], a[244:247], a[32:35], a[112:115]
    s_add_u32 s50, s62, 143360
    s_add_u32 m0, s66, 0
    ds_read_b64_tr_b16 a[240:241], v253 offset:33888
    ds_read_b64_tr_b16 a[242:243], v253 offset:34400
    v_mfma_f32_16x16x32_bf16 a[116:119], a[244:247], a[36:39], a[116:119]
    buffer_load_dwordx4 v247, s[32:35], s50 offen offset:0 lds
    v_cvt_pk_bf16_f32 v44, v172, v173
    v_mfma_f32_16x16x32_bf16 a[120:123], a[244:247], a[40:43], a[120:123]
    v_cvt_pk_bf16_f32 v45, v174, v175
    v_mfma_f32_16x16x32_bf16 a[124:127], a[244:247], a[44:47], a[124:127]
    v_cvt_pk_bf16_f32 v46, v188, v189
    v_cvt_pk_bf16_f32 v47, v190, v191
    v_mfma_f32_16x16x32_bf16 a[128:131], a[248:251], a[32:35], a[128:131]
    s_add_u32 m0, s66, 160
    ds_read_b64_tr_b16 a[244:245], v253 offset:33920
    ds_read_b64_tr_b16 a[246:247], v253 offset:34432
    v_mfma_f32_16x16x32_bf16 a[132:135], a[248:251], a[36:39], a[132:135]
    buffer_load_dwordx4 v247, s[32:35], s50 offen offset:896 lds
    v_cvt_pk_bf16_f32 v48, v192, v193
    v_mfma_f32_16x16x32_bf16 a[136:139], a[248:251], a[40:43], a[136:139]
    v_cvt_pk_bf16_f32 v49, v194, v195
    v_mfma_f32_16x16x32_bf16 a[140:143], a[248:251], a[44:47], a[140:143]
    s_waitcnt lgkmcnt(2)
    v_cvt_pk_bf16_f32 v50, v208, v209
    v_cvt_pk_bf16_f32 v51, v210, v211
    v_mfma_f32_16x16x32_bf16 a[144:147], a[236:239], a[32:35], a[144:147]
    s_add_u32 m0, s66, 320
    ds_read_b64_tr_b16 a[248:249], v253 offset:33952
    ds_read_b64_tr_b16 a[250:251], v253 offset:34464
    v_mfma_f32_16x16x32_bf16 a[148:151], a[236:239], a[36:39], a[148:151]
    buffer_load_dwordx4 v247, s[32:35], s50 offen offset:1792 lds
    v_cvt_pk_bf16_f32 v52, v196, v197
    v_mfma_f32_16x16x32_bf16 a[152:155], a[236:239], a[40:43], a[152:155]
    v_cvt_pk_bf16_f32 v53, v198, v199
    v_mfma_f32_16x16x32_bf16 a[156:159], a[236:239], a[44:47], a[156:159]
    v_cvt_pk_bf16_f32 v54, v212, v213
    v_cvt_pk_bf16_f32 v55, v214, v215
    v_mfma_f32_16x16x32_bf16 a[160:163], a[240:243], a[32:35], a[160:163]
    s_add_u32 m0, s66, 480
    ds_read_b64_tr_b16 a[236:237], v253 offset:33984
    ds_read_b64_tr_b16 a[238:239], v253 offset:34496
    v_mfma_f32_16x16x32_bf16 a[164:167], a[240:243], a[36:39], a[164:167]
    buffer_load_dwordx4 v247, s[32:35], s50 offen offset:2688 lds
    s_add_u32 s50, s62, 146944
    s_add_u32 m0, s66, 4224
    v_mfma_f32_16x16x32_bf16 a[168:171], a[240:243], a[40:43], a[168:171]
    buffer_load_dwordx4 v247, s[32:35], s50 offen offset:0 lds
    v_mfma_f32_16x16x32_bf16 a[172:175], a[240:243], a[44:47], a[172:175]
    s_waitcnt lgkmcnt(2)
    ds_write_b128 v237, v[28:31] offset:0
    v_mfma_f32_16x16x32_bf16 a[176:179], a[244:247], a[32:35], a[176:179]
    s_add_u32 m0, s66, 4384
    ds_read_b64_tr_b16 a[240:241], v252 offset:0
    ds_read_b64_tr_b16 a[242:243], v252 offset:512
    v_mfma_f32_16x16x32_bf16 a[180:183], a[244:247], a[36:39], a[180:183]
    buffer_load_dwordx4 v247, s[32:35], s50 offen offset:896 lds
    v_mfma_f32_16x16x32_bf16 a[184:187], a[244:247], a[40:43], a[184:187]
    ds_write_b128 v237, v[32:35] offset:1024
    v_mfma_f32_16x16x32_bf16 a[188:191], a[244:247], a[44:47], a[188:191]
    ds_write_b128 v237, v[36:39] offset:2048
    v_mfma_f32_16x16x32_bf16 a[192:195], a[248:251], a[32:35], a[192:195]
    s_add_u32 m0, s66, 4544
    ds_read_b64_tr_b16 a[244:245], v252 offset:32
    ds_read_b64_tr_b16 a[246:247], v252 offset:544
    v_mfma_f32_16x16x32_bf16 a[196:199], a[248:251], a[36:39], a[196:199]
    buffer_load_dwordx4 v247, s[32:35], s50 offen offset:1792 lds
    v_mfma_f32_16x16x32_bf16 a[200:203], a[248:251], a[40:43], a[200:203]
    ds_write_b128 v237, v[40:43] offset:3072
    v_mfma_f32_16x16x32_bf16 a[204:207], a[248:251], a[44:47], a[204:207]
    s_waitcnt lgkmcnt(8)
    ds_write_b128 v237, v[44:47] offset:4096
    v_mfma_f32_16x16x32_bf16 a[208:211], a[236:239], a[32:35], a[208:211]
    s_add_u32 m0, s66, 4704
    ds_read_b64_tr_b16 a[248:249], v252 offset:64
    ds_read_b64_tr_b16 a[250:251], v252 offset:576
    v_mfma_f32_16x16x32_bf16 a[212:215], a[236:239], a[36:39], a[212:215]
    buffer_load_dwordx4 v247, s[32:35], s50 offen offset:2688 lds
    v_mfma_f32_16x16x32_bf16 a[216:219], a[236:239], a[40:43], a[216:219]
    ds_write_b128 v237, v[48:51] offset:5120
    v_mfma_f32_16x16x32_bf16 a[220:223], a[236:239], a[44:47], a[220:223]
    ds_write_b128 v237, v[52:55] offset:6144
    s_waitcnt lgkmcnt(0)
    s_waitcnt vmcnt(8)
    s_barrier
    v_mfma_f32_16x16x32_bf16 a[112:115], a[240:243], a[48:51], a[112:115]
    s_add_u32 s50, s62, 172032
    s_add_u32 m0, s67, 0
    ds_read_b64_tr_b16 a[236:237], v252 offset:96
    ds_read_b64_tr_b16 a[238:239], v252 offset:608
    v_mfma_f32_16x16x32_bf16 a[116:119], a[240:243], a[52:55], a[116:119]
    buffer_load_dwordx4 v247, s[32:35], s50 offen offset:0 lds
    ds_read_b128 v[92:95], v236 offset:0
    v_mfma_f32_16x16x32_bf16 a[120:123], a[240:243], a[56:59], a[120:123]
    ds_read_b128 v[96:99], v236 offset:1024
    v_mfma_f32_16x16x32_bf16 a[124:127], a[240:243], a[60:63], a[124:127]
    v_mfma_f32_16x16x32_bf16 a[128:131], a[244:247], a[48:51], a[128:131]
    s_add_u32 m0, s67, 160
    ds_read_b64_tr_b16 a[240:241], v252 offset:128
    ds_read_b64_tr_b16 a[242:243], v252 offset:640
    ds_read_b128 v[100:103], v236 offset:2048
    v_mfma_f32_16x16x32_bf16 a[132:135], a[244:247], a[52:55], a[132:135]
    buffer_load_dwordx4 v247, s[32:35], s50 offen offset:896 lds
    v_mfma_f32_16x16x32_bf16 a[136:139], a[244:247], a[56:59], a[136:139]
    ds_read_b128 v[104:107], v236 offset:3072
    v_mfma_f32_16x16x32_bf16 a[140:143], a[244:247], a[60:63], a[140:143]
    ds_read_b128 v[108:111], v236 offset:4096
    v_mfma_f32_16x16x32_bf16 a[144:147], a[248:251], a[48:51], a[144:147]
    s_add_u32 m0, s67, 320
    ds_read_b64_tr_b16 a[244:245], v252 offset:160
    ds_read_b64_tr_b16 a[246:247], v252 offset:672
    v_mfma_f32_16x16x32_bf16 a[148:151], a[248:251], a[52:55], a[148:151]
    buffer_load_dwordx4 v247, s[32:35], s50 offen offset:1792 lds
    v_mfma_f32_16x16x32_bf16 a[152:155], a[248:251], a[56:59], a[152:155]
    ds_read_b128 v[112:115], v236 offset:5120
    v_mfma_f32_16x16x32_bf16 a[156:159], a[248:251], a[60:63], a[156:159]
    s_waitcnt lgkmcnt(6)
    ds_read_b128 v[116:119], v236 offset:6144
    s_waitcnt lgkmcnt(0)
    v_mfma_f32_16x16x32_bf16 a[160:163], a[236:239], a[48:51], a[160:163]
    s_add_u32 m0, s67, 480
    ds_read_b64_tr_b16 a[248:249], v252 offset:192
    ds_read_b64_tr_b16 a[250:251], v252 offset:704
    v_mfma_f32_16x16x32_bf16 a[164:167], a[236:239], a[52:55], a[164:167]
    buffer_load_dwordx4 v247, s[32:35], s50 offen offset:2688 lds
    s_add_u32 s50, s62, 175616
    s_add_u32 m0, s67, 4224
    v_cvt_pk_bf16_f32 v56, v200, v201
    v_mfma_f32_16x16x32_bf16 a[168:171], a[236:239], a[56:59], a[168:171]
    buffer_load_dwordx4 v247, s[32:35], s50 offen offset:0 lds
    v_mfma_f32_16x16x32_bf16 a[172:175], a[236:239], a[60:63], a[172:175]
    v_cvt_pk_bf16_f32 v57, v202, v203
    v_mfma_f32_16x16x32_bf16 a[176:179], a[240:243], a[48:51], a[176:179]
    s_add_u32 m0, s67, 4384
    ds_read_b64_tr_b16 a[236:237], v252 offset:33792
    ds_read_b64_tr_b16 a[238:239], v252 offset:34304
    v_mfma_f32_16x16x32_bf16 a[180:183], a[240:243], a[52:55], a[180:183]
    buffer_load_dwordx4 v247, s[32:35], s50 offen offset:896 lds
    v_mfma_f32_16x16x32_bf16 a[184:187], a[240:243], a[56:59], a[184:187]
    v_cvt_pk_bf16_f32 v58, v216, v217
    v_mfma_f32_16x16x32_bf16 a[188:191], a[240:243], a[60:63], a[188:191]
    s_waitcnt lgkmcnt(2)
    v_cvt_pk_bf16_f32 v59, v218, v219
    v_mfma_f32_16x16x32_bf16 a[192:195], a[244:247], a[48:51], a[192:195]
    s_add_u32 m0, s67, 4544
    ds_read_b64_tr_b16 a[240:241], v252 offset:33824
    ds_read_b64_tr_b16 a[242:243], v252 offset:34336
    v_mfma_f32_16x16x32_bf16 a[196:199], a[244:247], a[52:55], a[196:199]
    buffer_load_dwordx4 v247, s[32:35], s50 offen offset:1792 lds
    v_cvt_pk_bf16_f32 v60, v204, v205
    v_mfma_f32_16x16x32_bf16 a[200:203], a[244:247], a[56:59], a[200:203]
    v_mfma_f32_16x16x32_bf16 a[204:207], a[244:247], a[60:63], a[204:207]
    v_cvt_pk_bf16_f32 v61, v206, v207
    v_mfma_f32_16x16x32_bf16 a[208:211], a[248:251], a[48:51], a[208:211]
    s_add_u32 m0, s67, 4704
    ds_read_b64_tr_b16 a[244:245], v252 offset:33856
    ds_read_b64_tr_b16 a[246:247], v252 offset:34368
    v_cvt_pk_bf16_f32 v62, v220, v221
    v_mfma_f32_16x16x32_bf16 a[212:215], a[248:251], a[52:55], a[212:215]
    buffer_load_dwordx4 v247, s[32:35], s50 offen offset:2688 lds
    v_mfma_f32_16x16x32_bf16 a[216:219], a[248:251], a[56:59], a[216:219]
    v_cvt_pk_bf16_f32 v63, v222, v223
    v_mfma_f32_16x16x32_bf16 a[220:223], a[248:251], a[60:63], a[220:223]
    s_waitcnt vmcnt(8)
    s_barrier
    s_waitcnt lgkmcnt(2)
    v_mfma_f32_16x16x32_bf16 a[112:115], a[236:239], a[64:67], a[112:115]
    s_add_u32 s48, s48, 0x8000
    s_mov_b32 m0, s64
    ds_read_b64_tr_b16 a[248:249], v252 offset:33888
    ds_read_b64_tr_b16 a[250:251], v252 offset:34400
    v_mfma_f32_16x16x32_bf16 a[116:119], a[236:239], a[68:71], a[116:119]
    buffer_load_dwordx4 v250, s[8:11], s48 offen offset:0 lds
    v_mfma_f32_16x16x32_bf16 a[120:123], a[236:239], a[72:75], a[120:123]
    v_mfma_f32_16x16x32_bf16 a[124:127], a[236:239], a[76:79], a[124:127]
    v_mfma_f32_16x16x32_bf16 a[128:131], a[240:243], a[64:67], a[128:131]
    s_add_u32 m0, m0, 544
    ds_read_b64_tr_b16 a[236:237], v252 offset:33920
    ds_read_b64_tr_b16 a[238:239], v252 offset:34432
    v_mfma_f32_16x16x32_bf16 a[132:135], a[240:243], a[68:71], a[132:135]
    buffer_load_dwordx4 v250, s[8:11], s48 offen offset:512 lds
    v_mfma_f32_16x16x32_bf16 a[136:139], a[240:243], a[72:75], a[136:139]
    v_mfma_f32_16x16x32_bf16 a[140:143], a[240:243], a[76:79], a[140:143]
    s_waitcnt lgkmcnt(2)
    ds_write_b128 v237, v[56:59] offset:0
    v_mfma_f32_16x16x32_bf16 a[144:147], a[244:247], a[64:67], a[144:147]
    s_add_u32 m0, m0, 544
    ds_read_b64_tr_b16 a[240:241], v252 offset:33952
    ds_read_b64_tr_b16 a[242:243], v252 offset:34464
    v_mfma_f32_16x16x32_bf16 a[148:151], a[244:247], a[68:71], a[148:151]
    buffer_load_dwordx4 v250, s[8:11], s48 offen offset:1024 lds
    v_mfma_f32_16x16x32_bf16 a[152:155], a[244:247], a[72:75], a[152:155]
    v_mfma_f32_16x16x32_bf16 a[156:159], a[244:247], a[76:79], a[156:159]
    v_mfma_f32_16x16x32_bf16 a[160:163], a[248:251], a[64:67], a[160:163]
    s_add_u32 m0, m0, 544
    ds_read_b64_tr_b16 a[244:245], v252 offset:33984
    ds_read_b64_tr_b16 a[246:247], v252 offset:34496
    v_mfma_f32_16x16x32_bf16 a[164:167], a[248:251], a[68:71], a[164:167]
    buffer_load_dwordx4 v250, s[8:11], s48 offen offset:1536 lds
    s_add_u32 m0, m0, 544
    v_mfma_f32_16x16x32_bf16 a[168:171], a[248:251], a[72:75], a[168:171]
    buffer_load_dwordx4 v250, s[8:11], s48 offen offset:2048 lds
    v_mfma_f32_16x16x32_bf16 a[172:175], a[248:251], a[76:79], a[172:175]
    s_waitcnt lgkmcnt(2)
    v_mfma_f32_16x16x32_bf16 a[176:179], a[236:239], a[64:67], a[176:179]
    s_add_u32 m0, m0, 544
    ds_read_b64_tr_b16 a[248:249], v253 offset:0
    ds_read_b64_tr_b16 a[250:251], v253 offset:512
    v_mfma_f32_16x16x32_bf16 a[180:183], a[236:239], a[68:71], a[180:183]
    buffer_load_dwordx4 v250, s[8:11], s48 offen offset:2560 lds
    v_mfma_f32_16x16x32_bf16 a[184:187], a[236:239], a[72:75], a[184:187]
    v_mfma_f32_16x16x32_bf16 a[188:191], a[236:239], a[76:79], a[188:191]
    v_mfma_f32_16x16x32_bf16 a[192:195], a[240:243], a[64:67], a[192:195]
    s_add_u32 m0, m0, 544
    ds_read_b64_tr_b16 a[236:237], v253 offset:32
    ds_read_b64_tr_b16 a[238:239], v253 offset:544
    v_mfma_f32_16x16x32_bf16 a[196:199], a[240:243], a[68:71], a[196:199]
    buffer_load_dwordx4 v250, s[8:11], s48 offen offset:3072 lds
    v_mfma_f32_16x16x32_bf16 a[200:203], a[240:243], a[72:75], a[200:203]
    ds_write_b128 v237, v[60:63] offset:1024
    s_waitcnt lgkmcnt(0)
    v_mfma_f32_16x16x32_bf16 a[204:207], a[240:243], a[76:79], a[204:207]
    v_mfma_f32_16x16x32_bf16 a[208:211], a[244:247], a[64:67], a[208:211]
    s_add_u32 m0, m0, 544
    ds_read_b64_tr_b16 a[240:241], v253 offset:64
    ds_read_b64_tr_b16 a[242:243], v253 offset:576
    v_mfma_f32_16x16x32_bf16 a[212:215], a[244:247], a[68:71], a[212:215]
    buffer_load_dwordx4 v250, s[8:11], s48 offen offset:3584 lds
    v_mfma_f32_16x16x32_bf16 a[216:219], a[244:247], a[72:75], a[216:219]
    v_mfma_f32_16x16x32_bf16 a[220:223], a[244:247], a[76:79], a[220:223]
    s_waitcnt vmcnt(8)
    s_barrier
    v_mfma_f32_16x16x32_bf16 a[112:115], a[248:251], a[80:83], a[112:115]
    s_add_u32 s48, s48, 0x8000
    s_mov_b32 m0, s65
    ds_read_b64_tr_b16 a[244:245], v253 offset:96
    ds_read_b64_tr_b16 a[246:247], v253 offset:608
    v_mfma_f32_16x16x32_bf16 a[116:119], a[248:251], a[84:87], a[116:119]
    buffer_load_dwordx4 v250, s[8:11], s48 offen offset:0 lds
    ds_read_b128 v[120:123], v236 offset:0
    v_mfma_f32_16x16x32_bf16 a[120:123], a[248:251], a[88:91], a[120:123]
    v_mfma_f32_16x16x32_bf16 a[124:127], a[248:251], a[92:95], a[124:127]
    s_waitcnt lgkmcnt(3)
    v_mfma_f32_16x16x32_bf16 a[128:131], a[236:239], a[80:83], a[128:131]
    s_add_u32 m0, m0, 544
    ds_read_b64_tr_b16 a[248:249], v253 offset:128
    ds_read_b64_tr_b16 a[250:251], v253 offset:640
    v_mfma_f32_16x16x32_bf16 a[132:135], a[236:239], a[84:87], a[132:135]
    buffer_load_dwordx4 v250, s[8:11], s48 offen offset:512 lds
    v_mfma_f32_16x16x32_bf16 a[136:139], a[236:239], a[88:91], a[136:139]
    ds_read_b128 v[124:127], v236 offset:1024
    s_waitcnt lgkmcnt(0)
    v_mfma_f32_16x16x32_bf16 a[140:143], a[236:239], a[92:95], a[140:143]
    v_mfma_f32_16x16x32_bf16 a[144:147], a[240:243], a[80:83], a[144:147]
    s_add_u32 m0, m0, 544
    ds_read_b64_tr_b16 a[236:237], v253 offset:160
    ds_read_b64_tr_b16 a[238:239], v253 offset:672
    v_mfma_f32_16x16x32_bf16 a[148:151], a[240:243], a[84:87], a[148:151]
    buffer_load_dwordx4 v250, s[8:11], s48 offen offset:1024 lds
    v_mfma_f32_16x16x32_bf16 a[152:155], a[240:243], a[88:91], a[152:155]
    v_mfma_f32_16x16x32_bf16 a[156:159], a[240:243], a[92:95], a[156:159]
    v_mfma_f32_16x16x32_bf16 a[160:163], a[244:247], a[80:83], a[160:163]
    s_add_u32 m0, m0, 544
    ds_read_b64_tr_b16 a[240:241], v253 offset:192
    ds_read_b64_tr_b16 a[242:243], v253 offset:704
    v_mfma_f32_16x16x32_bf16 a[164:167], a[244:247], a[84:87], a[164:167]
    buffer_load_dwordx4 v250, s[8:11], s48 offen offset:1536 lds
    s_add_u32 m0, m0, 544
    v_and_b32 v232, 15, v251
    v_mfma_f32_16x16x32_bf16 a[168:171], a[244:247], a[88:91], a[168:171]
    buffer_load_dwordx4 v250, s[8:11], s48 offen offset:2048 lds
    v_mfma_f32_16x16x32_bf16 a[172:175], a[244:247], a[92:95], a[172:175]
    v_lshrrev_b32 v233, 4, v251
    s_mul_i32 s100, s54, 16896
    s_lshl_b32 s101, s54, 8
    v_mfma_f32_16x16x32_bf16 a[176:179], a[248:251], a[80:83], a[176:179]
    s_add_u32 m0, m0, 544
    ds_read_b64_tr_b16 a[244:245], v253 offset:33792
    ds_read_b64_tr_b16 a[246:247], v253 offset:34304
    v_mfma_f32_16x16x32_bf16 a[180:183], a[248:251], a[84:87], a[180:183]
    buffer_load_dwordx4 v250, s[8:11], s48 offen offset:2560 lds
    v_mul_u32_u24 v248, 1056, v232
    v_mfma_f32_16x16x32_bf16 a[184:187], a[248:251], a[88:91], a[184:187]
    v_lshl_add_u32 v248, v233, 4, v248
    v_mfma_f32_16x16x32_bf16 a[188:191], a[248:251], a[92:95], a[188:191]
    s_waitcnt lgkmcnt(2)
    v_add_u32 v248, s100, v248
    v_mfma_f32_16x16x32_bf16 a[192:195], a[236:239], a[80:83], a[192:195]
    s_add_u32 m0, m0, 544
    ds_read_b64_tr_b16 a[248:249], v253 offset:33824
    ds_read_b64_tr_b16 a[250:251], v253 offset:34336
    v_mfma_f32_16x16x32_bf16 a[196:199], a[236:239], a[84:87], a[196:199]
    buffer_load_dwordx4 v250, s[8:11], s48 offen offset:3072 lds
    v_mfma_f32_16x16x32_bf16 a[200:203], a[236:239], a[88:91], a[200:203]
    v_subrev_u32 v224, s101, v248
    v_mfma_f32_16x16x32_bf16 a[204:207], a[236:239], a[92:95], a[204:207]
    v_add_u32 v248, s101, v248
    v_mfma_f32_16x16x32_bf16 a[208:211], a[240:243], a[80:83], a[208:211]
    s_add_u32 m0, m0, 544
    ds_read_b64_tr_b16 a[236:237], v253 offset:33856
    ds_read_b64_tr_b16 a[238:239], v253 offset:34368
    v_lshl_add_u32 v249, v245, 3, v244
    v_mfma_f32_16x16x32_bf16 a[212:215], a[240:243], a[84:87], a[212:215]
    buffer_load_dwordx4 v250, s[8:11], s48 offen offset:3584 lds
    v_mfma_f32_16x16x32_bf16 a[216:219], a[240:243], a[88:91], a[216:219]
    v_add_u32 v249, s100, v249
    v_mfma_f32_16x16x32_bf16 a[220:223], a[240:243], a[92:95], a[220:223]
    v_add_u32 v249, 67584, v249
    s_waitcnt vmcnt(8)
    s_barrier
    s_waitcnt lgkmcnt(2)
    v_mfma_f32_16x16x32_bf16 a[112:115], a[244:247], a[96:99], a[112:115]
    s_add_u32 s49, s49, 0x8000
    s_mov_b32 m0, s66
    ds_read_b64_tr_b16 a[240:241], v253 offset:33888
    ds_read_b64_tr_b16 a[242:243], v253 offset:34400
    v_mfma_f32_16x16x32_bf16 a[116:119], a[244:247], a[100:103], a[116:119]
    buffer_load_dwordx4 v250, s[12:15], s49 offen offset:0 lds
    v_mov_b32 v192, 0
    v_mfma_f32_16x16x32_bf16 a[120:123], a[244:247], a[104:107], a[120:123]
    v_mov_b32 v193, 0
    v_mfma_f32_16x16x32_bf16 a[124:127], a[244:247], a[108:111], a[124:127]
    v_mov_b32 v194, 0
    v_mfma_f32_16x16x32_bf16 a[128:131], a[248:251], a[96:99], a[128:131]
    s_add_u32 m0, m0, 544
    ds_read_b64_tr_b16 a[244:245], v253 offset:33920
    ds_read_b64_tr_b16 a[246:247], v253 offset:34432
    v_mfma_f32_16x16x32_bf16 a[132:135], a[248:251], a[100:103], a[132:135]
    buffer_load_dwordx4 v250, s[12:15], s49 offen offset:512 lds
    v_mfma_f32_16x16x32_bf16 a[136:139], a[248:251], a[104:107], a[136:139]
    v_mov_b32 v195, 0
    v_mfma_f32_16x16x32_bf16 a[140:143], a[248:251], a[108:111], a[140:143]
    s_waitcnt lgkmcnt(2)
    v_mov_b32 v196, 0
    v_mfma_f32_16x16x32_bf16 a[144:147], a[236:239], a[96:99], a[144:147]
    s_add_u32 m0, m0, 544
    ds_read_b64_tr_b16 a[248:249], v253 offset:33952
    ds_read_b64_tr_b16 a[250:251], v253 offset:34464
    v_mfma_f32_16x16x32_bf16 a[148:151], a[236:239], a[100:103], a[148:151]
    buffer_load_dwordx4 v250, s[12:15], s49 offen offset:1024 lds
    v_mov_b32 v197, 0
    v_mfma_f32_16x16x32_bf16 a[152:155], a[236:239], a[104:107], a[152:155]
    v_mov_b32 v198, 0
    v_mfma_f32_16x16x32_bf16 a[156:159], a[236:239], a[108:111], a[156:159]
    v_mov_b32 v199, 0
    v_mfma_f32_16x16x32_bf16 a[160:163], a[240:243], a[96:99], a[160:163]
    s_add_u32 m0, m0, 544
    ds_read_b64_tr_b16 a[236:237], v253 offset:33984
    ds_read_b64_tr_b16 a[238:239], v253 offset:34496
    v_mfma_f32_16x16x32_bf16 a[164:167], a[240:243], a[100:103], a[164:167]
    buffer_load_dwordx4 v250, s[12:15], s49 offen offset:1536 lds
    s_add_u32 m0, m0, 544
    v_mfma_f32_16x16x32_bf16 a[168:171], a[240:243], a[104:107], a[168:171]
    buffer_load_dwordx4 v250, s[12:15], s49 offen offset:2048 lds
    v_mov_b32 v200, 0
    v_mfma_f32_16x16x32_bf16 a[172:175], a[240:243], a[108:111], a[172:175]
    s_waitcnt lgkmcnt(2)
    v_mov_b32 v201, 0
    v_mfma_f32_16x16x32_bf16 a[176:179], a[244:247], a[96:99], a[176:179]
    s_add_u32 m0, m0, 544
    ds_read_b128 v[212:215], v248 offset:0
    v_mfma_f32_16x16x32_bf16 a[180:183], a[244:247], a[100:103], a[180:183]
    buffer_load_dwordx4 v250, s[12:15], s49 offen offset:2560 lds
    v_mov_b32 v202, 0
    v_mfma_f32_16x16x32_bf16 a[184:187], a[244:247], a[104:107], a[184:187]
    v_mov_b32 v203, 0
    v_mfma_f32_16x16x32_bf16 a[188:191], a[244:247], a[108:111], a[188:191]
    v_mov_b32 v204, 0
    v_mfma_f32_16x16x32_bf16 a[192:195], a[248:251], a[96:99], a[192:195]
    s_add_u32 m0, m0, 544
    ds_read_b128 v[216:219], v248 offset:64
    v_mfma_f32_16x16x32_bf16 a[196:199], a[248:251], a[100:103], a[196:199]
    buffer_load_dwordx4 v250, s[12:15], s49 offen offset:3072 lds
    v_mov_b32 v205, 0
    v_mfma_f32_16x16x32_bf16 a[200:203], a[248:251], a[104:107], a[200:203]
    v_mov_b32 v206, 0
    v_mfma_f32_16x16x32_bf16 a[204:207], a[248:251], a[108:111], a[204:207]
    s_waitcnt lgkmcnt(2)
    v_mov_b32 v207, 0
    v_mfma_f32_16x16x32_bf16 a[208:211], a[236:239], a[96:99], a[208:211]
    s_add_u32 m0, m0, 544
    ds_read_b128 v[220:223], v248 offset:128
    v_mfma_f32_16x16x32_bf16 a[212:215], a[236:239], a[100:103], a[212:215]
    buffer_load_dwordx4 v250, s[12:15], s49 offen offset:3584 lds
    v_mfma_f32_16x16x32_bf16 a[216:219], a[236:239], a[104:107], a[216:219]
    s_cmp_eq_u32 s54, 0
    s_cselect_b32 s40, s8, s12
    s_cselect_b32 s41, s9, s13
    s_mov_b32 s42, 0x100000
    s_mov_b32 s58, 163840
    s_mov_b32 s32, s96
    s_mov_b32 s33, s97
    s_mov_b32 s34, 256
    s_lshl_b32 s100, s45, 10
    s_lshl_b32 s101, s53, 9
    s_add_u32 s100, s100, s101
    v_lshlrev_b32 v226, 7, v251
    v_add_u32 v226, s100, v226
    v_cmp_lt_u32 vcc, 3, v251
    v_mov_b32 v227, 0x40000000
    s_nop 1
    v_cndmask_b32 v226, v226, v227, vcc
    v_mfma_f32_16x16x32_bf16 a[220:223], a[236:239], a[108:111], a[220:223]
    s_waitcnt vmcnt(8)
    s_barrier
    s_waitcnt lgkmcnt(2)
    v_mfma_f32_16x16x32_bf16 v[128:131], v[212:215], v[0:3], v[192:195]
    ds_read_b128 v[208:211], v248 offset:192
    v_mfma_f32_16x16x32_bf16 v[132:135], v[212:215], v[4:7], v[196:199]
    v_mfma_f32_16x16x32_bf16 v[136:139], v[212:215], v[8:11], v[200:203]
    v_mfma_f32_16x16x32_bf16 v[140:143], v[212:215], v[12:15], v[204:207]
    s_waitcnt lgkmcnt(1)
    v_mfma_f32_16x16x32_bf16 v[128:131], v[216:219], v[16:19], v[128:131]
    ds_read_b128 v[212:215], v224 offset:256
    v_mfma_f32_16x16x32_bf16 v[132:135], v[216:219], v[20:23], v[132:135]
    v_mfma_f32_16x16x32_bf16 v[136:139], v[216:219], v[24:27], v[136:139]
    v_mfma_f32_16x16x32_bf16 v[140:143], v[216:219], v[28:31], v[140:143]
    v_mfma_f32_16x16x32_bf16 v[128:131], v[220:223], v[32:35], v[128:131]
    ds_read_b128 v[216:219], v224 offset:320
    v_mfma_f32_16x16x32_bf16 v[132:135], v[220:223], v[36:39], v[132:135]
    v_mfma_f32_16x16x32_bf16 v[136:139], v[220:223], v[40:43], v[136:139]
    v_mfma_f32_16x16x32_bf16 v[140:143], v[220:223], v[44:47], v[140:143]
    s_waitcnt lgkmcnt(1)
    v_mfma_f32_16x16x32_bf16 v[128:131], v[208:211], v[48:51], v[128:131]
    ds_read_b128 v[220:223], v224 offset:384
    v_mfma_f32_16x16x32_bf16 v[132:135], v[208:211], v[52:55], v[132:135]
    v_mfma_f32_16x16x32_bf16 v[136:139], v[208:211], v[56:59], v[136:139]
    v_mfma_f32_16x16x32_bf16 v[140:143], v[208:211], v[60:63], v[140:143]
    v_mfma_f32_16x16x32_bf16 v[128:131], v[212:215], v[64:67], v[128:131]
    ds_read_b128 v[208:211], v224 offset:448
    v_mfma_f32_16x16x32_bf16 v[132:135], v[212:215], v[68:71], v[132:135]
    v_mfma_f32_16x16x32_bf16 v[136:139], v[212:215], v[72:75], v[136:139]
    v_mfma_f32_16x16x32_bf16 v[140:143], v[212:215], v[76:79], v[140:143]
    s_waitcnt lgkmcnt(1)
    v_mfma_f32_16x16x32_bf16 v[128:131], v[216:219], v[80:83], v[128:131]
    ds_read_b128 v[212:215], v248 offset:512
    v_mfma_f32_16x16x32_bf16 v[132:135], v[216:219], v[84:87], v[132:135]
    v_mfma_f32_16x16x32_bf16 v[136:139], v[216:219], v[88:91], v[136:139]
    v_mfma_f32_16x16x32_bf16 v[140:143], v[216:219], v[92:95], v[140:143]
    v_mfma_f32_16x16x32_bf16 v[128:131], v[220:223], v[96:99], v[128:131]
    ds_read_b128 v[216:219], v248 offset:576
    v_mfma_f32_16x16x32_bf16 v[132:135], v[220:223], v[100:103], v[132:135]
    v_mfma_f32_16x16x32_bf16 v[136:139], v[220:223], v[104:107], v[136:139]
    v_mfma_f32_16x16x32_bf16 v[140:143], v[220:223], v[108:111], v[140:143]
    s_waitcnt lgkmcnt(1)
    v_mfma_f32_16x16x32_bf16 v[128:131], v[208:211], v[112:115], v[128:131]
    ds_read_b128 v[220:223], v248 offset:640
    v_mfma_f32_16x16x32_bf16 v[132:135], v[208:211], v[116:119], v[132:135]
    v_mfma_f32_16x16x32_bf16 v[136:139], v[208:211], v[120:123], v[136:139]
    v_mfma_f32_16x16x32_bf16 v[140:143], v[208:211], v[124:127], v[140:143]
    v_mfma_f32_16x16x32_bf16 v[144:147], v[212:215], v[0:3], v[192:195]
    ds_read_b128 v[208:211], v248 offset:704
    v_mfma_f32_16x16x32_bf16 v[148:151], v[212:215], v[4:7], v[196:199]
    v_mfma_f32_16x16x32_bf16 v[152:155], v[212:215], v[8:11], v[200:203]
    v_mfma_f32_16x16x32_bf16 v[156:159], v[212:215], v[12:15], v[204:207]
    s_waitcnt lgkmcnt(1)
    v_mfma_f32_16x16x32_bf16 v[144:147], v[216:219], v[16:19], v[144:147]
    ds_read_b128 v[212:215], v224 offset:768
    v_mfma_f32_16x16x32_bf16 v[148:151], v[216:219], v[20:23], v[148:151]
    v_mfma_f32_16x16x32_bf16 v[152:155], v[216:219], v[24:27], v[152:155]
    v_mfma_f32_16x16x32_bf16 v[156:159], v[216:219], v[28:31], v[156:159]
    v_mfma_f32_16x16x32_bf16 v[144:147], v[220:223], v[32:35], v[144:147]
    ds_read_b128 v[216:219], v224 offset:832
    v_mfma_f32_16x16x32_bf16 v[148:151], v[220:223], v[36:39], v[148:151]
    v_mfma_f32_16x16x32_bf16 v[152:155], v[220:223], v[40:43], v[152:155]
    v_mfma_f32_16x16x32_bf16 v[156:159], v[220:223], v[44:47], v[156:159]
    s_waitcnt lgkmcnt(1)
    v_mfma_f32_16x16x32_bf16 v[144:147], v[208:211], v[48:51], v[144:147]
    ds_read_b128 v[220:223], v224 offset:896
    v_mfma_f32_16x16x32_bf16 v[148:151], v[208:211], v[52:55], v[148:151]
    v_mfma_f32_16x16x32_bf16 v[152:155], v[208:211], v[56:59], v[152:155]
    v_mfma_f32_16x16x32_bf16 v[156:159], v[208:211], v[60:63], v[156:159]
    v_mfma_f32_16x16x32_bf16 v[144:147], v[212:215], v[64:67], v[144:147]
    ds_read_b128 v[208:211], v224 offset:960
    v_mfma_f32_16x16x32_bf16 v[148:151], v[212:215], v[68:71], v[148:151]
    v_mfma_f32_16x16x32_bf16 v[152:155], v[212:215], v[72:75], v[152:155]
    v_mfma_f32_16x16x32_bf16 v[156:159], v[212:215], v[76:79], v[156:159]
    s_waitcnt lgkmcnt(2)
    v_mfma_f32_16x16x32_bf16 v[144:147], v[216:219], v[80:83], v[144:147]
    v_mfma_f32_16x16x32_bf16 v[148:151], v[216:219], v[84:87], v[148:151]
    v_mfma_f32_16x16x32_bf16 v[152:155], v[216:219], v[88:91], v[152:155]
    v_mfma_f32_16x16x32_bf16 v[156:159], v[216:219], v[92:95], v[156:159]
    s_waitcnt vmcnt(0)
    s_waitcnt lgkmcnt(0)
    s_barrier
    v_mfma_f32_16x16x32_bf16 v[144:147], v[220:223], v[96:99], v[144:147]
    ds_read_b128 v[212:215], v248 offset:33792
    v_mfma_f32_16x16x32_bf16 v[148:151], v[220:223], v[100:103], v[148:151]
    ds_read_b128 v[216:219], v248 offset:33856
    v_mfma_f32_16x16x32_bf16 v[152:155], v[220:223], v[104:107], v[152:155]
    v_mfma_f32_16x16x32_bf16 v[156:159], v[220:223], v[108:111], v[156:159]
    v_mfma_f32_16x16x32_bf16 v[144:147], v[208:211], v[112:115], v[144:147]
    ds_read_b128 v[220:223], v248 offset:33920
    v_mfma_f32_16x16x32_bf16 v[148:151], v[208:211], v[116:119], v[148:151]
    v_mfma_f32_16x16x32_bf16 v[152:155], v[208:211], v[120:123], v[152:155]
    v_mfma_f32_16x16x32_bf16 v[156:159], v[208:211], v[124:127], v[156:159]
    v_mov_b32 v240, 0
    v_mov_b32 v241, 0
    v_mov_b32 v242, 0
    v_mov_b32 v243, 0
    v_mov_b32 v244, 0
    v_mov_b32 v245, 0
    v_mov_b32 v246, 0
    v_mov_b32 v247, 0
    s_nop 7
    s_nop 3
    v_max3_f32 v232, v128, v129, v130
    v_max3_f32 v233, v132, v133, v134
    v_max3_f32 v234, v136, v137, v138
    v_max3_f32 v235, v140, v141, v142
    v_max3_f32 v232, v232, v131, v144
    v_max3_f32 v233, v233, v135, v148
    v_max3_f32 v234, v234, v139, v152
    s_add_u32 s48, s48, 0x8000
    s_mov_b32 m0, s64
    v_max3_f32 v235, v235, v143, v156
    buffer_load_dwordx4 v250, s[8:11], s48 offen offset:0 lds
    v_max3_f32 v232, v232, v145, v146
    v_max3_f32 v233, v233, v149, v150
    v_max3_f32 v234, v234, v153, v154
    v_max3_f32 v235, v235, v157, v158
    v_max_f32 v232, v232, v147
    v_max_f32 v233, v233, v151
    v_max_f32 v234, v234, v155
    v_max_f32 v235, v235, v159
    s_nop 0
    s_add_u32 m0, m0, 544
    v_mov_b32 v236, v232
    buffer_load_dwordx4 v250, s[8:11], s48 offen offset:512 lds
    v_mov_b32 v237, v233
    v_mov_b32 v238, v234
    v_mov_b32 v239, v235
    v_permlane16_swap_b32 v232, v236
    v_permlane16_swap_b32 v233, v237
    v_permlane16_swap_b32 v234, v238
    v_permlane16_swap_b32 v235, v239
    v_max_f32 v232, v232, v236
    v_max_f32 v233, v233, v237
    s_add_u32 m0, m0, 544
    v_max_f32 v234, v234, v238
    buffer_load_dwordx4 v250, s[8:11], s48 offen offset:1024 lds
    v_max_f32 v235, v235, v239
    v_mov_b32 v236, v232
    v_mov_b32 v237, v233
    v_mov_b32 v238, v234
    v_mov_b32 v239, v235
    v_permlane32_swap_b32 v232, v236
    v_permlane32_swap_b32 v233, v237
    v_permlane32_swap_b32 v234, v238
    v_permlane32_swap_b32 v235, v239
    s_add_u32 m0, m0, 544
    v_max_f32 v232, v232, v236
    buffer_load_dwordx4 v250, s[8:11], s48 offen offset:1536 lds
    v_max_f32 v233, v233, v237
    v_max_f32 v234, v234, v238
    v_max_f32 v235, v235, v239
    v_sub_f32 v128, v128, v232
    v_sub_f32 v129, v129, v232
    v_sub_f32 v130, v130, v232
    v_sub_f32 v131, v131, v232
    v_sub_f32 v144, v144, v232
    v_sub_f32 v145, v145, v232
    s_add_u32 m0, m0, 544
    v_sub_f32 v146, v146, v232
    buffer_load_dwordx4 v250, s[8:11], s48 offen offset:2048 lds
    v_sub_f32 v147, v147, v232
    v_sub_f32 v192, v192, v232
    v_sub_f32 v193, v193, v232
    v_sub_f32 v194, v194, v232
    v_sub_f32 v195, v195, v232
    v_sub_f32 v132, v132, v233
    v_sub_f32 v133, v133, v233
    v_sub_f32 v134, v134, v233
    v_sub_f32 v135, v135, v233
    s_add_u32 m0, m0, 544
    v_sub_f32 v148, v148, v233
    buffer_load_dwordx4 v250, s[8:11], s48 offen offset:2560 lds
    v_sub_f32 v149, v149, v233
    v_sub_f32 v150, v150, v233
    v_sub_f32 v151, v151, v233
    v_sub_f32 v196, v196, v233
    v_sub_f32 v197, v197, v233
    v_sub_f32 v198, v198, v233
    v_sub_f32 v199, v199, v233
    v_sub_f32 v136, v136, v234
    v_sub_f32 v137, v137, v234
    s_add_u32 m0, m0, 544
    v_sub_f32 v138, v138, v234
    buffer_load_dwordx4 v250, s[8:11], s48 offen offset:3072 lds
    v_sub_f32 v139, v139, v234
    v_sub_f32 v152, v152, v234
    v_sub_f32 v153, v153, v234
    v_sub_f32 v154, v154, v234
    v_sub_f32 v155, v155, v234
    v_sub_f32 v200, v200, v234
    v_sub_f32 v201, v201, v234
    v_sub_f32 v202, v202, v234
    v_sub_f32 v203, v203, v234
    s_add_u32 m0, m0, 544
    v_sub_f32 v140, v140, v235
    buffer_load_dwordx4 v250, s[8:11], s48 offen offset:3584 lds
    v_sub_f32 v141, v141, v235
    v_sub_f32 v142, v142, v235
    v_sub_f32 v143, v143, v235
    v_sub_f32 v156, v156, v235
    v_sub_f32 v157, v157, v235
    v_sub_f32 v158, v158, v235
    v_sub_f32 v159, v159, v235
    v_sub_f32 v204, v204, v235
    v_sub_f32 v205, v205, v235
    s_add_u32 s49, s49, 0x8000
    s_mov_b32 m0, s67
    v_sub_f32 v206, v206, v235
    buffer_load_dwordx4 v250, s[12:15], s49 offen offset:0 lds
    v_sub_f32 v207, v207, v235
    v_exp_f32 v232, v128
    v_exp_f32 v233, v129
    v_add_f32 v240, v232, v244
    v_exp_f32 v234, v130
    v_add_f32 v240, v233, v240
    v_exp_f32 v235, v131
    v_add_f32 v240, v234, v240
    v_cvt_pk_bf16_f32 v160, v232, v233
    s_add_u32 m0, m0, 544
    v_exp_f32 v236, v132
    buffer_load_dwordx4 v250, s[12:15], s49 offen offset:512 lds
    v_add_f32 v240, v235, v240
    v_exp_f32 v237, v133
    v_add_f32 v241, v236, v245
    v_cvt_pk_bf16_f32 v161, v234, v235
    v_exp_f32 v238, v134
    v_add_f32 v241, v237, v241
    v_exp_f32 v239, v135
    v_add_f32 v241, v238, v241
    v_cvt_pk_bf16_f32 v164, v236, v237
    s_add_u32 m0, m0, 544
    v_exp_f32 v232, v136
    buffer_load_dwordx4 v250, s[12:15], s49 offen offset:1024 lds
    v_add_f32 v241, v239, v241
    v_exp_f32 v233, v137
    v_add_f32 v242, v232, v246
    v_cvt_pk_bf16_f32 v165, v238, v239
    v_exp_f32 v234, v138
    v_add_f32 v242, v233, v242
    v_exp_f32 v235, v139
    v_add_f32 v242, v234, v242
    v_cvt_pk_bf16_f32 v168, v232, v233
    s_add_u32 m0, m0, 544
    v_exp_f32 v236, v140
    buffer_load_dwordx4 v250, s[12:15], s49 offen offset:1536 lds
    v_add_f32 v242, v235, v242
    v_exp_f32 v237, v141
    v_add_f32 v243, v236, v247
    v_cvt_pk_bf16_f32 v169, v234, v235
    v_exp_f32 v238, v142
    v_add_f32 v243, v237, v243
    v_exp_f32 v239, v143
    v_add_f32 v243, v238, v243
    v_cvt_pk_bf16_f32 v172, v236, v237
    s_add_u32 m0, m0, 544
    v_add_f32 v243, v239, v243
    buffer_load_dwordx4 v250, s[12:15], s49 offen offset:2048 lds
    v_cvt_pk_bf16_f32 v173, v238, v239
    v_exp_f32 v232, v144
    v_exp_f32 v233, v145
    v_add_f32 v240, v232, v240
    v_exp_f32 v234, v146
    v_add_f32 v240, v233, v240
    v_exp_f32 v235, v147
    v_add_f32 v240, v234, v240
    v_cvt_pk_bf16_f32 v162, v232, v233
    s_add_u32 m0, m0, 544
    v_exp_f32 v236, v148
    buffer_load_dwordx4 v250, s[12:15], s49 offen offset:2560 lds
    v_add_f32 v240, v235, v240
    v_exp_f32 v237, v149
    v_add_f32 v241, v236, v241
    v_cvt_pk_bf16_f32 v163, v234, v235
    v_exp_f32 v238, v150
    v_add_f32 v241, v237, v241
    v_exp_f32 v239, v151
    v_add_f32 v241, v238, v241
    v_cvt_pk_bf16_f32 v166, v236, v237
    s_add_u32 m0, m0, 544
    v_exp_f32 v232, v152
    buffer_load_dwordx4 v250, s[12:15], s49 offen offset:3072 lds
    v_add_f32 v241, v239, v241
    v_exp_f32 v233, v153
    v_add_f32 v242, v232, v242
    v_cvt_pk_bf16_f32 v167, v238, v239
    v_exp_f32 v234, v154
    v_add_f32 v242, v233, v242
    v_exp_f32 v235, v155
    v_add_f32 v242, v234, v242
    v_cvt_pk_bf16_f32 v170, v232, v233
    s_add_u32 m0, m0, 544
    v_exp_f32 v236, v156
    buffer_load_dwordx4 v250, s[12:15], s49 offen offset:3584 lds
    v_add_f32 v242, v235, v242
    v_exp_f32 v237, v157
    v_add_f32 v243, v236, v243
    v_cvt_pk_bf16_f32 v171, v234, v235
    v_exp_f32 v238, v158
    v_add_f32 v243, v237, v243
    v_exp_f32 v239, v159
    v_add_f32 v243, v238, v243
    v_cvt_pk_bf16_f32 v174, v236, v237
    v_add_f32 v243, v239, v243
    v_cvt_pk_bf16_f32 v175, v238, v239
    s_nop 1
    v_lshlrev_b32 v252, 4, v251
    s_lshl_b32 s100, s44, 5
    s_add_u32 s100, s100, s45
    s_lshl_b32 s100, s100, 2
    s_add_u32 s100, s100, s3
    s_mul_i32 s100, s100, 14336
    s_add_u32 s100, s100, 16777216
    v_accvgpr_read_b32 v228, a112
    v_accvgpr_read_b32 v229, a113
    v_accvgpr_read_b32 v230, a114
    v_accvgpr_read_b32 v231, a115
    v_cvt_pk_bf16_f32 v176, v228, v229
    v_cvt_pk_bf16_f32 v177, v230, v231
    v_accvgpr_read_b32 v228, a116
    v_accvgpr_read_b32 v229, a117
    v_accvgpr_read_b32 v230, a118
    v_accvgpr_read_b32 v231, a119
    v_cvt_pk_bf16_f32 v178, v228, v229
    v_cvt_pk_bf16_f32 v179, v230, v231
    buffer_store_dwordx4 v[176:179], v252, s[36:39], s100 offen sc1
    s_add_u32 s100, s100, 1024
    v_accvgpr_read_b32 v228, a120
    v_accvgpr_read_b32 v229, a121
    v_accvgpr_read_b32 v230, a122
    v_accvgpr_read_b32 v231, a123
    v_cvt_pk_bf16_f32 v180, v228, v229
    v_cvt_pk_bf16_f32 v181, v230, v231
    v_accvgpr_read_b32 v228, a124
    v_accvgpr_read_b32 v229, a125
    v_accvgpr_read_b32 v230, a126
    v_accvgpr_read_b32 v231, a127
    v_cvt_pk_bf16_f32 v182, v228, v229
    v_cvt_pk_bf16_f32 v183, v230, v231
    buffer_store_dwordx4 v[180:183], v252, s[36:39], s100 offen sc1
    s_add_u32 s100, s100, 1024
    v_accvgpr_read_b32 v228, a128
    v_accvgpr_read_b32 v229, a129
    v_accvgpr_read_b32 v230, a130
    v_accvgpr_read_b32 v231, a131
    v_cvt_pk_bf16_f32 v176, v228, v229
    v_cvt_pk_bf16_f32 v177, v230, v231
    v_accvgpr_read_b32 v228, a132
    v_accvgpr_read_b32 v229, a133
    v_accvgpr_read_b32 v230, a134
    v_accvgpr_read_b32 v231, a135
    v_cvt_pk_bf16_f32 v178, v228, v229
    v_cvt_pk_bf16_f32 v179, v230, v231
    buffer_store_dwordx4 v[176:179], v252, s[36:39], s100 offen sc1
    s_add_u32 s100, s100, 1024
    v_accvgpr_read_b32 v228, a136
    v_accvgpr_read_b32 v229, a137
    v_accvgpr_read_b32 v230, a138
    v_accvgpr_read_b32 v231, a139
    v_cvt_pk_bf16_f32 v180, v228, v229
    v_cvt_pk_bf16_f32 v181, v230, v231
    v_accvgpr_read_b32 v228, a140
    v_accvgpr_read_b32 v229, a141
    v_accvgpr_read_b32 v230, a142
    v_accvgpr_read_b32 v231, a143
    v_cvt_pk_bf16_f32 v182, v228, v229
    v_cvt_pk_bf16_f32 v183, v230, v231
    buffer_store_dwordx4 v[180:183], v252, s[36:39], s100 offen sc1
    s_add_u32 s100, s100, 1024
    v_accvgpr_read_b32 v228, a144
    v_accvgpr_read_b32 v229, a145
    v_accvgpr_read_b32 v230, a146
    v_accvgpr_read_b32 v231, a147
    v_cvt_pk_bf16_f32 v176, v228, v229
    v_cvt_pk_bf16_f32 v177, v230, v231
    v_accvgpr_read_b32 v228, a148
    v_accvgpr_read_b32 v229, a149
    v_accvgpr_read_b32 v230, a150
    v_accvgpr_read_b32 v231, a151
    v_cvt_pk_bf16_f32 v178, v228, v229
    v_cvt_pk_bf16_f32 v179, v230, v231
    buffer_store_dwordx4 v[176:179], v252, s[36:39], s100 offen sc1
    s_add_u32 s100, s100, 1024
    v_accvgpr_read_b32 v228, a152
    v_accvgpr_read_b32 v229, a153
    v_accvgpr_read_b32 v230, a154
    v_accvgpr_read_b32 v231, a155
    v_cvt_pk_bf16_f32 v180, v228, v229
    v_cvt_pk_bf16_f32 v181, v230, v231
    v_accvgpr_read_b32 v228, a156
    v_accvgpr_read_b32 v229, a157
    v_accvgpr_read_b32 v230, a158
    v_accvgpr_read_b32 v231, a159
    v_cvt_pk_bf16_f32 v182, v228, v229
    v_cvt_pk_bf16_f32 v183, v230, v231
    buffer_store_dwordx4 v[180:183], v252, s[36:39], s100 offen sc1
    s_add_u32 s100, s100, 1024
    v_accvgpr_read_b32 v228, a160
    v_accvgpr_read_b32 v229, a161
    v_accvgpr_read_b32 v230, a162
    v_accvgpr_read_b32 v231, a163
    v_cvt_pk_bf16_f32 v176, v228, v229
    v_cvt_pk_bf16_f32 v177, v230, v231
    v_accvgpr_read_b32 v228, a164
    v_accvgpr_read_b32 v229, a165
    v_accvgpr_read_b32 v230, a166
    v_accvgpr_read_b32 v231, a167
    v_cvt_pk_bf16_f32 v178, v228, v229
    v_cvt_pk_bf16_f32 v179, v230, v231
    buffer_store_dwordx4 v[176:179], v252, s[36:39], s100 offen sc1
    s_add_u32 s100, s100, 1024
    v_accvgpr_read_b32 v228, a168
    v_accvgpr_read_b32 v229, a169
    v_accvgpr_read_b32 v230, a170
    v_accvgpr_read_b32 v231, a171
    v_cvt_pk_bf16_f32 v180, v228, v229
    v_cvt_pk_bf16_f32 v181, v230, v231
    v_accvgpr_read_b32 v228, a172
    v_accvgpr_read_b32 v229, a173
    v_accvgpr_read_b32 v230, a174
    v_accvgpr_read_b32 v231, a175
    v_cvt_pk_bf16_f32 v182, v228, v229
    v_cvt_pk_bf16_f32 v183, v230, v231
    buffer_store_dwordx4 v[180:183], v252, s[36:39], s100 offen sc1
    s_add_u32 s100, s100, 1024
    v_accvgpr_read_b32 v228, a176
    v_accvgpr_read_b32 v229, a177
    v_accvgpr_read_b32 v230, a178
    v_accvgpr_read_b32 v231, a179
    v_cvt_pk_bf16_f32 v176, v228, v229
    v_cvt_pk_bf16_f32 v177, v230, v231
    v_accvgpr_read_b32 v228, a180
    v_accvgpr_read_b32 v229, a181
    v_accvgpr_read_b32 v230, a182
    v_accvgpr_read_b32 v231, a183
    v_cvt_pk_bf16_f32 v178, v228, v229
    v_cvt_pk_bf16_f32 v179, v230, v231
    buffer_store_dwordx4 v[176:179], v252, s[36:39], s100 offen sc1
    s_add_u32 s100, s100, 1024
    v_accvgpr_read_b32 v228, a184
    v_accvgpr_read_b32 v229, a185
    v_accvgpr_read_b32 v230, a186
    v_accvgpr_read_b32 v231, a187
    v_cvt_pk_bf16_f32 v180, v228, v229
    v_cvt_pk_bf16_f32 v181, v230, v231
    v_accvgpr_read_b32 v228, a188
    v_accvgpr_read_b32 v229, a189
    v_accvgpr_read_b32 v230, a190
    v_accvgpr_read_b32 v231, a191
    v_cvt_pk_bf16_f32 v182, v228, v229
    v_cvt_pk_bf16_f32 v183, v230, v231
    buffer_store_dwordx4 v[180:183], v252, s[36:39], s100 offen sc1
    s_add_u32 s100, s100, 1024
    v_accvgpr_read_b32 v228, a192
    v_accvgpr_read_b32 v229, a193
    v_accvgpr_read_b32 v230, a194
    v_accvgpr_read_b32 v231, a195
    v_cvt_pk_bf16_f32 v176, v228, v229
    v_cvt_pk_bf16_f32 v177, v230, v231
    v_accvgpr_read_b32 v228, a196
    v_accvgpr_read_b32 v229, a197
    v_accvgpr_read_b32 v230, a198
    v_accvgpr_read_b32 v231, a199
    v_cvt_pk_bf16_f32 v178, v228, v229
    v_cvt_pk_bf16_f32 v179, v230, v231
    buffer_store_dwordx4 v[176:179], v252, s[36:39], s100 offen sc1
    s_add_u32 s100, s100, 1024
    v_accvgpr_read_b32 v228, a200
    v_accvgpr_read_b32 v229, a201
    v_accvgpr_read_b32 v230, a202
    v_accvgpr_read_b32 v231, a203
    v_cvt_pk_bf16_f32 v180, v228, v229
    v_cvt_pk_bf16_f32 v181, v230, v231
    v_accvgpr_read_b32 v228, a204
    v_accvgpr_read_b32 v229, a205
    v_accvgpr_read_b32 v230, a206
    v_accvgpr_read_b32 v231, a207
    v_cvt_pk_bf16_f32 v182, v228, v229
    v_cvt_pk_bf16_f32 v183, v230, v231
    buffer_store_dwordx4 v[180:183], v252, s[36:39], s100 offen sc1
    s_add_u32 s100, s100, 1024
    v_accvgpr_read_b32 v228, a208
    v_accvgpr_read_b32 v229, a209
    v_accvgpr_read_b32 v230, a210
    v_accvgpr_read_b32 v231, a211
    v_cvt_pk_bf16_f32 v176, v228, v229
    v_cvt_pk_bf16_f32 v177, v230, v231
    v_accvgpr_read_b32 v228, a212
    v_accvgpr_read_b32 v229, a213
    v_accvgpr_read_b32 v230, a214
    v_accvgpr_read_b32 v231, a215
    v_cvt_pk_bf16_f32 v178, v228, v229
    v_cvt_pk_bf16_f32 v179, v230, v231
    buffer_store_dwordx4 v[176:179], v252, s[36:39], s100 offen sc1
    s_add_u32 s100, s100, 1024
    v_accvgpr_read_b32 v228, a216
    v_accvgpr_read_b32 v229, a217
    v_accvgpr_read_b32 v230, a218
    v_accvgpr_read_b32 v231, a219
    v_cvt_pk_bf16_f32 v180, v228, v229
    v_cvt_pk_bf16_f32 v181, v230, v231
    v_accvgpr_read_b32 v228, a220
    v_accvgpr_read_b32 v229, a221
    v_accvgpr_read_b32 v230, a222
    v_accvgpr_read_b32 v231, a223
    v_cvt_pk_bf16_f32 v182, v228, v229
    v_cvt_pk_bf16_f32 v183, v230, v231
    buffer_store_dwordx4 v[180:183], v252, s[36:39], s100 offen sc1
    s_add_u32 s100, s100, 1024
    s_lshl_b32 s55, s45, 2
    s_add_u32 s55, s55, s3
    s_mul_i32 s55, s55, 3584
    s_mul_i32 s56, s44, 458752
    s_add_u32 s55, s55, s56
    v_lshlrev_b32 v236, 7, v251
    v_cmp_lt_u32 vcc, 27, v251
    v_mov_b32 v237, 0x40000000
    s_nop 1
    v_cndmask_b32 v236, v236, v237, vcc
    buffer_load_dword v227, v236, s[24:27], s55 offen
    s_waitcnt lgkmcnt(2)
    v_mfma_f32_16x16x32_bf16 v[128:131], v[212:215], v[0:3], v[192:195]
    ds_read_b128 v[208:211], v248 offset:33984
    v_mfma_f32_16x16x32_bf16 v[132:135], v[212:215], v[4:7], v[196:199]
    v_mfma_f32_16x16x32_bf16 v[136:139], v[212:215], v[8:11], v[200:203]
    v_mfma_f32_16x16x32_bf16 v[140:143], v[212:215], v[12:15], v[204:207]
    s_waitcnt lgkmcnt(1)
    v_mfma_f32_16x16x32_bf16 v[128:131], v[216:219], v[16:19], v[128:131]
    ds_read_b128 v[212:215], v224 offset:34048
    v_mfma_f32_16x16x32_bf16 v[132:135], v[216:219], v[20:23], v[132:135]
    v_mfma_f32_16x16x32_bf16 v[136:139], v[216:219], v[24:27], v[136:139]
    v_mfma_f32_16x16x32_bf16 v[140:143], v[216:219], v[28:31], v[140:143]
    v_mfma_f32_16x16x32_bf16 v[128:131], v[220:223], v[32:35], v[128:131]
    ds_read_b128 v[216:219], v224 offset:34112
    v_mfma_f32_16x16x32_bf16 v[132:135], v[220:223], v[36:39], v[132:135]
    v_mfma_f32_16x16x32_bf16 v[136:139], v[220:223], v[40:43], v[136:139]
    v_mfma_f32_16x16x32_bf16 v[140:143], v[220:223], v[44:47], v[140:143]
    s_waitcnt lgkmcnt(1)
    v_mfma_f32_16x16x32_bf16 v[128:131], v[208:211], v[48:51], v[128:131]
    ds_read_b128 v[220:223], v224 offset:34176
    v_mfma_f32_16x16x32_bf16 v[132:135], v[208:211], v[52:55], v[132:135]
    v_mfma_f32_16x16x32_bf16 v[136:139], v[208:211], v[56:59], v[136:139]
    v_mfma_f32_16x16x32_bf16 v[140:143], v[208:211], v[60:63], v[140:143]
    v_mfma_f32_16x16x32_bf16 v[128:131], v[212:215], v[64:67], v[128:131]
    ds_read_b128 v[208:211], v224 offset:34240
    v_mfma_f32_16x16x32_bf16 v[132:135], v[212:215], v[68:71], v[132:135]
    v_mfma_f32_16x16x32_bf16 v[136:139], v[212:215], v[72:75], v[136:139]
    v_mfma_f32_16x16x32_bf16 v[140:143], v[212:215], v[76:79], v[140:143]
    s_waitcnt lgkmcnt(1)
    v_mfma_f32_16x16x32_bf16 v[128:131], v[216:219], v[80:83], v[128:131]
    ds_read_b128 v[212:215], v248 offset:34304
    v_mfma_f32_16x16x32_bf16 v[132:135], v[216:219], v[84:87], v[132:135]
    v_mfma_f32_16x16x32_bf16 v[136:139], v[216:219], v[88:91], v[136:139]
    v_mfma_f32_16x16x32_bf16 v[140:143], v[216:219], v[92:95], v[140:143]
    v_mfma_f32_16x16x32_bf16 v[128:131], v[220:223], v[96:99], v[128:131]
    ds_read_b128 v[216:219], v248 offset:34368
    v_mfma_f32_16x16x32_bf16 v[132:135], v[220:223], v[100:103], v[132:135]
    v_mfma_f32_16x16x32_bf16 v[136:139], v[220:223], v[104:107], v[136:139]
    v_mfma_f32_16x16x32_bf16 v[140:143], v[220:223], v[108:111], v[140:143]
    s_waitcnt lgkmcnt(1)
    v_mfma_f32_16x16x32_bf16 v[128:131], v[208:211], v[112:115], v[128:131]
    ds_read_b128 v[220:223], v248 offset:34432
    v_mfma_f32_16x16x32_bf16 v[132:135], v[208:211], v[116:119], v[132:135]
    v_mfma_f32_16x16x32_bf16 v[136:139], v[208:211], v[120:123], v[136:139]
    v_mfma_f32_16x16x32_bf16 v[140:143], v[208:211], v[124:127], v[140:143]
    v_mfma_f32_16x16x32_bf16 v[144:147], v[212:215], v[0:3], v[192:195]
    ds_read_b128 v[208:211], v248 offset:34496
    v_mfma_f32_16x16x32_bf16 v[148:151], v[212:215], v[4:7], v[196:199]
    v_mfma_f32_16x16x32_bf16 v[152:155], v[212:215], v[8:11], v[200:203]
    v_mfma_f32_16x16x32_bf16 v[156:159], v[212:215], v[12:15], v[204:207]
    s_waitcnt lgkmcnt(1)
    v_mfma_f32_16x16x32_bf16 v[144:147], v[216:219], v[16:19], v[144:147]
    ds_read_b128 v[212:215], v224 offset:34560
    v_mfma_f32_16x16x32_bf16 v[148:151], v[216:219], v[20:23], v[148:151]
    v_exp_f32 v232, v128
    v_mfma_f32_16x16x32_bf16 v[152:155], v[216:219], v[24:27], v[152:155]
    v_exp_f32 v233, v129
    v_mfma_f32_16x16x32_bf16 v[156:159], v[216:219], v[28:31], v[156:159]
    v_exp_f32 v234, v130
    v_mfma_f32_16x16x32_bf16 v[144:147], v[220:223], v[32:35], v[144:147]
    ds_read_b128 v[216:219], v224 offset:34624
    v_cvt_pk_bf16_f32 v176, v232, v233
    v_mfma_f32_16x16x32_bf16 v[148:151], v[220:223], v[36:39], v[148:151]
    v_exp_f32 v235, v131
    v_mfma_f32_16x16x32_bf16 v[152:155], v[220:223], v[40:43], v[152:155]
    v_add_f32 v244, v232, v240
    v_add_f32 v244, v233, v244
    v_mfma_f32_16x16x32_bf16 v[156:159], v[220:223], v[44:47], v[156:159]
    s_waitcnt lgkmcnt(1)
    v_exp_f32 v236, v132
    v_mfma_f32_16x16x32_bf16 v[144:147], v[208:211], v[48:51], v[144:147]
    ds_read_b128 v[220:223], v224 offset:34688
    v_cvt_pk_bf16_f32 v177, v234, v235
    v_mfma_f32_16x16x32_bf16 v[148:151], v[208:211], v[52:55], v[148:151]
    v_exp_f32 v237, v133
    v_mfma_f32_16x16x32_bf16 v[152:155], v[208:211], v[56:59], v[152:155]
    v_add_f32 v244, v234, v244
    v_add_f32 v244, v235, v244
    v_mfma_f32_16x16x32_bf16 v[156:159], v[208:211], v[60:63], v[156:159]
    v_exp_f32 v238, v134
    v_mfma_f32_16x16x32_bf16 v[144:147], v[212:215], v[64:67], v[144:147]
    ds_read_b128 v[208:211], v224 offset:34752
    v_cvt_pk_bf16_f32 v180, v236, v237
    v_mfma_f32_16x16x32_bf16 v[148:151], v[212:215], v[68:71], v[148:151]
    v_exp_f32 v239, v135
    v_mfma_f32_16x16x32_bf16 v[152:155], v[212:215], v[72:75], v[152:155]
    v_add_f32 v245, v236, v241
    v_add_f32 v245, v237, v245
    v_mfma_f32_16x16x32_bf16 v[156:159], v[212:215], v[76:79], v[156:159]
    s_waitcnt lgkmcnt(1)
    v_exp_f32 v232, v136
    v_mfma_f32_16x16x32_bf16 v[144:147], v[216:219], v[80:83], v[144:147]
    ds_read_b64_tr_b16 v[212:213], v249 offset:0
    v_cvt_pk_bf16_f32 v181, v238, v239
    v_mfma_f32_16x16x32_bf16 v[148:151], v[216:219], v[84:87], v[148:151]
    ds_read_b64_tr_b16 v[214:215], v249 offset:512
    v_add_f32 v245, v238, v245
    v_mfma_f32_16x16x32_bf16 v[152:155], v[216:219], v[88:91], v[152:155]
    v_exp_f32 v233, v137
    v_mfma_f32_16x16x32_bf16 v[156:159], v[216:219], v[92:95], v[156:159]
    v_exp_f32 v234, v138
    v_mfma_f32_16x16x32_bf16 v[144:147], v[220:223], v[96:99], v[144:147]
    ds_read_b64_tr_b16 v[216:217], v249 offset:32
    v_add_f32 v245, v239, v245
    v_mfma_f32_16x16x32_bf16 v[148:151], v[220:223], v[100:103], v[148:151]
    ds_read_b64_tr_b16 v[218:219], v249 offset:544
    v_cvt_pk_bf16_f32 v184, v232, v233
    v_mfma_f32_16x16x32_bf16 v[152:155], v[220:223], v[104:107], v[152:155]
    v_exp_f32 v235, v139
    v_mfma_f32_16x16x32_bf16 v[156:159], v[220:223], v[108:111], v[156:159]
    s_waitcnt lgkmcnt(2)
    v_add_f32 v246, v232, v242
    v_add_f32 v246, v233, v246
    v_mfma_f32_16x16x32_bf16 v[144:147], v[208:211], v[112:115], v[144:147]
    ds_read_b64_tr_b16 v[220:221], v249 offset:64
    v_cvt_pk_bf16_f32 v185, v234, v235
    v_mfma_f32_16x16x32_bf16 v[148:151], v[208:211], v[116:119], v[148:151]
    ds_read_b64_tr_b16 v[222:223], v249 offset:576
    v_add_f32 v246, v234, v246
    v_mfma_f32_16x16x32_bf16 v[152:155], v[208:211], v[120:123], v[152:155]
    v_exp_f32 v236, v140
    v_mfma_f32_16x16x32_bf16 v[156:159], v[208:211], v[124:127], v[156:159]
    v_exp_f32 v237, v141
    v_mfma_f32_16x16x32_bf16 a[0:3], v[212:215], v[160:163], 0
    ds_read_b64_tr_b16 v[208:209], v249 offset:96
    v_add_f32 v246, v235, v246
    v_mfma_f32_16x16x32_bf16 a[4:7], v[212:215], v[164:167], 0
    ds_read_b64_tr_b16 v[210:211], v249 offset:608
    v_cvt_pk_bf16_f32 v188, v236, v237
    v_mfma_f32_16x16x32_bf16 a[8:11], v[212:215], v[168:171], 0
    v_exp_f32 v238, v142
    v_mfma_f32_16x16x32_bf16 a[12:15], v[212:215], v[172:175], 0
    s_waitcnt lgkmcnt(2)
    v_exp_f32 v239, v143
    v_mfma_f32_16x16x32_bf16 a[16:19], v[216:219], v[160:163], 0
    ds_read_b64_tr_b16 v[212:213], v249 offset:128
    v_add_f32 v247, v236, v243
    v_mfma_f32_16x16x32_bf16 a[20:23], v[216:219], v[164:167], 0
    s_add_u32 s58, s58, 0x8000
    ds_read_b64_tr_b16 v[214:215], v249 offset:640
    v_add_f32 v247, v237, v247
    v_mfma_f32_16x16x32_bf16 a[24:27], v[216:219], v[168:171], 0
    buffer_load_dword v227, v226, s[40:43], s58 offen
    v_mfma_f32_16x16x32_bf16 a[28:31], v[216:219], v[172:175], 0
    v_exp_f32 v232, v144
    v_mfma_f32_16x16x32_bf16 a[32:35], v[220:223], v[160:163], 0
    ds_read_b64_tr_b16 v[216:217], v249 offset:160
    v_cvt_pk_bf16_f32 v189, v238, v239
    v_mfma_f32_16x16x32_bf16 a[36:39], v[220:223], v[164:167], 0
    ds_read_b64_tr_b16 v[218:219], v249 offset:672
    v_add_f32 v247, v238, v247
    v_mfma_f32_16x16x32_bf16 a[40:43], v[220:223], v[168:171], 0
    v_exp_f32 v233, v145
    v_mfma_f32_16x16x32_bf16 a[44:47], v[220:223], v[172:175], 0
    s_waitcnt lgkmcnt(2)
    v_exp_f32 v234, v146
    v_mfma_f32_16x16x32_bf16 a[48:51], v[208:211], v[160:163], 0
    ds_read_b64_tr_b16 v[220:221], v249 offset:192
    v_add_f32 v247, v239, v247
    v_mfma_f32_16x16x32_bf16 a[52:55], v[208:211], v[164:167], 0
    ds_read_b64_tr_b16 v[222:223], v249 offset:704
    v_cvt_pk_bf16_f32 v178, v232, v233
    v_mfma_f32_16x16x32_bf16 a[56:59], v[208:211], v[168:171], 0
    v_exp_f32 v235, v147
    v_mfma_f32_16x16x32_bf16 a[60:63], v[208:211], v[172:175], 0
    v_add_f32 v244, v232, v244
    v_add_f32 v244, v233, v244
    v_mfma_f32_16x16x32_bf16 a[64:67], v[212:215], v[160:163], 0
    ds_read_b64_tr_b16 v[208:209], v249 offset:224
    v_cvt_pk_bf16_f32 v179, v234, v235
    v_mfma_f32_16x16x32_bf16 a[68:71], v[212:215], v[164:167], 0
    ds_read_b64_tr_b16 v[210:211], v249 offset:736
    v_add_f32 v244, v234, v244
    v_mfma_f32_16x16x32_bf16 a[72:75], v[212:215], v[168:171], 0
    v_exp_f32 v236, v148
    v_mfma_f32_16x16x32_bf16 a[76:79], v[212:215], v[172:175], 0
    s_waitcnt lgkmcnt(2)
    v_exp_f32 v237, v149
    v_mfma_f32_16x16x32_bf16 a[80:83], v[216:219], v[160:163], 0
    ds_read_b64_tr_b16 v[212:213], v249 offset:256
    v_add_f32 v244, v235, v244
    v_mfma_f32_16x16x32_bf16 a[84:87], v[216:219], v[164:167], 0
    ds_read_b64_tr_b16 v[214:215], v249 offset:768
    v_cvt_pk_bf16_f32 v182, v236, v237
    v_mfma_f32_16x16x32_bf16 a[88:91], v[216:219], v[168:171], 0
    v_exp_f32 v238, v150
    v_mfma_f32_16x16x32_bf16 a[92:95], v[216:219], v[172:175], 0
    v_exp_f32 v239, v151
    v_mfma_f32_16x16x32_bf16 a[96:99], v[220:223], v[160:163], 0
    ds_read_b64_tr_b16 v[216:217], v249 offset:288
    v_add_f32 v245, v236, v245
    v_mfma_f32_16x16x32_bf16 a[100:103], v[220:223], v[164:167], 0
    ds_read_b64_tr_b16 v[218:219], v249 offset:800
    v_add_f32 v245, v237, v245
    v_mfma_f32_16x16x32_bf16 a[104:107], v[220:223], v[168:171], 0
    v_exp_f32 v232, v152
    v_mfma_f32_16x16x32_bf16 a[108:111], v[220:223], v[172:175], 0
    s_waitcnt lgkmcnt(2)
    v_exp_f32 v233, v153
    v_mfma_f32_16x16x32_bf16 a[112:115], v[208:211], v[160:163], 0
    ds_read_b64_tr_b16 v[220:221], v249 offset:320
    v_cvt_pk_bf16_f32 v183, v238, v239
    v_mfma_f32_16x16x32_bf16 a[116:119], v[208:211], v[164:167], 0
    ds_read_b64_tr_b16 v[222:223], v249 offset:832
    v_add_f32 v245, v238, v245
    v_mfma_f32_16x16x32_bf16 a[120:123], v[208:211], v[168:171], 0
    v_exp_f32 v234, v154
    v_mfma_f32_16x16x32_bf16 a[124:127], v[208:211], v[172:175], 0
    v_add_f32 v245, v239, v245
    v_cvt_pk_bf16_f32 v186, v232, v233
    v_mfma_f32_16x16x32_bf16 a[128:131], v[212:215], v[160:163], 0
    ds_read_b64_tr_b16 v[208:209], v249 offset:352
    v_add_f32 v246, v232, v246
    v_mfma_f32_16x16x32_bf16 a[132:135], v[212:215], v[164:167], 0
    ds_read_b64_tr_b16 v[210:211], v249 offset:864
    v_add_f32 v246, v233, v246
    v_mfma_f32_16x16x32_bf16 a[136:139], v[212:215], v[168:171], 0
    v_exp_f32 v235, v155
    v_mfma_f32_16x16x32_bf16 a[140:143], v[212:215], v[172:175], 0
    s_waitcnt lgkmcnt(2)
    v_exp_f32 v236, v156
    v_mfma_f32_16x16x32_bf16 a[144:147], v[216:219], v[160:163], 0
    ds_read_b64_tr_b16 v[212:213], v249 offset:384
    v_cvt_pk_bf16_f32 v187, v234, v235
    v_mfma_f32_16x16x32_bf16 a[148:151], v[216:219], v[164:167], 0
    ds_read_b64_tr_b16 v[214:215], v249 offset:896
    v_add_f32 v246, v234, v246
    v_mfma_f32_16x16x32_bf16 a[152:155], v[216:219], v[168:171], 0
    v_exp_f32 v237, v157
    v_mfma_f32_16x16x32_bf16 a[156:159], v[216:219], v[172:175], 0
    v_exp_f32 v238, v158
    v_mfma_f32_16x16x32_bf16 a[160:163], v[220:223], v[160:163], 0
    ds_read_b64_tr_b16 v[216:217], v249 offset:416
    v_add_f32 v246, v235, v246
    v_mfma_f32_16x16x32_bf16 a[164:167], v[220:223], v[164:167], 0
    ds_read_b64_tr_b16 v[218:219], v249 offset:928
    v_cvt_pk_bf16_f32 v190, v236, v237
    v_mfma_f32_16x16x32_bf16 a[168:171], v[220:223], v[168:171], 0
    v_exp_f32 v239, v159
    v_mfma_f32_16x16x32_bf16 a[172:175], v[220:223], v[172:175], 0
    s_waitcnt lgkmcnt(2)
    v_add_f32 v247, v236, v247
    v_add_f32 v247, v237, v247
    v_mfma_f32_16x16x32_bf16 a[176:179], v[208:211], v[160:163], 0
    ds_read_b64_tr_b16 v[220:221], v249 offset:448
    v_cvt_pk_bf16_f32 v191, v238, v239
    v_mfma_f32_16x16x32_bf16 a[180:183], v[208:211], v[164:167], 0
    ds_read_b64_tr_b16 v[222:223], v249 offset:960
    v_add_f32 v247, v238, v247
    v_mfma_f32_16x16x32_bf16 a[184:187], v[208:211], v[168:171], 0
    v_add_f32 v247, v239, v247
    v_mfma_f32_16x16x32_bf16 a[188:191], v[208:211], v[172:175], 0
    v_mfma_f32_16x16x32_bf16 a[192:195], v[212:215], v[160:163], 0
    ds_read_b64_tr_b16 v[208:209], v249 offset:480
    v_mfma_f32_16x16x32_bf16 a[196:199], v[212:215], v[164:167], 0
    ds_read_b64_tr_b16 v[210:211], v249 offset:992
    v_mfma_f32_16x16x32_bf16 a[200:203], v[212:215], v[168:171], 0
    v_mfma_f32_16x16x32_bf16 a[204:207], v[212:215], v[172:175], 0
    s_waitcnt lgkmcnt(4)
    v_mfma_f32_16x16x32_bf16 a[208:211], v[216:219], v[160:163], 0
    v_mfma_f32_16x16x32_bf16 a[212:215], v[216:219], v[164:167], 0
    v_mfma_f32_16x16x32_bf16 a[216:219], v[216:219], v[168:171], 0
    v_mfma_f32_16x16x32_bf16 a[220:223], v[216:219], v[172:175], 0
    s_waitcnt vmcnt(16)
    s_waitcnt lgkmcnt(0)
    s_barrier
    v_mfma_f32_16x16x32_bf16 a[224:227], v[220:223], v[160:163], 0
    ds_read_b128 v[212:215], v248 offset:0
    v_mfma_f32_16x16x32_bf16 a[228:231], v[220:223], v[164:167], 0
    ds_read_b128 v[216:219], v248 offset:64
    v_mfma_f32_16x16x32_bf16 a[232:235], v[220:223], v[168:171], 0
    v_mfma_f32_16x16x32_bf16 a[236:239], v[220:223], v[172:175], 0
    v_mfma_f32_16x16x32_bf16 a[240:243], v[208:211], v[160:163], 0
    ds_read_b128 v[220:223], v248 offset:128
    v_max3_f32 v232, v244, v245, v246
    v_mfma_f32_16x16x32_bf16 a[244:247], v[208:211], v[164:167], 0
    v_max_f32 v232, v232, v247
    v_mfma_f32_16x16x32_bf16 a[248:251], v[208:211], v[168:171], 0
    v_cmp_lt_f32 vcc, s52, v232
    v_mfma_f32_16x16x32_bf16 a[252:255], v[208:211], v[172:175], 0
    s_cbranch_vccnz L_slowZ
L_retZ:
    s_mov_b32 s51, 15
    .p2align 6
L_loop:
    s_waitcnt lgkmcnt(2)
    v_mfma_f32_16x16x32_bf16 v[128:131], v[212:215], v[0:3], v[192:195]
    ds_read_b128 v[208:211], v248 offset:192
    v_mfma_f32_16x16x32_bf16 v[132:135], v[212:215], v[4:7], v[196:199]
    s_add_u32 s48, s48, 0x8000
    s_mov_b32 m0, s65
    v_mfma_f32_16x16x32_bf16 v[136:139], v[212:215], v[8:11], v[200:203]
    buffer_load_dwordx4 v250, s[8:11], s48 offen offset:0 lds
    v_mfma_f32_16x16x32_bf16 v[140:143], v[212:215], v[12:15], v[204:207]
    s_waitcnt lgkmcnt(1)
    v_mfma_f32_16x16x32_bf16 v[128:131], v[216:219], v[16:19], v[128:131]
    ds_read_b128 v[212:215], v224 offset:256
    v_mfma_f32_16x16x32_bf16 v[132:135], v[216:219], v[20:23], v[132:135]
    s_add_u32 m0, m0, 544
    v_mfma_f32_16x16x32_bf16 v[136:139], v[216:219], v[24:27], v[136:139]
    buffer_load_dwordx4 v250, s[8:11], s48 offen offset:512 lds
    v_mfma_f32_16x16x32_bf16 v[140:143], v[216:219], v[28:31], v[140:143]
    v_mfma_f32_16x16x32_bf16 v[128:131], v[220:223], v[32:35], v[128:131]
    ds_read_b128 v[216:219], v224 offset:320
    v_mfma_f32_16x16x32_bf16 v[132:135], v[220:223], v[36:39], v[132:135]
    s_add_u32 m0, m0, 544
    v_mfma_f32_16x16x32_bf16 v[136:139], v[220:223], v[40:43], v[136:139]
    buffer_load_dwordx4 v250, s[8:11], s48 offen offset:1024 lds
    v_mfma_f32_16x16x32_bf16 v[140:143], v[220:223], v[44:47], v[140:143]
    s_waitcnt lgkmcnt(1)
    v_mfma_f32_16x16x32_bf16 v[128:131], v[208:211], v[48:51], v[128:131]
    ds_read_b128 v[220:223], v224 offset:384
    v_mfma_f32_16x16x32_bf16 v[132:135], v[208:211], v[52:55], v[132:135]
    s_add_u32 m0, m0, 544
    v_mfma_f32_16x16x32_bf16 v[136:139], v[208:211], v[56:59], v[136:139]
    buffer_load_dwordx4 v250, s[8:11], s48 offen offset:1536 lds
    v_mfma_f32_16x16x32_bf16 v[140:143], v[208:211], v[60:63], v[140:143]
    v_mfma_f32_16x16x32_bf16 v[128:131], v[212:215], v[64:67], v[128:131]
    ds_read_b128 v[208:211], v224 offset:448
    v_mfma_f32_16x16x32_bf16 v[132:135], v[212:215], v[68:71], v[132:135]
    s_add_u32 m0, m0, 544
    v_mfma_f32_16x16x32_bf16 v[136:139], v[212:215], v[72:75], v[136:139]
    buffer_load_dwordx4 v250, s[8:11], s48 offen offset:2048 lds
    v_mfma_f32_16x16x32_bf16 v[140:143], v[212:215], v[76:79], v[140:143]
    s_waitcnt lgkmcnt(1)
    v_mfma_f32_16x16x32_bf16 v[128:131], v[216:219], v[80:83], v[128:131]
    ds_read_b128 v[212:215], v248 offset:512
    v_mfma_f32_16x16x32_bf16 v[132:135], v[216:219], v[84:87], v[132:135]
    s_add_u32 m0, m0, 544
    v_mfma_f32_16x16x32_bf16 v[136:139], v[216:219], v[88:91], v[136:139]
    buffer_load_dwordx4 v250, s[8:11], s48 offen offset:2560 lds
    v_mfma_f32_16x16x32_bf16 v[140:143], v[216:219], v[92:95], v[140:143]
    v_mfma_f32_16x16x32_bf16 v[128:131], v[220:223], v[96:99], v[128:131]
    ds_read_b128 v[216:219], v248 offset:576
    v_mfma_f32_16x16x32_bf16 v[132:135], v[220:223], v[100:103], v[132:135]
    s_add_u32 m0, m0, 544
    v_mfma_f32_16x16x32_bf16 v[136:139], v[220:223], v[104:107], v[136:139]
    buffer_load_dwordx4 v250, s[8:11], s48 offen offset:3072 lds
    v_mfma_f32_16x16x32_bf16 v[140:143], v[220:223], v[108:111], v[140:143]
    s_waitcnt lgkmcnt(1)
    v_mfma_f32_16x16x32_bf16 v[128:131], v[208:211], v[112:115], v[128:131]
    ds_read_b128 v[220:223], v248 offset:640
    v_mfma_f32_16x16x32_bf16 v[132:135], v[208:211], v[116:119], v[132:135]
    s_add_u32 m0, m0, 544
    v_mfma_f32_16x16x32_bf16 v[136:139], v[208:211], v[120:123], v[136:139]
    buffer_load_dwordx4 v250, s[8:11], s48 offen offset:3584 lds
    v_mfma_f32_16x16x32_bf16 v[140:143], v[208:211], v[124:127], v[140:143]
    v_mfma_f32_16x16x32_bf16 v[144:147], v[212:215], v[0:3], v[192:195]
    ds_read_b128 v[208:211], v248 offset:704
    v_mfma_f32_16x16x32_bf16 v[148:151], v[212:215], v[4:7], v[196:199]
    s_add_u32 s49, s49, 0x8000
    s_mov_b32 m0, s66
    v_mfma_f32_16x16x32_bf16 v[152:155], v[212:215], v[8:11], v[200:203]
    buffer_load_dwordx4 v250, s[12:15], s49 offen offset:0 lds
    v_mfma_f32_16x16x32_bf16 v[156:159], v[212:215], v[12:15], v[204:207]
    s_waitcnt lgkmcnt(1)
    v_mfma_f32_16x16x32_bf16 v[144:147], v[216:219], v[16:19], v[144:147]
    ds_read_b128 v[212:215], v224 offset:768
    v_mfma_f32_16x16x32_bf16 v[148:151], v[216:219], v[20:23], v[148:151]
    s_add_u32 m0, m0, 544
    v_exp_f32 v232, v128
    v_mfma_f32_16x16x32_bf16 v[152:155], v[216:219], v[24:27], v[152:155]
    buffer_load_dwordx4 v250, s[12:15], s49 offen offset:512 lds
    v_mfma_f32_16x16x32_bf16 v[156:159], v[216:219], v[28:31], v[156:159]
    v_exp_f32 v233, v129
    v_mfma_f32_16x16x32_bf16 v[144:147], v[220:223], v[32:35], v[144:147]
    ds_read_b128 v[216:219], v224 offset:832
    v_cvt_pk_bf16_f32 v160, v232, v233
    v_mfma_f32_16x16x32_bf16 v[148:151], v[220:223], v[36:39], v[148:151]
    s_add_u32 m0, m0, 544
    v_exp_f32 v234, v130
    v_mfma_f32_16x16x32_bf16 v[152:155], v[220:223], v[40:43], v[152:155]
    buffer_load_dwordx4 v250, s[12:15], s49 offen offset:1024 lds
    v_mfma_f32_16x16x32_bf16 v[156:159], v[220:223], v[44:47], v[156:159]
    s_waitcnt lgkmcnt(1)
    v_exp_f32 v235, v131
    v_mfma_f32_16x16x32_bf16 v[144:147], v[208:211], v[48:51], v[144:147]
    ds_read_b128 v[220:223], v224 offset:896
    v_add_f32 v240, v232, v244
    v_mfma_f32_16x16x32_bf16 v[148:151], v[208:211], v[52:55], v[148:151]
    s_add_u32 m0, m0, 544
    v_exp_f32 v236, v132
    v_mfma_f32_16x16x32_bf16 v[152:155], v[208:211], v[56:59], v[152:155]
    buffer_load_dwordx4 v250, s[12:15], s49 offen offset:1536 lds
    v_mfma_f32_16x16x32_bf16 v[156:159], v[208:211], v[60:63], v[156:159]
    v_add_f32 v240, v233, v240
    v_cvt_pk_bf16_f32 v161, v234, v235
    v_mfma_f32_16x16x32_bf16 v[144:147], v[212:215], v[64:67], v[144:147]
    ds_read_b128 v[208:211], v224 offset:960
    v_add_f32 v240, v234, v240
    v_mfma_f32_16x16x32_bf16 v[148:151], v[212:215], v[68:71], v[148:151]
    s_add_u32 m0, m0, 544
    v_exp_f32 v237, v133
    v_mfma_f32_16x16x32_bf16 v[152:155], v[212:215], v[72:75], v[152:155]
    buffer_load_dwordx4 v250, s[12:15], s49 offen offset:2048 lds
    v_mfma_f32_16x16x32_bf16 v[156:159], v[212:215], v[76:79], v[156:159]
    s_waitcnt lgkmcnt(1)
    v_exp_f32 v238, v134
    v_mfma_f32_16x16x32_bf16 v[144:147], v[216:219], v[80:83], v[144:147]
    ds_read_b64_tr_b16 v[212:213], v249 offset:33792
    v_add_f32 v240, v235, v240
    v_mfma_f32_16x16x32_bf16 v[148:151], v[216:219], v[84:87], v[148:151]
    s_add_u32 m0, m0, 544
    ds_read_b64_tr_b16 v[214:215], v249 offset:34304
    v_cvt_pk_bf16_f32 v164, v236, v237
    v_mfma_f32_16x16x32_bf16 v[152:155], v[216:219], v[88:91], v[152:155]
    buffer_load_dwordx4 v250, s[12:15], s49 offen offset:2560 lds
    v_mfma_f32_16x16x32_bf16 v[156:159], v[216:219], v[92:95], v[156:159]
    v_exp_f32 v239, v135
    v_mfma_f32_16x16x32_bf16 v[144:147], v[220:223], v[96:99], v[144:147]
    ds_read_b64_tr_b16 v[216:217], v249 offset:33824
    v_add_f32 v241, v236, v245
    v_mfma_f32_16x16x32_bf16 v[148:151], v[220:223], v[100:103], v[148:151]
    s_add_u32 m0, m0, 544
    ds_read_b64_tr_b16 v[218:219], v249 offset:34336
    v_add_f32 v241, v237, v241
    v_mfma_f32_16x16x32_bf16 v[152:155], v[220:223], v[104:107], v[152:155]
    buffer_load_dwordx4 v250, s[12:15], s49 offen offset:3072 lds
    v_mfma_f32_16x16x32_bf16 v[156:159], v[220:223], v[108:111], v[156:159]
    s_waitcnt lgkmcnt(2)
    v_exp_f32 v232, v136
    v_mfma_f32_16x16x32_bf16 v[144:147], v[208:211], v[112:115], v[144:147]
    ds_read_b64_tr_b16 v[220:221], v249 offset:33856
    v_cvt_pk_bf16_f32 v165, v238, v239
    v_mfma_f32_16x16x32_bf16 v[148:151], v[208:211], v[116:119], v[148:151]
    s_add_u32 m0, m0, 544
    ds_read_b64_tr_b16 v[222:223], v249 offset:34368
    v_add_f32 v241, v238, v241
    v_mfma_f32_16x16x32_bf16 v[152:155], v[208:211], v[120:123], v[152:155]
    buffer_load_dwordx4 v250, s[12:15], s49 offen offset:3584 lds
    v_mfma_f32_16x16x32_bf16 v[156:159], v[208:211], v[124:127], v[156:159]
    v_exp_f32 v233, v137
    v_mfma_f32_16x16x32_bf16 a[0:3], v[212:215], v[176:179], a[0:3]
    ds_read_b64_tr_b16 v[208:209], v249 offset:33888
    v_add_f32 v241, v239, v241
    v_mfma_f32_16x16x32_bf16 a[4:7], v[212:215], v[180:183], a[4:7]
    ds_read_b64_tr_b16 v[210:211], v249 offset:34400
    v_cvt_pk_bf16_f32 v168, v232, v233
    v_mfma_f32_16x16x32_bf16 a[8:11], v[212:215], v[184:187], a[8:11]
    v_exp_f32 v234, v138
    v_mfma_f32_16x16x32_bf16 a[12:15], v[212:215], v[188:191], a[12:15]
    s_waitcnt lgkmcnt(2)
    v_exp_f32 v235, v139
    v_mfma_f32_16x16x32_bf16 a[16:19], v[216:219], v[176:179], a[16:19]
    ds_read_b64_tr_b16 v[212:213], v249 offset:33920
    v_add_f32 v242, v232, v246
    v_mfma_f32_16x16x32_bf16 a[20:23], v[216:219], v[180:183], a[20:23]
    s_add_u32 s58, s58, 0x8000
    ds_read_b64_tr_b16 v[214:215], v249 offset:34432
    v_add_f32 v242, v233, v242
    v_mfma_f32_16x16x32_bf16 a[24:27], v[216:219], v[184:187], a[24:27]
    buffer_load_dword v227, v226, s[40:43], s58 offen
    v_mfma_f32_16x16x32_bf16 a[28:31], v[216:219], v[188:191], a[28:31]
    v_exp_f32 v236, v140
    v_mfma_f32_16x16x32_bf16 a[32:35], v[220:223], v[176:179], a[32:35]
    ds_read_b64_tr_b16 v[216:217], v249 offset:33952
    v_cvt_pk_bf16_f32 v169, v234, v235
    v_mfma_f32_16x16x32_bf16 a[36:39], v[220:223], v[180:183], a[36:39]
    ds_read_b64_tr_b16 v[218:219], v249 offset:34464
    v_add_f32 v242, v234, v242
    v_mfma_f32_16x16x32_bf16 a[40:43], v[220:223], v[184:187], a[40:43]
    v_exp_f32 v237, v141
    v_mfma_f32_16x16x32_bf16 a[44:47], v[220:223], v[188:191], a[44:47]
    s_waitcnt lgkmcnt(2)
    v_exp_f32 v238, v142
    v_mfma_f32_16x16x32_bf16 a[48:51], v[208:211], v[176:179], a[48:51]
    ds_read_b64_tr_b16 v[220:221], v249 offset:33984
    v_add_f32 v242, v235, v242
    v_mfma_f32_16x16x32_bf16 a[52:55], v[208:211], v[180:183], a[52:55]
    ds_read_b64_tr_b16 v[222:223], v249 offset:34496
    v_cvt_pk_bf16_f32 v172, v236, v237
    v_mfma_f32_16x16x32_bf16 a[56:59], v[208:211], v[184:187], a[56:59]
    v_exp_f32 v239, v143
    v_mfma_f32_16x16x32_bf16 a[60:63], v[208:211], v[188:191], a[60:63]
    v_add_f32 v243, v236, v247
    v_add_f32 v243, v237, v243
    v_mfma_f32_16x16x32_bf16 a[64:67], v[212:215], v[176:179], a[64:67]
    ds_read_b64_tr_b16 v[208:209], v249 offset:34016
    v_cvt_pk_bf16_f32 v173, v238, v239
    v_mfma_f32_16x16x32_bf16 a[68:71], v[212:215], v[180:183], a[68:71]
    ds_read_b64_tr_b16 v[210:211], v249 offset:34528
    v_add_f32 v243, v238, v243
    v_mfma_f32_16x16x32_bf16 a[72:75], v[212:215], v[184:187], a[72:75]
    v_exp_f32 v232, v144
    v_mfma_f32_16x16x32_bf16 a[76:79], v[212:215], v[188:191], a[76:79]
    s_waitcnt lgkmcnt(2)
    v_exp_f32 v233, v145
    v_mfma_f32_16x16x32_bf16 a[80:83], v[216:219], v[176:179], a[80:83]
    ds_read_b64_tr_b16 v[212:213], v249 offset:34048
    v_add_f32 v243, v239, v243
    v_mfma_f32_16x16x32_bf16 a[84:87], v[216:219], v[180:183], a[84:87]
    ds_read_b64_tr_b16 v[214:215], v249 offset:34560
    v_cvt_pk_bf16_f32 v162, v232, v233
    v_mfma_f32_16x16x32_bf16 a[88:91], v[216:219], v[184:187], a[88:91]
    v_exp_f32 v234, v146
    v_mfma_f32_16x16x32_bf16 a[92:95], v[216:219], v[188:191], a[92:95]
    v_exp_f32 v235, v147
    v_mfma_f32_16x16x32_bf16 a[96:99], v[220:223], v[176:179], a[96:99]
    ds_read_b64_tr_b16 v[216:217], v249 offset:34080
    v_add_f32 v240, v232, v240
    v_mfma_f32_16x16x32_bf16 a[100:103], v[220:223], v[180:183], a[100:103]
    ds_read_b64_tr_b16 v[218:219], v249 offset:34592
    v_add_f32 v240, v233, v240
    v_mfma_f32_16x16x32_bf16 a[104:107], v[220:223], v[184:187], a[104:107]
    v_exp_f32 v236, v148
    v_mfma_f32_16x16x32_bf16 a[108:111], v[220:223], v[188:191], a[108:111]
    s_waitcnt lgkmcnt(2)
    v_exp_f32 v237, v149
    v_mfma_f32_16x16x32_bf16 a[112:115], v[208:211], v[176:179], a[112:115]
    ds_read_b64_tr_b16 v[220:221], v249 offset:34112
    v_cvt_pk_bf16_f32 v163, v234, v235
    v_mfma_f32_16x16x32_bf16 a[116:119], v[208:211], v[180:183], a[116:119]
    ds_read_b64_tr_b16 v[222:223], v249 offset:34624
    v_add_f32 v240, v234, v240
    v_mfma_f32_16x16x32_bf16 a[120:123], v[208:211], v[184:187], a[120:123]
    v_exp_f32 v238, v150
    v_mfma_f32_16x16x32_bf16 a[124:127], v[208:211], v[188:191], a[124:127]
    v_add_f32 v240, v235, v240
    v_cvt_pk_bf16_f32 v166, v236, v237
    v_mfma_f32_16x16x32_bf16 a[128:131], v[212:215], v[176:179], a[128:131]
    ds_read_b64_tr_b16 v[208:209], v249 offset:34144
    v_add_f32 v241, v236, v241
    v_mfma_f32_16x16x32_bf16 a[132:135], v[212:215], v[180:183], a[132:135]
    ds_read_b64_tr_b16 v[210:211], v249 offset:34656
    v_add_f32 v241, v237, v241
    v_mfma_f32_16x16x32_bf16 a[136:139], v[212:215], v[184:187], a[136:139]
    v_exp_f32 v239, v151
    v_mfma_f32_16x16x32_bf16 a[140:143], v[212:215], v[188:191], a[140:143]
    s_waitcnt lgkmcnt(2)
    v_exp_f32 v232, v152
    v_mfma_f32_16x16x32_bf16 a[144:147], v[216:219], v[176:179], a[144:147]
    ds_read_b64_tr_b16 v[212:213], v249 offset:34176
    v_cvt_pk_bf16_f32 v167, v238, v239
    v_mfma_f32_16x16x32_bf16 a[148:151], v[216:219], v[180:183], a[148:151]
    ds_read_b64_tr_b16 v[214:215], v249 offset:34688
    v_add_f32 v241, v238, v241
    v_mfma_f32_16x16x32_bf16 a[152:155], v[216:219], v[184:187], a[152:155]
    v_exp_f32 v233, v153
    v_mfma_f32_16x16x32_bf16 a[156:159], v[216:219], v[188:191], a[156:159]
    v_exp_f32 v234, v154
    v_mfma_f32_16x16x32_bf16 a[160:163], v[220:223], v[176:179], a[160:163]
    ds_read_b64_tr_b16 v[216:217], v249 offset:34208
    v_add_f32 v241, v239, v241
    v_mfma_f32_16x16x32_bf16 a[164:167], v[220:223], v[180:183], a[164:167]
    ds_read_b64_tr_b16 v[218:219], v249 offset:34720
    v_cvt_pk_bf16_f32 v170, v232, v233
    v_mfma_f32_16x16x32_bf16 a[168:171], v[220:223], v[184:187], a[168:171]
    v_exp_f32 v235, v155
    v_mfma_f32_16x16x32_bf16 a[172:175], v[220:223], v[188:191], a[172:175]
    s_waitcnt lgkmcnt(2)
    v_add_f32 v242, v232, v242
    v_add_f32 v242, v233, v242
    v_mfma_f32_16x16x32_bf16 a[176:179], v[208:211], v[176:179], a[176:179]
    ds_read_b64_tr_b16 v[220:221], v249 offset:34240
    v_cvt_pk_bf16_f32 v171, v234, v235
    v_mfma_f32_16x16x32_bf16 a[180:183], v[208:211], v[180:183], a[180:183]
    ds_read_b64_tr_b16 v[222:223], v249 offset:34752
    v_add_f32 v242, v234, v242
    v_mfma_f32_16x16x32_bf16 a[184:187], v[208:211], v[184:187], a[184:187]
    v_exp_f32 v236, v156
    v_mfma_f32_16x16x32_bf16 a[188:191], v[208:211], v[188:191], a[188:191]
    v_exp_f32 v237, v157
    v_mfma_f32_16x16x32_bf16 a[192:195], v[212:215], v[176:179], a[192:195]
    ds_read_b64_tr_b16 v[208:209], v249 offset:34272
    v_add_f32 v242, v235, v242
    v_mfma_f32_16x16x32_bf16 a[196:199], v[212:215], v[180:183], a[196:199]
    ds_read_b64_tr_b16 v[210:211], v249 offset:34784
    v_cvt_pk_bf16_f32 v174, v236, v237
    v_mfma_f32_16x16x32_bf16 a[200:203], v[212:215], v[184:187], a[200:203]
    v_exp_f32 v238, v158
    v_mfma_f32_16x16x32_bf16 a[204:207], v[212:215], v[188:191], a[204:207]
    s_waitcnt lgkmcnt(4)
    v_exp_f32 v239, v159
    v_mfma_f32_16x16x32_bf16 a[208:211], v[216:219], v[176:179], a[208:211]
    v_add_f32 v243, v236, v243
    v_add_f32 v243, v237, v243
    v_mfma_f32_16x16x32_bf16 a[212:215], v[216:219], v[180:183], a[212:215]
    v_cvt_pk_bf16_f32 v175, v238, v239
    v_add_f32 v243, v238, v243
    v_mfma_f32_16x16x32_bf16 a[216:219], v[216:219], v[184:187], a[216:219]
    v_add_f32 v243, v239, v243
    v_mfma_f32_16x16x32_bf16 a[220:223], v[216:219], v[188:191], a[220:223]
    s_waitcnt vmcnt(1)
    s_waitcnt lgkmcnt(0)
    s_barrier
    v_mfma_f32_16x16x32_bf16 a[224:227], v[220:223], v[176:179], a[224:227]
    ds_read_b128 v[212:215], v248 offset:33792
    v_mfma_f32_16x16x32_bf16 a[228:231], v[220:223], v[180:183], a[228:231]
    ds_read_b128 v[216:219], v248 offset:33856
    v_mfma_f32_16x16x32_bf16 a[232:235], v[220:223], v[184:187], a[232:235]
    v_mfma_f32_16x16x32_bf16 a[236:239], v[220:223], v[188:191], a[236:239]
    v_mfma_f32_16x16x32_bf16 a[240:243], v[208:211], v[176:179], a[240:243]
    ds_read_b128 v[220:223], v248 offset:33920
    v_max3_f32 v232, v240, v241, v242
    v_mfma_f32_16x16x32_bf16 a[244:247], v[208:211], v[180:183], a[244:247]
    v_max_f32 v232, v232, v243
    v_mfma_f32_16x16x32_bf16 a[248:251], v[208:211], v[184:187], a[248:251]
    v_cmp_lt_f32 vcc, s52, v232
    v_mfma_f32_16x16x32_bf16 a[252:255], v[208:211], v[188:191], a[252:255]
    s_cbranch_vccnz L_slowA
L_retA:
    s_waitcnt lgkmcnt(2)
    v_mfma_f32_16x16x32_bf16 v[128:131], v[212:215], v[0:3], v[192:195]
    ds_read_b128 v[208:211], v248 offset:33984
    v_mfma_f32_16x16x32_bf16 v[132:135], v[212:215], v[4:7], v[196:199]
    s_add_u32 s48, s48, 0x8000
    s_mov_b32 m0, s64
    v_mfma_f32_16x16x32_bf16 v[136:139], v[212:215], v[8:11], v[200:203]
    buffer_load_dwordx4 v250, s[8:11], s48 offen offset:0 lds
    v_mfma_f32_16x16x32_bf16 v[140:143], v[212:215], v[12:15], v[204:207]
    s_waitcnt lgkmcnt(1)
    v_mfma_f32_16x16x32_bf16 v[128:131], v[216:219], v[16:19], v[128:131]
    ds_read_b128 v[212:215], v224 offset:34048
    v_mfma_f32_16x16x32_bf16 v[132:135], v[216:219], v[20:23], v[132:135]
    s_add_u32 m0, m0, 544
    v_mfma_f32_16x16x32_bf16 v[136:139], v[216:219], v[24:27], v[136:139]
    buffer_load_dwordx4 v250, s[8:11], s48 offen offset:512 lds
    v_mfma_f32_16x16x32_bf16 v[140:143], v[216:219], v[28:31], v[140:143]
    v_mfma_f32_16x16x32_bf16 v[128:131], v[220:223], v[32:35], v[128:131]
    ds_read_b128 v[216:219], v224 offset:34112
    v_mfma_f32_16x16x32_bf16 v[132:135], v[220:223], v[36:39], v[132:135]
    s_add_u32 m0, m0, 544
    v_mfma_f32_16x16x32_bf16 v[136:139], v[220:223], v[40:43], v[136:139]
    buffer_load_dwordx4 v250, s[8:11], s48 offen offset:1024 lds
    v_mfma_f32_16x16x32_bf16 v[140:143], v[220:223], v[44:47], v[140:143]
    s_waitcnt lgkmcnt(1)
    v_mfma_f32_16x16x32_bf16 v[128:131], v[208:211], v[48:51], v[128:131]
    ds_read_b128 v[220:223], v224 offset:34176
    v_mfma_f32_16x16x32_bf16 v[132:135], v[208:211], v[52:55], v[132:135]
    s_add_u32 m0, m0, 544
    v_mfma_f32_16x16x32_bf16 v[136:139], v[208:211], v[56:59], v[136:139]
    buffer_load_dwordx4 v250, s[8:11], s48 offen offset:1536 lds
    v_mfma_f32_16x16x32_bf16 v[140:143], v[208:211], v[60:63], v[140:143]
    v_mfma_f32_16x16x32_bf16 v[128:131], v[212:215], v[64:67], v[128:131]
    ds_read_b128 v[208:211], v224 offset:34240
    v_mfma_f32_16x16x32_bf16 v[132:135], v[212:215], v[68:71], v[132:135]
    s_add_u32 m0, m0, 544
    v_mfma_f32_16x16x32_bf16 v[136:139], v[212:215], v[72:75], v[136:139]
    buffer_load_dwordx4 v250, s[8:11], s48 offen offset:2048 lds
    v_mfma_f32_16x16x32_bf16 v[140:143], v[212:215], v[76:79], v[140:143]
    s_waitcnt lgkmcnt(1)
    v_mfma_f32_16x16x32_bf16 v[128:131], v[216:219], v[80:83], v[128:131]
    ds_read_b128 v[212:215], v248 offset:34304
    v_mfma_f32_16x16x32_bf16 v[132:135], v[216:219], v[84:87], v[132:135]
    s_add_u32 m0, m0, 544
    v_mfma_f32_16x16x32_bf16 v[136:139], v[216:219], v[88:91], v[136:139]
    buffer_load_dwordx4 v250, s[8:11], s48 offen offset:2560 lds
    v_mfma_f32_16x16x32_bf16 v[140:143], v[216:219], v[92:95], v[140:143]
    v_mfma_f32_16x16x32_bf16 v[128:131], v[220:223], v[96:99], v[128:131]
    ds_read_b128 v[216:219], v248 offset:34368
    v_mfma_f32_16x16x32_bf16 v[132:135], v[220:223], v[100:103], v[132:135]
    s_add_u32 m0, m0, 544
    v_mfma_f32_16x16x32_bf16 v[136:139], v[220:223], v[104:107], v[136:139]
    buffer_load_dwordx4 v250, s[8:11], s48 offen offset:3072 lds
    v_mfma_f32_16x16x32_bf16 v[140:143], v[220:223], v[108:111], v[140:143]
    s_waitcnt lgkmcnt(1)
    v_mfma_f32_16x16x32_bf16 v[128:131], v[208:211], v[112:115], v[128:131]
    ds_read_b128 v[220:223], v248 offset:34432
    v_mfma_f32_16x16x32_bf16 v[132:135], v[208:211], v[116:119], v[132:135]
    s_add_u32 m0, m0, 544
    v_mfma_f32_16x16x32_bf16 v[136:139], v[208:211], v[120:123], v[136:139]
    buffer_load_dwordx4 v250, s[8:11], s48 offen offset:3584 lds
    v_mfma_f32_16x16x32_bf16 v[140:143], v[208:211], v[124:127], v[140:143]
    v_mfma_f32_16x16x32_bf16 v[144:147], v[212:215], v[0:3], v[192:195]
    ds_read_b128 v[208:211], v248 offset:34496
    v_mfma_f32_16x16x32_bf16 v[148:151], v[212:215], v[4:7], v[196:199]
    s_add_u32 s49, s49, 0x8000
    s_mov_b32 m0, s67
    v_mfma_f32_16x16x32_bf16 v[152:155], v[212:215], v[8:11], v[200:203]
    buffer_load_dwordx4 v250, s[12:15], s49 offen offset:0 lds
    v_mfma_f32_16x16x32_bf16 v[156:159], v[212:215], v[12:15], v[204:207]
    s_waitcnt lgkmcnt(1)
    v_mfma_f32_16x16x32_bf16 v[144:147], v[216:219], v[16:19], v[144:147]
    ds_read_b128 v[212:215], v224 offset:34560
    v_mfma_f32_16x16x32_bf16 v[148:151], v[216:219], v[20:23], v[148:151]
    s_add_u32 m0, m0, 544
    v_exp_f32 v232, v128
    v_mfma_f32_16x16x32_bf16 v[152:155], v[216:219], v[24:27], v[152:155]
    buffer_load_dwordx4 v250, s[12:15], s49 offen offset:512 lds
    v_mfma_f32_16x16x32_bf16 v[156:159], v[216:219], v[28:31], v[156:159]
    v_exp_f32 v233, v129
    v_mfma_f32_16x16x32_bf16 v[144:147], v[220:223], v[32:35], v[144:147]
    ds_read_b128 v[216:219], v224 offset:34624
    v_cvt_pk_bf16_f32 v176, v232, v233
    v_mfma_f32_16x16x32_bf16 v[148:151], v[220:223], v[36:39], v[148:151]
    s_add_u32 m0, m0, 544
    v_exp_f32 v234, v130
    v_mfma_f32_16x16x32_bf16 v[152:155], v[220:223], v[40:43], v[152:155]
    buffer_load_dwordx4 v250, s[12:15], s49 offen offset:1024 lds
    v_mfma_f32_16x16x32_bf16 v[156:159], v[220:223], v[44:47], v[156:159]
    s_waitcnt lgkmcnt(1)
    v_exp_f32 v235, v131
    v_mfma_f32_16x16x32_bf16 v[144:147], v[208:211], v[48:51], v[144:147]
    ds_read_b128 v[220:223], v224 offset:34688
    v_add_f32 v244, v232, v240
    v_mfma_f32_16x16x32_bf16 v[148:151], v[208:211], v[52:55], v[148:151]
    s_add_u32 m0, m0, 544
    v_exp_f32 v236, v132
    v_mfma_f32_16x16x32_bf16 v[152:155], v[208:211], v[56:59], v[152:155]
    buffer_load_dwordx4 v250, s[12:15], s49 offen offset:1536 lds
    v_mfma_f32_16x16x32_bf16 v[156:159], v[208:211], v[60:63], v[156:159]
    v_add_f32 v244, v233, v244
    v_cvt_pk_bf16_f32 v177, v234, v235
    v_mfma_f32_16x16x32_bf16 v[144:147], v[212:215], v[64:67], v[144:147]
    ds_read_b128 v[208:211], v224 offset:34752
    v_add_f32 v244, v234, v244
    v_mfma_f32_16x16x32_bf16 v[148:151], v[212:215], v[68:71], v[148:151]
    s_add_u32 m0, m0, 544
    v_exp_f32 v237, v133
    v_mfma_f32_16x16x32_bf16 v[152:155], v[212:215], v[72:75], v[152:155]
    buffer_load_dwordx4 v250, s[12:15], s49 offen offset:2048 lds
    v_mfma_f32_16x16x32_bf16 v[156:159], v[212:215], v[76:79], v[156:159]
    s_waitcnt lgkmcnt(1)
    v_exp_f32 v238, v134
    v_mfma_f32_16x16x32_bf16 v[144:147], v[216:219], v[80:83], v[144:147]
    ds_read_b64_tr_b16 v[212:213], v249 offset:0
    v_add_f32 v244, v235, v244
    v_mfma_f32_16x16x32_bf16 v[148:151], v[216:219], v[84:87], v[148:151]
    s_add_u32 m0, m0, 544
    ds_read_b64_tr_b16 v[214:215], v249 offset:512
    v_cvt_pk_bf16_f32 v180, v236, v237
    v_mfma_f32_16x16x32_bf16 v[152:155], v[216:219], v[88:91], v[152:155]
    buffer_load_dwordx4 v250, s[12:15], s49 offen offset:2560 lds
    v_mfma_f32_16x16x32_bf16 v[156:159], v[216:219], v[92:95], v[156:159]
    v_exp_f32 v239, v135
    v_mfma_f32_16x16x32_bf16 v[144:147], v[220:223], v[96:99], v[144:147]
    ds_read_b64_tr_b16 v[216:217], v249 offset:32
    v_add_f32 v245, v236, v241
    v_mfma_f32_16x16x32_bf16 v[148:151], v[220:223], v[100:103], v[148:151]
    s_add_u32 m0, m0, 544
    ds_read_b64_tr_b16 v[218:219], v249 offset:544
    v_add_f32 v245, v237, v245
    v_mfma_f32_16x16x32_bf16 v[152:155], v[220:223], v[104:107], v[152:155]
    buffer_load_dwordx4 v250, s[12:15], s49 offen offset:3072 lds
    v_mfma_f32_16x16x32_bf16 v[156:159], v[220:223], v[108:111], v[156:159]
    s_waitcnt lgkmcnt(2)
    v_exp_f32 v232, v136
    v_mfma_f32_16x16x32_bf16 v[144:147], v[208:211], v[112:115], v[144:147]
    ds_read_b64_tr_b16 v[220:221], v249 offset:64
    v_cvt_pk_bf16_f32 v181, v238, v239
    v_mfma_f32_16x16x32_bf16 v[148:151], v[208:211], v[116:119], v[148:151]
    s_add_u32 m0, m0, 544
    ds_read_b64_tr_b16 v[222:223], v249 offset:576
    v_add_f32 v245, v238, v245
    v_mfma_f32_16x16x32_bf16 v[152:155], v[208:211], v[120:123], v[152:155]
    buffer_load_dwordx4 v250, s[12:15], s49 offen offset:3584 lds
    v_mfma_f32_16x16x32_bf16 v[156:159], v[208:211], v[124:127], v[156:159]
    v_exp_f32 v233, v137
    v_mfma_f32_16x16x32_bf16 a[0:3], v[212:215], v[160:163], a[0:3]
    ds_read_b64_tr_b16 v[208:209], v249 offset:96
    v_add_f32 v245, v239, v245
    v_mfma_f32_16x16x32_bf16 a[4:7], v[212:215], v[164:167], a[4:7]
    ds_read_b64_tr_b16 v[210:211], v249 offset:608
    v_cvt_pk_bf16_f32 v184, v232, v233
    v_mfma_f32_16x16x32_bf16 a[8:11], v[212:215], v[168:171], a[8:11]
    v_exp_f32 v234, v138
    v_mfma_f32_16x16x32_bf16 a[12:15], v[212:215], v[172:175], a[12:15]
    s_waitcnt lgkmcnt(2)
    v_exp_f32 v235, v139
    v_mfma_f32_16x16x32_bf16 a[16:19], v[216:219], v[160:163], a[16:19]
    ds_read_b64_tr_b16 v[212:213], v249 offset:128
    v_add_f32 v246, v232, v242
    v_mfma_f32_16x16x32_bf16 a[20:23], v[216:219], v[164:167], a[20:23]
    s_add_u32 s58, s58, 0x8000
    ds_read_b64_tr_b16 v[214:215], v249 offset:640
    v_add_f32 v246, v233, v246
    v_mfma_f32_16x16x32_bf16 a[24:27], v[216:219], v[168:171], a[24:27]
    buffer_load_dword v227, v226, s[40:43], s58 offen
    v_mfma_f32_16x16x32_bf16 a[28:31], v[216:219], v[172:175], a[28:31]
    v_exp_f32 v236, v140
    v_mfma_f32_16x16x32_bf16 a[32:35], v[220:223], v[160:163], a[32:35]
    ds_read_b64_tr_b16 v[216:217], v249 offset:160
    v_cvt_pk_bf16_f32 v185, v234, v235
    v_mfma_f32_16x16x32_bf16 a[36:39], v[220:223], v[164:167], a[36:39]
    ds_read_b64_tr_b16 v[218:219], v249 offset:672
    v_add_f32 v246, v234, v246
    v_mfma_f32_16x16x32_bf16 a[40:43], v[220:223], v[168:171], a[40:43]
    v_exp_f32 v237, v141
    v_mfma_f32_16x16x32_bf16 a[44:47], v[220:223], v[172:175], a[44:47]
    s_waitcnt lgkmcnt(2)
    v_exp_f32 v238, v142
    v_mfma_f32_16x16x32_bf16 a[48:51], v[208:211], v[160:163], a[48:51]
    ds_read_b64_tr_b16 v[220:221], v249 offset:192
    v_add_f32 v246, v235, v246
    v_mfma_f32_16x16x32_bf16 a[52:55], v[208:211], v[164:167], a[52:55]
    ds_read_b64_tr_b16 v[222:223], v249 offset:704
    v_cvt_pk_bf16_f32 v188, v236, v237
    v_mfma_f32_16x16x32_bf16 a[56:59], v[208:211], v[168:171], a[56:59]
    v_exp_f32 v239, v143
    v_mfma_f32_16x16x32_bf16 a[60:63], v[208:211], v[172:175], a[60:63]
    v_add_f32 v247, v236, v243
    v_add_f32 v247, v237, v247
    v_mfma_f32_16x16x32_bf16 a[64:67], v[212:215], v[160:163], a[64:67]
    ds_read_b64_tr_b16 v[208:209], v249 offset:224
    v_cvt_pk_bf16_f32 v189, v238, v239
    v_mfma_f32_16x16x32_bf16 a[68:71], v[212:215], v[164:167], a[68:71]
    ds_read_b64_tr_b16 v[210:211], v249 offset:736
    v_add_f32 v247, v238, v247
    v_mfma_f32_16x16x32_bf16 a[72:75], v[212:215], v[168:171], a[72:75]
    v_exp_f32 v232, v144
    v_mfma_f32_16x16x32_bf16 a[76:79], v[212:215], v[172:175], a[76:79]
    s_waitcnt lgkmcnt(2)
    v_exp_f32 v233, v145
    v_mfma_f32_16x16x32_bf16 a[80:83], v[216:219], v[160:163], a[80:83]
    ds_read_b64_tr_b16 v[212:213], v249 offset:256
    v_add_f32 v247, v239, v247
    v_mfma_f32_16x16x32_bf16 a[84:87], v[216:219], v[164:167], a[84:87]
    ds_read_b64_tr_b16 v[214:215], v249 offset:768
    v_cvt_pk_bf16_f32 v178, v232, v233
    v_mfma_f32_16x16x32_bf16 a[88:91], v[216:219], v[168:171], a[88:91]
    v_exp_f32 v234, v146
    v_mfma_f32_16x16x32_bf16 a[92:95], v[216:219], v[172:175], a[92:95]
    v_exp_f32 v235, v147
    v_mfma_f32_16x16x32_bf16 a[96:99], v[220:223], v[160:163], a[96:99]
    ds_read_b64_tr_b16 v[216:217], v249 offset:288
    v_add_f32 v244, v232, v244
    v_mfma_f32_16x16x32_bf16 a[100:103], v[220:223], v[164:167], a[100:103]
    ds_read_b64_tr_b16 v[218:219], v249 offset:800
    v_add_f32 v244, v233, v244
    v_mfma_f32_16x16x32_bf16 a[104:107], v[220:223], v[168:171], a[104:107]
    v_exp_f32 v236, v148
    v_mfma_f32_16x16x32_bf16 a[108:111], v[220:223], v[172:175], a[108:111]
    s_waitcnt lgkmcnt(2)
    v_exp_f32 v237, v149
    v_mfma_f32_16x16x32_bf16 a[112:115], v[208:211], v[160:163], a[112:115]
    ds_read_b64_tr_b16 v[220:221], v249 offset:320
    v_cvt_pk_bf16_f32 v179, v234, v235
    v_mfma_f32_16x16x32_bf16 a[116:119], v[208:211], v[164:167], a[116:119]
    ds_read_b64_tr_b16 v[222:223], v249 offset:832
    v_add_f32 v244, v234, v244
    v_mfma_f32_16x16x32_bf16 a[120:123], v[208:211], v[168:171], a[120:123]
    v_exp_f32 v238, v150
    v_mfma_f32_16x16x32_bf16 a[124:127], v[208:211], v[172:175], a[124:127]
    v_add_f32 v244, v235, v244
    v_cvt_pk_bf16_f32 v182, v236, v237
    v_mfma_f32_16x16x32_bf16 a[128:131], v[212:215], v[160:163], a[128:131]
    ds_read_b64_tr_b16 v[208:209], v249 offset:352
    v_add_f32 v245, v236, v245
    v_mfma_f32_16x16x32_bf16 a[132:135], v[212:215], v[164:167], a[132:135]
    ds_read_b64_tr_b16 v[210:211], v249 offset:864
    v_add_f32 v245, v237, v245
    v_mfma_f32_16x16x32_bf16 a[136:139], v[212:215], v[168:171], a[136:139]
    v_exp_f32 v239, v151
    v_mfma_f32_16x16x32_bf16 a[140:143], v[212:215], v[172:175], a[140:143]
    s_waitcnt lgkmcnt(2)
    v_exp_f32 v232, v152
    v_mfma_f32_16x16x32_bf16 a[144:147], v[216:219], v[160:163], a[144:147]
    ds_read_b64_tr_b16 v[212:213], v249 offset:384
    v_cvt_pk_bf16_f32 v183, v238, v239
    v_mfma_f32_16x16x32_bf16 a[148:151], v[216:219], v[164:167], a[148:151]
    ds_read_b64_tr_b16 v[214:215], v249 offset:896
    v_add_f32 v245, v238, v245
    v_mfma_f32_16x16x32_bf16 a[152:155], v[216:219], v[168:171], a[152:155]
    v_exp_f32 v233, v153
    v_mfma_f32_16x16x32_bf16 a[156:159], v[216:219], v[172:175], a[156:159]
    v_exp_f32 v234, v154
    v_mfma_f32_16x16x32_bf16 a[160:163], v[220:223], v[160:163], a[160:163]
    ds_read_b64_tr_b16 v[216:217], v249 offset:416
    v_add_f32 v245, v239, v245
    v_mfma_f32_16x16x32_bf16 a[164:167], v[220:223], v[164:167], a[164:167]
    ds_read_b64_tr_b16 v[218:219], v249 offset:928
    v_cvt_pk_bf16_f32 v186, v232, v233
    v_mfma_f32_16x16x32_bf16 a[168:171], v[220:223], v[168:171], a[168:171]
    v_exp_f32 v235, v155
    v_mfma_f32_16x16x32_bf16 a[172:175], v[220:223], v[172:175], a[172:175]
    s_waitcnt lgkmcnt(2)
    v_add_f32 v246, v232, v246
    v_add_f32 v246, v233, v246
    v_mfma_f32_16x16x32_bf16 a[176:179], v[208:211], v[160:163], a[176:179]
    ds_read_b64_tr_b16 v[220:221], v249 offset:448
    v_cvt_pk_bf16_f32 v187, v234, v235
    v_mfma_f32_16x16x32_bf16 a[180:183], v[208:211], v[164:167], a[180:183]
    ds_read_b64_tr_b16 v[222:223], v249 offset:960
    v_add_f32 v246, v234, v246
    v_mfma_f32_16x16x32_bf16 a[184:187], v[208:211], v[168:171], a[184:187]
    v_exp_f32 v236, v156
    v_mfma_f32_16x16x32_bf16 a[188:191], v[208:211], v[172:175], a[188:191]
    v_exp_f32 v237, v157
    v_mfma_f32_16x16x32_bf16 a[192:195], v[212:215], v[160:163], a[192:195]
    ds_read_b64_tr_b16 v[208:209], v249 offset:480
    v_add_f32 v246, v235, v246
    v_mfma_f32_16x16x32_bf16 a[196:199], v[212:215], v[164:167], a[196:199]
    ds_read_b64_tr_b16 v[210:211], v249 offset:992
    v_cvt_pk_bf16_f32 v190, v236, v237
    v_mfma_f32_16x16x32_bf16 a[200:203], v[212:215], v[168:171], a[200:203]
    v_exp_f32 v238, v158
    v_mfma_f32_16x16x32_bf16 a[204:207], v[212:215], v[172:175], a[204:207]
    s_waitcnt lgkmcnt(4)
    v_exp_f32 v239, v159
    v_mfma_f32_16x16x32_bf16 a[208:211], v[216:219], v[160:163], a[208:211]
    v_add_f32 v247, v236, v247
    v_add_f32 v247, v237, v247
    v_mfma_f32_16x16x32_bf16 a[212:215], v[216:219], v[164:167], a[212:215]
    v_cvt_pk_bf16_f32 v191, v238, v239
    v_add_f32 v247, v238, v247
    v_mfma_f32_16x16x32_bf16 a[216:219], v[216:219], v[168:171], a[216:219]
    v_add_f32 v247, v239, v247
    v_mfma_f32_16x16x32_bf16 a[220:223], v[216:219], v[172:175], a[220:223]
    s_waitcnt vmcnt(1)
    s_waitcnt lgkmcnt(0)
    s_barrier
    v_mfma_f32_16x16x32_bf16 a[224:227], v[220:223], v[160:163], a[224:227]
    ds_read_b128 v[212:215], v248 offset:0
    v_mfma_f32_16x16x32_bf16 a[228:231], v[220:223], v[164:167], a[228:231]
    ds_read_b128 v[216:219], v248 offset:64
    v_mfma_f32_16x16x32_bf16 a[232:235], v[220:223], v[168:171], a[232:235]
    v_mfma_f32_16x16x32_bf16 a[236:239], v[220:223], v[172:175], a[236:239]
    v_mfma_f32_16x16x32_bf16 a[240:243], v[208:211], v[160:163], a[240:243]
    ds_read_b128 v[220:223], v248 offset:128
    v_max3_f32 v232, v244, v245, v246
    v_mfma_f32_16x16x32_bf16 a[244:247], v[208:211], v[164:167], a[244:247]
    v_max_f32 v232, v232, v247
    v_mfma_f32_16x16x32_bf16 a[248:251], v[208:211], v[168:171], a[248:251]
    v_cmp_lt_f32 vcc, s52, v232
    v_mfma_f32_16x16x32_bf16 a[252:255], v[208:211], v[172:175], a[252:255]
    s_cbranch_vccnz L_slowB
L_retB:
    s_sub_u32 s51, s51, 1
    s_cmp_lg_u32 s51, 0
    s_cbranch_scc1 L_loop
    s_cmp_lg_u32 s3, 0
    s_cbranch_scc1 L_mpsig
    s_lshl_b32 s100, s45, 8
    s_lshl_b32 s101, s44, 2
    s_add_u32 s100, s100, s101
    s_add_u32 s100, s100, 33554432
    s_mov_b64 exec, 1
    v_mov_b32 v228, s59
    v_mov_b32 v229, 0
    buffer_store_dword v228, v229, s[36:39], s100 offen sc1
    s_mov_b64 exec, -1
L_mpsig:
    v_lshrrev_b32 v236, 5, v251
    v_and_b32 v237, 31, v251
    v_lshlrev_b32 v237, 4, v237
    v_mul_u32_u24 v225, 14336, v236
    v_add_u32 v225, v225, v237
    v_cmp_lt_u32 vcc, 432, v237
    v_mov_b32 v238, 0x40000000
    s_nop 1
    v_cndmask_b32 v225, v225, v238, vcc
    ds_read_b64_tr_b16 v[212:213], v249 offset:33792
    ds_read_b64_tr_b16 v[214:215], v249 offset:34304
    ds_read_b64_tr_b16 v[216:217], v249 offset:33824
    ds_read_b64_tr_b16 v[218:219], v249 offset:34336
    ds_read_b64_tr_b16 v[220:221], v249 offset:33856
    ds_read_b64_tr_b16 v[222:223], v249 offset:34368
    s_waitcnt lgkmcnt(4)
    v_mfma_f32_16x16x32_bf16 a[0:3], v[212:215], v[176:179], a[0:3]
    ds_read_b64_tr_b16 v[208:209], v249 offset:33888
    v_mfma_f32_16x16x32_bf16 a[4:7], v[212:215], v[180:183], a[4:7]
    s_add_u32 s50, s63, 0
    s_add_u32 m0, s64, 0
    ds_read_b64_tr_b16 v[210:211], v249 offset:34400
    v_mov_b32 v0, v244
    v_mfma_f32_16x16x32_bf16 a[8:11], v[212:215], v[184:187], a[8:11]
    buffer_load_dwordx4 v225, s[24:27], s50 offen offset:0 lds
    v_mfma_f32_16x16x32_bf16 a[12:15], v[212:215], v[188:191], a[12:15]
    s_waitcnt lgkmcnt(2)
    v_mov_b32 v1, v245
    v_mov_b32 v2, v246
    v_mfma_f32_16x16x32_bf16 a[16:19], v[216:219], v[176:179], a[16:19]
    ds_read_b64_tr_b16 v[212:213], v249 offset:33920
    v_mov_b32 v3, v247
    v_mfma_f32_16x16x32_bf16 a[20:23], v[216:219], v[180:183], a[20:23]
    s_add_u32 m0, s64, 160
    ds_read_b64_tr_b16 v[214:215], v249 offset:34432
    v_permlane16_swap_b32 v244, v0
    v_mfma_f32_16x16x32_bf16 a[24:27], v[216:219], v[184:187], a[24:27]
    buffer_load_dwordx4 v225, s[24:27], s50 offen offset:896 lds
    v_mfma_f32_16x16x32_bf16 a[28:31], v[216:219], v[188:191], a[28:31]
    v_permlane16_swap_b32 v245, v1
    v_permlane16_swap_b32 v246, v2
    v_mfma_f32_16x16x32_bf16 a[32:35], v[220:223], v[176:179], a[32:35]
    ds_read_b64_tr_b16 v[216:217], v249 offset:33952
    v_permlane16_swap_b32 v247, v3
    v_mfma_f32_16x16x32_bf16 a[36:39], v[220:223], v[180:183], a[36:39]
    s_add_u32 m0, s64, 320
    ds_read_b64_tr_b16 v[218:219], v249 offset:34464
    v_add_f32 v244, v244, v0
    v_mfma_f32_16x16x32_bf16 a[40:43], v[220:223], v[184:187], a[40:43]
    buffer_load_dwordx4 v225, s[24:27], s50 offen offset:1792 lds
    v_mfma_f32_16x16x32_bf16 a[44:47], v[220:223], v[188:191], a[44:47]
    s_waitcnt lgkmcnt(2)
    v_add_f32 v245, v245, v1
    v_add_f32 v246, v246, v2
    v_mfma_f32_16x16x32_bf16 a[48:51], v[208:211], v[176:179], a[48:51]
    ds_read_b64_tr_b16 v[220:221], v249 offset:33984
    v_add_f32 v247, v247, v3
    v_mfma_f32_16x16x32_bf16 a[52:55], v[208:211], v[180:183], a[52:55]
    s_add_u32 m0, s64, 480
    ds_read_b64_tr_b16 v[222:223], v249 offset:34496
    v_mov_b32 v0, v244
    v_mfma_f32_16x16x32_bf16 a[56:59], v[208:211], v[184:187], a[56:59]
    buffer_load_dwordx4 v225, s[24:27], s50 offen offset:2688 lds
    v_mfma_f32_16x16x32_bf16 a[60:63], v[208:211], v[188:191], a[60:63]
    v_mov_b32 v1, v245
    v_mov_b32 v2, v246
    v_mfma_f32_16x16x32_bf16 a[64:67], v[212:215], v[176:179], a[64:67]
    ds_read_b64_tr_b16 v[208:209], v249 offset:34016
    v_mov_b32 v3, v247
    v_mfma_f32_16x16x32_bf16 a[68:71], v[212:215], v[180:183], a[68:71]
    s_add_u32 s50, s63, 3584
    s_add_u32 m0, s64, 4224
    ds_read_b64_tr_b16 v[210:211], v249 offset:34528
    v_permlane32_swap_b32 v244, v0
    v_mfma_f32_16x16x32_bf16 a[72:75], v[212:215], v[184:187], a[72:75]
    buffer_load_dwordx4 v225, s[24:27], s50 offen offset:0 lds
    v_mfma_f32_16x16x32_bf16 a[76:79], v[212:215], v[188:191], a[76:79]
    s_waitcnt lgkmcnt(2)
    v_permlane32_swap_b32 v245, v1
    v_permlane32_swap_b32 v246, v2
    v_mfma_f32_16x16x32_bf16 a[80:83], v[216:219], v[176:179], a[80:83]
    ds_read_b64_tr_b16 v[212:213], v249 offset:34048
    v_permlane32_swap_b32 v247, v3
    v_mfma_f32_16x16x32_bf16 a[84:87], v[216:219], v[180:183], a[84:87]
    s_add_u32 m0, s64, 4384
    ds_read_b64_tr_b16 v[214:215], v249 offset:34560
    v_add_f32 v244, v244, v0
    v_mfma_f32_16x16x32_bf16 a[88:91], v[216:219], v[184:187], a[88:91]
    buffer_load_dwordx4 v225, s[24:27], s50 offen offset:896 lds
    v_mfma_f32_16x16x32_bf16 a[92:95], v[216:219], v[188:191], a[92:95]
    v_add_f32 v245, v245, v1
    v_add_f32 v246, v246, v2
    v_mfma_f32_16x16x32_bf16 a[96:99], v[220:223], v[176:179], a[96:99]
    ds_read_b64_tr_b16 v[216:217], v249 offset:34080
    v_add_f32 v247, v247, v3
    v_mfma_f32_16x16x32_bf16 a[100:103], v[220:223], v[180:183], a[100:103]
    s_add_u32 m0, s64, 4544
    ds_read_b64_tr_b16 v[218:219], v249 offset:34592
    v_sub_f32 v0, 0, v192
    v_mfma_f32_16x16x32_bf16 a[104:107], v[220:223], v[184:187], a[104:107]
    buffer_load_dwordx4 v225, s[24:27], s50 offen offset:1792 lds
    v_mfma_f32_16x16x32_bf16 a[108:111], v[220:223], v[188:191], a[108:111]
    v_mov_b32 v1, v244
    v_sub_f32 v2, 0, v196
    v_mov_b32 v3, v245
    v_sub_f32 v4, 0, v200
    v_mov_b32 v5, v246
    v_sub_f32 v6, 0, v204
    v_mov_b32 v7, v247
    v_and_b32 v29, 15, v251
    v_lshlrev_b32 v29, 3, v29
    s_lshl_b32 s100, s3, 9
    s_add_u32 s100, s100, 135168
    v_add_u32 v28, s100, v29
    s_xor_b32 s100, s100, 512
    v_add_u32 v29, s100, v29
    ds_write_b64 v28, v[0:1] offset:0
    ds_write_b64 v28, v[2:3] offset:128
    ds_write_b64 v28, v[4:5] offset:256
    ds_write_b64 v28, v[6:7] offset:384
    s_waitcnt lgkmcnt(0)
    s_barrier
    v_mfma_f32_16x16x32_bf16 a[112:115], v[208:211], v[176:179], a[112:115]
    ds_read_b64_tr_b16 v[220:221], v249 offset:34112
    v_mfma_f32_16x16x32_bf16 a[116:119], v[208:211], v[180:183], a[116:119]
    s_add_u32 m0, s64, 4704
    ds_read_b64_tr_b16 v[222:223], v249 offset:34624
    ds_read_b64 v[8:9], v29 offset:0
    v_mfma_f32_16x16x32_bf16 a[120:123], v[208:211], v[184:187], a[120:123]
    buffer_load_dwordx4 v225, s[24:27], s50 offen offset:2688 lds
    v_mfma_f32_16x16x32_bf16 a[124:127], v[208:211], v[188:191], a[124:127]
    ds_read_b64 v[10:11], v29 offset:128
    ds_read_b64 v[12:13], v29 offset:256
    v_mfma_f32_16x16x32_bf16 a[128:131], v[212:215], v[176:179], a[128:131]
    ds_read_b64_tr_b16 v[208:209], v249 offset:34144
    ds_read_b64 v[14:15], v29 offset:384
    v_mfma_f32_16x16x32_bf16 a[132:135], v[212:215], v[180:183], a[132:135]
    s_add_u32 s50, s63, 28672
    s_add_u32 m0, s65, 0
    ds_read_b64_tr_b16 v[210:211], v249 offset:34656
    v_lshlrev_b32 v228, 4, v251
    s_lshl_b32 s100, s3, 14
    s_add_u32 s100, s100, 67584
    v_mfma_f32_16x16x32_bf16 a[136:139], v[212:215], v[184:187], a[136:139]
    buffer_load_dwordx4 v225, s[24:27], s50 offen offset:0 lds
    v_mfma_f32_16x16x32_bf16 a[140:143], v[212:215], v[188:191], a[140:143]
    s_waitcnt lgkmcnt(6)
    v_add_u32 v30, s100, v228
    s_xor_b32 s101, s3, 1
    s_lshl_b32 s101, s101, 14
    s_add_u32 s101, s101, 67584
    v_add_u32 v31, s101, v228
    s_waitcnt lgkmcnt(1)
    v_mfma_f32_16x16x32_bf16 a[144:147], v[216:219], v[176:179], a[144:147]
    ds_read_b64_tr_b16 v[212:213], v249 offset:34176
    v_max_f32 v20, v0, v8
    v_mfma_f32_16x16x32_bf16 a[148:151], v[216:219], v[180:183], a[148:151]
    s_add_u32 m0, s65, 160
    ds_read_b64_tr_b16 v[214:215], v249 offset:34688
    v_max_f32 v21, v2, v10
    v_mfma_f32_16x16x32_bf16 a[152:155], v[216:219], v[184:187], a[152:155]
    buffer_load_dwordx4 v225, s[24:27], s50 offen offset:896 lds
    v_mfma_f32_16x16x32_bf16 a[156:159], v[216:219], v[188:191], a[156:159]
    v_max_f32 v22, v4, v12
    v_max_f32 v23, v6, v14
    v_mfma_f32_16x16x32_bf16 a[160:163], v[220:223], v[176:179], a[160:163]
    ds_read_b64_tr_b16 v[216:217], v249 offset:34208
    v_sub_f32 v0, v0, v20
    v_mfma_f32_16x16x32_bf16 a[164:167], v[220:223], v[180:183], a[164:167]
    s_add_u32 m0, s65, 320
    ds_read_b64_tr_b16 v[218:219], v249 offset:34720
    v_sub_f32 v8, v8, v20
    v_mfma_f32_16x16x32_bf16 a[168:171], v[220:223], v[184:187], a[168:171]
    buffer_load_dwordx4 v225, s[24:27], s50 offen offset:1792 lds
    v_mfma_f32_16x16x32_bf16 a[172:175], v[220:223], v[188:191], a[172:175]
    s_waitcnt lgkmcnt(2)
    v_sub_f32 v2, v2, v21
    v_sub_f32 v10, v10, v21
    v_mfma_f32_16x16x32_bf16 a[176:179], v[208:211], v[176:179], a[176:179]
    ds_read_b64_tr_b16 v[220:221], v249 offset:34240
    v_sub_f32 v4, v4, v22
    v_mfma_f32_16x16x32_bf16 a[180:183], v[208:211], v[180:183], a[180:183]
    s_add_u32 m0, s65, 480
    ds_read_b64_tr_b16 v[222:223], v249 offset:34752
    v_sub_f32 v12, v12, v22
    v_mfma_f32_16x16x32_bf16 a[184:187], v[208:211], v[184:187], a[184:187]
    buffer_load_dwordx4 v225, s[24:27], s50 offen offset:2688 lds
    v_mfma_f32_16x16x32_bf16 a[188:191], v[208:211], v[188:191], a[188:191]
    v_sub_f32 v6, v6, v23
    v_sub_f32 v14, v14, v23
    v_mfma_f32_16x16x32_bf16 a[192:195], v[212:215], v[176:179], a[192:195]
    ds_read_b64_tr_b16 v[208:209], v249 offset:34272
    v_mfma_f32_16x16x32_bf16 a[196:199], v[212:215], v[180:183], a[196:199]
    s_add_u32 s50, s63, 32256
    s_add_u32 m0, s65, 4224
    ds_read_b64_tr_b16 v[210:211], v249 offset:34784
    v_mfma_f32_16x16x32_bf16 a[200:203], v[212:215], v[184:187], a[200:203]
    buffer_load_dwordx4 v225, s[24:27], s50 offen offset:0 lds
    v_mfma_f32_16x16x32_bf16 a[204:207], v[212:215], v[188:191], a[204:207]
    s_waitcnt lgkmcnt(2)
    v_exp_f32 v0, v0
    v_mfma_f32_16x16x32_bf16 a[208:211], v[216:219], v[176:179], a[208:211]
    s_add_u32 m0, s65, 4384
    v_exp_f32 v8, v8
    v_mfma_f32_16x16x32_bf16 a[212:215], v[216:219], v[180:183], a[212:215]
    buffer_load_dwordx4 v225, s[24:27], s50 offen offset:896 lds
    v_mfma_f32_16x16x32_bf16 a[216:219], v[216:219], v[184:187], a[216:219]
    v_exp_f32 v2, v2
    v_mfma_f32_16x16x32_bf16 a[220:223], v[216:219], v[188:191], a[220:223]
    s_add_u32 m0, s65, 4544
    v_exp_f32 v10, v10
    v_mfma_f32_16x16x32_bf16 a[224:227], v[220:223], v[176:179], a[224:227]
    buffer_load_dwordx4 v225, s[24:27], s50 offen offset:1792 lds
    v_mfma_f32_16x16x32_bf16 a[228:231], v[220:223], v[180:183], a[228:231]
    v_exp_f32 v4, v4
    v_mfma_f32_16x16x32_bf16 a[232:235], v[220:223], v[184:187], a[232:235]
    s_add_u32 m0, s65, 4704
    v_exp_f32 v12, v12
    v_mfma_f32_16x16x32_bf16 a[236:239], v[220:223], v[188:191], a[236:239]
    s_waitcnt lgkmcnt(0)
    buffer_load_dwordx4 v225, s[24:27], s50 offen offset:2688 lds
    v_mfma_f32_16x16x32_bf16 a[240:243], v[208:211], v[176:179], a[240:243]
    v_exp_f32 v6, v6
    v_mfma_f32_16x16x32_bf16 a[244:247], v[208:211], v[180:183], a[244:247]
    v_exp_f32 v14, v14
    v_mfma_f32_16x16x32_bf16 a[248:251], v[208:211], v[184:187], a[248:251]
    v_mul_f32 v1, v1, v0
    v_mul_f32 v3, v3, v2
    v_mfma_f32_16x16x32_bf16 a[252:255], v[208:211], v[188:191], a[252:255]
    v_mul_f32 v5, v5, v4
    v_mul_f32 v7, v7, v6
    v_fma_f32 v1, v9, v8, v1
    v_fma_f32 v3, v11, v10, v3
    v_fma_f32 v5, v13, v12, v5
    v_fma_f32 v7, v15, v14, v7
    v_rcp_f32 v1, v1
    v_rcp_f32 v3, v3
    v_rcp_f32 v5, v5
    v_rcp_f32 v7, v7
    v_mul_f32 v16, v0, v1
    v_mul_f32 v17, v2, v3
    v_mul_f32 v18, v4, v5
    v_mul_f32 v19, v6, v7
    v_mul_f32 v24, v8, v1
    v_mul_f32 v25, v10, v3
    v_mul_f32 v26, v12, v5
    v_mul_f32 v27, v14, v7
    s_nop 7
    s_nop 3
    s_barrier
    s_cmp_eq_u32 s54, 0
    s_cbranch_scc0 L_mv1
    ds_write_b128 v30, a[128:131] offset:0
    v_accvgpr_read_b32 v96, a0
    v_accvgpr_read_b32 v97, a1
    v_accvgpr_read_b32 v98, a2
    v_accvgpr_read_b32 v99, a3
    v_pk_mul_f32 v[96:97], v[96:97], v[16:17] op_sel_hi:[1,0]
    v_pk_mul_f32 v[98:99], v[98:99], v[16:17] op_sel_hi:[1,0]
    ds_write_b128 v30, a[132:135] offset:1024
    v_accvgpr_read_b32 v100, a4
    v_accvgpr_read_b32 v101, a5
    v_accvgpr_read_b32 v102, a6
    v_accvgpr_read_b32 v103, a7
    v_pk_mul_f32 v[100:101], v[100:101], v[16:17] op_sel:[0,1]
    v_pk_mul_f32 v[102:103], v[102:103], v[16:17] op_sel:[0,1]
    ds_write_b128 v30, a[136:139] offset:2048
    v_accvgpr_read_b32 v104, a8
    v_accvgpr_read_b32 v105, a9
    v_accvgpr_read_b32 v106, a10
    v_accvgpr_read_b32 v107, a11
    v_pk_mul_f32 v[104:105], v[104:105], v[18:19] op_sel_hi:[1,0]
    v_pk_mul_f32 v[106:107], v[106:107], v[18:19] op_sel_hi:[1,0]
    ds_write_b128 v30, a[140:143] offset:3072
    v_accvgpr_read_b32 v108, a12
    v_accvgpr_read_b32 v109, a13
    v_accvgpr_read_b32 v110, a14
    v_accvgpr_read_b32 v111, a15
    v_pk_mul_f32 v[108:109], v[108:109], v[18:19] op_sel:[0,1]
    v_pk_mul_f32 v[110:111], v[110:111], v[18:19] op_sel:[0,1]
    ds_write_b128 v30, a[144:147] offset:4096
    v_accvgpr_read_b32 v112, a16
    v_accvgpr_read_b32 v113, a17
    v_accvgpr_read_b32 v114, a18
    v_accvgpr_read_b32 v115, a19
    v_pk_mul_f32 v[112:113], v[112:113], v[16:17] op_sel_hi:[1,0]
    v_pk_mul_f32 v[114:115], v[114:115], v[16:17] op_sel_hi:[1,0]
    ds_write_b128 v30, a[148:151] offset:5120
    v_accvgpr_read_b32 v116, a20
    v_accvgpr_read_b32 v117, a21
    v_accvgpr_read_b32 v118, a22
    v_accvgpr_read_b32 v119, a23
    v_pk_mul_f32 v[116:117], v[116:117], v[16:17] op_sel:[0,1]
    v_pk_mul_f32 v[118:119], v[118:119], v[16:17] op_sel:[0,1]
    ds_write_b128 v30, a[152:155] offset:6144
    v_accvgpr_read_b32 v120, a24
    v_accvgpr_read_b32 v121, a25
    v_accvgpr_read_b32 v122, a26
    v_accvgpr_read_b32 v123, a27
    v_pk_mul_f32 v[120:121], v[120:121], v[18:19] op_sel_hi:[1,0]
    v_pk_mul_f32 v[122:123], v[122:123], v[18:19] op_sel_hi:[1,0]
    ds_write_b128 v30, a[156:159] offset:7168
    v_accvgpr_read_b32 v124, a28
    v_accvgpr_read_b32 v125, a29
    v_accvgpr_read_b32 v126, a30
    v_accvgpr_read_b32 v127, a31
    v_pk_mul_f32 v[124:125], v[124:125], v[18:19] op_sel:[0,1]
    v_pk_mul_f32 v[126:127], v[126:127], v[18:19] op_sel:[0,1]
    ds_write_b128 v30, a[160:163] offset:8192
    v_accvgpr_read_b32 v128, a32
    v_accvgpr_read_b32 v129, a33
    v_accvgpr_read_b32 v130, a34
    v_accvgpr_read_b32 v131, a35
    v_pk_mul_f32 v[128:129], v[128:129], v[16:17] op_sel_hi:[1,0]
    v_pk_mul_f32 v[130:131], v[130:131], v[16:17] op_sel_hi:[1,0]
    ds_write_b128 v30, a[164:167] offset:9216
    v_accvgpr_read_b32 v132, a36
    v_accvgpr_read_b32 v133, a37
    v_accvgpr_read_b32 v134, a38
    v_accvgpr_read_b32 v135, a39
    v_pk_mul_f32 v[132:133], v[132:133], v[16:17] op_sel:[0,1]
    v_pk_mul_f32 v[134:135], v[134:135], v[16:17] op_sel:[0,1]
    ds_write_b128 v30, a[168:171] offset:10240
    v_accvgpr_read_b32 v136, a40
    v_accvgpr_read_b32 v137, a41
    v_accvgpr_read_b32 v138, a42
    v_accvgpr_read_b32 v139, a43
    v_pk_mul_f32 v[136:137], v[136:137], v[18:19] op_sel_hi:[1,0]
    v_pk_mul_f32 v[138:139], v[138:139], v[18:19] op_sel_hi:[1,0]
    ds_write_b128 v30, a[172:175] offset:11264
    v_accvgpr_read_b32 v140, a44
    v_accvgpr_read_b32 v141, a45
    v_accvgpr_read_b32 v142, a46
    v_accvgpr_read_b32 v143, a47
    v_pk_mul_f32 v[140:141], v[140:141], v[18:19] op_sel:[0,1]
    v_pk_mul_f32 v[142:143], v[142:143], v[18:19] op_sel:[0,1]
    ds_write_b128 v30, a[176:179] offset:12288
    v_accvgpr_read_b32 v144, a48
    v_accvgpr_read_b32 v145, a49
    v_accvgpr_read_b32 v146, a50
    v_accvgpr_read_b32 v147, a51
    v_pk_mul_f32 v[144:145], v[144:145], v[16:17] op_sel_hi:[1,0]
    v_pk_mul_f32 v[146:147], v[146:147], v[16:17] op_sel_hi:[1,0]
    ds_write_b128 v30, a[180:183] offset:13312
    v_accvgpr_read_b32 v148, a52
    v_accvgpr_read_b32 v149, a53
    v_accvgpr_read_b32 v150, a54
    v_accvgpr_read_b32 v151, a55
    v_pk_mul_f32 v[148:149], v[148:149], v[16:17] op_sel:[0,1]
    v_pk_mul_f32 v[150:151], v[150:151], v[16:17] op_sel:[0,1]
    ds_write_b128 v30, a[184:187] offset:14336
    v_accvgpr_read_b32 v152, a56
    v_accvgpr_read_b32 v153, a57
    v_accvgpr_read_b32 v154, a58
    v_accvgpr_read_b32 v155, a59
    v_pk_mul_f32 v[152:153], v[152:153], v[18:19] op_sel_hi:[1,0]
    v_pk_mul_f32 v[154:155], v[154:155], v[18:19] op_sel_hi:[1,0]
    ds_write_b128 v30, a[188:191] offset:15360
    v_accvgpr_read_b32 v156, a60
    v_accvgpr_read_b32 v157, a61
    v_accvgpr_read_b32 v158, a62
    v_accvgpr_read_b32 v159, a63
    v_pk_mul_f32 v[156:157], v[156:157], v[18:19] op_sel:[0,1]
    v_pk_mul_f32 v[158:159], v[158:159], v[18:19] op_sel:[0,1]
    s_waitcnt lgkmcnt(0)
    s_barrier
    ds_read_b128 v[160:163], v31 offset:0
    ds_read_b128 v[164:167], v31 offset:1024
    ds_read_b128 v[168:171], v31 offset:2048
    ds_read_b128 v[172:175], v31 offset:3072
    ds_read_b128 v[176:179], v31 offset:4096
    ds_read_b128 v[180:183], v31 offset:5120
    ds_read_b128 v[184:187], v31 offset:6144
    ds_read_b128 v[188:191], v31 offset:7168
    ds_read_b128 v[192:195], v31 offset:8192
    ds_read_b128 v[196:199], v31 offset:9216
    ds_read_b128 v[200:203], v31 offset:10240
    ds_read_b128 v[204:207], v31 offset:11264
    ds_read_b128 v[208:211], v31 offset:12288
    ds_read_b128 v[212:215], v31 offset:13312
    ds_read_b128 v[216:219], v31 offset:14336
    ds_read_b128 v[220:223], v31 offset:15360
    s_waitcnt lgkmcnt(14)
    v_pk_fma_f32 v[96:97], v[160:161], v[24:25], v[96:97] op_sel_hi:[1,0,1]
    v_pk_fma_f32 v[98:99], v[162:163], v[24:25], v[98:99] op_sel_hi:[1,0,1]
    v_pk_fma_f32 v[100:101], v[164:165], v[24:25], v[100:101] op_sel:[0,1,0]
    v_pk_fma_f32 v[102:103], v[166:167], v[24:25], v[102:103] op_sel:[0,1,0]
    v_cvt_pk_bf16_f32 v32, v96, v97
    v_cvt_pk_bf16_f32 v33, v98, v99
    v_cvt_pk_bf16_f32 v36, v100, v101
    v_cvt_pk_bf16_f32 v37, v102, v103
    s_waitcnt lgkmcnt(12)
    v_pk_fma_f32 v[104:105], v[168:169], v[26:27], v[104:105] op_sel_hi:[1,0,1]
    v_pk_fma_f32 v[106:107], v[170:171], v[26:27], v[106:107] op_sel_hi:[1,0,1]
    v_pk_fma_f32 v[108:109], v[172:173], v[26:27], v[108:109] op_sel:[0,1,0]
    v_pk_fma_f32 v[110:111], v[174:175], v[26:27], v[110:111] op_sel:[0,1,0]
    v_cvt_pk_bf16_f32 v40, v104, v105
    v_cvt_pk_bf16_f32 v41, v106, v107
    v_cvt_pk_bf16_f32 v44, v108, v109
    v_cvt_pk_bf16_f32 v45, v110, v111
    s_waitcnt lgkmcnt(10)
    v_pk_fma_f32 v[112:113], v[176:177], v[24:25], v[112:113] op_sel_hi:[1,0,1]
    v_pk_fma_f32 v[114:115], v[178:179], v[24:25], v[114:115] op_sel_hi:[1,0,1]
    v_pk_fma_f32 v[116:117], v[180:181], v[24:25], v[116:117] op_sel:[0,1,0]
    v_pk_fma_f32 v[118:119], v[182:183], v[24:25], v[118:119] op_sel:[0,1,0]
    v_cvt_pk_bf16_f32 v34, v112, v113
    v_cvt_pk_bf16_f32 v35, v114, v115
    v_cvt_pk_bf16_f32 v38, v116, v117
    v_cvt_pk_bf16_f32 v39, v118, v119
    s_waitcnt lgkmcnt(8)
    v_pk_fma_f32 v[120:121], v[184:185], v[26:27], v[120:121] op_sel_hi:[1,0,1]
    v_pk_fma_f32 v[122:123], v[186:187], v[26:27], v[122:123] op_sel_hi:[1,0,1]
    v_pk_fma_f32 v[124:125], v[188:189], v[26:27], v[124:125] op_sel:[0,1,0]
    v_pk_fma_f32 v[126:127], v[190:191], v[26:27], v[126:127] op_sel:[0,1,0]
    v_cvt_pk_bf16_f32 v42, v120, v121
    v_cvt_pk_bf16_f32 v43, v122, v123
    v_cvt_pk_bf16_f32 v46, v124, v125
    v_cvt_pk_bf16_f32 v47, v126, v127
    s_waitcnt lgkmcnt(6)
    v_pk_fma_f32 v[128:129], v[192:193], v[24:25], v[128:129] op_sel_hi:[1,0,1]
    v_pk_fma_f32 v[130:131], v[194:195], v[24:25], v[130:131] op_sel_hi:[1,0,1]
    v_pk_fma_f32 v[132:133], v[196:197], v[24:25], v[132:133] op_sel:[0,1,0]
    v_pk_fma_f32 v[134:135], v[198:199], v[24:25], v[134:135] op_sel:[0,1,0]
    v_cvt_pk_bf16_f32 v48, v128, v129
    v_cvt_pk_bf16_f32 v49, v130, v131
    v_cvt_pk_bf16_f32 v52, v132, v133
    v_cvt_pk_bf16_f32 v53, v134, v135
    s_waitcnt lgkmcnt(4)
    v_pk_fma_f32 v[136:137], v[200:201], v[26:27], v[136:137] op_sel_hi:[1,0,1]
    v_pk_fma_f32 v[138:139], v[202:203], v[26:27], v[138:139] op_sel_hi:[1,0,1]
    v_pk_fma_f32 v[140:141], v[204:205], v[26:27], v[140:141] op_sel:[0,1,0]
    v_pk_fma_f32 v[142:143], v[206:207], v[26:27], v[142:143] op_sel:[0,1,0]
    v_cvt_pk_bf16_f32 v56, v136, v137
    v_cvt_pk_bf16_f32 v57, v138, v139
    v_cvt_pk_bf16_f32 v60, v140, v141
    v_cvt_pk_bf16_f32 v61, v142, v143
    s_waitcnt lgkmcnt(2)
    v_pk_fma_f32 v[144:145], v[208:209], v[24:25], v[144:145] op_sel_hi:[1,0,1]
    v_pk_fma_f32 v[146:147], v[210:211], v[24:25], v[146:147] op_sel_hi:[1,0,1]
    v_pk_fma_f32 v[148:149], v[212:213], v[24:25], v[148:149] op_sel:[0,1,0]
    v_pk_fma_f32 v[150:151], v[214:215], v[24:25], v[150:151] op_sel:[0,1,0]
    v_cvt_pk_bf16_f32 v50, v144, v145
    v_cvt_pk_bf16_f32 v51, v146, v147
    v_cvt_pk_bf16_f32 v54, v148, v149
    v_cvt_pk_bf16_f32 v55, v150, v151
    s_waitcnt lgkmcnt(0)
    v_pk_fma_f32 v[152:153], v[216:217], v[26:27], v[152:153] op_sel_hi:[1,0,1]
    v_pk_fma_f32 v[154:155], v[218:219], v[26:27], v[154:155] op_sel_hi:[1,0,1]
    v_pk_fma_f32 v[156:157], v[220:221], v[26:27], v[156:157] op_sel:[0,1,0]
    v_pk_fma_f32 v[158:159], v[222:223], v[26:27], v[158:159] op_sel:[0,1,0]
    v_cvt_pk_bf16_f32 v58, v152, v153
    v_cvt_pk_bf16_f32 v59, v154, v155
    v_cvt_pk_bf16_f32 v62, v156, v157
    v_cvt_pk_bf16_f32 v63, v158, v159
    s_barrier
    ds_write_b128 v30, a[192:195] offset:0
    v_accvgpr_read_b32 v96, a64
    v_accvgpr_read_b32 v97, a65
    v_accvgpr_read_b32 v98, a66
    v_accvgpr_read_b32 v99, a67
    v_pk_mul_f32 v[96:97], v[96:97], v[16:17] op_sel_hi:[1,0]
    v_pk_mul_f32 v[98:99], v[98:99], v[16:17] op_sel_hi:[1,0]
    ds_write_b128 v30, a[196:199] offset:1024
    v_accvgpr_read_b32 v100, a68
    v_accvgpr_read_b32 v101, a69
    v_accvgpr_read_b32 v102, a70
    v_accvgpr_read_b32 v103, a71
    v_pk_mul_f32 v[100:101], v[100:101], v[16:17] op_sel:[0,1]
    v_pk_mul_f32 v[102:103], v[102:103], v[16:17] op_sel:[0,1]
    ds_write_b128 v30, a[200:203] offset:2048
    v_accvgpr_read_b32 v104, a72
    v_accvgpr_read_b32 v105, a73
    v_accvgpr_read_b32 v106, a74
    v_accvgpr_read_b32 v107, a75
    v_pk_mul_f32 v[104:105], v[104:105], v[18:19] op_sel_hi:[1,0]
    v_pk_mul_f32 v[106:107], v[106:107], v[18:19] op_sel_hi:[1,0]
    ds_write_b128 v30, a[204:207] offset:3072
    v_accvgpr_read_b32 v108, a76
    v_accvgpr_read_b32 v109, a77
    v_accvgpr_read_b32 v110, a78
    v_accvgpr_read_b32 v111, a79
    v_pk_mul_f32 v[108:109], v[108:109], v[18:19] op_sel:[0,1]
    v_pk_mul_f32 v[110:111], v[110:111], v[18:19] op_sel:[0,1]
    ds_write_b128 v30, a[208:211] offset:4096
    v_accvgpr_read_b32 v112, a80
    v_accvgpr_read_b32 v113, a81
    v_accvgpr_read_b32 v114, a82
    v_accvgpr_read_b32 v115, a83
    v_pk_mul_f32 v[112:113], v[112:113], v[16:17] op_sel_hi:[1,0]
    v_pk_mul_f32 v[114:115], v[114:115], v[16:17] op_sel_hi:[1,0]
    ds_write_b128 v30, a[212:215] offset:5120
    v_accvgpr_read_b32 v116, a84
    v_accvgpr_read_b32 v117, a85
    v_accvgpr_read_b32 v118, a86
    v_accvgpr_read_b32 v119, a87
    v_pk_mul_f32 v[116:117], v[116:117], v[16:17] op_sel:[0,1]
    v_pk_mul_f32 v[118:119], v[118:119], v[16:17] op_sel:[0,1]
    ds_write_b128 v30, a[216:219] offset:6144
    v_accvgpr_read_b32 v120, a88
    v_accvgpr_read_b32 v121, a89
    v_accvgpr_read_b32 v122, a90
    v_accvgpr_read_b32 v123, a91
    v_pk_mul_f32 v[120:121], v[120:121], v[18:19] op_sel_hi:[1,0]
    v_pk_mul_f32 v[122:123], v[122:123], v[18:19] op_sel_hi:[1,0]
    ds_write_b128 v30, a[220:223] offset:7168
    v_accvgpr_read_b32 v124, a92
    v_accvgpr_read_b32 v125, a93
    v_accvgpr_read_b32 v126, a94
    v_accvgpr_read_b32 v127, a95
    v_pk_mul_f32 v[124:125], v[124:125], v[18:19] op_sel:[0,1]
    v_pk_mul_f32 v[126:127], v[126:127], v[18:19] op_sel:[0,1]
    ds_write_b128 v30, a[224:227] offset:8192
    v_accvgpr_read_b32 v128, a96
    v_accvgpr_read_b32 v129, a97
    v_accvgpr_read_b32 v130, a98
    v_accvgpr_read_b32 v131, a99
    v_pk_mul_f32 v[128:129], v[128:129], v[16:17] op_sel_hi:[1,0]
    v_pk_mul_f32 v[130:131], v[130:131], v[16:17] op_sel_hi:[1,0]
    ds_write_b128 v30, a[228:231] offset:9216
    v_accvgpr_read_b32 v132, a100
    v_accvgpr_read_b32 v133, a101
    v_accvgpr_read_b32 v134, a102
    v_accvgpr_read_b32 v135, a103
    v_pk_mul_f32 v[132:133], v[132:133], v[16:17] op_sel:[0,1]
    v_pk_mul_f32 v[134:135], v[134:135], v[16:17] op_sel:[0,1]
    ds_write_b128 v30, a[232:235] offset:10240
    v_accvgpr_read_b32 v136, a104
    v_accvgpr_read_b32 v137, a105
    v_accvgpr_read_b32 v138, a106
    v_accvgpr_read_b32 v139, a107
    v_pk_mul_f32 v[136:137], v[136:137], v[18:19] op_sel_hi:[1,0]
    v_pk_mul_f32 v[138:139], v[138:139], v[18:19] op_sel_hi:[1,0]
    ds_write_b128 v30, a[236:239] offset:11264
    v_accvgpr_read_b32 v140, a108
    v_accvgpr_read_b32 v141, a109
    v_accvgpr_read_b32 v142, a110
    v_accvgpr_read_b32 v143, a111
    v_pk_mul_f32 v[140:141], v[140:141], v[18:19] op_sel:[0,1]
    v_pk_mul_f32 v[142:143], v[142:143], v[18:19] op_sel:[0,1]
    ds_write_b128 v30, a[240:243] offset:12288
    v_accvgpr_read_b32 v144, a112
    v_accvgpr_read_b32 v145, a113
    v_accvgpr_read_b32 v146, a114
    v_accvgpr_read_b32 v147, a115
    v_pk_mul_f32 v[144:145], v[144:145], v[16:17] op_sel_hi:[1,0]
    v_pk_mul_f32 v[146:147], v[146:147], v[16:17] op_sel_hi:[1,0]
    ds_write_b128 v30, a[244:247] offset:13312
    v_accvgpr_read_b32 v148, a116
    v_accvgpr_read_b32 v149, a117
    v_accvgpr_read_b32 v150, a118
    v_accvgpr_read_b32 v151, a119
    v_pk_mul_f32 v[148:149], v[148:149], v[16:17] op_sel:[0,1]
    v_pk_mul_f32 v[150:151], v[150:151], v[16:17] op_sel:[0,1]
    ds_write_b128 v30, a[248:251] offset:14336
    v_accvgpr_read_b32 v152, a120
    v_accvgpr_read_b32 v153, a121
    v_accvgpr_read_b32 v154, a122
    v_accvgpr_read_b32 v155, a123
    v_pk_mul_f32 v[152:153], v[152:153], v[18:19] op_sel_hi:[1,0]
    v_pk_mul_f32 v[154:155], v[154:155], v[18:19] op_sel_hi:[1,0]
    ds_write_b128 v30, a[252:255] offset:15360
    v_accvgpr_read_b32 v156, a124
    v_accvgpr_read_b32 v157, a125
    v_accvgpr_read_b32 v158, a126
    v_accvgpr_read_b32 v159, a127
    v_pk_mul_f32 v[156:157], v[156:157], v[18:19] op_sel:[0,1]
    v_pk_mul_f32 v[158:159], v[158:159], v[18:19] op_sel:[0,1]
    s_waitcnt lgkmcnt(0)
    s_barrier
    ds_read_b128 v[160:163], v31 offset:0
    ds_read_b128 v[164:167], v31 offset:1024
    ds_read_b128 v[168:171], v31 offset:2048
    ds_read_b128 v[172:175], v31 offset:3072
    ds_read_b128 v[176:179], v31 offset:4096
    ds_read_b128 v[180:183], v31 offset:5120
    ds_read_b128 v[184:187], v31 offset:6144
    ds_read_b128 v[188:191], v31 offset:7168
    ds_read_b128 v[192:195], v31 offset:8192
    ds_read_b128 v[196:199], v31 offset:9216
    ds_read_b128 v[200:203], v31 offset:10240
    ds_read_b128 v[204:207], v31 offset:11264
    ds_read_b128 v[208:211], v31 offset:12288
    ds_read_b128 v[212:215], v31 offset:13312
    ds_read_b128 v[216:219], v31 offset:14336
    ds_read_b128 v[220:223], v31 offset:15360
    s_waitcnt lgkmcnt(14)
    v_pk_fma_f32 v[96:97], v[160:161], v[24:25], v[96:97] op_sel_hi:[1,0,1]
    v_pk_fma_f32 v[98:99], v[162:163], v[24:25], v[98:99] op_sel_hi:[1,0,1]
    v_pk_fma_f32 v[100:101], v[164:165], v[24:25], v[100:101] op_sel:[0,1,0]
    v_pk_fma_f32 v[102:103], v[166:167], v[24:25], v[102:103] op_sel:[0,1,0]
    v_cvt_pk_bf16_f32 v64, v96, v97
    v_cvt_pk_bf16_f32 v65, v98, v99
    v_cvt_pk_bf16_f32 v68, v100, v101
    v_cvt_pk_bf16_f32 v69, v102, v103
    s_waitcnt lgkmcnt(12)
    v_pk_fma_f32 v[104:105], v[168:169], v[26:27], v[104:105] op_sel_hi:[1,0,1]
    v_pk_fma_f32 v[106:107], v[170:171], v[26:27], v[106:107] op_sel_hi:[1,0,1]
    v_pk_fma_f32 v[108:109], v[172:173], v[26:27], v[108:109] op_sel:[0,1,0]
    v_pk_fma_f32 v[110:111], v[174:175], v[26:27], v[110:111] op_sel:[0,1,0]
    v_cvt_pk_bf16_f32 v72, v104, v105
    v_cvt_pk_bf16_f32 v73, v106, v107
    v_cvt_pk_bf16_f32 v76, v108, v109
    v_cvt_pk_bf16_f32 v77, v110, v111
    s_waitcnt lgkmcnt(10)
    v_pk_fma_f32 v[112:113], v[176:177], v[24:25], v[112:113] op_sel_hi:[1,0,1]
    v_pk_fma_f32 v[114:115], v[178:179], v[24:25], v[114:115] op_sel_hi:[1,0,1]
    v_pk_fma_f32 v[116:117], v[180:181], v[24:25], v[116:117] op_sel:[0,1,0]
    v_pk_fma_f32 v[118:119], v[182:183], v[24:25], v[118:119] op_sel:[0,1,0]
    v_cvt_pk_bf16_f32 v66, v112, v113
    v_cvt_pk_bf16_f32 v67, v114, v115
    v_cvt_pk_bf16_f32 v70, v116, v117
    v_cvt_pk_bf16_f32 v71, v118, v119
    s_waitcnt lgkmcnt(8)
    v_pk_fma_f32 v[120:121], v[184:185], v[26:27], v[120:121] op_sel_hi:[1,0,1]
    v_pk_fma_f32 v[122:123], v[186:187], v[26:27], v[122:123] op_sel_hi:[1,0,1]
    v_pk_fma_f32 v[124:125], v[188:189], v[26:27], v[124:125] op_sel:[0,1,0]
    v_pk_fma_f32 v[126:127], v[190:191], v[26:27], v[126:127] op_sel:[0,1,0]
    v_cvt_pk_bf16_f32 v74, v120, v121
    v_cvt_pk_bf16_f32 v75, v122, v123
    v_cvt_pk_bf16_f32 v78, v124, v125
    v_cvt_pk_bf16_f32 v79, v126, v127
    s_waitcnt lgkmcnt(6)
    v_pk_fma_f32 v[128:129], v[192:193], v[24:25], v[128:129] op_sel_hi:[1,0,1]
    v_pk_fma_f32 v[130:131], v[194:195], v[24:25], v[130:131] op_sel_hi:[1,0,1]
    v_pk_fma_f32 v[132:133], v[196:197], v[24:25], v[132:133] op_sel:[0,1,0]
    v_pk_fma_f32 v[134:135], v[198:199], v[24:25], v[134:135] op_sel:[0,1,0]
    v_cvt_pk_bf16_f32 v80, v128, v129
    v_cvt_pk_bf16_f32 v81, v130, v131
    v_cvt_pk_bf16_f32 v84, v132, v133
    v_cvt_pk_bf16_f32 v85, v134, v135
    s_waitcnt lgkmcnt(4)
    v_pk_fma_f32 v[136:137], v[200:201], v[26:27], v[136:137] op_sel_hi:[1,0,1]
    v_pk_fma_f32 v[138:139], v[202:203], v[26:27], v[138:139] op_sel_hi:[1,0,1]
    v_pk_fma_f32 v[140:141], v[204:205], v[26:27], v[140:141] op_sel:[0,1,0]
    v_pk_fma_f32 v[142:143], v[206:207], v[26:27], v[142:143] op_sel:[0,1,0]
    v_cvt_pk_bf16_f32 v88, v136, v137
    v_cvt_pk_bf16_f32 v89, v138, v139
    v_cvt_pk_bf16_f32 v92, v140, v141
    v_cvt_pk_bf16_f32 v93, v142, v143
    s_waitcnt lgkmcnt(2)
    v_pk_fma_f32 v[144:145], v[208:209], v[24:25], v[144:145] op_sel_hi:[1,0,1]
    v_pk_fma_f32 v[146:147], v[210:211], v[24:25], v[146:147] op_sel_hi:[1,0,1]
    v_pk_fma_f32 v[148:149], v[212:213], v[24:25], v[148:149] op_sel:[0,1,0]
    v_pk_fma_f32 v[150:151], v[214:215], v[24:25], v[150:151] op_sel:[0,1,0]
    v_cvt_pk_bf16_f32 v82, v144, v145
    v_cvt_pk_bf16_f32 v83, v146, v147
    v_cvt_pk_bf16_f32 v86, v148, v149
    v_cvt_pk_bf16_f32 v87, v150, v151
    s_waitcnt lgkmcnt(0)
    v_pk_fma_f32 v[152:153], v[216:217], v[26:27], v[152:153] op_sel_hi:[1,0,1]
    v_pk_fma_f32 v[154:155], v[218:219], v[26:27], v[154:155] op_sel_hi:[1,0,1]
    v_pk_fma_f32 v[156:157], v[220:221], v[26:27], v[156:157] op_sel:[0,1,0]
    v_pk_fma_f32 v[158:159], v[222:223], v[26:27], v[158:159] op_sel:[0,1,0]
    v_cvt_pk_bf16_f32 v90, v152, v153
    v_cvt_pk_bf16_f32 v91, v154, v155
    v_cvt_pk_bf16_f32 v94, v156, v157
    v_cvt_pk_bf16_f32 v95, v158, v159
    s_barrier
    s_branch L_mvd
L_mv1:
    ds_write_b128 v30, a[0:3] offset:0
    v_accvgpr_read_b32 v96, a128
    v_accvgpr_read_b32 v97, a129
    v_accvgpr_read_b32 v98, a130
    v_accvgpr_read_b32 v99, a131
    v_pk_mul_f32 v[96:97], v[96:97], v[16:17] op_sel_hi:[1,0]
    v_pk_mul_f32 v[98:99], v[98:99], v[16:17] op_sel_hi:[1,0]
    ds_write_b128 v30, a[4:7] offset:1024
    v_accvgpr_read_b32 v100, a132
    v_accvgpr_read_b32 v101, a133
    v_accvgpr_read_b32 v102, a134
    v_accvgpr_read_b32 v103, a135
    v_pk_mul_f32 v[100:101], v[100:101], v[16:17] op_sel:[0,1]
    v_pk_mul_f32 v[102:103], v[102:103], v[16:17] op_sel:[0,1]
    ds_write_b128 v30, a[8:11] offset:2048
    v_accvgpr_read_b32 v104, a136
    v_accvgpr_read_b32 v105, a137
    v_accvgpr_read_b32 v106, a138
    v_accvgpr_read_b32 v107, a139
    v_pk_mul_f32 v[104:105], v[104:105], v[18:19] op_sel_hi:[1,0]
    v_pk_mul_f32 v[106:107], v[106:107], v[18:19] op_sel_hi:[1,0]
    ds_write_b128 v30, a[12:15] offset:3072
    v_accvgpr_read_b32 v108, a140
    v_accvgpr_read_b32 v109, a141
    v_accvgpr_read_b32 v110, a142
    v_accvgpr_read_b32 v111, a143
    v_pk_mul_f32 v[108:109], v[108:109], v[18:19] op_sel:[0,1]
    v_pk_mul_f32 v[110:111], v[110:111], v[18:19] op_sel:[0,1]
    ds_write_b128 v30, a[16:19] offset:4096
    v_accvgpr_read_b32 v112, a144
    v_accvgpr_read_b32 v113, a145
    v_accvgpr_read_b32 v114, a146
    v_accvgpr_read_b32 v115, a147
    v_pk_mul_f32 v[112:113], v[112:113], v[16:17] op_sel_hi:[1,0]
    v_pk_mul_f32 v[114:115], v[114:115], v[16:17] op_sel_hi:[1,0]
    ds_write_b128 v30, a[20:23] offset:5120
    v_accvgpr_read_b32 v116, a148
    v_accvgpr_read_b32 v117, a149
    v_accvgpr_read_b32 v118, a150
    v_accvgpr_read_b32 v119, a151
    v_pk_mul_f32 v[116:117], v[116:117], v[16:17] op_sel:[0,1]
    v_pk_mul_f32 v[118:119], v[118:119], v[16:17] op_sel:[0,1]
    ds_write_b128 v30, a[24:27] offset:6144
    v_accvgpr_read_b32 v120, a152
    v_accvgpr_read_b32 v121, a153
    v_accvgpr_read_b32 v122, a154
    v_accvgpr_read_b32 v123, a155
    v_pk_mul_f32 v[120:121], v[120:121], v[18:19] op_sel_hi:[1,0]
    v_pk_mul_f32 v[122:123], v[122:123], v[18:19] op_sel_hi:[1,0]
    ds_write_b128 v30, a[28:31] offset:7168
    v_accvgpr_read_b32 v124, a156
    v_accvgpr_read_b32 v125, a157
    v_accvgpr_read_b32 v126, a158
    v_accvgpr_read_b32 v127, a159
    v_pk_mul_f32 v[124:125], v[124:125], v[18:19] op_sel:[0,1]
    v_pk_mul_f32 v[126:127], v[126:127], v[18:19] op_sel:[0,1]
    ds_write_b128 v30, a[32:35] offset:8192
    v_accvgpr_read_b32 v128, a160
    v_accvgpr_read_b32 v129, a161
    v_accvgpr_read_b32 v130, a162
    v_accvgpr_read_b32 v131, a163
    v_pk_mul_f32 v[128:129], v[128:129], v[16:17] op_sel_hi:[1,0]
    v_pk_mul_f32 v[130:131], v[130:131], v[16:17] op_sel_hi:[1,0]
    ds_write_b128 v30, a[36:39] offset:9216
    v_accvgpr_read_b32 v132, a164
    v_accvgpr_read_b32 v133, a165
    v_accvgpr_read_b32 v134, a166
    v_accvgpr_read_b32 v135, a167
    v_pk_mul_f32 v[132:133], v[132:133], v[16:17] op_sel:[0,1]
    v_pk_mul_f32 v[134:135], v[134:135], v[16:17] op_sel:[0,1]
    ds_write_b128 v30, a[40:43] offset:10240
    v_accvgpr_read_b32 v136, a168
    v_accvgpr_read_b32 v137, a169
    v_accvgpr_read_b32 v138, a170
    v_accvgpr_read_b32 v139, a171
    v_pk_mul_f32 v[136:137], v[136:137], v[18:19] op_sel_hi:[1,0]
    v_pk_mul_f32 v[138:139], v[138:139], v[18:19] op_sel_hi:[1,0]
    ds_write_b128 v30, a[44:47] offset:11264
    v_accvgpr_read_b32 v140, a172
    v_accvgpr_read_b32 v141, a173
    v_accvgpr_read_b32 v142, a174
    v_accvgpr_read_b32 v143, a175
    v_pk_mul_f32 v[140:141], v[140:141], v[18:19] op_sel:[0,1]
    v_pk_mul_f32 v[142:143], v[142:143], v[18:19] op_sel:[0,1]
    ds_write_b128 v30, a[48:51] offset:12288
    v_accvgpr_read_b32 v144, a176
    v_accvgpr_read_b32 v145, a177
    v_accvgpr_read_b32 v146, a178
    v_accvgpr_read_b32 v147, a179
    v_pk_mul_f32 v[144:145], v[144:145], v[16:17] op_sel_hi:[1,0]
    v_pk_mul_f32 v[146:147], v[146:147], v[16:17] op_sel_hi:[1,0]
    ds_write_b128 v30, a[52:55] offset:13312
    v_accvgpr_read_b32 v148, a180
    v_accvgpr_read_b32 v149, a181
    v_accvgpr_read_b32 v150, a182
    v_accvgpr_read_b32 v151, a183
    v_pk_mul_f32 v[148:149], v[148:149], v[16:17] op_sel:[0,1]
    v_pk_mul_f32 v[150:151], v[150:151], v[16:17] op_sel:[0,1]
    ds_write_b128 v30, a[56:59] offset:14336
    v_accvgpr_read_b32 v152, a184
    v_accvgpr_read_b32 v153, a185
    v_accvgpr_read_b32 v154, a186
    v_accvgpr_read_b32 v155, a187
    v_pk_mul_f32 v[152:153], v[152:153], v[18:19] op_sel_hi:[1,0]
    v_pk_mul_f32 v[154:155], v[154:155], v[18:19] op_sel_hi:[1,0]
    ds_write_b128 v30, a[60:63] offset:15360
    v_accvgpr_read_b32 v156, a188
    v_accvgpr_read_b32 v157, a189
    v_accvgpr_read_b32 v158, a190
    v_accvgpr_read_b32 v159, a191
    v_pk_mul_f32 v[156:157], v[156:157], v[18:19] op_sel:[0,1]
    v_pk_mul_f32 v[158:159], v[158:159], v[18:19] op_sel:[0,1]
    s_waitcnt lgkmcnt(0)
    s_barrier
    ds_read_b128 v[160:163], v31 offset:0
    ds_read_b128 v[164:167], v31 offset:1024
    ds_read_b128 v[168:171], v31 offset:2048
    ds_read_b128 v[172:175], v31 offset:3072
    ds_read_b128 v[176:179], v31 offset:4096
    ds_read_b128 v[180:183], v31 offset:5120
    ds_read_b128 v[184:187], v31 offset:6144
    ds_read_b128 v[188:191], v31 offset:7168
    ds_read_b128 v[192:195], v31 offset:8192
    ds_read_b128 v[196:199], v31 offset:9216
    ds_read_b128 v[200:203], v31 offset:10240
    ds_read_b128 v[204:207], v31 offset:11264
    ds_read_b128 v[208:211], v31 offset:12288
    ds_read_b128 v[212:215], v31 offset:13312
    ds_read_b128 v[216:219], v31 offset:14336
    ds_read_b128 v[220:223], v31 offset:15360
    s_waitcnt lgkmcnt(14)
    v_pk_fma_f32 v[96:97], v[160:161], v[24:25], v[96:97] op_sel_hi:[1,0,1]
    v_pk_fma_f32 v[98:99], v[162:163], v[24:25], v[98:99] op_sel_hi:[1,0,1]
    v_pk_fma_f32 v[100:101], v[164:165], v[24:25], v[100:101] op_sel:[0,1,0]
    v_pk_fma_f32 v[102:103], v[166:167], v[24:25], v[102:103] op_sel:[0,1,0]
    v_cvt_pk_bf16_f32 v32, v96, v97
    v_cvt_pk_bf16_f32 v33, v98, v99
    v_cvt_pk_bf16_f32 v36, v100, v101
    v_cvt_pk_bf16_f32 v37, v102, v103
    s_waitcnt lgkmcnt(12)
    v_pk_fma_f32 v[104:105], v[168:169], v[26:27], v[104:105] op_sel_hi:[1,0,1]
    v_pk_fma_f32 v[106:107], v[170:171], v[26:27], v[106:107] op_sel_hi:[1,0,1]
    v_pk_fma_f32 v[108:109], v[172:173], v[26:27], v[108:109] op_sel:[0,1,0]
    v_pk_fma_f32 v[110:111], v[174:175], v[26:27], v[110:111] op_sel:[0,1,0]
    v_cvt_pk_bf16_f32 v40, v104, v105
    v_cvt_pk_bf16_f32 v41, v106, v107
    v_cvt_pk_bf16_f32 v44, v108, v109
    v_cvt_pk_bf16_f32 v45, v110, v111
    s_waitcnt lgkmcnt(10)
    v_pk_fma_f32 v[112:113], v[176:177], v[24:25], v[112:113] op_sel_hi:[1,0,1]
    v_pk_fma_f32 v[114:115], v[178:179], v[24:25], v[114:115] op_sel_hi:[1,0,1]
    v_pk_fma_f32 v[116:117], v[180:181], v[24:25], v[116:117] op_sel:[0,1,0]
    v_pk_fma_f32 v[118:119], v[182:183], v[24:25], v[118:119] op_sel:[0,1,0]
    v_cvt_pk_bf16_f32 v34, v112, v113
    v_cvt_pk_bf16_f32 v35, v114, v115
    v_cvt_pk_bf16_f32 v38, v116, v117
    v_cvt_pk_bf16_f32 v39, v118, v119
    s_waitcnt lgkmcnt(8)
    v_pk_fma_f32 v[120:121], v[184:185], v[26:27], v[120:121] op_sel_hi:[1,0,1]
    v_pk_fma_f32 v[122:123], v[186:187], v[26:27], v[122:123] op_sel_hi:[1,0,1]
    v_pk_fma_f32 v[124:125], v[188:189], v[26:27], v[124:125] op_sel:[0,1,0]
    v_pk_fma_f32 v[126:127], v[190:191], v[26:27], v[126:127] op_sel:[0,1,0]
    v_cvt_pk_bf16_f32 v42, v120, v121
    v_cvt_pk_bf16_f32 v43, v122, v123
    v_cvt_pk_bf16_f32 v46, v124, v125
    v_cvt_pk_bf16_f32 v47, v126, v127
    s_waitcnt lgkmcnt(6)
    v_pk_fma_f32 v[128:129], v[192:193], v[24:25], v[128:129] op_sel_hi:[1,0,1]
    v_pk_fma_f32 v[130:131], v[194:195], v[24:25], v[130:131] op_sel_hi:[1,0,1]
    v_pk_fma_f32 v[132:133], v[196:197], v[24:25], v[132:133] op_sel:[0,1,0]
    v_pk_fma_f32 v[134:135], v[198:199], v[24:25], v[134:135] op_sel:[0,1,0]
    v_cvt_pk_bf16_f32 v48, v128, v129
    v_cvt_pk_bf16_f32 v49, v130, v131
    v_cvt_pk_bf16_f32 v52, v132, v133
    v_cvt_pk_bf16_f32 v53, v134, v135
    s_waitcnt lgkmcnt(4)
    v_pk_fma_f32 v[136:137], v[200:201], v[26:27], v[136:137] op_sel_hi:[1,0,1]
    v_pk_fma_f32 v[138:139], v[202:203], v[26:27], v[138:139] op_sel_hi:[1,0,1]
    v_pk_fma_f32 v[140:141], v[204:205], v[26:27], v[140:141] op_sel:[0,1,0]
    v_pk_fma_f32 v[142:143], v[206:207], v[26:27], v[142:143] op_sel:[0,1,0]
    v_cvt_pk_bf16_f32 v56, v136, v137
    v_cvt_pk_bf16_f32 v57, v138, v139
    v_cvt_pk_bf16_f32 v60, v140, v141
    v_cvt_pk_bf16_f32 v61, v142, v143
    s_waitcnt lgkmcnt(2)
    v_pk_fma_f32 v[144:145], v[208:209], v[24:25], v[144:145] op_sel_hi:[1,0,1]
    v_pk_fma_f32 v[146:147], v[210:211], v[24:25], v[146:147] op_sel_hi:[1,0,1]
    v_pk_fma_f32 v[148:149], v[212:213], v[24:25], v[148:149] op_sel:[0,1,0]
    v_pk_fma_f32 v[150:151], v[214:215], v[24:25], v[150:151] op_sel:[0,1,0]
    v_cvt_pk_bf16_f32 v50, v144, v145
    v_cvt_pk_bf16_f32 v51, v146, v147
    v_cvt_pk_bf16_f32 v54, v148, v149
    v_cvt_pk_bf16_f32 v55, v150, v151
    s_waitcnt lgkmcnt(0)
    v_pk_fma_f32 v[152:153], v[216:217], v[26:27], v[152:153] op_sel_hi:[1,0,1]
    v_pk_fma_f32 v[154:155], v[218:219], v[26:27], v[154:155] op_sel_hi:[1,0,1]
    v_pk_fma_f32 v[156:157], v[220:221], v[26:27], v[156:157] op_sel:[0,1,0]
    v_pk_fma_f32 v[158:159], v[222:223], v[26:27], v[158:159] op_sel:[0,1,0]
    v_cvt_pk_bf16_f32 v58, v152, v153
    v_cvt_pk_bf16_f32 v59, v154, v155
    v_cvt_pk_bf16_f32 v62, v156, v157
    v_cvt_pk_bf16_f32 v63, v158, v159
    s_barrier
    ds_write_b128 v30, a[64:67] offset:0
    v_accvgpr_read_b32 v96, a192
    v_accvgpr_read_b32 v97, a193
    v_accvgpr_read_b32 v98, a194
    v_accvgpr_read_b32 v99, a195
    v_pk_mul_f32 v[96:97], v[96:97], v[16:17] op_sel_hi:[1,0]
    v_pk_mul_f32 v[98:99], v[98:99], v[16:17] op_sel_hi:[1,0]
    ds_write_b128 v30, a[68:71] offset:1024
    v_accvgpr_read_b32 v100, a196
    v_accvgpr_read_b32 v101, a197
    v_accvgpr_read_b32 v102, a198
    v_accvgpr_read_b32 v103, a199
    v_pk_mul_f32 v[100:101], v[100:101], v[16:17] op_sel:[0,1]
    v_pk_mul_f32 v[102:103], v[102:103], v[16:17] op_sel:[0,1]
    ds_write_b128 v30, a[72:75] offset:2048
    v_accvgpr_read_b32 v104, a200
    v_accvgpr_read_b32 v105, a201
    v_accvgpr_read_b32 v106, a202
    v_accvgpr_read_b32 v107, a203
    v_pk_mul_f32 v[104:105], v[104:105], v[18:19] op_sel_hi:[1,0]
    v_pk_mul_f32 v[106:107], v[106:107], v[18:19] op_sel_hi:[1,0]
    ds_write_b128 v30, a[76:79] offset:3072
    v_accvgpr_read_b32 v108, a204
    v_accvgpr_read_b32 v109, a205
    v_accvgpr_read_b32 v110, a206
    v_accvgpr_read_b32 v111, a207
    v_pk_mul_f32 v[108:109], v[108:109], v[18:19] op_sel:[0,1]
    v_pk_mul_f32 v[110:111], v[110:111], v[18:19] op_sel:[0,1]
    ds_write_b128 v30, a[80:83] offset:4096
    v_accvgpr_read_b32 v112, a208
    v_accvgpr_read_b32 v113, a209
    v_accvgpr_read_b32 v114, a210
    v_accvgpr_read_b32 v115, a211
    v_pk_mul_f32 v[112:113], v[112:113], v[16:17] op_sel_hi:[1,0]
    v_pk_mul_f32 v[114:115], v[114:115], v[16:17] op_sel_hi:[1,0]
    ds_write_b128 v30, a[84:87] offset:5120
    v_accvgpr_read_b32 v116, a212
    v_accvgpr_read_b32 v117, a213
    v_accvgpr_read_b32 v118, a214
    v_accvgpr_read_b32 v119, a215
    v_pk_mul_f32 v[116:117], v[116:117], v[16:17] op_sel:[0,1]
    v_pk_mul_f32 v[118:119], v[118:119], v[16:17] op_sel:[0,1]
    ds_write_b128 v30, a[88:91] offset:6144
    v_accvgpr_read_b32 v120, a216
    v_accvgpr_read_b32 v121, a217
    v_accvgpr_read_b32 v122, a218
    v_accvgpr_read_b32 v123, a219
    v_pk_mul_f32 v[120:121], v[120:121], v[18:19] op_sel_hi:[1,0]
    v_pk_mul_f32 v[122:123], v[122:123], v[18:19] op_sel_hi:[1,0]
    ds_write_b128 v30, a[92:95] offset:7168
    v_accvgpr_read_b32 v124, a220
    v_accvgpr_read_b32 v125, a221
    v_accvgpr_read_b32 v126, a222
    v_accvgpr_read_b32 v127, a223
    v_pk_mul_f32 v[124:125], v[124:125], v[18:19] op_sel:[0,1]
    v_pk_mul_f32 v[126:127], v[126:127], v[18:19] op_sel:[0,1]
    ds_write_b128 v30, a[96:99] offset:8192
    v_accvgpr_read_b32 v128, a224
    v_accvgpr_read_b32 v129, a225
    v_accvgpr_read_b32 v130, a226
    v_accvgpr_read_b32 v131, a227
    v_pk_mul_f32 v[128:129], v[128:129], v[16:17] op_sel_hi:[1,0]
    v_pk_mul_f32 v[130:131], v[130:131], v[16:17] op_sel_hi:[1,0]
    ds_write_b128 v30, a[100:103] offset:9216
    v_accvgpr_read_b32 v132, a228
    v_accvgpr_read_b32 v133, a229
    v_accvgpr_read_b32 v134, a230
    v_accvgpr_read_b32 v135, a231
    v_pk_mul_f32 v[132:133], v[132:133], v[16:17] op_sel:[0,1]
    v_pk_mul_f32 v[134:135], v[134:135], v[16:17] op_sel:[0,1]
    ds_write_b128 v30, a[104:107] offset:10240
    v_accvgpr_read_b32 v136, a232
    v_accvgpr_read_b32 v137, a233
    v_accvgpr_read_b32 v138, a234
    v_accvgpr_read_b32 v139, a235
    v_pk_mul_f32 v[136:137], v[136:137], v[18:19] op_sel_hi:[1,0]
    v_pk_mul_f32 v[138:139], v[138:139], v[18:19] op_sel_hi:[1,0]
    ds_write_b128 v30, a[108:111] offset:11264
    v_accvgpr_read_b32 v140, a236
    v_accvgpr_read_b32 v141, a237
    v_accvgpr_read_b32 v142, a238
    v_accvgpr_read_b32 v143, a239
    v_pk_mul_f32 v[140:141], v[140:141], v[18:19] op_sel:[0,1]
    v_pk_mul_f32 v[142:143], v[142:143], v[18:19] op_sel:[0,1]
    ds_write_b128 v30, a[112:115] offset:12288
    v_accvgpr_read_b32 v144, a240
    v_accvgpr_read_b32 v145, a241
    v_accvgpr_read_b32 v146, a242
    v_accvgpr_read_b32 v147, a243
    v_pk_mul_f32 v[144:145], v[144:145], v[16:17] op_sel_hi:[1,0]
    v_pk_mul_f32 v[146:147], v[146:147], v[16:17] op_sel_hi:[1,0]
    ds_write_b128 v30, a[116:119] offset:13312
    v_accvgpr_read_b32 v148, a244
    v_accvgpr_read_b32 v149, a245
    v_accvgpr_read_b32 v150, a246
    v_accvgpr_read_b32 v151, a247
    v_pk_mul_f32 v[148:149], v[148:149], v[16:17] op_sel:[0,1]
    v_pk_mul_f32 v[150:151], v[150:151], v[16:17] op_sel:[0,1]
    ds_write_b128 v30, a[120:123] offset:14336
    v_accvgpr_read_b32 v152, a248
    v_accvgpr_read_b32 v153, a249
    v_accvgpr_read_b32 v154, a250
    v_accvgpr_read_b32 v155, a251
    v_pk_mul_f32 v[152:153], v[152:153], v[18:19] op_sel_hi:[1,0]
    v_pk_mul_f32 v[154:155], v[154:155], v[18:19] op_sel_hi:[1,0]
    ds_write_b128 v30, a[124:127] offset:15360
    v_accvgpr_read_b32 v156, a252
    v_accvgpr_read_b32 v157, a253
    v_accvgpr_read_b32 v158, a254
    v_accvgpr_read_b32 v159, a255
    v_pk_mul_f32 v[156:157], v[156:157], v[18:19] op_sel:[0,1]
    v_pk_mul_f32 v[158:159], v[158:159], v[18:19] op_sel:[0,1]
    s_waitcnt lgkmcnt(0)
    s_barrier
    ds_read_b128 v[160:163], v31 offset:0
    ds_read_b128 v[164:167], v31 offset:1024
    ds_read_b128 v[168:171], v31 offset:2048
    ds_read_b128 v[172:175], v31 offset:3072
    ds_read_b128 v[176:179], v31 offset:4096
    ds_read_b128 v[180:183], v31 offset:5120
    ds_read_b128 v[184:187], v31 offset:6144
    ds_read_b128 v[188:191], v31 offset:7168
    ds_read_b128 v[192:195], v31 offset:8192
    ds_read_b128 v[196:199], v31 offset:9216
    ds_read_b128 v[200:203], v31 offset:10240
    ds_read_b128 v[204:207], v31 offset:11264
    ds_read_b128 v[208:211], v31 offset:12288
    ds_read_b128 v[212:215], v31 offset:13312
    ds_read_b128 v[216:219], v31 offset:14336
    ds_read_b128 v[220:223], v31 offset:15360
    s_waitcnt lgkmcnt(14)
    v_pk_fma_f32 v[96:97], v[160:161], v[24:25], v[96:97] op_sel_hi:[1,0,1]
    v_pk_fma_f32 v[98:99], v[162:163], v[24:25], v[98:99] op_sel_hi:[1,0,1]
    v_pk_fma_f32 v[100:101], v[164:165], v[24:25], v[100:101] op_sel:[0,1,0]
    v_pk_fma_f32 v[102:103], v[166:167], v[24:25], v[102:103] op_sel:[0,1,0]
    v_cvt_pk_bf16_f32 v64, v96, v97
    v_cvt_pk_bf16_f32 v65, v98, v99
    v_cvt_pk_bf16_f32 v68, v100, v101
    v_cvt_pk_bf16_f32 v69, v102, v103
    s_waitcnt lgkmcnt(12)
    v_pk_fma_f32 v[104:105], v[168:169], v[26:27], v[104:105] op_sel_hi:[1,0,1]
    v_pk_fma_f32 v[106:107], v[170:171], v[26:27], v[106:107] op_sel_hi:[1,0,1]
    v_pk_fma_f32 v[108:109], v[172:173], v[26:27], v[108:109] op_sel:[0,1,0]
    v_pk_fma_f32 v[110:111], v[174:175], v[26:27], v[110:111] op_sel:[0,1,0]
    v_cvt_pk_bf16_f32 v72, v104, v105
    v_cvt_pk_bf16_f32 v73, v106, v107
    v_cvt_pk_bf16_f32 v76, v108, v109
    v_cvt_pk_bf16_f32 v77, v110, v111
    s_waitcnt lgkmcnt(10)
    v_pk_fma_f32 v[112:113], v[176:177], v[24:25], v[112:113] op_sel_hi:[1,0,1]
    v_pk_fma_f32 v[114:115], v[178:179], v[24:25], v[114:115] op_sel_hi:[1,0,1]
    v_pk_fma_f32 v[116:117], v[180:181], v[24:25], v[116:117] op_sel:[0,1,0]
    v_pk_fma_f32 v[118:119], v[182:183], v[24:25], v[118:119] op_sel:[0,1,0]
    v_cvt_pk_bf16_f32 v66, v112, v113
    v_cvt_pk_bf16_f32 v67, v114, v115
    v_cvt_pk_bf16_f32 v70, v116, v117
    v_cvt_pk_bf16_f32 v71, v118, v119
    s_waitcnt lgkmcnt(8)
    v_pk_fma_f32 v[120:121], v[184:185], v[26:27], v[120:121] op_sel_hi:[1,0,1]
    v_pk_fma_f32 v[122:123], v[186:187], v[26:27], v[122:123] op_sel_hi:[1,0,1]
    v_pk_fma_f32 v[124:125], v[188:189], v[26:27], v[124:125] op_sel:[0,1,0]
    v_pk_fma_f32 v[126:127], v[190:191], v[26:27], v[126:127] op_sel:[0,1,0]
    v_cvt_pk_bf16_f32 v74, v120, v121
    v_cvt_pk_bf16_f32 v75, v122, v123
    v_cvt_pk_bf16_f32 v78, v124, v125
    v_cvt_pk_bf16_f32 v79, v126, v127
    s_waitcnt lgkmcnt(6)
    v_pk_fma_f32 v[128:129], v[192:193], v[24:25], v[128:129] op_sel_hi:[1,0,1]
    v_pk_fma_f32 v[130:131], v[194:195], v[24:25], v[130:131] op_sel_hi:[1,0,1]
    v_pk_fma_f32 v[132:133], v[196:197], v[24:25], v[132:133] op_sel:[0,1,0]
    v_pk_fma_f32 v[134:135], v[198:199], v[24:25], v[134:135] op_sel:[0,1,0]
    v_cvt_pk_bf16_f32 v80, v128, v129
    v_cvt_pk_bf16_f32 v81, v130, v131
    v_cvt_pk_bf16_f32 v84, v132, v133
    v_cvt_pk_bf16_f32 v85, v134, v135
    s_waitcnt lgkmcnt(4)
    v_pk_fma_f32 v[136:137], v[200:201], v[26:27], v[136:137] op_sel_hi:[1,0,1]
    v_pk_fma_f32 v[138:139], v[202:203], v[26:27], v[138:139] op_sel_hi:[1,0,1]
    v_pk_fma_f32 v[140:141], v[204:205], v[26:27], v[140:141] op_sel:[0,1,0]
    v_pk_fma_f32 v[142:143], v[206:207], v[26:27], v[142:143] op_sel:[0,1,0]
    v_cvt_pk_bf16_f32 v88, v136, v137
    v_cvt_pk_bf16_f32 v89, v138, v139
    v_cvt_pk_bf16_f32 v92, v140, v141
    v_cvt_pk_bf16_f32 v93, v142, v143
    s_waitcnt lgkmcnt(2)
    v_pk_fma_f32 v[144:145], v[208:209], v[24:25], v[144:145] op_sel_hi:[1,0,1]
    v_pk_fma_f32 v[146:147], v[210:211], v[24:25], v[146:147] op_sel_hi:[1,0,1]
    v_pk_fma_f32 v[148:149], v[212:213], v[24:25], v[148:149] op_sel:[0,1,0]
    v_pk_fma_f32 v[150:151], v[214:215], v[24:25], v[150:151] op_sel:[0,1,0]
    v_cvt_pk_bf16_f32 v82, v144, v145
    v_cvt_pk_bf16_f32 v83, v146, v147
    v_cvt_pk_bf16_f32 v86, v148, v149
    v_cvt_pk_bf16_f32 v87, v150, v151
    s_waitcnt lgkmcnt(0)
    v_pk_fma_f32 v[152:153], v[216:217], v[26:27], v[152:153] op_sel_hi:[1,0,1]
    v_pk_fma_f32 v[154:155], v[218:219], v[26:27], v[154:155] op_sel_hi:[1,0,1]
    v_pk_fma_f32 v[156:157], v[220:221], v[26:27], v[156:157] op_sel:[0,1,0]
    v_pk_fma_f32 v[158:159], v[222:223], v[26:27], v[158:159] op_sel:[0,1,0]
    v_cvt_pk_bf16_f32 v90, v152, v153
    v_cvt_pk_bf16_f32 v91, v154, v155
    v_cvt_pk_bf16_f32 v94, v156, v157
    v_cvt_pk_bf16_f32 v95, v158, v159
    s_barrier
L_mvd:
    ds_write_b128 v30, v[32:35] offset:0
    ds_write_b128 v30, v[36:39] offset:1024
    ds_write_b128 v30, v[40:43] offset:2048
    ds_write_b128 v30, v[44:47] offset:3072
    ds_write_b128 v30, v[48:51] offset:4096
    ds_write_b128 v30, v[52:55] offset:5120
    ds_write_b128 v30, v[56:59] offset:6144
    ds_write_b128 v30, v[60:63] offset:7168
    ds_write_b128 v30, v[64:67] offset:8192
    ds_write_b128 v30, v[68:71] offset:9216
    ds_write_b128 v30, v[72:75] offset:10240
    ds_write_b128 v30, v[76:79] offset:11264
    ds_write_b128 v30, v[80:83] offset:12288
    ds_write_b128 v30, v[84:87] offset:13312
    ds_write_b128 v30, v[88:91] offset:14336
    ds_write_b128 v30, v[92:95] offset:15360
    v_add_u32 v228, 67584, v228
    v_bfe_u32 v244, v251, 2, 2
    v_lshrrev_b32 v245, 4, v251
    v_lshl_add_u32 v244, v245, 2, v244
    v_mul_u32_u24 v244, 1056, v244
    v_and_b32 v245, 3, v251
    v_lshl_add_u32 v252, v245, 3, v244
    s_mul_i32 s55, s53, 16896
    s_mul_i32 s56, s54, 224
    s_add_u32 s55, s55, s56
    v_add_u32 v252, s55, v252
    v_add_u32 v253, 67584, v252
    s_waitcnt lgkmcnt(0)
    s_barrier
    ds_read_b128 a[0:3], v228 offset:0
    ds_read_b128 a[4:7], v228 offset:1024
    ds_read_b128 a[8:11], v228 offset:2048
    ds_read_b128 a[12:15], v228 offset:3072
    ds_read_b128 a[16:19], v228 offset:4096
    ds_read_b128 a[20:23], v228 offset:5120
    ds_read_b128 a[24:27], v228 offset:6144
    ds_read_b128 a[28:31], v228 offset:7168
    ds_read_b128 a[32:35], v228 offset:8192
    ds_read_b128 a[36:39], v228 offset:9216
    ds_read_b128 a[40:43], v228 offset:10240
    ds_read_b128 a[44:47], v228 offset:11264
    s_waitcnt lgkmcnt(4)
    ds_read_b128 a[48:51], v228 offset:12288
    ds_read_b128 a[52:55], v228 offset:13312
    ds_read_b128 a[56:59], v228 offset:14336
    ds_read_b128 a[60:63], v228 offset:15360
    ds_read_b128 a[64:67], v228 offset:16384
    ds_read_b128 a[68:71], v228 offset:17408
    ds_read_b128 a[72:75], v228 offset:18432
    ds_read_b128 a[76:79], v228 offset:19456
    ds_read_b128 a[80:83], v228 offset:20480
    ds_read_b128 a[84:87], v228 offset:21504
    ds_read_b128 a[88:91], v228 offset:22528
    ds_read_b128 a[92:95], v228 offset:23552
    s_waitcnt lgkmcnt(4)
    ds_read_b128 a[96:99], v228 offset:24576
    ds_read_b128 a[100:103], v228 offset:25600
    ds_read_b128 a[104:107], v228 offset:26624
    ds_read_b128 a[108:111], v228 offset:27648
    ds_read_b128 a[112:115], v228 offset:28672
    ds_read_b128 a[116:119], v228 offset:29696
    ds_read_b128 a[120:123], v228 offset:30720
    ds_read_b128 a[124:127], v228 offset:31744
    ds_read_b128 a[128:131], v228 offset:32768
    ds_read_b128 a[132:135], v228 offset:33792
    ds_read_b128 a[136:139], v228 offset:34816
    ds_read_b128 a[140:143], v228 offset:35840
    s_waitcnt lgkmcnt(4)
    ds_read_b128 a[144:147], v228 offset:36864
    ds_read_b128 a[148:151], v228 offset:37888
    ds_read_b128 a[152:155], v228 offset:38912
    ds_read_b128 a[156:159], v228 offset:39936
    ds_read_b128 a[160:163], v228 offset:40960
    ds_read_b128 a[164:167], v228 offset:41984
    ds_read_b128 a[168:171], v228 offset:43008
    ds_read_b128 a[172:175], v228 offset:44032
    ds_read_b128 a[176:179], v228 offset:45056
    ds_read_b128 a[180:183], v228 offset:46080
    ds_read_b128 a[184:187], v228 offset:47104
    ds_read_b128 a[188:191], v228 offset:48128
    s_waitcnt lgkmcnt(4)
    ds_read_b128 a[192:195], v228 offset:49152
    ds_read_b128 a[196:199], v228 offset:50176
    ds_read_b128 a[200:203], v228 offset:51200
    ds_read_b128 a[204:207], v228 offset:52224
    ds_read_b128 a[208:211], v228 offset:53248
    ds_read_b128 a[212:215], v228 offset:54272
    ds_read_b128 a[216:219], v228 offset:55296
    ds_read_b128 a[220:223], v228 offset:56320
    ds_read_b128 a[224:227], v228 offset:57344
    ds_read_b128 a[228:231], v228 offset:58368
    ds_read_b128 a[232:235], v228 offset:59392
    ds_read_b128 a[236:239], v228 offset:60416
    s_waitcnt lgkmcnt(4)
    ds_read_b128 a[240:243], v228 offset:61440
    ds_read_b128 a[244:247], v228 offset:62464
    ds_read_b128 a[248:251], v228 offset:63488
    ds_read_b128 a[252:255], v228 offset:64512
    s_waitcnt lgkmcnt(0)
    s_waitcnt vmcnt(0)
    s_barrier
    s_add_u32 s50, s63, 57344
    s_add_u32 m0, s66, 0
    s_nop 0
    buffer_load_dwordx4 v225, s[24:27], s50 offen offset:0 lds
    s_add_u32 m0, s66, 160
    s_nop 0
    buffer_load_dwordx4 v225, s[24:27], s50 offen offset:896 lds
    s_add_u32 m0, s66, 320
    s_nop 0
    buffer_load_dwordx4 v225, s[24:27], s50 offen offset:1792 lds
    s_add_u32 m0, s66, 480
    s_nop 0
    buffer_load_dwordx4 v225, s[24:27], s50 offen offset:2688 lds
    s_add_u32 s50, s63, 60928
    s_add_u32 m0, s66, 4224
    s_nop 0
    buffer_load_dwordx4 v225, s[24:27], s50 offen offset:0 lds
    s_add_u32 m0, s66, 4384
    s_nop 0
    buffer_load_dwordx4 v225, s[24:27], s50 offen offset:896 lds
    s_add_u32 m0, s66, 4544
    s_nop 0
    buffer_load_dwordx4 v225, s[24:27], s50 offen offset:1792 lds
    s_add_u32 m0, s66, 4704
    s_nop 0
    buffer_load_dwordx4 v225, s[24:27], s50 offen offset:2688 lds
    s_add_u32 s50, s63, 86016
    s_add_u32 m0, s67, 0
    s_nop 0
    buffer_load_dwordx4 v225, s[24:27], s50 offen offset:0 lds
    s_add_u32 m0, s67, 160
    s_nop 0
    buffer_load_dwordx4 v225, s[24:27], s50 offen offset:896 lds
    s_add_u32 m0, s67, 320
    s_nop 0
    buffer_load_dwordx4 v225, s[24:27], s50 offen offset:1792 lds
    s_add_u32 m0, s67, 480
    s_nop 0
    buffer_load_dwordx4 v225, s[24:27], s50 offen offset:2688 lds
    s_add_u32 s50, s63, 89600
    s_add_u32 m0, s67, 4224
    s_nop 0
    buffer_load_dwordx4 v225, s[24:27], s50 offen offset:0 lds
    s_add_u32 m0, s67, 4384
    s_nop 0
    buffer_load_dwordx4 v225, s[24:27], s50 offen offset:896 lds
    s_add_u32 m0, s67, 4544
    s_nop 0
    buffer_load_dwordx4 v225, s[24:27], s50 offen offset:1792 lds
    s_add_u32 m0, s67, 4704
    s_nop 0
    buffer_load_dwordx4 v225, s[24:27], s50 offen offset:2688 lds
    ds_read_b64_tr_b16 v[212:213], v252 offset:0
    ds_read_b64_tr_b16 v[214:215], v252 offset:512
    ds_read_b64_tr_b16 v[216:217], v252 offset:32
    ds_read_b64_tr_b16 v[218:219], v252 offset:544
    ds_read_b64_tr_b16 v[220:221], v252 offset:64
    ds_read_b64_tr_b16 v[222:223], v252 offset:576
    s_waitcnt lgkmcnt(4)
    v_mfma_f32_16x16x32_bf16 v[0:3], v[212:215], a[0:3], 0
    ds_read_b64_tr_b16 v[208:209], v252 offset:96
    ds_read_b64_tr_b16 v[210:211], v252 offset:608
    v_mfma_f32_16x16x32_bf16 v[4:7], v[212:215], a[4:7], 0
    v_mfma_f32_16x16x32_bf16 v[8:11], v[212:215], a[8:11], 0
    v_mfma_f32_16x16x32_bf16 v[12:15], v[212:215], a[12:15], 0
    s_waitcnt lgkmcnt(2)
    v_mfma_f32_16x16x32_bf16 v[16:19], v[216:219], a[0:3], 0
    ds_read_b64_tr_b16 v[212:213], v252 offset:128
    ds_read_b64_tr_b16 v[214:215], v252 offset:640
    v_mfma_f32_16x16x32_bf16 v[20:23], v[216:219], a[4:7], 0
    v_mfma_f32_16x16x32_bf16 v[24:27], v[216:219], a[8:11], 0
    v_mfma_f32_16x16x32_bf16 v[28:31], v[216:219], a[12:15], 0
    v_mfma_f32_16x16x32_bf16 v[32:35], v[220:223], a[0:3], 0
    ds_read_b64_tr_b16 v[216:217], v252 offset:160
    ds_read_b64_tr_b16 v[218:219], v252 offset:672
    v_mfma_f32_16x16x32_bf16 v[36:39], v[220:223], a[4:7], 0
    v_mfma_f32_16x16x32_bf16 v[40:43], v[220:223], a[8:11], 0
    v_mfma_f32_16x16x32_bf16 v[44:47], v[220:223], a[12:15], 0
    s_waitcnt lgkmcnt(2)
    v_mfma_f32_16x16x32_bf16 v[48:51], v[208:211], a[0:3], 0
    ds_read_b64_tr_b16 v[220:221], v252 offset:192
    ds_read_b64_tr_b16 v[222:223], v252 offset:704
    v_mfma_f32_16x16x32_bf16 v[52:55], v[208:211], a[4:7], 0
    v_mfma_f32_16x16x32_bf16 v[56:59], v[208:211], a[8:11], 0
    v_mfma_f32_16x16x32_bf16 v[60:63], v[208:211], a[12:15], 0
    v_mfma_f32_16x16x32_bf16 v[64:67], v[212:215], a[0:3], 0
    ds_read_b64_tr_b16 v[208:209], v252 offset:33792
    ds_read_b64_tr_b16 v[210:211], v252 offset:34304
    v_mfma_f32_16x16x32_bf16 v[68:71], v[212:215], a[4:7], 0
    v_mfma_f32_16x16x32_bf16 v[72:75], v[212:215], a[8:11], 0
    v_mfma_f32_16x16x32_bf16 v[76:79], v[212:215], a[12:15], 0
    s_waitcnt lgkmcnt(2)
    v_mfma_f32_16x16x32_bf16 v[80:83], v[216:219], a[0:3], 0
    ds_read_b64_tr_b16 v[212:213], v252 offset:33824
    ds_read_b64_tr_b16 v[214:215], v252 offset:34336
    v_mfma_f32_16x16x32_bf16 v[84:87], v[216:219], a[4:7], 0
    v_mfma_f32_16x16x32_bf16 v[88:91], v[216:219], a[8:11], 0
    v_mfma_f32_16x16x32_bf16 v[92:95], v[216:219], a[12:15], 0
    v_mfma_f32_16x16x32_bf16 v[96:99], v[220:223], a[0:3], 0
    ds_read_b64_tr_b16 v[216:217], v252 offset:33856
    ds_read_b64_tr_b16 v[218:219], v252 offset:34368
    v_mfma_f32_16x16x32_bf16 v[100:103], v[220:223], a[4:7], 0
    v_mfma_f32_16x16x32_bf16 v[104:107], v[220:223], a[8:11], 0
    v_mfma_f32_16x16x32_bf16 v[108:111], v[220:223], a[12:15], 0
    s_waitcnt vmcnt(8)
    s_barrier
    s_waitcnt lgkmcnt(2)
    v_mfma_f32_16x16x32_bf16 v[0:3], v[208:211], a[16:19], v[0:3]
    s_add_u32 s50, s63, 114688
    s_add_u32 m0, s64, 0
    ds_read_b64_tr_b16 v[220:221], v252 offset:33888
    ds_read_b64_tr_b16 v[222:223], v252 offset:34400
    v_mfma_f32_16x16x32_bf16 v[4:7], v[208:211], a[20:23], v[4:7]
    buffer_load_dwordx4 v225, s[24:27], s50 offen offset:0 lds
    v_mfma_f32_16x16x32_bf16 v[8:11], v[208:211], a[24:27], v[8:11]
    v_mfma_f32_16x16x32_bf16 v[12:15], v[208:211], a[28:31], v[12:15]
    v_mfma_f32_16x16x32_bf16 v[16:19], v[212:215], a[16:19], v[16:19]
    s_add_u32 m0, s64, 160
    ds_read_b64_tr_b16 v[208:209], v252 offset:33920
    ds_read_b64_tr_b16 v[210:211], v252 offset:34432
    v_mfma_f32_16x16x32_bf16 v[20:23], v[212:215], a[20:23], v[20:23]
    buffer_load_dwordx4 v225, s[24:27], s50 offen offset:896 lds
    v_mfma_f32_16x16x32_bf16 v[24:27], v[212:215], a[24:27], v[24:27]
    v_mfma_f32_16x16x32_bf16 v[28:31], v[212:215], a[28:31], v[28:31]
    s_waitcnt lgkmcnt(2)
    v_mfma_f32_16x16x32_bf16 v[32:35], v[216:219], a[16:19], v[32:35]
    s_add_u32 m0, s64, 320
    ds_read_b64_tr_b16 v[212:213], v252 offset:33952
    ds_read_b64_tr_b16 v[214:215], v252 offset:34464
    v_mfma_f32_16x16x32_bf16 v[36:39], v[216:219], a[20:23], v[36:39]
    buffer_load_dwordx4 v225, s[24:27], s50 offen offset:1792 lds
    v_mfma_f32_16x16x32_bf16 v[40:43], v[216:219], a[24:27], v[40:43]
    v_mfma_f32_16x16x32_bf16 v[44:47], v[216:219], a[28:31], v[44:47]
    v_mfma_f32_16x16x32_bf16 v[48:51], v[220:223], a[16:19], v[48:51]
    s_add_u32 m0, s64, 480
    ds_read_b64_tr_b16 v[216:217], v252 offset:33984
    ds_read_b64_tr_b16 v[218:219], v252 offset:34496
    v_mfma_f32_16x16x32_bf16 v[52:55], v[220:223], a[20:23], v[52:55]
    buffer_load_dwordx4 v225, s[24:27], s50 offen offset:2688 lds
    s_add_u32 s50, s63, 118272
    s_add_u32 m0, s64, 4224
    v_mfma_f32_16x16x32_bf16 v[56:59], v[220:223], a[24:27], v[56:59]
    buffer_load_dwordx4 v225, s[24:27], s50 offen offset:0 lds
    v_mfma_f32_16x16x32_bf16 v[60:63], v[220:223], a[28:31], v[60:63]
    s_waitcnt lgkmcnt(2)
    v_mfma_f32_16x16x32_bf16 v[64:67], v[208:211], a[16:19], v[64:67]
    s_add_u32 m0, s64, 4384
    ds_read_b64_tr_b16 v[220:221], v253 offset:0
    ds_read_b64_tr_b16 v[222:223], v253 offset:512
    v_mfma_f32_16x16x32_bf16 v[68:71], v[208:211], a[20:23], v[68:71]
    buffer_load_dwordx4 v225, s[24:27], s50 offen offset:896 lds
    v_mfma_f32_16x16x32_bf16 v[72:75], v[208:211], a[24:27], v[72:75]
    v_mfma_f32_16x16x32_bf16 v[76:79], v[208:211], a[28:31], v[76:79]
    v_mfma_f32_16x16x32_bf16 v[80:83], v[212:215], a[16:19], v[80:83]
    s_add_u32 m0, s64, 4544
    ds_read_b64_tr_b16 v[208:209], v253 offset:32
    ds_read_b64_tr_b16 v[210:211], v253 offset:544
    v_mfma_f32_16x16x32_bf16 v[84:87], v[212:215], a[20:23], v[84:87]
    buffer_load_dwordx4 v225, s[24:27], s50 offen offset:1792 lds
    v_mfma_f32_16x16x32_bf16 v[88:91], v[212:215], a[24:27], v[88:91]
    v_mfma_f32_16x16x32_bf16 v[92:95], v[212:215], a[28:31], v[92:95]
    s_waitcnt lgkmcnt(4)
    v_mfma_f32_16x16x32_bf16 v[96:99], v[216:219], a[16:19], v[96:99]
    s_add_u32 m0, s64, 4704
    ds_read_b64_tr_b16 v[212:213], v253 offset:64
    ds_read_b64_tr_b16 v[214:215], v253 offset:576
    v_mfma_f32_16x16x32_bf16 v[100:103], v[216:219], a[20:23], v[100:103]
    buffer_load_dwordx4 v225, s[24:27], s50 offen offset:2688 lds
    v_mfma_f32_16x16x32_bf16 v[104:107], v[216:219], a[24:27], v[104:107]
    v_mfma_f32_16x16x32_bf16 v[108:111], v[216:219], a[28:31], v[108:111]
    s_waitcnt vmcnt(8)
    s_barrier
    s_waitcnt lgkmcnt(4)
    v_mfma_f32_16x16x32_bf16 v[0:3], v[220:223], a[32:35], v[0:3]
    s_add_u32 s50, s63, 143360
    s_add_u32 m0, s65, 0
    ds_read_b64_tr_b16 v[216:217], v253 offset:96
    ds_read_b64_tr_b16 v[218:219], v253 offset:608
    v_mfma_f32_16x16x32_bf16 v[4:7], v[220:223], a[36:39], v[4:7]
    buffer_load_dwordx4 v225, s[24:27], s50 offen offset:0 lds
    v_mfma_f32_16x16x32_bf16 v[8:11], v[220:223], a[40:43], v[8:11]
    v_mfma_f32_16x16x32_bf16 v[12:15], v[220:223], a[44:47], v[12:15]
    s_waitcnt lgkmcnt(2)
    v_mfma_f32_16x16x32_bf16 v[16:19], v[208:211], a[32:35], v[16:19]
    s_add_u32 m0, s65, 160
    ds_read_b64_tr_b16 v[220:221], v253 offset:128
    ds_read_b64_tr_b16 v[222:223], v253 offset:640
    v_mfma_f32_16x16x32_bf16 v[20:23], v[208:211], a[36:39], v[20:23]
    buffer_load_dwordx4 v225, s[24:27], s50 offen offset:896 lds
    v_mfma_f32_16x16x32_bf16 v[24:27], v[208:211], a[40:43], v[24:27]
    v_mfma_f32_16x16x32_bf16 v[28:31], v[208:211], a[44:47], v[28:31]
    v_mfma_f32_16x16x32_bf16 v[32:35], v[212:215], a[32:35], v[32:35]
    s_add_u32 m0, s65, 320
    ds_read_b64_tr_b16 v[208:209], v253 offset:160
    ds_read_b64_tr_b16 v[210:211], v253 offset:672
    v_mfma_f32_16x16x32_bf16 v[36:39], v[212:215], a[36:39], v[36:39]
    buffer_load_dwordx4 v225, s[24:27], s50 offen offset:1792 lds
    v_mfma_f32_16x16x32_bf16 v[40:43], v[212:215], a[40:43], v[40:43]
    v_mfma_f32_16x16x32_bf16 v[44:47], v[212:215], a[44:47], v[44:47]
    s_waitcnt lgkmcnt(2)
    v_mfma_f32_16x16x32_bf16 v[48:51], v[216:219], a[32:35], v[48:51]
    s_add_u32 m0, s65, 480
    ds_read_b64_tr_b16 v[212:213], v253 offset:192
    ds_read_b64_tr_b16 v[214:215], v253 offset:704
    v_mfma_f32_16x16x32_bf16 v[52:55], v[216:219], a[36:39], v[52:55]
    buffer_load_dwordx4 v225, s[24:27], s50 offen offset:2688 lds
    s_add_u32 s50, s63, 146944
    s_add_u32 m0, s65, 4224
    v_mfma_f32_16x16x32_bf16 v[56:59], v[216:219], a[40:43], v[56:59]
    buffer_load_dwordx4 v225, s[24:27], s50 offen offset:0 lds
    v_mfma_f32_16x16x32_bf16 v[60:63], v[216:219], a[44:47], v[60:63]
    v_mfma_f32_16x16x32_bf16 v[64:67], v[220:223], a[32:35], v[64:67]
    s_add_u32 m0, s65, 4384
    ds_read_b64_tr_b16 v[216:217], v253 offset:33792
    ds_read_b64_tr_b16 v[218:219], v253 offset:34304
    v_mfma_f32_16x16x32_bf16 v[68:71], v[220:223], a[36:39], v[68:71]
    buffer_load_dwordx4 v225, s[24:27], s50 offen offset:896 lds
    v_mfma_f32_16x16x32_bf16 v[72:75], v[220:223], a[40:43], v[72:75]
    v_mfma_f32_16x16x32_bf16 v[76:79], v[220:223], a[44:47], v[76:79]
    s_waitcnt lgkmcnt(2)
    v_mfma_f32_16x16x32_bf16 v[80:83], v[208:211], a[32:35], v[80:83]
    s_add_u32 m0, s65, 4544
    ds_read_b64_tr_b16 v[220:221], v253 offset:33824
    ds_read_b64_tr_b16 v[222:223], v253 offset:34336
    v_mfma_f32_16x16x32_bf16 v[84:87], v[208:211], a[36:39], v[84:87]
    buffer_load_dwordx4 v225, s[24:27], s50 offen offset:1792 lds
    v_mfma_f32_16x16x32_bf16 v[88:91], v[208:211], a[40:43], v[88:91]
    v_mfma_f32_16x16x32_bf16 v[92:95], v[208:211], a[44:47], v[92:95]
    v_mfma_f32_16x16x32_bf16 v[96:99], v[212:215], a[32:35], v[96:99]
    s_add_u32 m0, s65, 4704
    ds_read_b64_tr_b16 v[208:209], v253 offset:33856
    ds_read_b64_tr_b16 v[210:211], v253 offset:34368
    v_mfma_f32_16x16x32_bf16 v[100:103], v[212:215], a[36:39], v[100:103]
    buffer_load_dwordx4 v225, s[24:27], s50 offen offset:2688 lds
    v_mfma_f32_16x16x32_bf16 v[104:107], v[212:215], a[40:43], v[104:107]
    v_mfma_f32_16x16x32_bf16 v[108:111], v[212:215], a[44:47], v[108:111]
    s_waitcnt vmcnt(8)
    s_barrier
    s_waitcnt lgkmcnt(2)
    v_mfma_f32_16x16x32_bf16 v[0:3], v[216:219], a[48:51], v[0:3]
    s_add_u32 s50, s63, 172032
    s_add_u32 m0, s66, 0
    ds_read_b64_tr_b16 v[212:213], v253 offset:33888
    ds_read_b64_tr_b16 v[214:215], v253 offset:34400
    v_mfma_f32_16x16x32_bf16 v[4:7], v[216:219], a[52:55], v[4:7]
    buffer_load_dwordx4 v225, s[24:27], s50 offen offset:0 lds
    v_mfma_f32_16x16x32_bf16 v[8:11], v[216:219], a[56:59], v[8:11]
    v_mfma_f32_16x16x32_bf16 v[12:15], v[216:219], a[60:63], v[12:15]
    v_mfma_f32_16x16x32_bf16 v[16:19], v[220:223], a[48:51], v[16:19]
    s_add_u32 m0, s66, 160
    ds_read_b64_tr_b16 v[216:217], v253 offset:33920
    ds_read_b64_tr_b16 v[218:219], v253 offset:34432
    v_mfma_f32_16x16x32_bf16 v[20:23], v[220:223], a[52:55], v[20:23]
    buffer_load_dwordx4 v225, s[24:27], s50 offen offset:896 lds
    v_mfma_f32_16x16x32_bf16 v[24:27], v[220:223], a[56:59], v[24:27]
    v_mfma_f32_16x16x32_bf16 v[28:31], v[220:223], a[60:63], v[28:31]
    s_waitcnt lgkmcnt(2)
    v_mfma_f32_16x16x32_bf16 v[32:35], v[208:211], a[48:51], v[32:35]
    s_add_u32 m0, s66, 320
    ds_read_b64_tr_b16 v[220:221], v253 offset:33952
    ds_read_b64_tr_b16 v[222:223], v253 offset:34464
    v_mfma_f32_16x16x32_bf16 v[36:39], v[208:211], a[52:55], v[36:39]
    buffer_load_dwordx4 v225, s[24:27], s50 offen offset:1792 lds
    v_mfma_f32_16x16x32_bf16 v[40:43], v[208:211], a[56:59], v[40:43]
    v_mfma_f32_16x16x32_bf16 v[44:47], v[208:211], a[60:63], v[44:47]
    v_mfma_f32_16x16x32_bf16 v[48:51], v[212:215], a[48:51], v[48:51]
    s_add_u32 m0, s66, 480
    ds_read_b64_tr_b16 v[208:209], v253 offset:33984
    ds_read_b64_tr_b16 v[210:211], v253 offset:34496
    v_mfma_f32_16x16x32_bf16 v[52:55], v[212:215], a[52:55], v[52:55]
    buffer_load_dwordx4 v225, s[24:27], s50 offen offset:2688 lds
    s_add_u32 s50, s63, 175616
    s_add_u32 m0, s66, 4224
    v_mfma_f32_16x16x32_bf16 v[56:59], v[212:215], a[56:59], v[56:59]
    buffer_load_dwordx4 v225, s[24:27], s50 offen offset:0 lds
    v_mfma_f32_16x16x32_bf16 v[60:63], v[212:215], a[60:63], v[60:63]
    s_waitcnt lgkmcnt(2)
    v_mfma_f32_16x16x32_bf16 v[64:67], v[216:219], a[48:51], v[64:67]
    s_add_u32 m0, s66, 4384
    ds_read_b64_tr_b16 v[212:213], v252 offset:0
    ds_read_b64_tr_b16 v[214:215], v252 offset:512
    v_mfma_f32_16x16x32_bf16 v[68:71], v[216:219], a[52:55], v[68:71]
    buffer_load_dwordx4 v225, s[24:27], s50 offen offset:896 lds
    v_mfma_f32_16x16x32_bf16 v[72:75], v[216:219], a[56:59], v[72:75]
    v_mfma_f32_16x16x32_bf16 v[76:79], v[216:219], a[60:63], v[76:79]
    v_mfma_f32_16x16x32_bf16 v[80:83], v[220:223], a[48:51], v[80:83]
    s_add_u32 m0, s66, 4544
    ds_read_b64_tr_b16 v[216:217], v252 offset:32
    ds_read_b64_tr_b16 v[218:219], v252 offset:544
    v_mfma_f32_16x16x32_bf16 v[84:87], v[220:223], a[52:55], v[84:87]
    buffer_load_dwordx4 v225, s[24:27], s50 offen offset:1792 lds
    v_mfma_f32_16x16x32_bf16 v[88:91], v[220:223], a[56:59], v[88:91]
    v_mfma_f32_16x16x32_bf16 v[92:95], v[220:223], a[60:63], v[92:95]
    s_waitcnt lgkmcnt(4)
    v_mfma_f32_16x16x32_bf16 v[96:99], v[208:211], a[48:51], v[96:99]
    s_add_u32 m0, s66, 4704
    ds_read_b64_tr_b16 v[220:221], v252 offset:64
    ds_read_b64_tr_b16 v[222:223], v252 offset:576
    v_mfma_f32_16x16x32_bf16 v[100:103], v[208:211], a[52:55], v[100:103]
    buffer_load_dwordx4 v225, s[24:27], s50 offen offset:2688 lds
    v_mfma_f32_16x16x32_bf16 v[104:107], v[208:211], a[56:59], v[104:107]
    v_mfma_f32_16x16x32_bf16 v[108:111], v[208:211], a[60:63], v[108:111]
    s_waitcnt vmcnt(8)
    s_barrier
    s_waitcnt lgkmcnt(4)
    v_mfma_f32_16x16x32_bf16 v[0:3], v[212:215], a[64:67], v[0:3]
    s_add_u32 s50, s63, 200704
    s_add_u32 m0, s67, 0
    ds_read_b64_tr_b16 v[208:209], v252 offset:96
    ds_read_b64_tr_b16 v[210:211], v252 offset:608
    v_mfma_f32_16x16x32_bf16 v[4:7], v[212:215], a[68:71], v[4:7]
    buffer_load_dwordx4 v225, s[24:27], s50 offen offset:0 lds
    v_mfma_f32_16x16x32_bf16 v[8:11], v[212:215], a[72:75], v[8:11]
    v_mfma_f32_16x16x32_bf16 v[12:15], v[212:215], a[76:79], v[12:15]
    s_waitcnt lgkmcnt(2)
    v_mfma_f32_16x16x32_bf16 v[16:19], v[216:219], a[64:67], v[16:19]
    s_add_u32 m0, s67, 160
    ds_read_b64_tr_b16 v[212:213], v252 offset:128
    ds_read_b64_tr_b16 v[214:215], v252 offset:640
    v_mfma_f32_16x16x32_bf16 v[20:23], v[216:219], a[68:71], v[20:23]
    buffer_load_dwordx4 v225, s[24:27], s50 offen offset:896 lds
    v_mfma_f32_16x16x32_bf16 v[24:27], v[216:219], a[72:75], v[24:27]
    v_mfma_f32_16x16x32_bf16 v[28:31], v[216:219], a[76:79], v[28:31]
    v_mfma_f32_16x16x32_bf16 v[32:35], v[220:223], a[64:67], v[32:35]
    s_add_u32 m0, s67, 320
    ds_read_b64_tr_b16 v[216:217], v252 offset:160
    ds_read_b64_tr_b16 v[218:219], v252 offset:672
    v_mfma_f32_16x16x32_bf16 v[36:39], v[220:223], a[68:71], v[36:39]
    buffer_load_dwordx4 v225, s[24:27], s50 offen offset:1792 lds
    v_mfma_f32_16x16x32_bf16 v[40:43], v[220:223], a[72:75], v[40:43]
    v_mfma_f32_16x16x32_bf16 v[44:47], v[220:223], a[76:79], v[44:47]
    s_waitcnt lgkmcnt(2)
    v_mfma_f32_16x16x32_bf16 v[48:51], v[208:211], a[64:67], v[48:51]
    s_add_u32 m0, s67, 480
    ds_read_b64_tr_b16 v[220:221], v252 offset:192
    ds_read_b64_tr_b16 v[222:223], v252 offset:704
    v_mfma_f32_16x16x32_bf16 v[52:55], v[208:211], a[68:71], v[52:55]
    buffer_load_dwordx4 v225, s[24:27], s50 offen offset:2688 lds
    s_add_u32 s50, s63, 204288
    s_add_u32 m0, s67, 4224
    v_mfma_f32_16x16x32_bf16 v[56:59], v[208:211], a[72:75], v[56:59]
    buffer_load_dwordx4 v225, s[24:27], s50 offen offset:0 lds
    v_mfma_f32_16x16x32_bf16 v[60:63], v[208:211], a[76:79], v[60:63]
    v_mfma_f32_16x16x32_bf16 v[64:67], v[212:215], a[64:67], v[64:67]
    s_add_u32 m0, s67, 4384
    ds_read_b64_tr_b16 v[208:209], v252 offset:33792
    ds_read_b64_tr_b16 v[210:211], v252 offset:34304
    v_mfma_f32_16x16x32_bf16 v[68:71], v[212:215], a[68:71], v[68:71]
    buffer_load_dwordx4 v225, s[24:27], s50 offen offset:896 lds
    v_mfma_f32_16x16x32_bf16 v[72:75], v[212:215], a[72:75], v[72:75]
    v_mfma_f32_16x16x32_bf16 v[76:79], v[212:215], a[76:79], v[76:79]
    s_waitcnt lgkmcnt(2)
    v_mfma_f32_16x16x32_bf16 v[80:83], v[216:219], a[64:67], v[80:83]
    s_add_u32 m0, s67, 4544
    ds_read_b64_tr_b16 v[212:213], v252 offset:33824
    ds_read_b64_tr_b16 v[214:215], v252 offset:34336
    v_mfma_f32_16x16x32_bf16 v[84:87], v[216:219], a[68:71], v[84:87]
    buffer_load_dwordx4 v225, s[24:27], s50 offen offset:1792 lds
    v_mfma_f32_16x16x32_bf16 v[88:91], v[216:219], a[72:75], v[88:91]
    v_mfma_f32_16x16x32_bf16 v[92:95], v[216:219], a[76:79], v[92:95]
    v_mfma_f32_16x16x32_bf16 v[96:99], v[220:223], a[64:67], v[96:99]
    s_add_u32 m0, s67, 4704
    ds_read_b64_tr_b16 v[216:217], v252 offset:33856
    ds_read_b64_tr_b16 v[218:219], v252 offset:34368
    v_mfma_f32_16x16x32_bf16 v[100:103], v[220:223], a[68:71], v[100:103]
    buffer_load_dwordx4 v225, s[24:27], s50 offen offset:2688 lds
    v_mfma_f32_16x16x32_bf16 v[104:107], v[220:223], a[72:75], v[104:107]
    v_mfma_f32_16x16x32_bf16 v[108:111], v[220:223], a[76:79], v[108:111]
    s_waitcnt vmcnt(8)
    s_barrier
    s_waitcnt lgkmcnt(2)
    v_mfma_f32_16x16x32_bf16 v[0:3], v[208:211], a[80:83], v[0:3]
    s_add_u32 s50, s63, 229376
    s_add_u32 m0, s64, 0
    ds_read_b64_tr_b16 v[220:221], v252 offset:33888
    ds_read_b64_tr_b16 v[222:223], v252 offset:34400
    v_mfma_f32_16x16x32_bf16 v[4:7], v[208:211], a[84:87], v[4:7]
    buffer_load_dwordx4 v225, s[24:27], s50 offen offset:0 lds
    v_mfma_f32_16x16x32_bf16 v[8:11], v[208:211], a[88:91], v[8:11]
    v_mfma_f32_16x16x32_bf16 v[12:15], v[208:211], a[92:95], v[12:15]
    v_mfma_f32_16x16x32_bf16 v[16:19], v[212:215], a[80:83], v[16:19]
    s_add_u32 m0, s64, 160
    ds_read_b64_tr_b16 v[208:209], v252 offset:33920
    ds_read_b64_tr_b16 v[210:211], v252 offset:34432
    v_mfma_f32_16x16x32_bf16 v[20:23], v[212:215], a[84:87], v[20:23]
    buffer_load_dwordx4 v225, s[24:27], s50 offen offset:896 lds
    v_mfma_f32_16x16x32_bf16 v[24:27], v[212:215], a[88:91], v[24:27]
    v_mfma_f32_16x16x32_bf16 v[28:31], v[212:215], a[92:95], v[28:31]
    s_waitcnt lgkmcnt(2)
    v_mfma_f32_16x16x32_bf16 v[32:35], v[216:219], a[80:83], v[32:35]
    s_add_u32 m0, s64, 320
    ds_read_b64_tr_b16 v[212:213], v252 offset:33952
    ds_read_b64_tr_b16 v[214:215], v252 offset:34464
    v_mfma_f32_16x16x32_bf16 v[36:39], v[216:219], a[84:87], v[36:39]
    buffer_load_dwordx4 v225, s[24:27], s50 offen offset:1792 lds
    v_mfma_f32_16x16x32_bf16 v[40:43], v[216:219], a[88:91], v[40:43]
    v_mfma_f32_16x16x32_bf16 v[44:47], v[216:219], a[92:95], v[44:47]
    v_mfma_f32_16x16x32_bf16 v[48:51], v[220:223], a[80:83], v[48:51]
    s_add_u32 m0, s64, 480
    ds_read_b64_tr_b16 v[216:217], v252 offset:33984
    ds_read_b64_tr_b16 v[218:219], v252 offset:34496
    v_mfma_f32_16x16x32_bf16 v[52:55], v[220:223], a[84:87], v[52:55]
    buffer_load_dwordx4 v225, s[24:27], s50 offen offset:2688 lds
    s_add_u32 s50, s63, 232960
    s_add_u32 m0, s64, 4224
    v_mfma_f32_16x16x32_bf16 v[56:59], v[220:223], a[88:91], v[56:59]
    buffer_load_dwordx4 v225, s[24:27], s50 offen offset:0 lds
    v_mfma_f32_16x16x32_bf16 v[60:63], v[220:223], a[92:95], v[60:63]
    s_waitcnt lgkmcnt(2)
    v_mfma_f32_16x16x32_bf16 v[64:67], v[208:211], a[80:83], v[64:67]
    s_add_u32 m0, s64, 4384
    ds_read_b64_tr_b16 v[220:221], v253 offset:0
    ds_read_b64_tr_b16 v[222:223], v253 offset:512
    v_mfma_f32_16x16x32_bf16 v[68:71], v[208:211], a[84:87], v[68:71]
    buffer_load_dwordx4 v225, s[24:27], s50 offen offset:896 lds
    v_mfma_f32_16x16x32_bf16 v[72:75], v[208:211], a[88:91], v[72:75]
    v_mfma_f32_16x16x32_bf16 v[76:79], v[208:211], a[92:95], v[76:79]
    v_mfma_f32_16x16x32_bf16 v[80:83], v[212:215], a[80:83], v[80:83]
    s_add_u32 m0, s64, 4544
    ds_read_b64_tr_b16 v[208:209], v253 offset:32
    ds_read_b64_tr_b16 v[210:211], v253 offset:544
    v_mfma_f32_16x16x32_bf16 v[84:87], v[212:215], a[84:87], v[84:87]
    buffer_load_dwordx4 v225, s[24:27], s50 offen offset:1792 lds
    v_mfma_f32_16x16x32_bf16 v[88:91], v[212:215], a[88:91], v[88:91]
    v_mfma_f32_16x16x32_bf16 v[92:95], v[212:215], a[92:95], v[92:95]
    s_waitcnt lgkmcnt(4)
    v_mfma_f32_16x16x32_bf16 v[96:99], v[216:219], a[80:83], v[96:99]
    s_add_u32 m0, s64, 4704
    ds_read_b64_tr_b16 v[212:213], v253 offset:64
    ds_read_b64_tr_b16 v[214:215], v253 offset:576
    v_mfma_f32_16x16x32_bf16 v[100:103], v[216:219], a[84:87], v[100:103]
    buffer_load_dwordx4 v225, s[24:27], s50 offen offset:2688 lds
    v_mfma_f32_16x16x32_bf16 v[104:107], v[216:219], a[88:91], v[104:107]
    v_mfma_f32_16x16x32_bf16 v[108:111], v[216:219], a[92:95], v[108:111]
    s_waitcnt vmcnt(8)
    s_barrier
    s_waitcnt lgkmcnt(4)
    v_mfma_f32_16x16x32_bf16 v[0:3], v[220:223], a[96:99], v[0:3]
    s_add_u32 s50, s63, 258048
    s_add_u32 m0, s65, 0
    ds_read_b64_tr_b16 v[216:217], v253 offset:96
    ds_read_b64_tr_b16 v[218:219], v253 offset:608
    v_mfma_f32_16x16x32_bf16 v[4:7], v[220:223], a[100:103], v[4:7]
    buffer_load_dwordx4 v225, s[24:27], s50 offen offset:0 lds
    v_mfma_f32_16x16x32_bf16 v[8:11], v[220:223], a[104:107], v[8:11]
    v_mfma_f32_16x16x32_bf16 v[12:15], v[220:223], a[108:111], v[12:15]
    s_waitcnt lgkmcnt(2)
    v_mfma_f32_16x16x32_bf16 v[16:19], v[208:211], a[96:99], v[16:19]
    s_add_u32 m0, s65, 160
    ds_read_b64_tr_b16 v[220:221], v253 offset:128
    ds_read_b64_tr_b16 v[222:223], v253 offset:640
    v_mfma_f32_16x16x32_bf16 v[20:23], v[208:211], a[100:103], v[20:23]
    buffer_load_dwordx4 v225, s[24:27], s50 offen offset:896 lds
    v_mfma_f32_16x16x32_bf16 v[24:27], v[208:211], a[104:107], v[24:27]
    v_mfma_f32_16x16x32_bf16 v[28:31], v[208:211], a[108:111], v[28:31]
    v_mfma_f32_16x16x32_bf16 v[32:35], v[212:215], a[96:99], v[32:35]
    s_add_u32 m0, s65, 320
    ds_read_b64_tr_b16 v[208:209], v253 offset:160
    ds_read_b64_tr_b16 v[210:211], v253 offset:672
    v_mfma_f32_16x16x32_bf16 v[36:39], v[212:215], a[100:103], v[36:39]
    buffer_load_dwordx4 v225, s[24:27], s50 offen offset:1792 lds
    v_mfma_f32_16x16x32_bf16 v[40:43], v[212:215], a[104:107], v[40:43]
    v_mfma_f32_16x16x32_bf16 v[44:47], v[212:215], a[108:111], v[44:47]
    s_waitcnt lgkmcnt(2)
    v_mfma_f32_16x16x32_bf16 v[48:51], v[216:219], a[96:99], v[48:51]
    s_add_u32 m0, s65, 480
    ds_read_b64_tr_b16 v[212:213], v253 offset:192
    ds_read_b64_tr_b16 v[214:215], v253 offset:704
    v_mfma_f32_16x16x32_bf16 v[52:55], v[216:219], a[100:103], v[52:55]
    buffer_load_dwordx4 v225, s[24:27], s50 offen offset:2688 lds
    s_add_u32 s50, s63, 261632
    s_add_u32 m0, s65, 4224
    v_mfma_f32_16x16x32_bf16 v[56:59], v[216:219], a[104:107], v[56:59]
    buffer_load_dwordx4 v225, s[24:27], s50 offen offset:0 lds
    v_mfma_f32_16x16x32_bf16 v[60:63], v[216:219], a[108:111], v[60:63]
    v_mfma_f32_16x16x32_bf16 v[64:67], v[220:223], a[96:99], v[64:67]
    s_add_u32 m0, s65, 4384
    ds_read_b64_tr_b16 v[216:217], v253 offset:33792
    ds_read_b64_tr_b16 v[218:219], v253 offset:34304
    v_mfma_f32_16x16x32_bf16 v[68:71], v[220:223], a[100:103], v[68:71]
    buffer_load_dwordx4 v225, s[24:27], s50 offen offset:896 lds
    v_mfma_f32_16x16x32_bf16 v[72:75], v[220:223], a[104:107], v[72:75]
    v_mfma_f32_16x16x32_bf16 v[76:79], v[220:223], a[108:111], v[76:79]
    s_waitcnt lgkmcnt(2)
    v_mfma_f32_16x16x32_bf16 v[80:83], v[208:211], a[96:99], v[80:83]
    s_add_u32 m0, s65, 4544
    ds_read_b64_tr_b16 v[220:221], v253 offset:33824
    ds_read_b64_tr_b16 v[222:223], v253 offset:34336
    v_mfma_f32_16x16x32_bf16 v[84:87], v[208:211], a[100:103], v[84:87]
    buffer_load_dwordx4 v225, s[24:27], s50 offen offset:1792 lds
    v_mfma_f32_16x16x32_bf16 v[88:91], v[208:211], a[104:107], v[88:91]
    v_mfma_f32_16x16x32_bf16 v[92:95], v[208:211], a[108:111], v[92:95]
    v_mfma_f32_16x16x32_bf16 v[96:99], v[212:215], a[96:99], v[96:99]
    s_add_u32 m0, s65, 4704
    ds_read_b64_tr_b16 v[208:209], v253 offset:33856
    ds_read_b64_tr_b16 v[210:211], v253 offset:34368
    v_mfma_f32_16x16x32_bf16 v[100:103], v[212:215], a[100:103], v[100:103]
    buffer_load_dwordx4 v225, s[24:27], s50 offen offset:2688 lds
    v_mfma_f32_16x16x32_bf16 v[104:107], v[212:215], a[104:107], v[104:107]
    v_mfma_f32_16x16x32_bf16 v[108:111], v[212:215], a[108:111], v[108:111]
    s_waitcnt vmcnt(8)
    s_barrier
    s_waitcnt lgkmcnt(2)
    v_mfma_f32_16x16x32_bf16 v[0:3], v[216:219], a[112:115], v[0:3]
    s_add_u32 s50, s63, 286720
    s_add_u32 m0, s66, 0
    ds_read_b64_tr_b16 v[212:213], v253 offset:33888
    ds_read_b64_tr_b16 v[214:215], v253 offset:34400
    v_mfma_f32_16x16x32_bf16 v[4:7], v[216:219], a[116:119], v[4:7]
    buffer_load_dwordx4 v225, s[24:27], s50 offen offset:0 lds
    v_mfma_f32_16x16x32_bf16 v[8:11], v[216:219], a[120:123], v[8:11]
    v_mfma_f32_16x16x32_bf16 v[12:15], v[216:219], a[124:127], v[12:15]
    v_mfma_f32_16x16x32_bf16 v[16:19], v[220:223], a[112:115], v[16:19]
    s_add_u32 m0, s66, 160
    ds_read_b64_tr_b16 v[216:217], v253 offset:33920
    ds_read_b64_tr_b16 v[218:219], v253 offset:34432
    v_mfma_f32_16x16x32_bf16 v[20:23], v[220:223], a[116:119], v[20:23]
    buffer_load_dwordx4 v225, s[24:27], s50 offen offset:896 lds
    v_mfma_f32_16x16x32_bf16 v[24:27], v[220:223], a[120:123], v[24:27]
    v_mfma_f32_16x16x32_bf16 v[28:31], v[220:223], a[124:127], v[28:31]
    s_waitcnt lgkmcnt(2)
    v_mfma_f32_16x16x32_bf16 v[32:35], v[208:211], a[112:115], v[32:35]
    s_add_u32 m0, s66, 320
    ds_read_b64_tr_b16 v[220:221], v253 offset:33952
    ds_read_b64_tr_b16 v[222:223], v253 offset:34464
    v_mfma_f32_16x16x32_bf16 v[36:39], v[208:211], a[116:119], v[36:39]
    buffer_load_dwordx4 v225, s[24:27], s50 offen offset:1792 lds
    v_mfma_f32_16x16x32_bf16 v[40:43], v[208:211], a[120:123], v[40:43]
    v_mfma_f32_16x16x32_bf16 v[44:47], v[208:211], a[124:127], v[44:47]
    v_mfma_f32_16x16x32_bf16 v[48:51], v[212:215], a[112:115], v[48:51]
    s_add_u32 m0, s66, 480
    ds_read_b64_tr_b16 v[208:209], v253 offset:33984
    ds_read_b64_tr_b16 v[210:211], v253 offset:34496
    v_mfma_f32_16x16x32_bf16 v[52:55], v[212:215], a[116:119], v[52:55]
    buffer_load_dwordx4 v225, s[24:27], s50 offen offset:2688 lds
    s_add_u32 s50, s63, 290304
    s_add_u32 m0, s66, 4224
    v_mfma_f32_16x16x32_bf16 v[56:59], v[212:215], a[120:123], v[56:59]
    buffer_load_dwordx4 v225, s[24:27], s50 offen offset:0 lds
    v_mfma_f32_16x16x32_bf16 v[60:63], v[212:215], a[124:127], v[60:63]
    s_waitcnt lgkmcnt(2)
    v_mfma_f32_16x16x32_bf16 v[64:67], v[216:219], a[112:115], v[64:67]
    s_add_u32 m0, s66, 4384
    ds_read_b64_tr_b16 v[212:213], v252 offset:0
    ds_read_b64_tr_b16 v[214:215], v252 offset:512
    v_mfma_f32_16x16x32_bf16 v[68:71], v[216:219], a[116:119], v[68:71]
    buffer_load_dwordx4 v225, s[24:27], s50 offen offset:896 lds
    v_mfma_f32_16x16x32_bf16 v[72:75], v[216:219], a[120:123], v[72:75]
    v_mfma_f32_16x16x32_bf16 v[76:79], v[216:219], a[124:127], v[76:79]
    v_mfma_f32_16x16x32_bf16 v[80:83], v[220:223], a[112:115], v[80:83]
    s_add_u32 m0, s66, 4544
    ds_read_b64_tr_b16 v[216:217], v252 offset:32
    ds_read_b64_tr_b16 v[218:219], v252 offset:544
    v_mfma_f32_16x16x32_bf16 v[84:87], v[220:223], a[116:119], v[84:87]
    buffer_load_dwordx4 v225, s[24:27], s50 offen offset:1792 lds
    v_mfma_f32_16x16x32_bf16 v[88:91], v[220:223], a[120:123], v[88:91]
    v_mfma_f32_16x16x32_bf16 v[92:95], v[220:223], a[124:127], v[92:95]
    s_waitcnt lgkmcnt(4)
    v_mfma_f32_16x16x32_bf16 v[96:99], v[208:211], a[112:115], v[96:99]
    s_add_u32 m0, s66, 4704
    ds_read_b64_tr_b16 v[220:221], v252 offset:64
    ds_read_b64_tr_b16 v[222:223], v252 offset:576
    v_mfma_f32_16x16x32_bf16 v[100:103], v[208:211], a[116:119], v[100:103]
    buffer_load_dwordx4 v225, s[24:27], s50 offen offset:2688 lds
    v_mfma_f32_16x16x32_bf16 v[104:107], v[208:211], a[120:123], v[104:107]
    v_mfma_f32_16x16x32_bf16 v[108:111], v[208:211], a[124:127], v[108:111]
    s_waitcnt vmcnt(8)
    s_barrier
    s_waitcnt lgkmcnt(4)
    v_mfma_f32_16x16x32_bf16 v[0:3], v[212:215], a[128:131], v[0:3]
    s_add_u32 s50, s63, 315392
    s_add_u32 m0, s67, 0
    ds_read_b64_tr_b16 v[208:209], v252 offset:96
    ds_read_b64_tr_b16 v[210:211], v252 offset:608
    v_mfma_f32_16x16x32_bf16 v[4:7], v[212:215], a[132:135], v[4:7]
    buffer_load_dwordx4 v225, s[24:27], s50 offen offset:0 lds
    v_mfma_f32_16x16x32_bf16 v[8:11], v[212:215], a[136:139], v[8:11]
    v_mfma_f32_16x16x32_bf16 v[12:15], v[212:215], a[140:143], v[12:15]
    s_waitcnt lgkmcnt(2)
    v_mfma_f32_16x16x32_bf16 v[16:19], v[216:219], a[128:131], v[16:19]
    s_add_u32 m0, s67, 160
    ds_read_b64_tr_b16 v[212:213], v252 offset:128
    ds_read_b64_tr_b16 v[214:215], v252 offset:640
    v_mfma_f32_16x16x32_bf16 v[20:23], v[216:219], a[132:135], v[20:23]
    buffer_load_dwordx4 v225, s[24:27], s50 offen offset:896 lds
    v_mfma_f32_16x16x32_bf16 v[24:27], v[216:219], a[136:139], v[24:27]
    v_mfma_f32_16x16x32_bf16 v[28:31], v[216:219], a[140:143], v[28:31]
    v_mfma_f32_16x16x32_bf16 v[32:35], v[220:223], a[128:131], v[32:35]
    s_add_u32 m0, s67, 320
    ds_read_b64_tr_b16 v[216:217], v252 offset:160
    ds_read_b64_tr_b16 v[218:219], v252 offset:672
    v_mfma_f32_16x16x32_bf16 v[36:39], v[220:223], a[132:135], v[36:39]
    buffer_load_dwordx4 v225, s[24:27], s50 offen offset:1792 lds
    v_mfma_f32_16x16x32_bf16 v[40:43], v[220:223], a[136:139], v[40:43]
    v_mfma_f32_16x16x32_bf16 v[44:47], v[220:223], a[140:143], v[44:47]
    s_waitcnt lgkmcnt(2)
    v_mfma_f32_16x16x32_bf16 v[48:51], v[208:211], a[128:131], v[48:51]
    s_add_u32 m0, s67, 480
    ds_read_b64_tr_b16 v[220:221], v252 offset:192
    ds_read_b64_tr_b16 v[222:223], v252 offset:704
    v_mfma_f32_16x16x32_bf16 v[52:55], v[208:211], a[132:135], v[52:55]
    buffer_load_dwordx4 v225, s[24:27], s50 offen offset:2688 lds
    s_add_u32 s50, s63, 318976
    s_add_u32 m0, s67, 4224
    v_mfma_f32_16x16x32_bf16 v[56:59], v[208:211], a[136:139], v[56:59]
    buffer_load_dwordx4 v225, s[24:27], s50 offen offset:0 lds
    v_mfma_f32_16x16x32_bf16 v[60:63], v[208:211], a[140:143], v[60:63]
    v_mfma_f32_16x16x32_bf16 v[64:67], v[212:215], a[128:131], v[64:67]
    s_add_u32 m0, s67, 4384
    ds_read_b64_tr_b16 v[208:209], v252 offset:33792
    ds_read_b64_tr_b16 v[210:211], v252 offset:34304
    v_mfma_f32_16x16x32_bf16 v[68:71], v[212:215], a[132:135], v[68:71]
    buffer_load_dwordx4 v225, s[24:27], s50 offen offset:896 lds
    v_mfma_f32_16x16x32_bf16 v[72:75], v[212:215], a[136:139], v[72:75]
    v_mfma_f32_16x16x32_bf16 v[76:79], v[212:215], a[140:143], v[76:79]
    s_waitcnt lgkmcnt(2)
    v_mfma_f32_16x16x32_bf16 v[80:83], v[216:219], a[128:131], v[80:83]
    s_add_u32 m0, s67, 4544
    ds_read_b64_tr_b16 v[212:213], v252 offset:33824
    ds_read_b64_tr_b16 v[214:215], v252 offset:34336
    v_mfma_f32_16x16x32_bf16 v[84:87], v[216:219], a[132:135], v[84:87]
    buffer_load_dwordx4 v225, s[24:27], s50 offen offset:1792 lds
    v_mfma_f32_16x16x32_bf16 v[88:91], v[216:219], a[136:139], v[88:91]
    v_mfma_f32_16x16x32_bf16 v[92:95], v[216:219], a[140:143], v[92:95]
    v_mfma_f32_16x16x32_bf16 v[96:99], v[220:223], a[128:131], v[96:99]
    s_add_u32 m0, s67, 4704
    ds_read_b64_tr_b16 v[216:217], v252 offset:33856
    ds_read_b64_tr_b16 v[218:219], v252 offset:34368
    v_mfma_f32_16x16x32_bf16 v[100:103], v[220:223], a[132:135], v[100:103]
    buffer_load_dwordx4 v225, s[24:27], s50 offen offset:2688 lds
    v_mfma_f32_16x16x32_bf16 v[104:107], v[220:223], a[136:139], v[104:107]
    v_mfma_f32_16x16x32_bf16 v[108:111], v[220:223], a[140:143], v[108:111]
    s_waitcnt vmcnt(8)
    s_barrier
    s_mov_b32 s28, s94
    s_mov_b32 s29, s95
    s_mov_b32 s30, 1835008
    s_mov_b32 s31, 0x20000
    s_mov_b32 s20, s92
    s_mov_b32 s21, s93
    s_mov_b32 s22, 896
    s_mov_b32 s23, 0x20000
    v_lshlrev_b32 v204, 4, v251
    v_and_b32 v232, 15, v251
    v_lshrrev_b32 v233, 4, v251
    v_mul_u32_u24 v205, 896, v232
    v_lshl_add_u32 v205, v233, 3, v205
    v_lshlrev_b32 v206, 3, v233
    s_lshl_b32 s100, s45, 8
    s_add_u32 s100, s100, 33554432
    s_load_dwordx8 s[8:15], s[4:5], s100
    s_waitcnt lgkmcnt(2)
    v_mfma_f32_16x16x32_bf16 v[0:3], v[208:211], a[144:147], v[0:3]
    s_add_u32 s50, s63, 344064
    s_add_u32 m0, s64, 0
    ds_read_b64_tr_b16 v[220:221], v252 offset:33888
    ds_read_b64_tr_b16 v[222:223], v252 offset:34400
    v_mfma_f32_16x16x32_bf16 v[4:7], v[208:211], a[148:151], v[4:7]
    buffer_load_dwordx4 v225, s[24:27], s50 offen offset:0 lds
    v_mfma_f32_16x16x32_bf16 v[8:11], v[208:211], a[152:155], v[8:11]
    v_mfma_f32_16x16x32_bf16 v[12:15], v[208:211], a[156:159], v[12:15]
    v_mfma_f32_16x16x32_bf16 v[16:19], v[212:215], a[144:147], v[16:19]
    s_add_u32 m0, s64, 160
    ds_read_b64_tr_b16 v[208:209], v252 offset:33920
    ds_read_b64_tr_b16 v[210:211], v252 offset:34432
    v_mfma_f32_16x16x32_bf16 v[20:23], v[212:215], a[148:151], v[20:23]
    buffer_load_dwordx4 v225, s[24:27], s50 offen offset:896 lds
    v_mfma_f32_16x16x32_bf16 v[24:27], v[212:215], a[152:155], v[24:27]
    v_mfma_f32_16x16x32_bf16 v[28:31], v[212:215], a[156:159], v[28:31]
    s_waitcnt lgkmcnt(2)
    v_mfma_f32_16x16x32_bf16 v[32:35], v[216:219], a[144:147], v[32:35]
    s_add_u32 m0, s64, 320
    ds_read_b64_tr_b16 v[212:213], v252 offset:33952
    ds_read_b64_tr_b16 v[214:215], v252 offset:34464
    v_mfma_f32_16x16x32_bf16 v[36:39], v[216:219], a[148:151], v[36:39]
    buffer_load_dwordx4 v225, s[24:27], s50 offen offset:1792 lds
    v_mfma_f32_16x16x32_bf16 v[40:43], v[216:219], a[152:155], v[40:43]
    v_mfma_f32_16x16x32_bf16 v[44:47], v[216:219], a[156:159], v[44:47]
    v_mfma_f32_16x16x32_bf16 v[48:51], v[220:223], a[144:147], v[48:51]
    s_add_u32 m0, s64, 480
    ds_read_b64_tr_b16 v[216:217], v252 offset:33984
    ds_read_b64_tr_b16 v[218:219], v252 offset:34496
    v_mfma_f32_16x16x32_bf16 v[52:55], v[220:223], a[148:151], v[52:55]
    buffer_load_dwordx4 v225, s[24:27], s50 offen offset:2688 lds
    s_add_u32 s50, s63, 347648
    s_add_u32 m0, s64, 4224
    v_mfma_f32_16x16x32_bf16 v[56:59], v[220:223], a[152:155], v[56:59]
    buffer_load_dwordx4 v225, s[24:27], s50 offen offset:0 lds
    v_mfma_f32_16x16x32_bf16 v[60:63], v[220:223], a[156:159], v[60:63]
    s_waitcnt lgkmcnt(2)
    v_mfma_f32_16x16x32_bf16 v[64:67], v[208:211], a[144:147], v[64:67]
    s_add_u32 m0, s64, 4384
    ds_read_b64_tr_b16 v[220:221], v253 offset:0
    ds_read_b64_tr_b16 v[222:223], v253 offset:512
    v_mfma_f32_16x16x32_bf16 v[68:71], v[208:211], a[148:151], v[68:71]
    buffer_load_dwordx4 v225, s[24:27], s50 offen offset:896 lds
    v_mfma_f32_16x16x32_bf16 v[72:75], v[208:211], a[152:155], v[72:75]
    v_mfma_f32_16x16x32_bf16 v[76:79], v[208:211], a[156:159], v[76:79]
    v_mfma_f32_16x16x32_bf16 v[80:83], v[212:215], a[144:147], v[80:83]
    s_add_u32 m0, s64, 4544
    ds_read_b64_tr_b16 v[208:209], v253 offset:32
    ds_read_b64_tr_b16 v[210:211], v253 offset:544
    v_mfma_f32_16x16x32_bf16 v[84:87], v[212:215], a[148:151], v[84:87]
    buffer_load_dwordx4 v225, s[24:27], s50 offen offset:1792 lds
    v_mfma_f32_16x16x32_bf16 v[88:91], v[212:215], a[152:155], v[88:91]
    v_mfma_f32_16x16x32_bf16 v[92:95], v[212:215], a[156:159], v[92:95]
    s_waitcnt lgkmcnt(4)
    v_mfma_f32_16x16x32_bf16 v[96:99], v[216:219], a[144:147], v[96:99]
    s_add_u32 m0, s64, 4704
    ds_read_b64_tr_b16 v[212:213], v253 offset:64
    ds_read_b64_tr_b16 v[214:215], v253 offset:576
    v_mfma_f32_16x16x32_bf16 v[100:103], v[216:219], a[148:151], v[100:103]
    buffer_load_dwordx4 v225, s[24:27], s50 offen offset:2688 lds
    v_mfma_f32_16x16x32_bf16 v[104:107], v[216:219], a[152:155], v[104:107]
    v_mfma_f32_16x16x32_bf16 v[108:111], v[216:219], a[156:159], v[108:111]
    s_waitcnt vmcnt(8)
    s_barrier
    s_waitcnt lgkmcnt(4)
    v_mfma_f32_16x16x32_bf16 v[0:3], v[220:223], a[160:163], v[0:3]
    s_add_u32 s50, s63, 372736
    s_add_u32 m0, s65, 0
    ds_read_b64_tr_b16 v[216:217], v253 offset:96
    ds_read_b64_tr_b16 v[218:219], v253 offset:608
    v_mfma_f32_16x16x32_bf16 v[4:7], v[220:223], a[164:167], v[4:7]
    buffer_load_dwordx4 v225, s[24:27], s50 offen offset:0 lds
    v_mfma_f32_16x16x32_bf16 v[8:11], v[220:223], a[168:171], v[8:11]
    v_mfma_f32_16x16x32_bf16 v[12:15], v[220:223], a[172:175], v[12:15]
    s_waitcnt lgkmcnt(2)
    v_mfma_f32_16x16x32_bf16 v[16:19], v[208:211], a[160:163], v[16:19]
    s_add_u32 m0, s65, 160
    ds_read_b64_tr_b16 v[220:221], v253 offset:128
    ds_read_b64_tr_b16 v[222:223], v253 offset:640
    v_mfma_f32_16x16x32_bf16 v[20:23], v[208:211], a[164:167], v[20:23]
    buffer_load_dwordx4 v225, s[24:27], s50 offen offset:896 lds
    v_mfma_f32_16x16x32_bf16 v[24:27], v[208:211], a[168:171], v[24:27]
    v_mfma_f32_16x16x32_bf16 v[28:31], v[208:211], a[172:175], v[28:31]
    v_mfma_f32_16x16x32_bf16 v[32:35], v[212:215], a[160:163], v[32:35]
    s_add_u32 m0, s65, 320
    ds_read_b64_tr_b16 v[208:209], v253 offset:160
    ds_read_b64_tr_b16 v[210:211], v253 offset:672
    v_mfma_f32_16x16x32_bf16 v[36:39], v[212:215], a[164:167], v[36:39]
    buffer_load_dwordx4 v225, s[24:27], s50 offen offset:1792 lds
    v_mfma_f32_16x16x32_bf16 v[40:43], v[212:215], a[168:171], v[40:43]
    v_mfma_f32_16x16x32_bf16 v[44:47], v[212:215], a[172:175], v[44:47]
    s_waitcnt lgkmcnt(2)
    v_mfma_f32_16x16x32_bf16 v[48:51], v[216:219], a[160:163], v[48:51]
    s_add_u32 m0, s65, 480
    ds_read_b64_tr_b16 v[212:213], v253 offset:192
    ds_read_b64_tr_b16 v[214:215], v253 offset:704
    v_mfma_f32_16x16x32_bf16 v[52:55], v[216:219], a[164:167], v[52:55]
    buffer_load_dwordx4 v225, s[24:27], s50 offen offset:2688 lds
    s_add_u32 s50, s63, 376320
    s_add_u32 m0, s65, 4224
    v_mfma_f32_16x16x32_bf16 v[56:59], v[216:219], a[168:171], v[56:59]
    buffer_load_dwordx4 v225, s[24:27], s50 offen offset:0 lds
    v_mfma_f32_16x16x32_bf16 v[60:63], v[216:219], a[172:175], v[60:63]
    v_mfma_f32_16x16x32_bf16 v[64:67], v[220:223], a[160:163], v[64:67]
    s_add_u32 m0, s65, 4384
    ds_read_b64_tr_b16 v[216:217], v253 offset:33792
    ds_read_b64_tr_b16 v[218:219], v253 offset:34304
    v_mfma_f32_16x16x32_bf16 v[68:71], v[220:223], a[164:167], v[68:71]
    buffer_load_dwordx4 v225, s[24:27], s50 offen offset:896 lds
    v_mfma_f32_16x16x32_bf16 v[72:75], v[220:223], a[168:171], v[72:75]
    v_mfma_f32_16x16x32_bf16 v[76:79], v[220:223], a[172:175], v[76:79]
    s_waitcnt lgkmcnt(2)
    v_mfma_f32_16x16x32_bf16 v[80:83], v[208:211], a[160:163], v[80:83]
    s_add_u32 m0, s65, 4544
    ds_read_b64_tr_b16 v[220:221], v253 offset:33824
    ds_read_b64_tr_b16 v[222:223], v253 offset:34336
    v_mfma_f32_16x16x32_bf16 v[84:87], v[208:211], a[164:167], v[84:87]
    buffer_load_dwordx4 v225, s[24:27], s50 offen offset:1792 lds
    v_mfma_f32_16x16x32_bf16 v[88:91], v[208:211], a[168:171], v[88:91]
    v_mfma_f32_16x16x32_bf16 v[92:95], v[208:211], a[172:175], v[92:95]
    v_mfma_f32_16x16x32_bf16 v[96:99], v[212:215], a[160:163], v[96:99]
    s_add_u32 m0, s65, 4704
    ds_read_b64_tr_b16 v[208:209], v253 offset:33856
    ds_read_b64_tr_b16 v[210:211], v253 offset:34368
    v_mfma_f32_16x16x32_bf16 v[100:103], v[212:215], a[164:167], v[100:103]
    buffer_load_dwordx4 v225, s[24:27], s50 offen offset:2688 lds
    v_mfma_f32_16x16x32_bf16 v[104:107], v[212:215], a[168:171], v[104:107]
    v_mfma_f32_16x16x32_bf16 v[108:111], v[212:215], a[172:175], v[108:111]
    s_waitcnt vmcnt(8)
    s_barrier
    s_waitcnt lgkmcnt(2)
    v_mfma_f32_16x16x32_bf16 v[0:3], v[216:219], a[176:179], v[0:3]
    s_add_u32 s50, s63, 401408
    s_add_u32 m0, s66, 0
    ds_read_b64_tr_b16 v[212:213], v253 offset:33888
    ds_read_b64_tr_b16 v[214:215], v253 offset:34400
    v_mfma_f32_16x16x32_bf16 v[4:7], v[216:219], a[180:183], v[4:7]
    buffer_load_dwordx4 v225, s[24:27], s50 offen offset:0 lds
    v_mfma_f32_16x16x32_bf16 v[8:11], v[216:219], a[184:187], v[8:11]
    v_mfma_f32_16x16x32_bf16 v[12:15], v[216:219], a[188:191], v[12:15]
    v_mfma_f32_16x16x32_bf16 v[16:19], v[220:223], a[176:179], v[16:19]
    s_add_u32 m0, s66, 160
    ds_read_b64_tr_b16 v[216:217], v253 offset:33920
    ds_read_b64_tr_b16 v[218:219], v253 offset:34432
    v_mfma_f32_16x16x32_bf16 v[20:23], v[220:223], a[180:183], v[20:23]
    buffer_load_dwordx4 v225, s[24:27], s50 offen offset:896 lds
    v_mfma_f32_16x16x32_bf16 v[24:27], v[220:223], a[184:187], v[24:27]
    v_mfma_f32_16x16x32_bf16 v[28:31], v[220:223], a[188:191], v[28:31]
    s_waitcnt lgkmcnt(2)
    v_mfma_f32_16x16x32_bf16 v[32:35], v[208:211], a[176:179], v[32:35]
    s_add_u32 m0, s66, 320
    ds_read_b64_tr_b16 v[220:221], v253 offset:33952
    ds_read_b64_tr_b16 v[222:223], v253 offset:34464
    v_mfma_f32_16x16x32_bf16 v[36:39], v[208:211], a[180:183], v[36:39]
    buffer_load_dwordx4 v225, s[24:27], s50 offen offset:1792 lds
    v_mfma_f32_16x16x32_bf16 v[40:43], v[208:211], a[184:187], v[40:43]
    v_mfma_f32_16x16x32_bf16 v[44:47], v[208:211], a[188:191], v[44:47]
    v_mfma_f32_16x16x32_bf16 v[48:51], v[212:215], a[176:179], v[48:51]
    s_add_u32 m0, s66, 480
    ds_read_b64_tr_b16 v[208:209], v253 offset:33984
    ds_read_b64_tr_b16 v[210:211], v253 offset:34496
    v_mfma_f32_16x16x32_bf16 v[52:55], v[212:215], a[180:183], v[52:55]
    buffer_load_dwordx4 v225, s[24:27], s50 offen offset:2688 lds
    s_add_u32 s50, s63, 404992
    s_add_u32 m0, s66, 4224
    v_mfma_f32_16x16x32_bf16 v[56:59], v[212:215], a[184:187], v[56:59]
    buffer_load_dwordx4 v225, s[24:27], s50 offen offset:0 lds
    v_mfma_f32_16x16x32_bf16 v[60:63], v[212:215], a[188:191], v[60:63]
    s_waitcnt lgkmcnt(2)
    v_mfma_f32_16x16x32_bf16 v[64:67], v[216:219], a[176:179], v[64:67]
    s_add_u32 m0, s66, 4384
    ds_read_b64_tr_b16 v[212:213], v252 offset:0
    ds_read_b64_tr_b16 v[214:215], v252 offset:512
    v_mfma_f32_16x16x32_bf16 v[68:71], v[216:219], a[180:183], v[68:71]
    buffer_load_dwordx4 v225, s[24:27], s50 offen offset:896 lds
    v_mfma_f32_16x16x32_bf16 v[72:75], v[216:219], a[184:187], v[72:75]
    v_mfma_f32_16x16x32_bf16 v[76:79], v[216:219], a[188:191], v[76:79]
    v_mfma_f32_16x16x32_bf16 v[80:83], v[220:223], a[176:179], v[80:83]
    s_add_u32 m0, s66, 4544
    ds_read_b64_tr_b16 v[216:217], v252 offset:32
    ds_read_b64_tr_b16 v[218:219], v252 offset:544
    v_mfma_f32_16x16x32_bf16 v[84:87], v[220:223], a[180:183], v[84:87]
    buffer_load_dwordx4 v225, s[24:27], s50 offen offset:1792 lds
    v_mfma_f32_16x16x32_bf16 v[88:91], v[220:223], a[184:187], v[88:91]
    v_mfma_f32_16x16x32_bf16 v[92:95], v[220:223], a[188:191], v[92:95]
    s_waitcnt lgkmcnt(4)
    v_mfma_f32_16x16x32_bf16 v[96:99], v[208:211], a[176:179], v[96:99]
    s_add_u32 m0, s66, 4704
    ds_read_b64_tr_b16 v[220:221], v252 offset:64
    ds_read_b64_tr_b16 v[222:223], v252 offset:576
    v_mfma_f32_16x16x32_bf16 v[100:103], v[208:211], a[180:183], v[100:103]
    buffer_load_dwordx4 v225, s[24:27], s50 offen offset:2688 lds
    v_mfma_f32_16x16x32_bf16 v[104:107], v[208:211], a[184:187], v[104:107]
    v_mfma_f32_16x16x32_bf16 v[108:111], v[208:211], a[188:191], v[108:111]
    s_waitcnt vmcnt(8)
    s_barrier
    s_waitcnt lgkmcnt(0)
    s_mov_b32 s101, 0
    s_xor_b32 s8, s8, s59
    s_or_b32 s101, s101, s8
    s_xor_b32 s9, s9, s59
    s_or_b32 s101, s101, s9
    s_xor_b32 s10, s10, s59
    s_or_b32 s101, s101, s10
    s_xor_b32 s11, s11, s59
    s_or_b32 s101, s101, s11
    s_xor_b32 s12, s12, s59
    s_or_b32 s101, s101, s12
    s_xor_b32 s13, s13, s59
    s_or_b32 s101, s101, s13
    s_xor_b32 s14, s14, s59
    s_or_b32 s101, s101, s14
    s_xor_b32 s15, s15, s59
    s_or_b32 s101, s101, s15
    s_cmp_eq_u32 s101, 0
    s_cselect_b32 s51, 1, 0
    s_mul_i32 s55, s44, 7
    s_add_u32 s55, s55, s3
    s_mul_i32 s60, s45, 57344
    s_lshl_b32 s56, s55, 10
    s_add_u32 s60, s60, s56
    s_mul_hi_u32 s56, s55, 0x12492493
    s_mul_i32 s57, s56, 14
    s_sub_u32 s57, s55, s57
    s_mul_i32 s56, s56, 112
    s_lshr_b32 s55, s57, 1
    s_lshl_b32 s55, s55, 4
    s_add_u32 s56, s56, s55
    s_lshl_b32 s46, s56, 1
    s_and_b32 s57, s57, 1
    s_lshl_b32 s57, s57, 5
    s_lshl_b32 s55, s45, 6
    s_add_u32 s57, s57, s55
    s_mul_i32 s57, s57, 896
    s_add_u32 s62, s57, s46
    s_mul_i32 s55, s44, 7
    s_add_u32 s55, s55, s3
    s_add_u32 s55, s55, 4
    s_mul_i32 s61, s45, 57344
    s_lshl_b32 s56, s55, 10
    s_add_u32 s61, s61, s56
    s_mul_hi_u32 s56, s55, 0x12492493
    s_mul_i32 s57, s56, 14
    s_sub_u32 s57, s55, s57
    s_mul_i32 s56, s56, 112
    s_lshr_b32 s55, s57, 1
    s_lshl_b32 s55, s55, 4
    s_add_u32 s56, s56, s55
    s_lshl_b32 s58, s56, 1
    s_and_b32 s57, s57, 1
    s_lshl_b32 s57, s57, 5
    s_lshl_b32 s55, s45, 6
    s_add_u32 s57, s57, s55
    s_mul_i32 s57, s57, 896
    s_add_u32 s47, s57, s58
    s_cmp_lt_u32 s3, 3
    s_cselect_b32 s61, s61, 0x40000000
    s_cselect_b32 s47, s47, 0x40000000
    s_cselect_b32 s58, s58, 0x40000000
    v_mfma_f32_16x16x32_bf16 v[0:3], v[212:215], a[192:195], v[0:3]
    s_add_u32 s50, s63, 430080
    s_add_u32 m0, s67, 0
    ds_read_b64_tr_b16 v[208:209], v252 offset:96
    ds_read_b64_tr_b16 v[210:211], v252 offset:608
    v_mfma_f32_16x16x32_bf16 v[4:7], v[212:215], a[196:199], v[4:7]
    buffer_load_dwordx4 v225, s[24:27], s50 offen offset:0 lds
    v_mfma_f32_16x16x32_bf16 v[8:11], v[212:215], a[200:203], v[8:11]
    v_mfma_f32_16x16x32_bf16 v[12:15], v[212:215], a[204:207], v[12:15]
    v_mfma_f32_16x16x32_bf16 v[16:19], v[216:219], a[192:195], v[16:19]
    s_add_u32 m0, s67, 160
    ds_read_b64_tr_b16 v[212:213], v252 offset:128
    ds_read_b64_tr_b16 v[214:215], v252 offset:640
    v_mfma_f32_16x16x32_bf16 v[20:23], v[216:219], a[196:199], v[20:23]
    buffer_load_dwordx4 v225, s[24:27], s50 offen offset:896 lds
    v_mfma_f32_16x16x32_bf16 v[24:27], v[216:219], a[200:203], v[24:27]
    v_mfma_f32_16x16x32_bf16 v[28:31], v[216:219], a[204:207], v[28:31]
    v_mfma_f32_16x16x32_bf16 v[32:35], v[220:223], a[192:195], v[32:35]
    s_add_u32 m0, s67, 320
    ds_read_b64_tr_b16 v[216:217], v252 offset:160
    ds_read_b64_tr_b16 v[218:219], v252 offset:672
    v_mfma_f32_16x16x32_bf16 v[36:39], v[220:223], a[196:199], v[36:39]
    buffer_load_dwordx4 v225, s[24:27], s50 offen offset:1792 lds
    v_mfma_f32_16x16x32_bf16 v[40:43], v[220:223], a[200:203], v[40:43]
    v_mfma_f32_16x16x32_bf16 v[44:47], v[220:223], a[204:207], v[44:47]
    s_waitcnt lgkmcnt(2)
    v_mfma_f32_16x16x32_bf16 v[48:51], v[208:211], a[192:195], v[48:51]
    s_add_u32 m0, s67, 480
    ds_read_b64_tr_b16 v[220:221], v252 offset:192
    ds_read_b64_tr_b16 v[222:223], v252 offset:704
    v_mfma_f32_16x16x32_bf16 v[52:55], v[208:211], a[196:199], v[52:55]
    buffer_load_dwordx4 v225, s[24:27], s50 offen offset:2688 lds
    s_add_u32 s50, s63, 433664
    s_add_u32 m0, s67, 4224
    v_mfma_f32_16x16x32_bf16 v[56:59], v[208:211], a[200:203], v[56:59]
    buffer_load_dwordx4 v225, s[24:27], s50 offen offset:0 lds
    v_mfma_f32_16x16x32_bf16 v[60:63], v[208:211], a[204:207], v[60:63]
    v_mfma_f32_16x16x32_bf16 v[64:67], v[212:215], a[192:195], v[64:67]
    s_add_u32 m0, s67, 4384
    ds_read_b64_tr_b16 v[208:209], v252 offset:33792
    ds_read_b64_tr_b16 v[210:211], v252 offset:34304
    v_mfma_f32_16x16x32_bf16 v[68:71], v[212:215], a[196:199], v[68:71]
    buffer_load_dwordx4 v225, s[24:27], s50 offen offset:896 lds
    v_mfma_f32_16x16x32_bf16 v[72:75], v[212:215], a[200:203], v[72:75]
    v_mfma_f32_16x16x32_bf16 v[76:79], v[212:215], a[204:207], v[76:79]
    s_waitcnt lgkmcnt(2)
    v_mfma_f32_16x16x32_bf16 v[80:83], v[216:219], a[192:195], v[80:83]
    s_add_u32 m0, s67, 4544
    ds_read_b64_tr_b16 v[212:213], v252 offset:33824
    ds_read_b64_tr_b16 v[214:215], v252 offset:34336
    v_mfma_f32_16x16x32_bf16 v[84:87], v[216:219], a[196:199], v[84:87]
    buffer_load_dwordx4 v225, s[24:27], s50 offen offset:1792 lds
    v_mfma_f32_16x16x32_bf16 v[88:91], v[216:219], a[200:203], v[88:91]
    v_mfma_f32_16x16x32_bf16 v[92:95], v[216:219], a[204:207], v[92:95]
    v_mfma_f32_16x16x32_bf16 v[96:99], v[220:223], a[192:195], v[96:99]
    s_add_u32 m0, s67, 4704
    ds_read_b64_tr_b16 v[216:217], v252 offset:33856
    ds_read_b64_tr_b16 v[218:219], v252 offset:34368
    v_mfma_f32_16x16x32_bf16 v[100:103], v[220:223], a[196:199], v[100:103]
    buffer_load_dwordx4 v225, s[24:27], s50 offen offset:2688 lds
    v_mfma_f32_16x16x32_bf16 v[104:107], v[220:223], a[200:203], v[104:107]
    v_mfma_f32_16x16x32_bf16 v[108:111], v[220:223], a[204:207], v[108:111]
    s_waitcnt vmcnt(8)
    s_barrier
    s_waitcnt lgkmcnt(2)
    v_mfma_f32_16x16x32_bf16 v[0:3], v[208:211], a[208:211], v[0:3]
    ds_read_b64_tr_b16 v[220:221], v252 offset:33888
    ds_read_b64_tr_b16 v[222:223], v252 offset:34400
    v_mfma_f32_16x16x32_bf16 v[4:7], v[208:211], a[212:215], v[4:7]
    s_add_u32 s101, s60, 16777216
    v_mfma_f32_16x16x32_bf16 v[8:11], v[208:211], a[216:219], v[8:11]
    buffer_load_dwordx4 v[112:115], v204, s[36:39], s101 offen sc1
    s_add_u32 s101, s60, 18612224
    v_mfma_f32_16x16x32_bf16 v[12:15], v[208:211], a[220:223], v[12:15]
    v_mfma_f32_16x16x32_bf16 v[16:19], v[212:215], a[208:211], v[16:19]
    ds_read_b64_tr_b16 v[208:209], v252 offset:33920
    ds_read_b64_tr_b16 v[210:211], v252 offset:34432
    v_mfma_f32_16x16x32_bf16 v[20:23], v[212:215], a[212:215], v[20:23]
    v_mfma_f32_16x16x32_bf16 v[24:27], v[212:215], a[216:219], v[24:27]
    buffer_load_dwordx4 v[116:119], v204, s[36:39], s101 offen sc1
    s_add_u32 s101, s60, 20447232
    v_mfma_f32_16x16x32_bf16 v[28:31], v[212:215], a[220:223], v[28:31]
    s_waitcnt lgkmcnt(2)
    v_mfma_f32_16x16x32_bf16 v[32:35], v[216:219], a[208:211], v[32:35]
    ds_read_b64_tr_b16 v[212:213], v252 offset:33952
    ds_read_b64_tr_b16 v[214:215], v252 offset:34464
    v_mfma_f32_16x16x32_bf16 v[36:39], v[216:219], a[212:215], v[36:39]
    v_mfma_f32_16x16x32_bf16 v[40:43], v[216:219], a[216:219], v[40:43]
    buffer_load_dwordx4 v[120:123], v204, s[36:39], s101 offen sc1
    s_add_u32 s101, s60, 22282240
    v_mfma_f32_16x16x32_bf16 v[44:47], v[216:219], a[220:223], v[44:47]
    v_mfma_f32_16x16x32_bf16 v[48:51], v[220:223], a[208:211], v[48:51]
    ds_read_b64_tr_b16 v[216:217], v252 offset:33984
    ds_read_b64_tr_b16 v[218:219], v252 offset:34496
    v_mfma_f32_16x16x32_bf16 v[52:55], v[220:223], a[212:215], v[52:55]
    v_mfma_f32_16x16x32_bf16 v[56:59], v[220:223], a[216:219], v[56:59]
    buffer_load_dwordx4 v[124:127], v204, s[36:39], s101 offen sc1
    s_add_u32 s101, s60, 24117248
    v_mfma_f32_16x16x32_bf16 v[60:63], v[220:223], a[220:223], v[60:63]
    s_waitcnt lgkmcnt(2)
    v_mfma_f32_16x16x32_bf16 v[64:67], v[208:211], a[208:211], v[64:67]
    ds_read_b64_tr_b16 v[220:221], v253 offset:0
    ds_read_b64_tr_b16 v[222:223], v253 offset:512
    v_mfma_f32_16x16x32_bf16 v[68:71], v[208:211], a[212:215], v[68:71]
    v_mfma_f32_16x16x32_bf16 v[72:75], v[208:211], a[216:219], v[72:75]
    buffer_load_dwordx4 v[128:131], v204, s[36:39], s101 offen sc1
    s_add_u32 s101, s60, 25952256
    v_mfma_f32_16x16x32_bf16 v[76:79], v[208:211], a[220:223], v[76:79]
    v_mfma_f32_16x16x32_bf16 v[80:83], v[212:215], a[208:211], v[80:83]
    ds_read_b64_tr_b16 v[208:209], v253 offset:32
    ds_read_b64_tr_b16 v[210:211], v253 offset:544
    v_mfma_f32_16x16x32_bf16 v[84:87], v[212:215], a[212:215], v[84:87]
    v_mfma_f32_16x16x32_bf16 v[88:91], v[212:215], a[216:219], v[88:91]
    buffer_load_dwordx4 v[132:135], v204, s[36:39], s101 offen sc1
    s_add_u32 s101, s60, 27787264
    v_mfma_f32_16x16x32_bf16 v[92:95], v[212:215], a[220:223], v[92:95]
    s_waitcnt lgkmcnt(4)
    v_mfma_f32_16x16x32_bf16 v[96:99], v[216:219], a[208:211], v[96:99]
    ds_read_b64_tr_b16 v[212:213], v253 offset:64
    ds_read_b64_tr_b16 v[214:215], v253 offset:576
    v_mfma_f32_16x16x32_bf16 v[100:103], v[216:219], a[212:215], v[100:103]
    v_mfma_f32_16x16x32_bf16 v[104:107], v[216:219], a[216:219], v[104:107]
    buffer_load_dwordx4 v[136:139], v204, s[36:39], s101 offen sc1
    s_add_u32 s101, s60, 29622272
    v_mfma_f32_16x16x32_bf16 v[108:111], v[216:219], a[220:223], v[108:111]
    s_waitcnt vmcnt(7)
    s_barrier
    s_waitcnt lgkmcnt(4)
    v_mfma_f32_16x16x32_bf16 v[0:3], v[220:223], a[224:227], v[0:3]
    ds_read_b64_tr_b16 v[216:217], v253 offset:96
    ds_read_b64_tr_b16 v[218:219], v253 offset:608
    v_mfma_f32_16x16x32_bf16 v[4:7], v[220:223], a[228:231], v[4:7]
    v_mfma_f32_16x16x32_bf16 v[8:11], v[220:223], a[232:235], v[8:11]
    buffer_load_dwordx4 v[140:143], v204, s[36:39], s101 offen sc1
    s_add_u32 s101, s61, 16777216
    v_mfma_f32_16x16x32_bf16 v[12:15], v[220:223], a[236:239], v[12:15]
    s_waitcnt lgkmcnt(2)
    v_mfma_f32_16x16x32_bf16 v[16:19], v[208:211], a[224:227], v[16:19]
    ds_read_b64_tr_b16 v[220:221], v253 offset:128
    ds_read_b64_tr_b16 v[222:223], v253 offset:640
    v_mfma_f32_16x16x32_bf16 v[20:23], v[208:211], a[228:231], v[20:23]
    v_mfma_f32_16x16x32_bf16 v[24:27], v[208:211], a[232:235], v[24:27]
    buffer_load_dwordx4 v[144:147], v204, s[36:39], s101 offen sc1
    s_add_u32 s101, s61, 18612224
    v_mfma_f32_16x16x32_bf16 v[28:31], v[208:211], a[236:239], v[28:31]
    v_mfma_f32_16x16x32_bf16 v[32:35], v[212:215], a[224:227], v[32:35]
    ds_read_b64_tr_b16 v[208:209], v253 offset:160
    ds_read_b64_tr_b16 v[210:211], v253 offset:672
    v_mfma_f32_16x16x32_bf16 v[36:39], v[212:215], a[228:231], v[36:39]
    buffer_load_dwordx4 v[148:151], v204, s[36:39], s101 offen sc1
    s_add_u32 s101, s61, 20447232
    v_mfma_f32_16x16x32_bf16 v[40:43], v[212:215], a[232:235], v[40:43]
    v_mfma_f32_16x16x32_bf16 v[44:47], v[212:215], a[236:239], v[44:47]
    s_waitcnt lgkmcnt(2)
    v_mfma_f32_16x16x32_bf16 v[48:51], v[216:219], a[224:227], v[48:51]
    ds_read_b64_tr_b16 v[212:213], v253 offset:192
    ds_read_b64_tr_b16 v[214:215], v253 offset:704
    v_mfma_f32_16x16x32_bf16 v[52:55], v[216:219], a[228:231], v[52:55]
    buffer_load_dwordx4 v[152:155], v204, s[36:39], s101 offen sc1
    s_add_u32 s101, s61, 22282240
    v_mfma_f32_16x16x32_bf16 v[56:59], v[216:219], a[232:235], v[56:59]
    v_mfma_f32_16x16x32_bf16 v[60:63], v[216:219], a[236:239], v[60:63]
    v_mfma_f32_16x16x32_bf16 v[64:67], v[220:223], a[224:227], v[64:67]
    ds_read_b64_tr_b16 v[216:217], v253 offset:33792
    ds_read_b64_tr_b16 v[218:219], v253 offset:34304
    v_mfma_f32_16x16x32_bf16 v[68:71], v[220:223], a[228:231], v[68:71]
    buffer_load_dwordx4 v[156:159], v204, s[36:39], s101 offen sc1
    s_add_u32 s101, s61, 24117248
    v_mfma_f32_16x16x32_bf16 v[72:75], v[220:223], a[232:235], v[72:75]
    v_mfma_f32_16x16x32_bf16 v[76:79], v[220:223], a[236:239], v[76:79]
    s_waitcnt lgkmcnt(2)
    v_mfma_f32_16x16x32_bf16 v[80:83], v[208:211], a[224:227], v[80:83]
    ds_read_b64_tr_b16 v[220:221], v253 offset:33824
    ds_read_b64_tr_b16 v[222:223], v253 offset:34336
    v_mfma_f32_16x16x32_bf16 v[84:87], v[208:211], a[228:231], v[84:87]
    buffer_load_dwordx4 v[160:163], v204, s[36:39], s101 offen sc1
    s_add_u32 s101, s61, 25952256
    v_mfma_f32_16x16x32_bf16 v[88:91], v[208:211], a[232:235], v[88:91]
    v_mfma_f32_16x16x32_bf16 v[92:95], v[208:211], a[236:239], v[92:95]
    v_mfma_f32_16x16x32_bf16 v[96:99], v[212:215], a[224:227], v[96:99]
    ds_read_b64_tr_b16 v[208:209], v253 offset:33856
    ds_read_b64_tr_b16 v[210:211], v253 offset:34368
    v_mfma_f32_16x16x32_bf16 v[100:103], v[212:215], a[228:231], v[100:103]
    buffer_load_dwordx4 v[164:167], v204, s[36:39], s101 offen sc1
    s_add_u32 s101, s61, 27787264
    v_mfma_f32_16x16x32_bf16 v[104:107], v[212:215], a[232:235], v[104:107]
    v_mfma_f32_16x16x32_bf16 v[108:111], v[212:215], a[236:239], v[108:111]
    s_barrier
    s_waitcnt lgkmcnt(2)
    v_mfma_f32_16x16x32_bf16 v[0:3], v[216:219], a[240:243], v[0:3]
    ds_read_b64_tr_b16 v[212:213], v253 offset:33888
    ds_read_b64_tr_b16 v[214:215], v253 offset:34400
    v_mfma_f32_16x16x32_bf16 v[4:7], v[216:219], a[244:247], v[4:7]
    buffer_load_dwordx4 v[168:171], v204, s[36:39], s101 offen sc1
    s_add_u32 s101, s61, 29622272
    v_mfma_f32_16x16x32_bf16 v[8:11], v[216:219], a[248:251], v[8:11]
    v_mfma_f32_16x16x32_bf16 v[12:15], v[216:219], a[252:255], v[12:15]
    v_mfma_f32_16x16x32_bf16 v[16:19], v[220:223], a[240:243], v[16:19]
    ds_read_b64_tr_b16 v[216:217], v253 offset:33920
    ds_read_b64_tr_b16 v[218:219], v253 offset:34432
    v_mfma_f32_16x16x32_bf16 v[20:23], v[220:223], a[244:247], v[20:23]
    buffer_load_dwordx4 v[172:175], v204, s[36:39], s101 offen sc1
    v_mfma_f32_16x16x32_bf16 v[24:27], v[220:223], a[248:251], v[24:27]
    v_mfma_f32_16x16x32_bf16 v[28:31], v[220:223], a[252:255], v[28:31]
    s_waitcnt lgkmcnt(2)
    v_mfma_f32_16x16x32_bf16 v[32:35], v[208:211], a[240:243], v[32:35]
    ds_read_b64_tr_b16 v[220:221], v253 offset:33952
    ds_read_b64_tr_b16 v[222:223], v253 offset:34464
    v_mfma_f32_16x16x32_bf16 v[36:39], v[208:211], a[244:247], v[36:39]
    buffer_load_dwordx2 v[192:193], v205, s[16:19], s62 offen
    s_add_u32 s101, s62, 14336
    v_mfma_f32_16x16x32_bf16 v[40:43], v[208:211], a[248:251], v[40:43]
    v_mfma_f32_16x16x32_bf16 v[44:47], v[208:211], a[252:255], v[44:47]
    v_mfma_f32_16x16x32_bf16 v[48:51], v[212:215], a[240:243], v[48:51]
    ds_read_b64_tr_b16 v[208:209], v253 offset:33984
    ds_read_b64_tr_b16 v[210:211], v253 offset:34496
    v_mfma_f32_16x16x32_bf16 v[52:55], v[212:215], a[244:247], v[52:55]
    buffer_load_dwordx2 v[194:195], v205, s[16:19], s101 offen
    v_mfma_f32_16x16x32_bf16 v[56:59], v[212:215], a[248:251], v[56:59]
    v_mfma_f32_16x16x32_bf16 v[60:63], v[212:215], a[252:255], v[60:63]
    s_waitcnt lgkmcnt(2)
    v_mfma_f32_16x16x32_bf16 v[64:67], v[216:219], a[240:243], v[64:67]
    buffer_load_dwordx2 v[200:201], v206, s[20:23], s46 offen
    v_mfma_f32_16x16x32_bf16 v[68:71], v[216:219], a[244:247], v[68:71]
    v_mfma_f32_16x16x32_bf16 v[72:75], v[216:219], a[248:251], v[72:75]
    v_mfma_f32_16x16x32_bf16 v[76:79], v[216:219], a[252:255], v[76:79]
    buffer_load_dwordx2 v[196:197], v205, s[16:19], s47 offen
    s_add_u32 s101, s47, 14336
    v_mfma_f32_16x16x32_bf16 v[80:83], v[220:223], a[240:243], v[80:83]
    v_mfma_f32_16x16x32_bf16 v[84:87], v[220:223], a[244:247], v[84:87]
    v_mfma_f32_16x16x32_bf16 v[88:91], v[220:223], a[248:251], v[88:91]
    v_mfma_f32_16x16x32_bf16 v[92:95], v[220:223], a[252:255], v[92:95]
    s_waitcnt lgkmcnt(0)
    buffer_load_dwordx2 v[198:199], v205, s[16:19], s101 offen
    v_mfma_f32_16x16x32_bf16 v[96:99], v[208:211], a[240:243], v[96:99]
    v_mfma_f32_16x16x32_bf16 v[100:103], v[208:211], a[244:247], v[100:103]
    v_mfma_f32_16x16x32_bf16 v[104:107], v[208:211], a[248:251], v[104:107]
    buffer_load_dwordx2 v[202:203], v206, s[20:23], s58 offen
    v_mfma_f32_16x16x32_bf16 v[108:111], v[208:211], a[252:255], v[108:111]
    s_nop 7
    s_nop 1
    v_lshlrev_b32 v238, 4, v251
    s_lshl_b32 s100, s44, 5
    s_add_u32 s100, s100, s45
    s_lshl_b32 s100, s100, 2
    s_add_u32 s100, s100, s3
    s_mul_i32 s100, s100, 14336
    s_add_u32 s100, s100, 0
    v_cvt_pk_bf16_f32 v208, v0, v1
    v_cvt_pk_bf16_f32 v209, v2, v3
    v_cvt_pk_bf16_f32 v210, v4, v5
    v_cvt_pk_bf16_f32 v211, v6, v7
    buffer_store_dwordx4 v[208:211], v238, s[36:39], s100 offen sc1
    s_add_u32 s100, s100, 1024
    v_cvt_pk_bf16_f32 v212, v8, v9
    v_cvt_pk_bf16_f32 v213, v10, v11
    v_cvt_pk_bf16_f32 v214, v12, v13
    v_cvt_pk_bf16_f32 v215, v14, v15
    buffer_store_dwordx4 v[212:215], v238, s[36:39], s100 offen sc1
    s_add_u32 s100, s100, 1024
    v_cvt_pk_bf16_f32 v208, v16, v17
    v_cvt_pk_bf16_f32 v209, v18, v19
    v_cvt_pk_bf16_f32 v210, v20, v21
    v_cvt_pk_bf16_f32 v211, v22, v23
    buffer_store_dwordx4 v[208:211], v238, s[36:39], s100 offen sc1
    s_add_u32 s100, s100, 1024
    v_cvt_pk_bf16_f32 v212, v24, v25
    v_cvt_pk_bf16_f32 v213, v26, v27
    v_cvt_pk_bf16_f32 v214, v28, v29
    v_cvt_pk_bf16_f32 v215, v30, v31
    buffer_store_dwordx4 v[212:215], v238, s[36:39], s100 offen sc1
    s_add_u32 s100, s100, 1024
    v_cvt_pk_bf16_f32 v208, v32, v33
    v_cvt_pk_bf16_f32 v209, v34, v35
    v_cvt_pk_bf16_f32 v210, v36, v37
    v_cvt_pk_bf16_f32 v211, v38, v39
    buffer_store_dwordx4 v[208:211], v238, s[36:39], s100 offen sc1
    s_add_u32 s100, s100, 1024
    v_cvt_pk_bf16_f32 v212, v40, v41
    v_cvt_pk_bf16_f32 v213, v42, v43
    v_cvt_pk_bf16_f32 v214, v44, v45
    v_cvt_pk_bf16_f32 v215, v46, v47
    buffer_store_dwordx4 v[212:215], v238, s[36:39], s100 offen sc1
    s_add_u32 s100, s100, 1024
    v_cvt_pk_bf16_f32 v208, v48, v49
    v_cvt_pk_bf16_f32 v209, v50, v51
    v_cvt_pk_bf16_f32 v210, v52, v53
    v_cvt_pk_bf16_f32 v211, v54, v55
    buffer_store_dwordx4 v[208:211], v238, s[36:39], s100 offen sc1
    s_add_u32 s100, s100, 1024
    v_cvt_pk_bf16_f32 v212, v56, v57
    v_cvt_pk_bf16_f32 v213, v58, v59
    v_cvt_pk_bf16_f32 v214, v60, v61
    v_cvt_pk_bf16_f32 v215, v62, v63
    buffer_store_dwordx4 v[212:215], v238, s[36:39], s100 offen sc1
    s_add_u32 s100, s100, 1024
    v_cvt_pk_bf16_f32 v208, v64, v65
    v_cvt_pk_bf16_f32 v209, v66, v67
    v_cvt_pk_bf16_f32 v210, v68, v69
    v_cvt_pk_bf16_f32 v211, v70, v71
    buffer_store_dwordx4 v[208:211], v238, s[36:39], s100 offen sc1
    s_add_u32 s100, s100, 1024
    v_cvt_pk_bf16_f32 v212, v72, v73
    v_cvt_pk_bf16_f32 v213, v74, v75
    v_cvt_pk_bf16_f32 v214, v76, v77
    v_cvt_pk_bf16_f32 v215, v78, v79
    buffer_store_dwordx4 v[212:215], v238, s[36:39], s100 offen sc1
    s_add_u32 s100, s100, 1024
    v_cvt_pk_bf16_f32 v208, v80, v81
    v_cvt_pk_bf16_f32 v209, v82, v83
    v_cvt_pk_bf16_f32 v210, v84, v85
    v_cvt_pk_bf16_f32 v211, v86, v87
    buffer_store_dwordx4 v[208:211], v238, s[36:39], s100 offen sc1
    s_add_u32 s100, s100, 1024
    v_cvt_pk_bf16_f32 v212, v88, v89
    v_cvt_pk_bf16_f32 v213, v90, v91
    v_cvt_pk_bf16_f32 v214, v92, v93
    v_cvt_pk_bf16_f32 v215, v94, v95
    buffer_store_dwordx4 v[212:215], v238, s[36:39], s100 offen sc1
    s_add_u32 s100, s100, 1024
    v_cvt_pk_bf16_f32 v208, v96, v97
    v_cvt_pk_bf16_f32 v209, v98, v99
    v_cvt_pk_bf16_f32 v210, v100, v101
    v_cvt_pk_bf16_f32 v211, v102, v103
    buffer_store_dwordx4 v[208:211], v238, s[36:39], s100 offen sc1
    s_add_u32 s100, s100, 1024
    v_cvt_pk_bf16_f32 v212, v104, v105
    v_cvt_pk_bf16_f32 v213, v106, v107
    v_cvt_pk_bf16_f32 v214, v108, v109
    v_cvt_pk_bf16_f32 v215, v110, v111
    buffer_store_dwordx4 v[212:215], v238, s[36:39], s100 offen sc1
    s_add_u32 s100, s100, 1024
    s_waitcnt vmcnt(0)
    s_barrier
    s_cmp_lg_u32 s3, 0
    s_cbranch_scc1 L_posted
    s_lshl_b32 s100, s45, 2
    s_lshl_b32 s101, s45, 8
    s_add_u32 s101, s101, 33554560
    s_mov_b64 exec, 1
    s_lshl_b32 s55, s44, 2
    v_mov_b32 v2, s55
    v_mov_b32 v4, s59
    buffer_store_dword v4, v2, s[36:39], s101 offen sc1
    v_mov_b32 v0, 1
    v_mov_b32 v1, 0
    buffer_atomic_add v0, v1, s[32:35], s100 offen sc0
    s_mov_b64 exec, -1
L_posted:
    s_mov_b32 s50, 0xbfb8aa3b
    v_lshlrev_b32 v176, 16, v112
    v_and_b32 v177, 0xffff0000, v112
    v_lshlrev_b32 v178, 16, v113
    v_and_b32 v179, 0xffff0000, v113
    v_lshlrev_b32 v180, 16, v114
    v_and_b32 v181, 0xffff0000, v114
    v_lshlrev_b32 v182, 16, v115
    v_and_b32 v183, 0xffff0000, v115
    v_lshlrev_b32 v232, 16, v116
    v_and_b32 v233, 0xffff0000, v116
    v_pk_add_f32 v[176:177], v[176:177], v[232:233]
    v_lshlrev_b32 v232, 16, v117
    v_and_b32 v233, 0xffff0000, v117
    v_pk_add_f32 v[178:179], v[178:179], v[232:233]
    v_lshlrev_b32 v232, 16, v118
    v_and_b32 v233, 0xffff0000, v118
    v_pk_add_f32 v[180:181], v[180:181], v[232:233]
    v_lshlrev_b32 v232, 16, v119
    v_and_b32 v233, 0xffff0000, v119
    v_pk_add_f32 v[182:183], v[182:183], v[232:233]
    v_lshlrev_b32 v232, 16, v120
    v_and_b32 v233, 0xffff0000, v120
    v_pk_add_f32 v[176:177], v[176:177], v[232:233]
    v_lshlrev_b32 v232, 16, v121
    v_and_b32 v233, 0xffff0000, v121
    v_pk_add_f32 v[178:179], v[178:179], v[232:233]
    v_lshlrev_b32 v232, 16, v122
    v_and_b32 v233, 0xffff0000, v122
    v_pk_add_f32 v[180:181], v[180:181], v[232:233]
    v_lshlrev_b32 v232, 16, v123
    v_and_b32 v233, 0xffff0000, v123
    v_pk_add_f32 v[182:183], v[182:183], v[232:233]
    v_lshlrev_b32 v232, 16, v124
    v_and_b32 v233, 0xffff0000, v124
    v_pk_add_f32 v[176:177], v[176:177], v[232:233]
    v_lshlrev_b32 v232, 16, v125
    v_and_b32 v233, 0xffff0000, v125
    v_pk_add_f32 v[178:179], v[178:179], v[232:233]
    v_lshlrev_b32 v232, 16, v126
    v_and_b32 v233, 0xffff0000, v126
    v_pk_add_f32 v[180:181], v[180:181], v[232:233]
    v_lshlrev_b32 v232, 16, v127
    v_and_b32 v233, 0xffff0000, v127
    v_pk_add_f32 v[182:183], v[182:183], v[232:233]
    v_lshlrev_b32 v232, 16, v128
    v_and_b32 v233, 0xffff0000, v128
    v_pk_add_f32 v[176:177], v[176:177], v[232:233]
    v_lshlrev_b32 v232, 16, v129
    v_and_b32 v233, 0xffff0000, v129
    v_pk_add_f32 v[178:179], v[178:179], v[232:233]
    v_lshlrev_b32 v232, 16, v130
    v_and_b32 v233, 0xffff0000, v130
    v_pk_add_f32 v[180:181], v[180:181], v[232:233]
    v_lshlrev_b32 v232, 16, v131
    v_and_b32 v233, 0xffff0000, v131
    v_pk_add_f32 v[182:183], v[182:183], v[232:233]
    v_lshlrev_b32 v232, 16, v132
    v_and_b32 v233, 0xffff0000, v132
    v_pk_add_f32 v[176:177], v[176:177], v[232:233]
    v_lshlrev_b32 v232, 16, v133
    v_and_b32 v233, 0xffff0000, v133
    v_pk_add_f32 v[178:179], v[178:179], v[232:233]
    v_lshlrev_b32 v232, 16, v134
    v_and_b32 v233, 0xffff0000, v134
    v_pk_add_f32 v[180:181], v[180:181], v[232:233]
    v_lshlrev_b32 v232, 16, v135
    v_and_b32 v233, 0xffff0000, v135
    v_pk_add_f32 v[182:183], v[182:183], v[232:233]
    v_lshlrev_b32 v232, 16, v136
    v_and_b32 v233, 0xffff0000, v136
    v_pk_add_f32 v[176:177], v[176:177], v[232:233]
    v_lshlrev_b32 v232, 16, v137
    v_and_b32 v233, 0xffff0000, v137
    v_pk_add_f32 v[178:179], v[178:179], v[232:233]
    v_lshlrev_b32 v232, 16, v138
    v_and_b32 v233, 0xffff0000, v138
    v_pk_add_f32 v[180:181], v[180:181], v[232:233]
    v_lshlrev_b32 v232, 16, v139
    v_and_b32 v233, 0xffff0000, v139
    v_pk_add_f32 v[182:183], v[182:183], v[232:233]
    v_lshlrev_b32 v232, 16, v140
    v_and_b32 v233, 0xffff0000, v140
    v_pk_add_f32 v[176:177], v[176:177], v[232:233]
    v_lshlrev_b32 v232, 16, v141
    v_and_b32 v233, 0xffff0000, v141
    v_pk_add_f32 v[178:179], v[178:179], v[232:233]
    v_lshlrev_b32 v232, 16, v142
    v_and_b32 v233, 0xffff0000, v142
    v_pk_add_f32 v[180:181], v[180:181], v[232:233]
    v_lshlrev_b32 v232, 16, v143
    v_and_b32 v233, 0xffff0000, v143
    v_pk_add_f32 v[182:183], v[182:183], v[232:233]
    v_lshlrev_b32 v234, 16, v200
    v_and_b32 v235, 0xffff0000, v200
    v_lshlrev_b32 v236, 16, v201
    v_and_b32 v237, 0xffff0000, v201
    v_add_f32 v176, v176, v234
    v_add_f32 v177, v177, v235
    v_add_f32 v178, v178, v236
    v_add_f32 v179, v179, v237
    v_add_f32 v180, v180, v234
    v_add_f32 v181, v181, v235
    v_add_f32 v182, v182, v236
    v_add_f32 v183, v183, v237
    v_mul_f32 v208, s50, v176
    v_mul_f32 v209, s50, v177
    v_mul_f32 v210, s50, v178
    v_mul_f32 v211, s50, v179
    v_mul_f32 v212, s50, v180
    v_mul_f32 v213, s50, v181
    v_mul_f32 v214, s50, v182
    v_mul_f32 v215, s50, v183
    v_exp_f32 v208, v208
    v_exp_f32 v209, v209
    v_exp_f32 v210, v210
    v_exp_f32 v211, v211
    v_exp_f32 v212, v212
    v_exp_f32 v213, v213
    v_exp_f32 v214, v214
    v_exp_f32 v215, v215
    v_add_f32 v208, 1.0, v208
    v_add_f32 v209, 1.0, v209
    v_add_f32 v210, 1.0, v210
    v_add_f32 v211, 1.0, v211
    v_add_f32 v212, 1.0, v212
    v_add_f32 v213, 1.0, v213
    v_add_f32 v214, 1.0, v214
    v_add_f32 v215, 1.0, v215
    v_rcp_f32 v208, v208
    v_rcp_f32 v209, v209
    v_rcp_f32 v210, v210
    v_rcp_f32 v211, v211
    v_rcp_f32 v212, v212
    v_rcp_f32 v213, v213
    v_rcp_f32 v214, v214
    v_rcp_f32 v215, v215
    s_nop 0
    v_mul_f32 v176, v176, v208
    v_mul_f32 v177, v177, v209
    v_mul_f32 v178, v178, v210
    v_mul_f32 v179, v179, v211
    v_mul_f32 v180, v180, v212
    v_mul_f32 v181, v181, v213
    v_mul_f32 v182, v182, v214
    v_mul_f32 v183, v183, v215
    v_lshlrev_b32 v184, 16, v144
    v_and_b32 v185, 0xffff0000, v144
    v_lshlrev_b32 v186, 16, v145
    v_and_b32 v187, 0xffff0000, v145
    v_lshlrev_b32 v188, 16, v146
    v_and_b32 v189, 0xffff0000, v146
    v_lshlrev_b32 v190, 16, v147
    v_and_b32 v191, 0xffff0000, v147
    v_lshlrev_b32 v232, 16, v148
    v_and_b32 v233, 0xffff0000, v148
    v_pk_add_f32 v[184:185], v[184:185], v[232:233]
    v_lshlrev_b32 v232, 16, v149
    v_and_b32 v233, 0xffff0000, v149
    v_pk_add_f32 v[186:187], v[186:187], v[232:233]
    v_lshlrev_b32 v232, 16, v150
    v_and_b32 v233, 0xffff0000, v150
    v_pk_add_f32 v[188:189], v[188:189], v[232:233]
    v_lshlrev_b32 v232, 16, v151
    v_and_b32 v233, 0xffff0000, v151
    v_pk_add_f32 v[190:191], v[190:191], v[232:233]
    v_lshlrev_b32 v232, 16, v152
    v_and_b32 v233, 0xffff0000, v152
    v_pk_add_f32 v[184:185], v[184:185], v[232:233]
    v_lshlrev_b32 v232, 16, v153
    v_and_b32 v233, 0xffff0000, v153
    v_pk_add_f32 v[186:187], v[186:187], v[232:233]
    v_lshlrev_b32 v232, 16, v154
    v_and_b32 v233, 0xffff0000, v154
    v_pk_add_f32 v[188:189], v[188:189], v[232:233]
    v_lshlrev_b32 v232, 16, v155
    v_and_b32 v233, 0xffff0000, v155
    v_pk_add_f32 v[190:191], v[190:191], v[232:233]
    v_lshlrev_b32 v232, 16, v156
    v_and_b32 v233, 0xffff0000, v156
    v_pk_add_f32 v[184:185], v[184:185], v[232:233]
    v_lshlrev_b32 v232, 16, v157
    v_and_b32 v233, 0xffff0000, v157
    v_pk_add_f32 v[186:187], v[186:187], v[232:233]
    v_lshlrev_b32 v232, 16, v158
    v_and_b32 v233, 0xffff0000, v158
    v_pk_add_f32 v[188:189], v[188:189], v[232:233]
    v_lshlrev_b32 v232, 16, v159
    v_and_b32 v233, 0xffff0000, v159
    v_pk_add_f32 v[190:191], v[190:191], v[232:233]
    v_lshlrev_b32 v232, 16, v160
    v_and_b32 v233, 0xffff0000, v160
    v_pk_add_f32 v[184:185], v[184:185], v[232:233]
    v_lshlrev_b32 v232, 16, v161
    v_and_b32 v233, 0xffff0000, v161
    v_pk_add_f32 v[186:187], v[186:187], v[232:233]
    v_lshlrev_b32 v232, 16, v162
    v_and_b32 v233, 0xffff0000, v162
    v_pk_add_f32 v[188:189], v[188:189], v[232:233]
    v_lshlrev_b32 v232, 16, v163
    v_and_b32 v233, 0xffff0000, v163
    v_pk_add_f32 v[190:191], v[190:191], v[232:233]
    v_lshlrev_b32 v232, 16, v164
    v_and_b32 v233, 0xffff0000, v164
    v_pk_add_f32 v[184:185], v[184:185], v[232:233]
    v_lshlrev_b32 v232, 16, v165
    v_and_b32 v233, 0xffff0000, v165
    v_pk_add_f32 v[186:187], v[186:187], v[232:233]
    v_lshlrev_b32 v232, 16, v166
    v_and_b32 v233, 0xffff0000, v166
    v_pk_add_f32 v[188:189], v[188:189], v[232:233]
    v_lshlrev_b32 v232, 16, v167
    v_and_b32 v233, 0xffff0000, v167
    v_pk_add_f32 v[190:191], v[190:191], v[232:233]
    v_lshlrev_b32 v232, 16, v168
    v_and_b32 v233, 0xffff0000, v168
    v_pk_add_f32 v[184:185], v[184:185], v[232:233]
    v_lshlrev_b32 v232, 16, v169
    v_and_b32 v233, 0xffff0000, v169
    v_pk_add_f32 v[186:187], v[186:187], v[232:233]
    v_lshlrev_b32 v232, 16, v170
    v_and_b32 v233, 0xffff0000, v170
    v_pk_add_f32 v[188:189], v[188:189], v[232:233]
    v_lshlrev_b32 v232, 16, v171
    v_and_b32 v233, 0xffff0000, v171
    v_pk_add_f32 v[190:191], v[190:191], v[232:233]
    v_lshlrev_b32 v232, 16, v172
    v_and_b32 v233, 0xffff0000, v172
    v_pk_add_f32 v[184:185], v[184:185], v[232:233]
    v_lshlrev_b32 v232, 16, v173
    v_and_b32 v233, 0xffff0000, v173
    v_pk_add_f32 v[186:187], v[186:187], v[232:233]
    v_lshlrev_b32 v232, 16, v174
    v_and_b32 v233, 0xffff0000, v174
    v_pk_add_f32 v[188:189], v[188:189], v[232:233]
    v_lshlrev_b32 v232, 16, v175
    v_and_b32 v233, 0xffff0000, v175
    v_pk_add_f32 v[190:191], v[190:191], v[232:233]
    v_lshlrev_b32 v234, 16, v202
    v_and_b32 v235, 0xffff0000, v202
    v_lshlrev_b32 v236, 16, v203
    v_and_b32 v237, 0xffff0000, v203
    v_add_f32 v184, v184, v234
    v_add_f32 v185, v185, v235
    v_add_f32 v186, v186, v236
    v_add_f32 v187, v187, v237
    v_add_f32 v188, v188, v234
    v_add_f32 v189, v189, v235
    v_add_f32 v190, v190, v236
    v_add_f32 v191, v191, v237
    v_mul_f32 v216, s50, v184
    v_mul_f32 v217, s50, v185
    v_mul_f32 v218, s50, v186
    v_mul_f32 v219, s50, v187
    v_mul_f32 v220, s50, v188
    v_mul_f32 v221, s50, v189
    v_mul_f32 v222, s50, v190
    v_mul_f32 v223, s50, v191
    v_exp_f32 v216, v216
    v_exp_f32 v217, v217
    v_exp_f32 v218, v218
    v_exp_f32 v219, v219
    v_exp_f32 v220, v220
    v_exp_f32 v221, v221
    v_exp_f32 v222, v222
    v_exp_f32 v223, v223
    v_add_f32 v216, 1.0, v216
    v_add_f32 v217, 1.0, v217
    v_add_f32 v218, 1.0, v218
    v_add_f32 v219, 1.0, v219
    v_add_f32 v220, 1.0, v220
    v_add_f32 v221, 1.0, v221
    v_add_f32 v222, 1.0, v222
    v_add_f32 v223, 1.0, v223
    v_rcp_f32 v216, v216
    v_rcp_f32 v217, v217
    v_rcp_f32 v218, v218
    v_rcp_f32 v219, v219
    v_rcp_f32 v220, v220
    v_rcp_f32 v221, v221
    v_rcp_f32 v222, v222
    v_rcp_f32 v223, v223
    s_nop 0
    v_mul_f32 v184, v184, v216
    v_mul_f32 v185, v185, v217
    v_mul_f32 v186, v186, v218
    v_mul_f32 v187, v187, v219
    v_mul_f32 v188, v188, v220
    v_mul_f32 v189, v189, v221
    v_mul_f32 v190, v190, v222
    v_mul_f32 v191, v191, v223
    s_cmp_lg_u32 s3, 0
    s_cbranch_scc1 L_sync_done
    v_lshlrev_b32 v3, 2, v251
    s_lshl_b32 s49, 1, s44
    s_mov_b32 s57, 64
    s_mov_b64 exec, 0xff
L_poll:
    s_cmp_eq_u32 s57, 0
    s_cbranch_scc1 L_abandon
    buffer_load_dword v5, v3, s[36:39], s101 offen sc1
    s_waitcnt vmcnt(0)
    v_cmp_eq_u32 vcc, s59, v5
    s_nop 4
    s_cmp_eq_u64 vcc, 0xff
    s_cbranch_scc1 L_polled
    s_sub_u32 s57, s57, 1
    s_sleep 4
    s_branch L_poll
L_abandon:
    s_mov_b64 exec, 1
    s_waitcnt vmcnt(0)
    v_readfirstlane_b32 s55, v0
    s_and_b32 s55, s55, 0xff
    s_cmp_eq_u32 s55, 7
    s_cbranch_scc1 L_polled
    s_add_u32 s56, s44, 8
    s_lshl_b32 s56, 1, s56
    v_mov_b32 v6, s56
    buffer_atomic_or v6, v1, s[32:35], s100 offen sc0
    s_waitcnt vmcnt(0)
    v_readfirstlane_b32 s55, v6
    s_and_b32 s55, s55, 0xff
    s_cmp_eq_u32 s55, 8
    s_cselect_b32 s49, s49, 0
    s_branch L_decided
L_polled:
    s_mov_b64 exec, 1
    v_readfirstlane_b32 s55, v0
    s_and_b32 s56, s55, 0xff
    s_cmp_eq_u32 s56, 7
    s_cbranch_scc0 L_decided
    s_bfe_u32 s56, s55, 0x80008
    s_or_b32 s49, s49, s56
L_decided:
    v_mov_b32 v0, s49
    v_mov_b32 v1, 135168
    ds_write_b32 v1, v0
    s_waitcnt lgkmcnt(0)
    s_mov_b64 exec, -1
L_sync_done:
    s_barrier
    v_mov_b32 v1, 135168
    ds_read_b32 v0, v1
    s_waitcnt lgkmcnt(0)
    v_readfirstlane_b32 s49, v0
L_shares:
    s_cmp_eq_u32 s49, 0
    s_cbranch_scc1 L_fin_done
    s_ff1_i32_b32 s48, s49
    s_bitset0_b32 s49, s48
    s_cmp_eq_u32 s48, s44
    s_cselect_b32 s100, s51, 0
    s_cmp_eq_u32 s100, 1
    s_cbranch_scc1 L_haveg
    s_mul_i32 s55, s48, 7
    s_add_u32 s55, s55, s3
    s_mul_i32 s60, s45, 57344
    s_lshl_b32 s56, s55, 10
    s_add_u32 s60, s60, s56
    s_mul_hi_u32 s56, s55, 0x12492493
    s_mul_i32 s57, s56, 14
    s_sub_u32 s57, s55, s57
    s_mul_i32 s56, s56, 112
    s_lshr_b32 s55, s57, 1
    s_lshl_b32 s55, s55, 4
    s_add_u32 s56, s56, s55
    s_lshl_b32 s46, s56, 1
    s_and_b32 s57, s57, 1
    s_lshl_b32 s57, s57, 5
    s_lshl_b32 s55, s45, 6
    s_add_u32 s57, s57, s55
    s_mul_i32 s57, s57, 896
    s_add_u32 s62, s57, s46
    s_mul_i32 s55, s48, 7
    s_add_u32 s55, s55, s3
    s_add_u32 s55, s55, 4
    s_mul_i32 s61, s45, 57344
    s_lshl_b32 s56, s55, 10
    s_add_u32 s61, s61, s56
    s_mul_hi_u32 s56, s55, 0x12492493
    s_mul_i32 s57, s56, 14
    s_sub_u32 s57, s55, s57
    s_mul_i32 s56, s56, 112
    s_lshr_b32 s55, s57, 1
    s_lshl_b32 s55, s55, 4
    s_add_u32 s56, s56, s55
    s_lshl_b32 s58, s56, 1
    s_and_b32 s57, s57, 1
    s_lshl_b32 s57, s57, 5
    s_lshl_b32 s55, s45, 6
    s_add_u32 s57, s57, s55
    s_mul_i32 s57, s57, 896
    s_add_u32 s47, s57, s58
    s_cmp_lt_u32 s3, 3
    s_cselect_b32 s61, s61, 0x40000000
    s_cselect_b32 s47, s47, 0x40000000
    s_cselect_b32 s58, s58, 0x40000000
    s_add_u32 s50, s60, 16777216
    buffer_load_dwordx4 v[112:115], v204, s[36:39], s50 offen sc1
    s_add_u32 s50, s60, 18612224
    buffer_load_dwordx4 v[116:119], v204, s[36:39], s50 offen sc1
    s_add_u32 s50, s60, 20447232
    buffer_load_dwordx4 v[120:123], v204, s[36:39], s50 offen sc1
    s_add_u32 s50, s60, 22282240
    buffer_load_dwordx4 v[124:127], v204, s[36:39], s50 offen sc1
    s_add_u32 s50, s60, 24117248
    buffer_load_dwordx4 v[128:131], v204, s[36:39], s50 offen sc1
    s_add_u32 s50, s60, 25952256
    buffer_load_dwordx4 v[132:135], v204, s[36:39], s50 offen sc1
    s_add_u32 s50, s60, 27787264
    buffer_load_dwordx4 v[136:139], v204, s[36:39], s50 offen sc1
    s_add_u32 s50, s60, 29622272
    buffer_load_dwordx4 v[140:143], v204, s[36:39], s50 offen sc1
    s_add_u32 s50, s61, 16777216
    buffer_load_dwordx4 v[144:147], v204, s[36:39], s50 offen sc1
    s_add_u32 s50, s61, 18612224
    buffer_load_dwordx4 v[148:151], v204, s[36:39], s50 offen sc1
    s_add_u32 s50, s61, 20447232
    buffer_load_dwordx4 v[152:155], v204, s[36:39], s50 offen sc1
    s_add_u32 s50, s61, 22282240
    buffer_load_dwordx4 v[156:159], v204, s[36:39], s50 offen sc1
    s_add_u32 s50, s61, 24117248
    buffer_load_dwordx4 v[160:163], v204, s[36:39], s50 offen sc1
    s_add_u32 s50, s61, 25952256
    buffer_load_dwordx4 v[164:167], v204, s[36:39], s50 offen sc1
    s_add_u32 s50, s61, 27787264
    buffer_load_dwordx4 v[168:171], v204, s[36:39], s50 offen sc1
    s_add_u32 s50, s61, 29622272
    buffer_load_dwordx4 v[172:175], v204, s[36:39], s50 offen sc1
    buffer_load_dwordx2 v[192:193], v205, s[16:19], s62 offen
    s_add_u32 s50, s62, 14336
    buffer_load_dwordx2 v[194:195], v205, s[16:19], s50 offen
    buffer_load_dwordx2 v[200:201], v206, s[20:23], s46 offen
    buffer_load_dwordx2 v[196:197], v205, s[16:19], s47 offen
    s_add_u32 s50, s47, 14336
    buffer_load_dwordx2 v[198:199], v205, s[16:19], s50 offen
    buffer_load_dwordx2 v[202:203], v206, s[20:23], s58 offen
    s_waitcnt vmcnt(0)
    s_mov_b32 s50, 0xbfb8aa3b
    v_lshlrev_b32 v176, 16, v112
    v_and_b32 v177, 0xffff0000, v112
    v_lshlrev_b32 v178, 16, v113
    v_and_b32 v179, 0xffff0000, v113
    v_lshlrev_b32 v180, 16, v114
    v_and_b32 v181, 0xffff0000, v114
    v_lshlrev_b32 v182, 16, v115
    v_and_b32 v183, 0xffff0000, v115
    v_lshlrev_b32 v232, 16, v116
    v_and_b32 v233, 0xffff0000, v116
    v_pk_add_f32 v[176:177], v[176:177], v[232:233]
    v_lshlrev_b32 v232, 16, v117
    v_and_b32 v233, 0xffff0000, v117
    v_pk_add_f32 v[178:179], v[178:179], v[232:233]
    v_lshlrev_b32 v232, 16, v118
    v_and_b32 v233, 0xffff0000, v118
    v_pk_add_f32 v[180:181], v[180:181], v[232:233]
    v_lshlrev_b32 v232, 16, v119
    v_and_b32 v233, 0xffff0000, v119
    v_pk_add_f32 v[182:183], v[182:183], v[232:233]
    v_lshlrev_b32 v232, 16, v120
    v_and_b32 v233, 0xffff0000, v120
    v_pk_add_f32 v[176:177], v[176:177], v[232:233]
    v_lshlrev_b32 v232, 16, v121
    v_and_b32 v233, 0xffff0000, v121
    v_pk_add_f32 v[178:179], v[178:179], v[232:233]
    v_lshlrev_b32 v232, 16, v122
    v_and_b32 v233, 0xffff0000, v122
    v_pk_add_f32 v[180:181], v[180:181], v[232:233]
    v_lshlrev_b32 v232, 16, v123
    v_and_b32 v233, 0xffff0000, v123
    v_pk_add_f32 v[182:183], v[182:183], v[232:233]
    v_lshlrev_b32 v232, 16, v124
    v_and_b32 v233, 0xffff0000, v124
    v_pk_add_f32 v[176:177], v[176:177], v[232:233]
    v_lshlrev_b32 v232, 16, v125
    v_and_b32 v233, 0xffff0000, v125
    v_pk_add_f32 v[178:179], v[178:179], v[232:233]
    v_lshlrev_b32 v232, 16, v126
    v_and_b32 v233, 0xffff0000, v126
    v_pk_add_f32 v[180:181], v[180:181], v[232:233]
    v_lshlrev_b32 v232, 16, v127
    v_and_b32 v233, 0xffff0000, v127
    v_pk_add_f32 v[182:183], v[182:183], v[232:233]
    v_lshlrev_b32 v232, 16, v128
    v_and_b32 v233, 0xffff0000, v128
    v_pk_add_f32 v[176:177], v[176:177], v[232:233]
    v_lshlrev_b32 v232, 16, v129
    v_and_b32 v233, 0xffff0000, v129
    v_pk_add_f32 v[178:179], v[178:179], v[232:233]
    v_lshlrev_b32 v232, 16, v130
    v_and_b32 v233, 0xffff0000, v130
    v_pk_add_f32 v[180:181], v[180:181], v[232:233]
    v_lshlrev_b32 v232, 16, v131
    v_and_b32 v233, 0xffff0000, v131
    v_pk_add_f32 v[182:183], v[182:183], v[232:233]
    v_lshlrev_b32 v232, 16, v132
    v_and_b32 v233, 0xffff0000, v132
    v_pk_add_f32 v[176:177], v[176:177], v[232:233]
    v_lshlrev_b32 v232, 16, v133
    v_and_b32 v233, 0xffff0000, v133
    v_pk_add_f32 v[178:179], v[178:179], v[232:233]
    v_lshlrev_b32 v232, 16, v134
    v_and_b32 v233, 0xffff0000, v134
    v_pk_add_f32 v[180:181], v[180:181], v[232:233]
    v_lshlrev_b32 v232, 16, v135
    v_and_b32 v233, 0xffff0000, v135
    v_pk_add_f32 v[182:183], v[182:183], v[232:233]
    v_lshlrev_b32 v232, 16, v136
    v_and_b32 v233, 0xffff0000, v136
    v_pk_add_f32 v[176:177], v[176:177], v[232:233]
    v_lshlrev_b32 v232, 16, v137
    v_and_b32 v233, 0xffff0000, v137
    v_pk_add_f32 v[178:179], v[178:179], v[232:233]
    v_lshlrev_b32 v232, 16, v138
    v_and_b32 v233, 0xffff0000, v138
    v_pk_add_f32 v[180:181], v[180:181], v[232:233]
    v_lshlrev_b32 v232, 16, v139
    v_and_b32 v233, 0xffff0000, v139
    v_pk_add_f32 v[182:183], v[182:183], v[232:233]
    v_lshlrev_b32 v232, 16, v140
    v_and_b32 v233, 0xffff0000, v140
    v_pk_add_f32 v[176:177], v[176:177], v[232:233]
    v_lshlrev_b32 v232, 16, v141
    v_and_b32 v233, 0xffff0000, v141
    v_pk_add_f32 v[178:179], v[178:179], v[232:233]
    v_lshlrev_b32 v232, 16, v142
    v_and_b32 v233, 0xffff0000, v142
    v_pk_add_f32 v[180:181], v[180:181], v[232:233]
    v_lshlrev_b32 v232, 16, v143
    v_and_b32 v233, 0xffff0000, v143
    v_pk_add_f32 v[182:183], v[182:183], v[232:233]
    v_lshlrev_b32 v234, 16, v200
    v_and_b32 v235, 0xffff0000, v200
    v_lshlrev_b32 v236, 16, v201
    v_and_b32 v237, 0xffff0000, v201
    v_add_f32 v176, v176, v234
    v_add_f32 v177, v177, v235
    v_add_f32 v178, v178, v236
    v_add_f32 v179, v179, v237
    v_add_f32 v180, v180, v234
    v_add_f32 v181, v181, v235
    v_add_f32 v182, v182, v236
    v_add_f32 v183, v183, v237
    v_mul_f32 v208, s50, v176
    v_mul_f32 v209, s50, v177
    v_mul_f32 v210, s50, v178
    v_mul_f32 v211, s50, v179
    v_mul_f32 v212, s50, v180
    v_mul_f32 v213, s50, v181
    v_mul_f32 v214, s50, v182
    v_mul_f32 v215, s50, v183
    v_exp_f32 v208, v208
    v_exp_f32 v209, v209
    v_exp_f32 v210, v210
    v_exp_f32 v211, v211
    v_exp_f32 v212, v212
    v_exp_f32 v213, v213
    v_exp_f32 v214, v214
    v_exp_f32 v215, v215
    v_add_f32 v208, 1.0, v208
    v_add_f32 v209, 1.0, v209
    v_add_f32 v210, 1.0, v210
    v_add_f32 v211, 1.0, v211
    v_add_f32 v212, 1.0, v212
    v_add_f32 v213, 1.0, v213
    v_add_f32 v214, 1.0, v214
    v_add_f32 v215, 1.0, v215
    v_rcp_f32 v208, v208
    v_rcp_f32 v209, v209
    v_rcp_f32 v210, v210
    v_rcp_f32 v211, v211
    v_rcp_f32 v212, v212
    v_rcp_f32 v213, v213
    v_rcp_f32 v214, v214
    v_rcp_f32 v215, v215
    s_nop 0
    v_mul_f32 v176, v176, v208
    v_mul_f32 v177, v177, v209
    v_mul_f32 v178, v178, v210
    v_mul_f32 v179, v179, v211
    v_mul_f32 v180, v180, v212
    v_mul_f32 v181, v181, v213
    v_mul_f32 v182, v182, v214
    v_mul_f32 v183, v183, v215
    v_lshlrev_b32 v184, 16, v144
    v_and_b32 v185, 0xffff0000, v144
    v_lshlrev_b32 v186, 16, v145
    v_and_b32 v187, 0xffff0000, v145
    v_lshlrev_b32 v188, 16, v146
    v_and_b32 v189, 0xffff0000, v146
    v_lshlrev_b32 v190, 16, v147
    v_and_b32 v191, 0xffff0000, v147
    v_lshlrev_b32 v232, 16, v148
    v_and_b32 v233, 0xffff0000, v148
    v_pk_add_f32 v[184:185], v[184:185], v[232:233]
    v_lshlrev_b32 v232, 16, v149
    v_and_b32 v233, 0xffff0000, v149
    v_pk_add_f32 v[186:187], v[186:187], v[232:233]
    v_lshlrev_b32 v232, 16, v150
    v_and_b32 v233, 0xffff0000, v150
    v_pk_add_f32 v[188:189], v[188:189], v[232:233]
    v_lshlrev_b32 v232, 16, v151
    v_and_b32 v233, 0xffff0000, v151
    v_pk_add_f32 v[190:191], v[190:191], v[232:233]
    v_lshlrev_b32 v232, 16, v152
    v_and_b32 v233, 0xffff0000, v152
    v_pk_add_f32 v[184:185], v[184:185], v[232:233]
    v_lshlrev_b32 v232, 16, v153
    v_and_b32 v233, 0xffff0000, v153
    v_pk_add_f32 v[186:187], v[186:187], v[232:233]
    v_lshlrev_b32 v232, 16, v154
    v_and_b32 v233, 0xffff0000, v154
    v_pk_add_f32 v[188:189], v[188:189], v[232:233]
    v_lshlrev_b32 v232, 16, v155
    v_and_b32 v233, 0xffff0000, v155
    v_pk_add_f32 v[190:191], v[190:191], v[232:233]
    v_lshlrev_b32 v232, 16, v156
    v_and_b32 v233, 0xffff0000, v156
    v_pk_add_f32 v[184:185], v[184:185], v[232:233]
    v_lshlrev_b32 v232, 16, v157
    v_and_b32 v233, 0xffff0000, v157
    v_pk_add_f32 v[186:187], v[186:187], v[232:233]
    v_lshlrev_b32 v232, 16, v158
    v_and_b32 v233, 0xffff0000, v158
    v_pk_add_f32 v[188:189], v[188:189], v[232:233]
    v_lshlrev_b32 v232, 16, v159
    v_and_b32 v233, 0xffff0000, v159
    v_pk_add_f32 v[190:191], v[190:191], v[232:233]
    v_lshlrev_b32 v232, 16, v160
    v_and_b32 v233, 0xffff0000, v160
    v_pk_add_f32 v[184:185], v[184:185], v[232:233]
    v_lshlrev_b32 v232, 16, v161
    v_and_b32 v233, 0xffff0000, v161
    v_pk_add_f32 v[186:187], v[186:187], v[232:233]
    v_lshlrev_b32 v232, 16, v162
    v_and_b32 v233, 0xffff0000, v162
    v_pk_add_f32 v[188:189], v[188:189], v[232:233]
    v_lshlrev_b32 v232, 16, v163
    v_and_b32 v233, 0xffff0000, v163
    v_pk_add_f32 v[190:191], v[190:191], v[232:233]
    v_lshlrev_b32 v232, 16, v164
    v_and_b32 v233, 0xffff0000, v164
    v_pk_add_f32 v[184:185], v[184:185], v[232:233]
    v_lshlrev_b32 v232, 16, v165
    v_and_b32 v233, 0xffff0000, v165
    v_pk_add_f32 v[186:187], v[186:187], v[232:233]
    v_lshlrev_b32 v232, 16, v166
    v_and_b32 v233, 0xffff0000, v166
    v_pk_add_f32 v[188:189], v[188:189], v[232:233]
    v_lshlrev_b32 v232, 16, v167
    v_and_b32 v233, 0xffff0000, v167
    v_pk_add_f32 v[190:191], v[190:191], v[232:233]
    v_lshlrev_b32 v232, 16, v168
    v_and_b32 v233, 0xffff0000, v168
    v_pk_add_f32 v[184:185], v[184:185], v[232:233]
    v_lshlrev_b32 v232, 16, v169
    v_and_b32 v233, 0xffff0000, v169
    v_pk_add_f32 v[186:187], v[186:187], v[232:233]
    v_lshlrev_b32 v232, 16, v170
    v_and_b32 v233, 0xffff0000, v170
    v_pk_add_f32 v[188:189], v[188:189], v[232:233]
    v_lshlrev_b32 v232, 16, v171
    v_and_b32 v233, 0xffff0000, v171
    v_pk_add_f32 v[190:191], v[190:191], v[232:233]
    v_lshlrev_b32 v232, 16, v172
    v_and_b32 v233, 0xffff0000, v172
    v_pk_add_f32 v[184:185], v[184:185], v[232:233]
    v_lshlrev_b32 v232, 16, v173
    v_and_b32 v233, 0xffff0000, v173
    v_pk_add_f32 v[186:187], v[186:187], v[232:233]
    v_lshlrev_b32 v232, 16, v174
    v_and_b32 v233, 0xffff0000, v174
    v_pk_add_f32 v[188:189], v[188:189], v[232:233]
    v_lshlrev_b32 v232, 16, v175
    v_and_b32 v233, 0xffff0000, v175
    v_pk_add_f32 v[190:191], v[190:191], v[232:233]
    v_lshlrev_b32 v234, 16, v202
    v_and_b32 v235, 0xffff0000, v202
    v_lshlrev_b32 v236, 16, v203
    v_and_b32 v237, 0xffff0000, v203
    v_add_f32 v184, v184, v234
    v_add_f32 v185, v185, v235
    v_add_f32 v186, v186, v236
    v_add_f32 v187, v187, v237
    v_add_f32 v188, v188, v234
    v_add_f32 v189, v189, v235
    v_add_f32 v190, v190, v236
    v_add_f32 v191, v191, v237
    v_mul_f32 v216, s50, v184
    v_mul_f32 v217, s50, v185
    v_mul_f32 v218, s50, v186
    v_mul_f32 v219, s50, v187
    v_mul_f32 v220, s50, v188
    v_mul_f32 v221, s50, v189
    v_mul_f32 v222, s50, v190
    v_mul_f32 v223, s50, v191
    v_exp_f32 v216, v216
    v_exp_f32 v217, v217
    v_exp_f32 v218, v218
    v_exp_f32 v219, v219
    v_exp_f32 v220, v220
    v_exp_f32 v221, v221
    v_exp_f32 v222, v222
    v_exp_f32 v223, v223
    v_add_f32 v216, 1.0, v216
    v_add_f32 v217, 1.0, v217
    v_add_f32 v218, 1.0, v218
    v_add_f32 v219, 1.0, v219
    v_add_f32 v220, 1.0, v220
    v_add_f32 v221, 1.0, v221
    v_add_f32 v222, 1.0, v222
    v_add_f32 v223, 1.0, v223
    v_rcp_f32 v216, v216
    v_rcp_f32 v217, v217
    v_rcp_f32 v218, v218
    v_rcp_f32 v219, v219
    v_rcp_f32 v220, v220
    v_rcp_f32 v221, v221
    v_rcp_f32 v222, v222
    v_rcp_f32 v223, v223
    s_nop 0
    v_mul_f32 v184, v184, v216
    v_mul_f32 v185, v185, v217
    v_mul_f32 v186, v186, v218
    v_mul_f32 v187, v187, v219
    v_mul_f32 v188, v188, v220
    v_mul_f32 v189, v189, v221
    v_mul_f32 v190, v190, v222
    v_mul_f32 v191, v191, v223
    s_mov_b32 s51, 0
L_haveg:
    s_add_u32 s50, s60, 0
    buffer_load_dwordx4 v[0:3], v204, s[36:39], s50 offen sc1
    s_add_u32 s50, s60, 1835008
    buffer_load_dwordx4 v[4:7], v204, s[36:39], s50 offen sc1
    s_add_u32 s50, s60, 3670016
    buffer_load_dwordx4 v[8:11], v204, s[36:39], s50 offen sc1
    s_add_u32 s50, s60, 5505024
    buffer_load_dwordx4 v[12:15], v204, s[36:39], s50 offen sc1
    s_add_u32 s50, s60, 7340032
    buffer_load_dwordx4 v[16:19], v204, s[36:39], s50 offen sc1
    s_add_u32 s50, s60, 9175040
    buffer_load_dwordx4 v[20:23], v204, s[36:39], s50 offen sc1
    s_add_u32 s50, s60, 11010048
    buffer_load_dwordx4 v[24:27], v204, s[36:39], s50 offen sc1
    s_add_u32 s50, s60, 12845056
    buffer_load_dwordx4 v[28:31], v204, s[36:39], s50 offen sc1
    s_add_u32 s50, s61, 0
    buffer_load_dwordx4 v[32:35], v204, s[36:39], s50 offen sc1
    s_add_u32 s50, s61, 1835008
    buffer_load_dwordx4 v[36:39], v204, s[36:39], s50 offen sc1
    s_add_u32 s50, s61, 3670016
    buffer_load_dwordx4 v[40:43], v204, s[36:39], s50 offen sc1
    s_add_u32 s50, s61, 5505024
    buffer_load_dwordx4 v[44:47], v204, s[36:39], s50 offen sc1
    s_add_u32 s50, s61, 7340032
    buffer_load_dwordx4 v[48:51], v204, s[36:39], s50 offen sc1
    s_add_u32 s50, s61, 9175040
    buffer_load_dwordx4 v[52:55], v204, s[36:39], s50 offen sc1
    s_add_u32 s50, s61, 11010048
    buffer_load_dwordx4 v[56:59], v204, s[36:39], s50 offen sc1
    s_add_u32 s50, s61, 12845056
    buffer_load_dwordx4 v[60:63], v204, s[36:39], s50 offen sc1
    s_waitcnt vmcnt(8)
    v_lshlrev_b32 v64, 16, v0
    v_and_b32 v65, 0xffff0000, v0
    v_lshlrev_b32 v66, 16, v1
    v_and_b32 v67, 0xffff0000, v1
    v_lshlrev_b32 v68, 16, v2
    v_and_b32 v69, 0xffff0000, v2
    v_lshlrev_b32 v70, 16, v3
    v_and_b32 v71, 0xffff0000, v3
    v_lshlrev_b32 v232, 16, v4
    v_and_b32 v233, 0xffff0000, v4
    v_pk_add_f32 v[64:65], v[64:65], v[232:233]
    v_lshlrev_b32 v232, 16, v5
    v_and_b32 v233, 0xffff0000, v5
    v_pk_add_f32 v[66:67], v[66:67], v[232:233]
    v_lshlrev_b32 v232, 16, v6
    v_and_b32 v233, 0xffff0000, v6
    v_pk_add_f32 v[68:69], v[68:69], v[232:233]
    v_lshlrev_b32 v232, 16, v7
    v_and_b32 v233, 0xffff0000, v7
    v_pk_add_f32 v[70:71], v[70:71], v[232:233]
    v_lshlrev_b32 v232, 16, v8
    v_and_b32 v233, 0xffff0000, v8
    v_pk_add_f32 v[64:65], v[64:65], v[232:233]
    v_lshlrev_b32 v232, 16, v9
    v_and_b32 v233, 0xffff0000, v9
    v_pk_add_f32 v[66:67], v[66:67], v[232:233]
    v_lshlrev_b32 v232, 16, v10
    v_and_b32 v233, 0xffff0000, v10
    v_pk_add_f32 v[68:69], v[68:69], v[232:233]
    v_lshlrev_b32 v232, 16, v11
    v_and_b32 v233, 0xffff0000, v11
    v_pk_add_f32 v[70:71], v[70:71], v[232:233]
    v_lshlrev_b32 v232, 16, v12
    v_and_b32 v233, 0xffff0000, v12
    v_pk_add_f32 v[64:65], v[64:65], v[232:233]
    v_lshlrev_b32 v232, 16, v13
    v_and_b32 v233, 0xffff0000, v13
    v_pk_add_f32 v[66:67], v[66:67], v[232:233]
    v_lshlrev_b32 v232, 16, v14
    v_and_b32 v233, 0xffff0000, v14
    v_pk_add_f32 v[68:69], v[68:69], v[232:233]
    v_lshlrev_b32 v232, 16, v15
    v_and_b32 v233, 0xffff0000, v15
    v_pk_add_f32 v[70:71], v[70:71], v[232:233]
    v_lshlrev_b32 v232, 16, v16
    v_and_b32 v233, 0xffff0000, v16
    v_pk_add_f32 v[64:65], v[64:65], v[232:233]
    v_lshlrev_b32 v232, 16, v17
    v_and_b32 v233, 0xffff0000, v17
    v_pk_add_f32 v[66:67], v[66:67], v[232:233]
    v_lshlrev_b32 v232, 16, v18
    v_and_b32 v233, 0xffff0000, v18
    v_pk_add_f32 v[68:69], v[68:69], v[232:233]
    v_lshlrev_b32 v232, 16, v19
    v_and_b32 v233, 0xffff0000, v19
    v_pk_add_f32 v[70:71], v[70:71], v[232:233]
    v_lshlrev_b32 v232, 16, v20
    v_and_b32 v233, 0xffff0000, v20
    v_pk_add_f32 v[64:65], v[64:65], v[232:233]
    v_lshlrev_b32 v232, 16, v21
    v_and_b32 v233, 0xffff0000, v21
    v_pk_add_f32 v[66:67], v[66:67], v[232:233]
    v_lshlrev_b32 v232, 16, v22
    v_and_b32 v233, 0xffff0000, v22
    v_pk_add_f32 v[68:69], v[68:69], v[232:233]
    v_lshlrev_b32 v232, 16, v23
    v_and_b32 v233, 0xffff0000, v23
    v_pk_add_f32 v[70:71], v[70:71], v[232:233]
    v_lshlrev_b32 v232, 16, v24
    v_and_b32 v233, 0xffff0000, v24
    v_pk_add_f32 v[64:65], v[64:65], v[232:233]
    v_lshlrev_b32 v232, 16, v25
    v_and_b32 v233, 0xffff0000, v25
    v_pk_add_f32 v[66:67], v[66:67], v[232:233]
    v_lshlrev_b32 v232, 16, v26
    v_and_b32 v233, 0xffff0000, v26
    v_pk_add_f32 v[68:69], v[68:69], v[232:233]
    v_lshlrev_b32 v232, 16, v27
    v_and_b32 v233, 0xffff0000, v27
    v_pk_add_f32 v[70:71], v[70:71], v[232:233]
    v_lshlrev_b32 v232, 16, v28
    v_and_b32 v233, 0xffff0000, v28
    v_pk_add_f32 v[64:65], v[64:65], v[232:233]
    v_lshlrev_b32 v232, 16, v29
    v_and_b32 v233, 0xffff0000, v29
    v_pk_add_f32 v[66:67], v[66:67], v[232:233]
    v_lshlrev_b32 v232, 16, v30
    v_and_b32 v233, 0xffff0000, v30
    v_pk_add_f32 v[68:69], v[68:69], v[232:233]
    v_lshlrev_b32 v232, 16, v31
    v_and_b32 v233, 0xffff0000, v31
    v_pk_add_f32 v[70:71], v[70:71], v[232:233]
    v_lshlrev_b32 v234, 16, v192
    v_and_b32 v235, 0xffff0000, v192
    v_fma_f32 v64, v64, v176, v234
    v_fma_f32 v65, v65, v177, v235
    v_lshlrev_b32 v234, 16, v193
    v_and_b32 v235, 0xffff0000, v193
    v_fma_f32 v66, v66, v178, v234
    v_fma_f32 v67, v67, v179, v235
    v_lshlrev_b32 v234, 16, v194
    v_and_b32 v235, 0xffff0000, v194
    v_fma_f32 v68, v68, v180, v234
    v_fma_f32 v69, v69, v181, v235
    v_lshlrev_b32 v234, 16, v195
    v_and_b32 v235, 0xffff0000, v195
    v_fma_f32 v70, v70, v182, v234
    v_fma_f32 v71, v71, v183, v235
    v_cvt_pk_bf16_f32 v80, v64, v65
    v_cvt_pk_bf16_f32 v81, v66, v67
    v_cvt_pk_bf16_f32 v82, v68, v69
    v_cvt_pk_bf16_f32 v83, v70, v71
    buffer_store_dwordx2 v[80:81], v205, s[28:31], s62 offen
    s_add_u32 s50, s62, 14336
    buffer_store_dwordx2 v[82:83], v205, s[28:31], s50 offen
    s_waitcnt vmcnt(0)
    v_lshlrev_b32 v72, 16, v32
    v_and_b32 v73, 0xffff0000, v32
    v_lshlrev_b32 v74, 16, v33
    v_and_b32 v75, 0xffff0000, v33
    v_lshlrev_b32 v76, 16, v34
    v_and_b32 v77, 0xffff0000, v34
    v_lshlrev_b32 v78, 16, v35
    v_and_b32 v79, 0xffff0000, v35
    v_lshlrev_b32 v232, 16, v36
    v_and_b32 v233, 0xffff0000, v36
    v_pk_add_f32 v[72:73], v[72:73], v[232:233]
    v_lshlrev_b32 v232, 16, v37
    v_and_b32 v233, 0xffff0000, v37
    v_pk_add_f32 v[74:75], v[74:75], v[232:233]
    v_lshlrev_b32 v232, 16, v38
    v_and_b32 v233, 0xffff0000, v38
    v_pk_add_f32 v[76:77], v[76:77], v[232:233]
    v_lshlrev_b32 v232, 16, v39
    v_and_b32 v233, 0xffff0000, v39
    v_pk_add_f32 v[78:79], v[78:79], v[232:233]
    v_lshlrev_b32 v232, 16, v40
    v_and_b32 v233, 0xffff0000, v40
    v_pk_add_f32 v[72:73], v[72:73], v[232:233]
    v_lshlrev_b32 v232, 16, v41
    v_and_b32 v233, 0xffff0000, v41
    v_pk_add_f32 v[74:75], v[74:75], v[232:233]
    v_lshlrev_b32 v232, 16, v42
    v_and_b32 v233, 0xffff0000, v42
    v_pk_add_f32 v[76:77], v[76:77], v[232:233]
    v_lshlrev_b32 v232, 16, v43
    v_and_b32 v233, 0xffff0000, v43
    v_pk_add_f32 v[78:79], v[78:79], v[232:233]
    v_lshlrev_b32 v232, 16, v44
    v_and_b32 v233, 0xffff0000, v44
    v_pk_add_f32 v[72:73], v[72:73], v[232:233]
    v_lshlrev_b32 v232, 16, v45
    v_and_b32 v233, 0xffff0000, v45
    v_pk_add_f32 v[74:75], v[74:75], v[232:233]
    v_lshlrev_b32 v232, 16, v46
    v_and_b32 v233, 0xffff0000, v46
    v_pk_add_f32 v[76:77], v[76:77], v[232:233]
    v_lshlrev_b32 v232, 16, v47
    v_and_b32 v233, 0xffff0000, v47
    v_pk_add_f32 v[78:79], v[78:79], v[232:233]
    v_lshlrev_b32 v232, 16, v48
    v_and_b32 v233, 0xffff0000, v48
    v_pk_add_f32 v[72:73], v[72:73], v[232:233]
    v_lshlrev_b32 v232, 16, v49
    v_and_b32 v233, 0xffff0000, v49
    v_pk_add_f32 v[74:75], v[74:75], v[232:233]
    v_lshlrev_b32 v232, 16, v50
    v_and_b32 v233, 0xffff0000, v50
    v_pk_add_f32 v[76:77], v[76:77], v[232:233]
    v_lshlrev_b32 v232, 16, v51
    v_and_b32 v233, 0xffff0000, v51
    v_pk_add_f32 v[78:79], v[78:79], v[232:233]
    v_lshlrev_b32 v232, 16, v52
    v_and_b32 v233, 0xffff0000, v52
    v_pk_add_f32 v[72:73], v[72:73], v[232:233]
    v_lshlrev_b32 v232, 16, v53
    v_and_b32 v233, 0xffff0000, v53
    v_pk_add_f32 v[74:75], v[74:75], v[232:233]
    v_lshlrev_b32 v232, 16, v54
    v_and_b32 v233, 0xffff0000, v54
    v_pk_add_f32 v[76:77], v[76:77], v[232:233]
    v_lshlrev_b32 v232, 16, v55
    v_and_b32 v233, 0xffff0000, v55
    v_pk_add_f32 v[78:79], v[78:79], v[232:233]
    v_lshlrev_b32 v232, 16, v56
    v_and_b32 v233, 0xffff0000, v56
    v_pk_add_f32 v[72:73], v[72:73], v[232:233]
    v_lshlrev_b32 v232, 16, v57
    v_and_b32 v233, 0xffff0000, v57
    v_pk_add_f32 v[74:75], v[74:75], v[232:233]
    v_lshlrev_b32 v232, 16, v58
    v_and_b32 v233, 0xffff0000, v58
    v_pk_add_f32 v[76:77], v[76:77], v[232:233]
    v_lshlrev_b32 v232, 16, v59
    v_and_b32 v233, 0xffff0000, v59
    v_pk_add_f32 v[78:79], v[78:79], v[232:233]
    v_lshlrev_b32 v232, 16, v60
    v_and_b32 v233, 0xffff0000, v60
    v_pk_add_f32 v[72:73], v[72:73], v[232:233]
    v_lshlrev_b32 v232, 16, v61
    v_and_b32 v233, 0xffff0000, v61
    v_pk_add_f32 v[74:75], v[74:75], v[232:233]
    v_lshlrev_b32 v232, 16, v62
    v_and_b32 v233, 0xffff0000, v62
    v_pk_add_f32 v[76:77], v[76:77], v[232:233]
    v_lshlrev_b32 v232, 16, v63
    v_and_b32 v233, 0xffff0000, v63
    v_pk_add_f32 v[78:79], v[78:79], v[232:233]
    v_lshlrev_b32 v234, 16, v196
    v_and_b32 v235, 0xffff0000, v196
    v_fma_f32 v72, v72, v184, v234
    v_fma_f32 v73, v73, v185, v235
    v_lshlrev_b32 v234, 16, v197
    v_and_b32 v235, 0xffff0000, v197
    v_fma_f32 v74, v74, v186, v234
    v_fma_f32 v75, v75, v187, v235
    v_lshlrev_b32 v234, 16, v198
    v_and_b32 v235, 0xffff0000, v198
    v_fma_f32 v76, v76, v188, v234
    v_fma_f32 v77, v77, v189, v235
    v_lshlrev_b32 v234, 16, v199
    v_and_b32 v235, 0xffff0000, v199
    v_fma_f32 v78, v78, v190, v234
    v_fma_f32 v79, v79, v191, v235
    v_cvt_pk_bf16_f32 v84, v72, v73
    v_cvt_pk_bf16_f32 v85, v74, v75
    v_cvt_pk_bf16_f32 v86, v76, v77
    v_cvt_pk_bf16_f32 v87, v78, v79
    buffer_store_dwordx2 v[84:85], v205, s[28:31], s47 offen
    s_add_u32 s50, s47, 14336
    buffer_store_dwordx2 v[86:87], v205, s[28:31], s50 offen
    s_branch L_shares
L_fin_done:
L_end:
    s_endpgm
L_slowZ:
    s_nop 7
    s_nop 3
    v_max3_f32 v232, v128, v129, v130
    v_max3_f32 v233, v132, v133, v134
    v_max3_f32 v234, v136, v137, v138
    v_max3_f32 v235, v140, v141, v142
    v_max3_f32 v232, v232, v131, v144
    v_max3_f32 v233, v233, v135, v148
    v_max3_f32 v234, v234, v139, v152
    v_max3_f32 v235, v235, v143, v156
    v_max3_f32 v232, v232, v145, v146
    v_max3_f32 v233, v233, v149, v150
    v_max3_f32 v234, v234, v153, v154
    v_max3_f32 v235, v235, v157, v158
    v_max_f32 v232, v232, v147
    v_max_f32 v233, v233, v151
    v_max_f32 v234, v234, v155
    v_max_f32 v235, v235, v159
    s_nop 0
    v_mov_b32 v236, v232
    v_mov_b32 v237, v233
    v_mov_b32 v238, v234
    v_mov_b32 v239, v235
    v_permlane16_swap_b32 v232, v236
    v_permlane16_swap_b32 v233, v237
    v_permlane16_swap_b32 v234, v238
    v_permlane16_swap_b32 v235, v239
    v_max_f32 v232, v232, v236
    v_max_f32 v233, v233, v237
    v_max_f32 v234, v234, v238
    v_max_f32 v235, v235, v239
    v_mov_b32 v236, v232
    v_mov_b32 v237, v233
    v_mov_b32 v238, v234
    v_mov_b32 v239, v235
    v_permlane32_swap_b32 v232, v236
    v_permlane32_swap_b32 v233, v237
    v_permlane32_swap_b32 v234, v238
    v_permlane32_swap_b32 v235, v239
    v_max_f32 v232, v232, v236
    v_max_f32 v233, v233, v237
    v_max_f32 v234, v234, v238
    v_max_f32 v235, v235, v239
    v_max_f32 v232, 0, v232
    v_max_f32 v233, 0, v233
    v_max_f32 v234, 0, v234
    v_max_f32 v235, 0, v235
    v_sub_f32 v128, v128, v232
    v_sub_f32 v129, v129, v232
    v_sub_f32 v130, v130, v232
    v_sub_f32 v131, v131, v232
    v_sub_f32 v144, v144, v232
    v_sub_f32 v145, v145, v232
    v_sub_f32 v146, v146, v232
    v_sub_f32 v147, v147, v232
    v_sub_f32 v192, v192, v232
    v_sub_f32 v193, v193, v232
    v_sub_f32 v194, v194, v232
    v_sub_f32 v195, v195, v232
    v_sub_f32 v132, v132, v233
    v_sub_f32 v133, v133, v233
    v_sub_f32 v134, v134, v233
    v_sub_f32 v135, v135, v233
    v_sub_f32 v148, v148, v233
    v_sub_f32 v149, v149, v233
    v_sub_f32 v150, v150, v233
    v_sub_f32 v151, v151, v233
    v_sub_f32 v196, v196, v233
    v_sub_f32 v197, v197, v233
    v_sub_f32 v198, v198, v233
    v_sub_f32 v199, v199, v233
    v_sub_f32 v136, v136, v234
    v_sub_f32 v137, v137, v234
    v_sub_f32 v138, v138, v234
    v_sub_f32 v139, v139, v234
    v_sub_f32 v152, v152, v234
    v_sub_f32 v153, v153, v234
    v_sub_f32 v154, v154, v234
    v_sub_f32 v155, v155, v234
    v_sub_f32 v200, v200, v234
    v_sub_f32 v201, v201, v234
    v_sub_f32 v202, v202, v234
    v_sub_f32 v203, v203, v234
    v_sub_f32 v140, v140, v235
    v_sub_f32 v141, v141, v235
    v_sub_f32 v142, v142, v235
    v_sub_f32 v143, v143, v235
    v_sub_f32 v156, v156, v235
    v_sub_f32 v157, v157, v235
    v_sub_f32 v158, v158, v235
    v_sub_f32 v159, v159, v235
    v_sub_f32 v204, v204, v235
    v_sub_f32 v205, v205, v235
    v_sub_f32 v206, v206, v235
    v_sub_f32 v207, v207, v235
    v_exp_f32 v232, -v232
    v_exp_f32 v233, -v233
    v_exp_f32 v234, -v234
    v_exp_f32 v235, -v235
    s_nop 0
    v_mul_f32 v240, v240, v232
    v_mul_f32 v241, v241, v233
    v_mul_f32 v242, v242, v234
    v_mul_f32 v243, v243, v235
    v_accvgpr_read_b32 v236, a0
    v_accvgpr_read_b32 v237, a1
    v_accvgpr_read_b32 v238, a2
    v_accvgpr_read_b32 v239, a3
    s_nop 0
    v_mul_f32 v236, v236, v232
    v_mul_f32 v237, v237, v232
    v_mul_f32 v238, v238, v232
    v_mul_f32 v239, v239, v232
    v_accvgpr_write_b32 a0, v236
    v_accvgpr_write_b32 a1, v237
    v_accvgpr_write_b32 a2, v238
    v_accvgpr_write_b32 a3, v239
    v_accvgpr_read_b32 v236, a4
    v_accvgpr_read_b32 v237, a5
    v_accvgpr_read_b32 v238, a6
    v_accvgpr_read_b32 v239, a7
    s_nop 0
    v_mul_f32 v236, v236, v233
    v_mul_f32 v237, v237, v233
    v_mul_f32 v238, v238, v233
    v_mul_f32 v239, v239, v233
    v_accvgpr_write_b32 a4, v236
    v_accvgpr_write_b32 a5, v237
    v_accvgpr_write_b32 a6, v238
    v_accvgpr_write_b32 a7, v239
    v_accvgpr_read_b32 v236, a8
    v_accvgpr_read_b32 v237, a9
    v_accvgpr_read_b32 v238, a10
    v_accvgpr_read_b32 v239, a11
    s_nop 0
    v_mul_f32 v236, v236, v234
    v_mul_f32 v237, v237, v234
    v_mul_f32 v238, v238, v234
    v_mul_f32 v239, v239, v234
    v_accvgpr_write_b32 a8, v236
    v_accvgpr_write_b32 a9, v237
    v_accvgpr_write_b32 a10, v238
    v_accvgpr_write_b32 a11, v239
    v_accvgpr_read_b32 v236, a12
    v_accvgpr_read_b32 v237, a13
    v_accvgpr_read_b32 v238, a14
    v_accvgpr_read_b32 v239, a15
    s_nop 0
    v_mul_f32 v236, v236, v235
    v_mul_f32 v237, v237, v235
    v_mul_f32 v238, v238, v235
    v_mul_f32 v239, v239, v235
    v_accvgpr_write_b32 a12, v236
    v_accvgpr_write_b32 a13, v237
    v_accvgpr_write_b32 a14, v238
    v_accvgpr_write_b32 a15, v239
    v_accvgpr_read_b32 v236, a16
    v_accvgpr_read_b32 v237, a17
    v_accvgpr_read_b32 v238, a18
    v_accvgpr_read_b32 v239, a19
    s_nop 0
    v_mul_f32 v236, v236, v232
    v_mul_f32 v237, v237, v232
    v_mul_f32 v238, v238, v232
    v_mul_f32 v239, v239, v232
    v_accvgpr_write_b32 a16, v236
    v_accvgpr_write_b32 a17, v237
    v_accvgpr_write_b32 a18, v238
    v_accvgpr_write_b32 a19, v239
    v_accvgpr_read_b32 v236, a20
    v_accvgpr_read_b32 v237, a21
    v_accvgpr_read_b32 v238, a22
    v_accvgpr_read_b32 v239, a23
    s_nop 0
    v_mul_f32 v236, v236, v233
    v_mul_f32 v237, v237, v233
    v_mul_f32 v238, v238, v233
    v_mul_f32 v239, v239, v233
    v_accvgpr_write_b32 a20, v236
    v_accvgpr_write_b32 a21, v237
    v_accvgpr_write_b32 a22, v238
    v_accvgpr_write_b32 a23, v239
    v_accvgpr_read_b32 v236, a24
    v_accvgpr_read_b32 v237, a25
    v_accvgpr_read_b32 v238, a26
    v_accvgpr_read_b32 v239, a27
    s_nop 0
    v_mul_f32 v236, v236, v234
    v_mul_f32 v237, v237, v234
    v_mul_f32 v238, v238, v234
    v_mul_f32 v239, v239, v234
    v_accvgpr_write_b32 a24, v236
    v_accvgpr_write_b32 a25, v237
    v_accvgpr_write_b32 a26, v238
    v_accvgpr_write_b32 a27, v239
    v_accvgpr_read_b32 v236, a28
    v_accvgpr_read_b32 v237, a29
    v_accvgpr_read_b32 v238, a30
    v_accvgpr_read_b32 v239, a31
    s_nop 0
    v_mul_f32 v236, v236, v235
    v_mul_f32 v237, v237, v235
    v_mul_f32 v238, v238, v235
    v_mul_f32 v239, v239, v235
    v_accvgpr_write_b32 a28, v236
    v_accvgpr_write_b32 a29, v237
    v_accvgpr_write_b32 a30, v238
    v_accvgpr_write_b32 a31, v239
    v_accvgpr_read_b32 v236, a32
    v_accvgpr_read_b32 v237, a33
    v_accvgpr_read_b32 v238, a34
    v_accvgpr_read_b32 v239, a35
    s_nop 0
    v_mul_f32 v236, v236, v232
    v_mul_f32 v237, v237, v232
    v_mul_f32 v238, v238, v232
    v_mul_f32 v239, v239, v232
    v_accvgpr_write_b32 a32, v236
    v_accvgpr_write_b32 a33, v237
    v_accvgpr_write_b32 a34, v238
    v_accvgpr_write_b32 a35, v239
    v_accvgpr_read_b32 v236, a36
    v_accvgpr_read_b32 v237, a37
    v_accvgpr_read_b32 v238, a38
    v_accvgpr_read_b32 v239, a39
    s_nop 0
    v_mul_f32 v236, v236, v233
    v_mul_f32 v237, v237, v233
    v_mul_f32 v238, v238, v233
    v_mul_f32 v239, v239, v233
    v_accvgpr_write_b32 a36, v236
    v_accvgpr_write_b32 a37, v237
    v_accvgpr_write_b32 a38, v238
    v_accvgpr_write_b32 a39, v239
    v_accvgpr_read_b32 v236, a40
    v_accvgpr_read_b32 v237, a41
    v_accvgpr_read_b32 v238, a42
    v_accvgpr_read_b32 v239, a43
    s_nop 0
    v_mul_f32 v236, v236, v234
    v_mul_f32 v237, v237, v234
    v_mul_f32 v238, v238, v234
    v_mul_f32 v239, v239, v234
    v_accvgpr_write_b32 a40, v236
    v_accvgpr_write_b32 a41, v237
    v_accvgpr_write_b32 a42, v238
    v_accvgpr_write_b32 a43, v239
    v_accvgpr_read_b32 v236, a44
    v_accvgpr_read_b32 v237, a45
    v_accvgpr_read_b32 v238, a46
    v_accvgpr_read_b32 v239, a47
    s_nop 0
    v_mul_f32 v236, v236, v235
    v_mul_f32 v237, v237, v235
    v_mul_f32 v238, v238, v235
    v_mul_f32 v239, v239, v235
    v_accvgpr_write_b32 a44, v236
    v_accvgpr_write_b32 a45, v237
    v_accvgpr_write_b32 a46, v238
    v_accvgpr_write_b32 a47, v239
    v_accvgpr_read_b32 v236, a48
    v_accvgpr_read_b32 v237, a49
    v_accvgpr_read_b32 v238, a50
    v_accvgpr_read_b32 v239, a51
    s_nop 0
    v_mul_f32 v236, v236, v232
    v_mul_f32 v237, v237, v232
    v_mul_f32 v238, v238, v232
    v_mul_f32 v239, v239, v232
    v_accvgpr_write_b32 a48, v236
    v_accvgpr_write_b32 a49, v237
    v_accvgpr_write_b32 a50, v238
    v_accvgpr_write_b32 a51, v239
    v_accvgpr_read_b32 v236, a52
    v_accvgpr_read_b32 v237, a53
    v_accvgpr_read_b32 v238, a54
    v_accvgpr_read_b32 v239, a55
    s_nop 0
    v_mul_f32 v236, v236, v233
    v_mul_f32 v237, v237, v233
    v_mul_f32 v238, v238, v233
    v_mul_f32 v239, v239, v233
    v_accvgpr_write_b32 a52, v236
    v_accvgpr_write_b32 a53, v237
    v_accvgpr_write_b32 a54, v238
    v_accvgpr_write_b32 a55, v239
    v_accvgpr_read_b32 v236, a56
    v_accvgpr_read_b32 v237, a57
    v_accvgpr_read_b32 v238, a58
    v_accvgpr_read_b32 v239, a59
    s_nop 0
    v_mul_f32 v236, v236, v234
    v_mul_f32 v237, v237, v234
    v_mul_f32 v238, v238, v234
    v_mul_f32 v239, v239, v234
    v_accvgpr_write_b32 a56, v236
    v_accvgpr_write_b32 a57, v237
    v_accvgpr_write_b32 a58, v238
    v_accvgpr_write_b32 a59, v239
    v_accvgpr_read_b32 v236, a60
    v_accvgpr_read_b32 v237, a61
    v_accvgpr_read_b32 v238, a62
    v_accvgpr_read_b32 v239, a63
    s_nop 0
    v_mul_f32 v236, v236, v235
    v_mul_f32 v237, v237, v235
    v_mul_f32 v238, v238, v235
    v_mul_f32 v239, v239, v235
    v_accvgpr_write_b32 a60, v236
    v_accvgpr_write_b32 a61, v237
    v_accvgpr_write_b32 a62, v238
    v_accvgpr_write_b32 a63, v239
    v_accvgpr_read_b32 v236, a64
    v_accvgpr_read_b32 v237, a65
    v_accvgpr_read_b32 v238, a66
    v_accvgpr_read_b32 v239, a67
    s_nop 0
    v_mul_f32 v236, v236, v232
    v_mul_f32 v237, v237, v232
    v_mul_f32 v238, v238, v232
    v_mul_f32 v239, v239, v232
    v_accvgpr_write_b32 a64, v236
    v_accvgpr_write_b32 a65, v237
    v_accvgpr_write_b32 a66, v238
    v_accvgpr_write_b32 a67, v239
    v_accvgpr_read_b32 v236, a68
    v_accvgpr_read_b32 v237, a69
    v_accvgpr_read_b32 v238, a70
    v_accvgpr_read_b32 v239, a71
    s_nop 0
    v_mul_f32 v236, v236, v233
    v_mul_f32 v237, v237, v233
    v_mul_f32 v238, v238, v233
    v_mul_f32 v239, v239, v233
    v_accvgpr_write_b32 a68, v236
    v_accvgpr_write_b32 a69, v237
    v_accvgpr_write_b32 a70, v238
    v_accvgpr_write_b32 a71, v239
    v_accvgpr_read_b32 v236, a72
    v_accvgpr_read_b32 v237, a73
    v_accvgpr_read_b32 v238, a74
    v_accvgpr_read_b32 v239, a75
    s_nop 0
    v_mul_f32 v236, v236, v234
    v_mul_f32 v237, v237, v234
    v_mul_f32 v238, v238, v234
    v_mul_f32 v239, v239, v234
    v_accvgpr_write_b32 a72, v236
    v_accvgpr_write_b32 a73, v237
    v_accvgpr_write_b32 a74, v238
    v_accvgpr_write_b32 a75, v239
    v_accvgpr_read_b32 v236, a76
    v_accvgpr_read_b32 v237, a77
    v_accvgpr_read_b32 v238, a78
    v_accvgpr_read_b32 v239, a79
    s_nop 0
    v_mul_f32 v236, v236, v235
    v_mul_f32 v237, v237, v235
    v_mul_f32 v238, v238, v235
    v_mul_f32 v239, v239, v235
    v_accvgpr_write_b32 a76, v236
    v_accvgpr_write_b32 a77, v237
    v_accvgpr_write_b32 a78, v238
    v_accvgpr_write_b32 a79, v239
    v_accvgpr_read_b32 v236, a80
    v_accvgpr_read_b32 v237, a81
    v_accvgpr_read_b32 v238, a82
    v_accvgpr_read_b32 v239, a83
    s_nop 0
    v_mul_f32 v236, v236, v232
    v_mul_f32 v237, v237, v232
    v_mul_f32 v238, v238, v232
    v_mul_f32 v239, v239, v232
    v_accvgpr_write_b32 a80, v236
    v_accvgpr_write_b32 a81, v237
    v_accvgpr_write_b32 a82, v238
    v_accvgpr_write_b32 a83, v239
    v_accvgpr_read_b32 v236, a84
    v_accvgpr_read_b32 v237, a85
    v_accvgpr_read_b32 v238, a86
    v_accvgpr_read_b32 v239, a87
    s_nop 0
    v_mul_f32 v236, v236, v233
    v_mul_f32 v237, v237, v233
    v_mul_f32 v238, v238, v233
    v_mul_f32 v239, v239, v233
    v_accvgpr_write_b32 a84, v236
    v_accvgpr_write_b32 a85, v237
    v_accvgpr_write_b32 a86, v238
    v_accvgpr_write_b32 a87, v239
    v_accvgpr_read_b32 v236, a88
    v_accvgpr_read_b32 v237, a89
    v_accvgpr_read_b32 v238, a90
    v_accvgpr_read_b32 v239, a91
    s_nop 0
    v_mul_f32 v236, v236, v234
    v_mul_f32 v237, v237, v234
    v_mul_f32 v238, v238, v234
    v_mul_f32 v239, v239, v234
    v_accvgpr_write_b32 a88, v236
    v_accvgpr_write_b32 a89, v237
    v_accvgpr_write_b32 a90, v238
    v_accvgpr_write_b32 a91, v239
    v_accvgpr_read_b32 v236, a92
    v_accvgpr_read_b32 v237, a93
    v_accvgpr_read_b32 v238, a94
    v_accvgpr_read_b32 v239, a95
    s_nop 0
    v_mul_f32 v236, v236, v235
    v_mul_f32 v237, v237, v235
    v_mul_f32 v238, v238, v235
    v_mul_f32 v239, v239, v235
    v_accvgpr_write_b32 a92, v236
    v_accvgpr_write_b32 a93, v237
    v_accvgpr_write_b32 a94, v238
    v_accvgpr_write_b32 a95, v239
    v_accvgpr_read_b32 v236, a96
    v_accvgpr_read_b32 v237, a97
    v_accvgpr_read_b32 v238, a98
    v_accvgpr_read_b32 v239, a99
    s_nop 0
    v_mul_f32 v236, v236, v232
    v_mul_f32 v237, v237, v232
    v_mul_f32 v238, v238, v232
    v_mul_f32 v239, v239, v232
    v_accvgpr_write_b32 a96, v236
    v_accvgpr_write_b32 a97, v237
    v_accvgpr_write_b32 a98, v238
    v_accvgpr_write_b32 a99, v239
    v_accvgpr_read_b32 v236, a100
    v_accvgpr_read_b32 v237, a101
    v_accvgpr_read_b32 v238, a102
    v_accvgpr_read_b32 v239, a103
    s_nop 0
    v_mul_f32 v236, v236, v233
    v_mul_f32 v237, v237, v233
    v_mul_f32 v238, v238, v233
    v_mul_f32 v239, v239, v233
    v_accvgpr_write_b32 a100, v236
    v_accvgpr_write_b32 a101, v237
    v_accvgpr_write_b32 a102, v238
    v_accvgpr_write_b32 a103, v239
    v_accvgpr_read_b32 v236, a104
    v_accvgpr_read_b32 v237, a105
    v_accvgpr_read_b32 v238, a106
    v_accvgpr_read_b32 v239, a107
    s_nop 0
    v_mul_f32 v236, v236, v234
    v_mul_f32 v237, v237, v234
    v_mul_f32 v238, v238, v234
    v_mul_f32 v239, v239, v234
    v_accvgpr_write_b32 a104, v236
    v_accvgpr_write_b32 a105, v237
    v_accvgpr_write_b32 a106, v238
    v_accvgpr_write_b32 a107, v239
    v_accvgpr_read_b32 v236, a108
    v_accvgpr_read_b32 v237, a109
    v_accvgpr_read_b32 v238, a110
    v_accvgpr_read_b32 v239, a111
    s_nop 0
    v_mul_f32 v236, v236, v235
    v_mul_f32 v237, v237, v235
    v_mul_f32 v238, v238, v235
    v_mul_f32 v239, v239, v235
    v_accvgpr_write_b32 a108, v236
    v_accvgpr_write_b32 a109, v237
    v_accvgpr_write_b32 a110, v238
    v_accvgpr_write_b32 a111, v239
    v_accvgpr_read_b32 v236, a112
    v_accvgpr_read_b32 v237, a113
    v_accvgpr_read_b32 v238, a114
    v_accvgpr_read_b32 v239, a115
    s_nop 0
    v_mul_f32 v236, v236, v232
    v_mul_f32 v237, v237, v232
    v_mul_f32 v238, v238, v232
    v_mul_f32 v239, v239, v232
    v_accvgpr_write_b32 a112, v236
    v_accvgpr_write_b32 a113, v237
    v_accvgpr_write_b32 a114, v238
    v_accvgpr_write_b32 a115, v239
    v_accvgpr_read_b32 v236, a116
    v_accvgpr_read_b32 v237, a117
    v_accvgpr_read_b32 v238, a118
    v_accvgpr_read_b32 v239, a119
    s_nop 0
    v_mul_f32 v236, v236, v233
    v_mul_f32 v237, v237, v233
    v_mul_f32 v238, v238, v233
    v_mul_f32 v239, v239, v233
    v_accvgpr_write_b32 a116, v236
    v_accvgpr_write_b32 a117, v237
    v_accvgpr_write_b32 a118, v238
    v_accvgpr_write_b32 a119, v239
    v_accvgpr_read_b32 v236, a120
    v_accvgpr_read_b32 v237, a121
    v_accvgpr_read_b32 v238, a122
    v_accvgpr_read_b32 v239, a123
    s_nop 0
    v_mul_f32 v236, v236, v234
    v_mul_f32 v237, v237, v234
    v_mul_f32 v238, v238, v234
    v_mul_f32 v239, v239, v234
    v_accvgpr_write_b32 a120, v236
    v_accvgpr_write_b32 a121, v237
    v_accvgpr_write_b32 a122, v238
    v_accvgpr_write_b32 a123, v239
    v_accvgpr_read_b32 v236, a124
    v_accvgpr_read_b32 v237, a125
    v_accvgpr_read_b32 v238, a126
    v_accvgpr_read_b32 v239, a127
    s_nop 0
    v_mul_f32 v236, v236, v235
    v_mul_f32 v237, v237, v235
    v_mul_f32 v238, v238, v235
    v_mul_f32 v239, v239, v235
    v_accvgpr_write_b32 a124, v236
    v_accvgpr_write_b32 a125, v237
    v_accvgpr_write_b32 a126, v238
    v_accvgpr_write_b32 a127, v239
    v_accvgpr_read_b32 v236, a128
    v_accvgpr_read_b32 v237, a129
    v_accvgpr_read_b32 v238, a130
    v_accvgpr_read_b32 v239, a131
    s_nop 0
    v_mul_f32 v236, v236, v232
    v_mul_f32 v237, v237, v232
    v_mul_f32 v238, v238, v232
    v_mul_f32 v239, v239, v232
    v_accvgpr_write_b32 a128, v236
    v_accvgpr_write_b32 a129, v237
    v_accvgpr_write_b32 a130, v238
    v_accvgpr_write_b32 a131, v239
    v_accvgpr_read_b32 v236, a132
    v_accvgpr_read_b32 v237, a133
    v_accvgpr_read_b32 v238, a134
    v_accvgpr_read_b32 v239, a135
    s_nop 0
    v_mul_f32 v236, v236, v233
    v_mul_f32 v237, v237, v233
    v_mul_f32 v238, v238, v233
    v_mul_f32 v239, v239, v233
    v_accvgpr_write_b32 a132, v236
    v_accvgpr_write_b32 a133, v237
    v_accvgpr_write_b32 a134, v238
    v_accvgpr_write_b32 a135, v239
    v_accvgpr_read_b32 v236, a136
    v_accvgpr_read_b32 v237, a137
    v_accvgpr_read_b32 v238, a138
    v_accvgpr_read_b32 v239, a139
    s_nop 0
    v_mul_f32 v236, v236, v234
    v_mul_f32 v237, v237, v234
    v_mul_f32 v238, v238, v234
    v_mul_f32 v239, v239, v234
    v_accvgpr_write_b32 a136, v236
    v_accvgpr_write_b32 a137, v237
    v_accvgpr_write_b32 a138, v238
    v_accvgpr_write_b32 a139, v239
    v_accvgpr_read_b32 v236, a140
    v_accvgpr_read_b32 v237, a141
    v_accvgpr_read_b32 v238, a142
    v_accvgpr_read_b32 v239, a143
    s_nop 0
    v_mul_f32 v236, v236, v235
    v_mul_f32 v237, v237, v235
    v_mul_f32 v238, v238, v235
    v_mul_f32 v239, v239, v235
    v_accvgpr_write_b32 a140, v236
    v_accvgpr_write_b32 a141, v237
    v_accvgpr_write_b32 a142, v238
    v_accvgpr_write_b32 a143, v239
    v_accvgpr_read_b32 v236, a144
    v_accvgpr_read_b32 v237, a145
    v_accvgpr_read_b32 v238, a146
    v_accvgpr_read_b32 v239, a147
    s_nop 0
    v_mul_f32 v236, v236, v232
    v_mul_f32 v237, v237, v232
    v_mul_f32 v238, v238, v232
    v_mul_f32 v239, v239, v232
    v_accvgpr_write_b32 a144, v236
    v_accvgpr_write_b32 a145, v237
    v_accvgpr_write_b32 a146, v238
    v_accvgpr_write_b32 a147, v239
    v_accvgpr_read_b32 v236, a148
    v_accvgpr_read_b32 v237, a149
    v_accvgpr_read_b32 v238, a150
    v_accvgpr_read_b32 v239, a151
    s_nop 0
    v_mul_f32 v236, v236, v233
    v_mul_f32 v237, v237, v233
    v_mul_f32 v238, v238, v233
    v_mul_f32 v239, v239, v233
    v_accvgpr_write_b32 a148, v236
    v_accvgpr_write_b32 a149, v237
    v_accvgpr_write_b32 a150, v238
    v_accvgpr_write_b32 a151, v239
    v_accvgpr_read_b32 v236, a152
    v_accvgpr_read_b32 v237, a153
    v_accvgpr_read_b32 v238, a154
    v_accvgpr_read_b32 v239, a155
    s_nop 0
    v_mul_f32 v236, v236, v234
    v_mul_f32 v237, v237, v234
    v_mul_f32 v238, v238, v234
    v_mul_f32 v239, v239, v234
    v_accvgpr_write_b32 a152, v236
    v_accvgpr_write_b32 a153, v237
    v_accvgpr_write_b32 a154, v238
    v_accvgpr_write_b32 a155, v239
    v_accvgpr_read_b32 v236, a156
    v_accvgpr_read_b32 v237, a157
    v_accvgpr_read_b32 v238, a158
    v_accvgpr_read_b32 v239, a159
    s_nop 0
    v_mul_f32 v236, v236, v235
    v_mul_f32 v237, v237, v235
    v_mul_f32 v238, v238, v235
    v_mul_f32 v239, v239, v235
    v_accvgpr_write_b32 a156, v236
    v_accvgpr_write_b32 a157, v237
    v_accvgpr_write_b32 a158, v238
    v_accvgpr_write_b32 a159, v239
    v_accvgpr_read_b32 v236, a160
    v_accvgpr_read_b32 v237, a161
    v_accvgpr_read_b32 v238, a162
    v_accvgpr_read_b32 v239, a163
    s_nop 0
    v_mul_f32 v236, v236, v232
    v_mul_f32 v237, v237, v232
    v_mul_f32 v238, v238, v232
    v_mul_f32 v239, v239, v232
    v_accvgpr_write_b32 a160, v236
    v_accvgpr_write_b32 a161, v237
    v_accvgpr_write_b32 a162, v238
    v_accvgpr_write_b32 a163, v239
    v_accvgpr_read_b32 v236, a164
    v_accvgpr_read_b32 v237, a165
    v_accvgpr_read_b32 v238, a166
    v_accvgpr_read_b32 v239, a167
    s_nop 0
    v_mul_f32 v236, v236, v233
    v_mul_f32 v237, v237, v233
    v_mul_f32 v238, v238, v233
    v_mul_f32 v239, v239, v233
    v_accvgpr_write_b32 a164, v236
    v_accvgpr_write_b32 a165, v237
    v_accvgpr_write_b32 a166, v238
    v_accvgpr_write_b32 a167, v239
    v_accvgpr_read_b32 v236, a168
    v_accvgpr_read_b32 v237, a169
    v_accvgpr_read_b32 v238, a170
    v_accvgpr_read_b32 v239, a171
    s_nop 0
    v_mul_f32 v236, v236, v234
    v_mul_f32 v237, v237, v234
    v_mul_f32 v238, v238, v234
    v_mul_f32 v239, v239, v234
    v_accvgpr_write_b32 a168, v236
    v_accvgpr_write_b32 a169, v237
    v_accvgpr_write_b32 a170, v238
    v_accvgpr_write_b32 a171, v239
    v_accvgpr_read_b32 v236, a172
    v_accvgpr_read_b32 v237, a173
    v_accvgpr_read_b32 v238, a174
    v_accvgpr_read_b32 v239, a175
    s_nop 0
    v_mul_f32 v236, v236, v235
    v_mul_f32 v237, v237, v235
    v_mul_f32 v238, v238, v235
    v_mul_f32 v239, v239, v235
    v_accvgpr_write_b32 a172, v236
    v_accvgpr_write_b32 a173, v237
    v_accvgpr_write_b32 a174, v238
    v_accvgpr_write_b32 a175, v239
    v_accvgpr_read_b32 v236, a176
    v_accvgpr_read_b32 v237, a177
    v_accvgpr_read_b32 v238, a178
    v_accvgpr_read_b32 v239, a179
    s_nop 0
    v_mul_f32 v236, v236, v232
    v_mul_f32 v237, v237, v232
    v_mul_f32 v238, v238, v232
    v_mul_f32 v239, v239, v232
    v_accvgpr_write_b32 a176, v236
    v_accvgpr_write_b32 a177, v237
    v_accvgpr_write_b32 a178, v238
    v_accvgpr_write_b32 a179, v239
    v_accvgpr_read_b32 v236, a180
    v_accvgpr_read_b32 v237, a181
    v_accvgpr_read_b32 v238, a182
    v_accvgpr_read_b32 v239, a183
    s_nop 0
    v_mul_f32 v236, v236, v233
    v_mul_f32 v237, v237, v233
    v_mul_f32 v238, v238, v233
    v_mul_f32 v239, v239, v233
    v_accvgpr_write_b32 a180, v236
    v_accvgpr_write_b32 a181, v237
    v_accvgpr_write_b32 a182, v238
    v_accvgpr_write_b32 a183, v239
    v_accvgpr_read_b32 v236, a184
    v_accvgpr_read_b32 v237, a185
    v_accvgpr_read_b32 v238, a186
    v_accvgpr_read_b32 v239, a187
    s_nop 0
    v_mul_f32 v236, v236, v234
    v_mul_f32 v237, v237, v234
    v_mul_f32 v238, v238, v234
    v_mul_f32 v239, v239, v234
    v_accvgpr_write_b32 a184, v236
    v_accvgpr_write_b32 a185, v237
    v_accvgpr_write_b32 a186, v238
    v_accvgpr_write_b32 a187, v239
    v_accvgpr_read_b32 v236, a188
    v_accvgpr_read_b32 v237, a189
    v_accvgpr_read_b32 v238, a190
    v_accvgpr_read_b32 v239, a191
    s_nop 0
    v_mul_f32 v236, v236, v235
    v_mul_f32 v237, v237, v235
    v_mul_f32 v238, v238, v235
    v_mul_f32 v239, v239, v235
    v_accvgpr_write_b32 a188, v236
    v_accvgpr_write_b32 a189, v237
    v_accvgpr_write_b32 a190, v238
    v_accvgpr_write_b32 a191, v239
    v_accvgpr_read_b32 v236, a192
    v_accvgpr_read_b32 v237, a193
    v_accvgpr_read_b32 v238, a194
    v_accvgpr_read_b32 v239, a195
    s_nop 0
    v_mul_f32 v236, v236, v232
    v_mul_f32 v237, v237, v232
    v_mul_f32 v238, v238, v232
    v_mul_f32 v239, v239, v232
    v_accvgpr_write_b32 a192, v236
    v_accvgpr_write_b32 a193, v237
    v_accvgpr_write_b32 a194, v238
    v_accvgpr_write_b32 a195, v239
    v_accvgpr_read_b32 v236, a196
    v_accvgpr_read_b32 v237, a197
    v_accvgpr_read_b32 v238, a198
    v_accvgpr_read_b32 v239, a199
    s_nop 0
    v_mul_f32 v236, v236, v233
    v_mul_f32 v237, v237, v233
    v_mul_f32 v238, v238, v233
    v_mul_f32 v239, v239, v233
    v_accvgpr_write_b32 a196, v236
    v_accvgpr_write_b32 a197, v237
    v_accvgpr_write_b32 a198, v238
    v_accvgpr_write_b32 a199, v239
    v_accvgpr_read_b32 v236, a200
    v_accvgpr_read_b32 v237, a201
    v_accvgpr_read_b32 v238, a202
    v_accvgpr_read_b32 v239, a203
    s_nop 0
    v_mul_f32 v236, v236, v234
    v_mul_f32 v237, v237, v234
    v_mul_f32 v238, v238, v234
    v_mul_f32 v239, v239, v234
    v_accvgpr_write_b32 a200, v236
    v_accvgpr_write_b32 a201, v237
    v_accvgpr_write_b32 a202, v238
    v_accvgpr_write_b32 a203, v239
    v_accvgpr_read_b32 v236, a204
    v_accvgpr_read_b32 v237, a205
    v_accvgpr_read_b32 v238, a206
    v_accvgpr_read_b32 v239, a207
    s_nop 0
    v_mul_f32 v236, v236, v235
    v_mul_f32 v237, v237, v235
    v_mul_f32 v238, v238, v235
    v_mul_f32 v239, v239, v235
    v_accvgpr_write_b32 a204, v236
    v_accvgpr_write_b32 a205, v237
    v_accvgpr_write_b32 a206, v238
    v_accvgpr_write_b32 a207, v239
    v_accvgpr_read_b32 v236, a208
    v_accvgpr_read_b32 v237, a209
    v_accvgpr_read_b32 v238, a210
    v_accvgpr_read_b32 v239, a211
    s_nop 0
    v_mul_f32 v236, v236, v232
    v_mul_f32 v237, v237, v232
    v_mul_f32 v238, v238, v232
    v_mul_f32 v239, v239, v232
    v_accvgpr_write_b32 a208, v236
    v_accvgpr_write_b32 a209, v237
    v_accvgpr_write_b32 a210, v238
    v_accvgpr_write_b32 a211, v239
    v_accvgpr_read_b32 v236, a212
    v_accvgpr_read_b32 v237, a213
    v_accvgpr_read_b32 v238, a214
    v_accvgpr_read_b32 v239, a215
    s_nop 0
    v_mul_f32 v236, v236, v233
    v_mul_f32 v237, v237, v233
    v_mul_f32 v238, v238, v233
    v_mul_f32 v239, v239, v233
    v_accvgpr_write_b32 a212, v236
    v_accvgpr_write_b32 a213, v237
    v_accvgpr_write_b32 a214, v238
    v_accvgpr_write_b32 a215, v239
    v_accvgpr_read_b32 v236, a216
    v_accvgpr_read_b32 v237, a217
    v_accvgpr_read_b32 v238, a218
    v_accvgpr_read_b32 v239, a219
    s_nop 0
    v_mul_f32 v236, v236, v234
    v_mul_f32 v237, v237, v234
    v_mul_f32 v238, v238, v234
    v_mul_f32 v239, v239, v234
    v_accvgpr_write_b32 a216, v236
    v_accvgpr_write_b32 a217, v237
    v_accvgpr_write_b32 a218, v238
    v_accvgpr_write_b32 a219, v239
    v_accvgpr_read_b32 v236, a220
    v_accvgpr_read_b32 v237, a221
    v_accvgpr_read_b32 v238, a222
    v_accvgpr_read_b32 v239, a223
    s_nop 0
    v_mul_f32 v236, v236, v235
    v_mul_f32 v237, v237, v235
    v_mul_f32 v238, v238, v235
    v_mul_f32 v239, v239, v235
    v_accvgpr_write_b32 a220, v236
    v_accvgpr_write_b32 a221, v237
    v_accvgpr_write_b32 a222, v238
    v_accvgpr_write_b32 a223, v239
    v_accvgpr_read_b32 v236, a224
    v_accvgpr_read_b32 v237, a225
    v_accvgpr_read_b32 v238, a226
    v_accvgpr_read_b32 v239, a227
    s_nop 0
    v_mul_f32 v236, v236, v232
    v_mul_f32 v237, v237, v232
    v_mul_f32 v238, v238, v232
    v_mul_f32 v239, v239, v232
    v_accvgpr_write_b32 a224, v236
    v_accvgpr_write_b32 a225, v237
    v_accvgpr_write_b32 a226, v238
    v_accvgpr_write_b32 a227, v239
    v_accvgpr_read_b32 v236, a228
    v_accvgpr_read_b32 v237, a229
    v_accvgpr_read_b32 v238, a230
    v_accvgpr_read_b32 v239, a231
    s_nop 0
    v_mul_f32 v236, v236, v233
    v_mul_f32 v237, v237, v233
    v_mul_f32 v238, v238, v233
    v_mul_f32 v239, v239, v233
    v_accvgpr_write_b32 a228, v236
    v_accvgpr_write_b32 a229, v237
    v_accvgpr_write_b32 a230, v238
    v_accvgpr_write_b32 a231, v239
    v_accvgpr_read_b32 v236, a232
    v_accvgpr_read_b32 v237, a233
    v_accvgpr_read_b32 v238, a234
    v_accvgpr_read_b32 v239, a235
    s_nop 0
    v_mul_f32 v236, v236, v234
    v_mul_f32 v237, v237, v234
    v_mul_f32 v238, v238, v234
    v_mul_f32 v239, v239, v234
    v_accvgpr_write_b32 a232, v236
    v_accvgpr_write_b32 a233, v237
    v_accvgpr_write_b32 a234, v238
    v_accvgpr_write_b32 a235, v239
    v_accvgpr_read_b32 v236, a236
    v_accvgpr_read_b32 v237, a237
    v_accvgpr_read_b32 v238, a238
    v_accvgpr_read_b32 v239, a239
    s_nop 0
    v_mul_f32 v236, v236, v235
    v_mul_f32 v237, v237, v235
    v_mul_f32 v238, v238, v235
    v_mul_f32 v239, v239, v235
    v_accvgpr_write_b32 a236, v236
    v_accvgpr_write_b32 a237, v237
    v_accvgpr_write_b32 a238, v238
    v_accvgpr_write_b32 a239, v239
    v_accvgpr_read_b32 v236, a240
    v_accvgpr_read_b32 v237, a241
    v_accvgpr_read_b32 v238, a242
    v_accvgpr_read_b32 v239, a243
    s_nop 0
    v_mul_f32 v236, v236, v232
    v_mul_f32 v237, v237, v232
    v_mul_f32 v238, v238, v232
    v_mul_f32 v239, v239, v232
    v_accvgpr_write_b32 a240, v236
    v_accvgpr_write_b32 a241, v237
    v_accvgpr_write_b32 a242, v238
    v_accvgpr_write_b32 a243, v239
    v_accvgpr_read_b32 v236, a244
    v_accvgpr_read_b32 v237, a245
    v_accvgpr_read_b32 v238, a246
    v_accvgpr_read_b32 v239, a247
    s_nop 0
    v_mul_f32 v236, v236, v233
    v_mul_f32 v237, v237, v233
    v_mul_f32 v238, v238, v233
    v_mul_f32 v239, v239, v233
    v_accvgpr_write_b32 a244, v236
    v_accvgpr_write_b32 a245, v237
    v_accvgpr_write_b32 a246, v238
    v_accvgpr_write_b32 a247, v239
    v_accvgpr_read_b32 v236, a248
    v_accvgpr_read_b32 v237, a249
    v_accvgpr_read_b32 v238, a250
    v_accvgpr_read_b32 v239, a251
    s_nop 0
    v_mul_f32 v236, v236, v234
    v_mul_f32 v237, v237, v234
    v_mul_f32 v238, v238, v234
    v_mul_f32 v239, v239, v234
    v_accvgpr_write_b32 a248, v236
    v_accvgpr_write_b32 a249, v237
    v_accvgpr_write_b32 a250, v238
    v_accvgpr_write_b32 a251, v239
    v_accvgpr_read_b32 v236, a252
    v_accvgpr_read_b32 v237, a253
    v_accvgpr_read_b32 v238, a254
    v_accvgpr_read_b32 v239, a255
    s_nop 0
    v_mul_f32 v236, v236, v235
    v_mul_f32 v237, v237, v235
    v_mul_f32 v238, v238, v235
    v_mul_f32 v239, v239, v235
    v_accvgpr_write_b32 a252, v236
    v_accvgpr_write_b32 a253, v237
    v_accvgpr_write_b32 a254, v238
    v_accvgpr_write_b32 a255, v239
    v_exp_f32 v232, v128
    v_exp_f32 v233, v129
    v_add_f32 v244, v232, v240
    v_exp_f32 v234, v130
    v_add_f32 v244, v233, v244
    v_exp_f32 v235, v131
    v_add_f32 v244, v234, v244
    v_cvt_pk_bf16_f32 v176, v232, v233
    v_exp_f32 v236, v132
    v_add_f32 v244, v235, v244
    v_exp_f32 v237, v133
    v_add_f32 v245, v236, v241
    v_cvt_pk_bf16_f32 v177, v234, v235
    v_exp_f32 v238, v134
    v_add_f32 v245, v237, v245
    v_exp_f32 v239, v135
    v_add_f32 v245, v238, v245
    v_cvt_pk_bf16_f32 v180, v236, v237
    v_exp_f32 v232, v136
    v_add_f32 v245, v239, v245
    v_exp_f32 v233, v137
    v_add_f32 v246, v232, v242
    v_cvt_pk_bf16_f32 v181, v238, v239
    v_exp_f32 v234, v138
    v_add_f32 v246, v233, v246
    v_exp_f32 v235, v139
    v_add_f32 v246, v234, v246
    v_cvt_pk_bf16_f32 v184, v232, v233
    v_exp_f32 v236, v140
    v_add_f32 v246, v235, v246
    v_exp_f32 v237, v141
    v_add_f32 v247, v236, v243
    v_cvt_pk_bf16_f32 v185, v234, v235
    v_exp_f32 v238, v142
    v_add_f32 v247, v237, v247
    v_exp_f32 v239, v143
    v_add_f32 v247, v238, v247
    v_cvt_pk_bf16_f32 v188, v236, v237
    v_add_f32 v247, v239, v247
    v_cvt_pk_bf16_f32 v189, v238, v239
    v_exp_f32 v232, v144
    v_exp_f32 v233, v145
    v_add_f32 v244, v232, v244
    v_exp_f32 v234, v146
    v_add_f32 v244, v233, v244
    v_exp_f32 v235, v147
    v_add_f32 v244, v234, v244
    v_cvt_pk_bf16_f32 v178, v232, v233
    v_exp_f32 v236, v148
    v_add_f32 v244, v235, v244
    v_exp_f32 v237, v149
    v_add_f32 v245, v236, v245
    v_cvt_pk_bf16_f32 v179, v234, v235
    v_exp_f32 v238, v150
    v_add_f32 v245, v237, v245
    v_exp_f32 v239, v151
    v_add_f32 v245, v238, v245
    v_cvt_pk_bf16_f32 v182, v236, v237
    v_exp_f32 v232, v152
    v_add_f32 v245, v239, v245
    v_exp_f32 v233, v153
    v_add_f32 v246, v232, v246
    v_cvt_pk_bf16_f32 v183, v238, v239
    v_exp_f32 v234, v154
    v_add_f32 v246, v233, v246
    v_exp_f32 v235, v155
    v_add_f32 v246, v234, v246
    v_cvt_pk_bf16_f32 v186, v232, v233
    v_exp_f32 v236, v156
    v_add_f32 v246, v235, v246
    v_exp_f32 v237, v157
    v_add_f32 v247, v236, v247
    v_cvt_pk_bf16_f32 v187, v234, v235
    v_exp_f32 v238, v158
    v_add_f32 v247, v237, v247
    v_exp_f32 v239, v159
    v_add_f32 v247, v238, v247
    v_cvt_pk_bf16_f32 v190, v236, v237
    v_add_f32 v247, v239, v247
    v_cvt_pk_bf16_f32 v191, v238, v239
    s_nop 1
    s_branch L_retZ
L_slowA:
    s_nop 7
    s_nop 3
    v_max3_f32 v232, v128, v129, v130
    v_max3_f32 v233, v132, v133, v134
    v_max3_f32 v234, v136, v137, v138
    v_max3_f32 v235, v140, v141, v142
    v_max3_f32 v232, v232, v131, v144
    v_max3_f32 v233, v233, v135, v148
    v_max3_f32 v234, v234, v139, v152
    v_max3_f32 v235, v235, v143, v156
    v_max3_f32 v232, v232, v145, v146
    v_max3_f32 v233, v233, v149, v150
    v_max3_f32 v234, v234, v153, v154
    v_max3_f32 v235, v235, v157, v158
    v_max_f32 v232, v232, v147
    v_max_f32 v233, v233, v151
    v_max_f32 v234, v234, v155
    v_max_f32 v235, v235, v159
    s_nop 0
    v_mov_b32 v236, v232
    v_mov_b32 v237, v233
    v_mov_b32 v238, v234
    v_mov_b32 v239, v235
    v_permlane16_swap_b32 v232, v236
    v_permlane16_swap_b32 v233, v237
    v_permlane16_swap_b32 v234, v238
    v_permlane16_swap_b32 v235, v239
    v_max_f32 v232, v232, v236
    v_max_f32 v233, v233, v237
    v_max_f32 v234, v234, v238
    v_max_f32 v235, v235, v239
    v_mov_b32 v236, v232
    v_mov_b32 v237, v233
    v_mov_b32 v238, v234
    v_mov_b32 v239, v235
    v_permlane32_swap_b32 v232, v236
    v_permlane32_swap_b32 v233, v237
    v_permlane32_swap_b32 v234, v238
    v_permlane32_swap_b32 v235, v239
    v_max_f32 v232, v232, v236
    v_max_f32 v233, v233, v237
    v_max_f32 v234, v234, v238
    v_max_f32 v235, v235, v239
    v_max_f32 v232, 0, v232
    v_max_f32 v233, 0, v233
    v_max_f32 v234, 0, v234
    v_max_f32 v235, 0, v235
    v_sub_f32 v128, v128, v232
    v_sub_f32 v129, v129, v232
    v_sub_f32 v130, v130, v232
    v_sub_f32 v131, v131, v232
    v_sub_f32 v144, v144, v232
    v_sub_f32 v145, v145, v232
    v_sub_f32 v146, v146, v232
    v_sub_f32 v147, v147, v232
    v_sub_f32 v192, v192, v232
    v_sub_f32 v193, v193, v232
    v_sub_f32 v194, v194, v232
    v_sub_f32 v195, v195, v232
    v_sub_f32 v132, v132, v233
    v_sub_f32 v133, v133, v233
    v_sub_f32 v134, v134, v233
    v_sub_f32 v135, v135, v233
    v_sub_f32 v148, v148, v233
    v_sub_f32 v149, v149, v233
    v_sub_f32 v150, v150, v233
    v_sub_f32 v151, v151, v233
    v_sub_f32 v196, v196, v233
    v_sub_f32 v197, v197, v233
    v_sub_f32 v198, v198, v233
    v_sub_f32 v199, v199, v233
    v_sub_f32 v136, v136, v234
    v_sub_f32 v137, v137, v234
    v_sub_f32 v138, v138, v234
    v_sub_f32 v139, v139, v234
    v_sub_f32 v152, v152, v234
    v_sub_f32 v153, v153, v234
    v_sub_f32 v154, v154, v234
    v_sub_f32 v155, v155, v234
    v_sub_f32 v200, v200, v234
    v_sub_f32 v201, v201, v234
    v_sub_f32 v202, v202, v234
    v_sub_f32 v203, v203, v234
    v_sub_f32 v140, v140, v235
    v_sub_f32 v141, v141, v235
    v_sub_f32 v142, v142, v235
    v_sub_f32 v143, v143, v235
    v_sub_f32 v156, v156, v235
    v_sub_f32 v157, v157, v235
    v_sub_f32 v158, v158, v235
    v_sub_f32 v159, v159, v235
    v_sub_f32 v204, v204, v235
    v_sub_f32 v205, v205, v235
    v_sub_f32 v206, v206, v235
    v_sub_f32 v207, v207, v235
    v_exp_f32 v232, -v232
    v_exp_f32 v233, -v233
    v_exp_f32 v234, -v234
    v_exp_f32 v235, -v235
    s_nop 0
    v_mul_f32 v244, v244, v232
    v_mul_f32 v245, v245, v233
    v_mul_f32 v246, v246, v234
    v_mul_f32 v247, v247, v235
    v_accvgpr_read_b32 v236, a0
    v_accvgpr_read_b32 v237, a1
    v_accvgpr_read_b32 v238, a2
    v_accvgpr_read_b32 v239, a3
    s_nop 0
    v_mul_f32 v236, v236, v232
    v_mul_f32 v237, v237, v232
    v_mul_f32 v238, v238, v232
    v_mul_f32 v239, v239, v232
    v_accvgpr_write_b32 a0, v236
    v_accvgpr_write_b32 a1, v237
    v_accvgpr_write_b32 a2, v238
    v_accvgpr_write_b32 a3, v239
    v_accvgpr_read_b32 v236, a4
    v_accvgpr_read_b32 v237, a5
    v_accvgpr_read_b32 v238, a6
    v_accvgpr_read_b32 v239, a7
    s_nop 0
    v_mul_f32 v236, v236, v233
    v_mul_f32 v237, v237, v233
    v_mul_f32 v238, v238, v233
    v_mul_f32 v239, v239, v233
    v_accvgpr_write_b32 a4, v236
    v_accvgpr_write_b32 a5, v237
    v_accvgpr_write_b32 a6, v238
    v_accvgpr_write_b32 a7, v239
    v_accvgpr_read_b32 v236, a8
    v_accvgpr_read_b32 v237, a9
    v_accvgpr_read_b32 v238, a10
    v_accvgpr_read_b32 v239, a11
    s_nop 0
    v_mul_f32 v236, v236, v234
    v_mul_f32 v237, v237, v234
    v_mul_f32 v238, v238, v234
    v_mul_f32 v239, v239, v234
    v_accvgpr_write_b32 a8, v236
    v_accvgpr_write_b32 a9, v237
    v_accvgpr_write_b32 a10, v238
    v_accvgpr_write_b32 a11, v239
    v_accvgpr_read_b32 v236, a12
    v_accvgpr_read_b32 v237, a13
    v_accvgpr_read_b32 v238, a14
    v_accvgpr_read_b32 v239, a15
    s_nop 0
    v_mul_f32 v236, v236, v235
    v_mul_f32 v237, v237, v235
    v_mul_f32 v238, v238, v235
    v_mul_f32 v239, v239, v235
    v_accvgpr_write_b32 a12, v236
    v_accvgpr_write_b32 a13, v237
    v_accvgpr_write_b32 a14, v238
    v_accvgpr_write_b32 a15, v239
    v_accvgpr_read_b32 v236, a16
    v_accvgpr_read_b32 v237, a17
    v_accvgpr_read_b32 v238, a18
    v_accvgpr_read_b32 v239, a19
    s_nop 0
    v_mul_f32 v236, v236, v232
    v_mul_f32 v237, v237, v232
    v_mul_f32 v238, v238, v232
    v_mul_f32 v239, v239, v232
    v_accvgpr_write_b32 a16, v236
    v_accvgpr_write_b32 a17, v237
    v_accvgpr_write_b32 a18, v238
    v_accvgpr_write_b32 a19, v239
    v_accvgpr_read_b32 v236, a20
    v_accvgpr_read_b32 v237, a21
    v_accvgpr_read_b32 v238, a22
    v_accvgpr_read_b32 v239, a23
    s_nop 0
    v_mul_f32 v236, v236, v233
    v_mul_f32 v237, v237, v233
    v_mul_f32 v238, v238, v233
    v_mul_f32 v239, v239, v233
    v_accvgpr_write_b32 a20, v236
    v_accvgpr_write_b32 a21, v237
    v_accvgpr_write_b32 a22, v238
    v_accvgpr_write_b32 a23, v239
    v_accvgpr_read_b32 v236, a24
    v_accvgpr_read_b32 v237, a25
    v_accvgpr_read_b32 v238, a26
    v_accvgpr_read_b32 v239, a27
    s_nop 0
    v_mul_f32 v236, v236, v234
    v_mul_f32 v237, v237, v234
    v_mul_f32 v238, v238, v234
    v_mul_f32 v239, v239, v234
    v_accvgpr_write_b32 a24, v236
    v_accvgpr_write_b32 a25, v237
    v_accvgpr_write_b32 a26, v238
    v_accvgpr_write_b32 a27, v239
    v_accvgpr_read_b32 v236, a28
    v_accvgpr_read_b32 v237, a29
    v_accvgpr_read_b32 v238, a30
    v_accvgpr_read_b32 v239, a31
    s_nop 0
    v_mul_f32 v236, v236, v235
    v_mul_f32 v237, v237, v235
    v_mul_f32 v238, v238, v235
    v_mul_f32 v239, v239, v235
    v_accvgpr_write_b32 a28, v236
    v_accvgpr_write_b32 a29, v237
    v_accvgpr_write_b32 a30, v238
    v_accvgpr_write_b32 a31, v239
    v_accvgpr_read_b32 v236, a32
    v_accvgpr_read_b32 v237, a33
    v_accvgpr_read_b32 v238, a34
    v_accvgpr_read_b32 v239, a35
    s_nop 0
    v_mul_f32 v236, v236, v232
    v_mul_f32 v237, v237, v232
    v_mul_f32 v238, v238, v232
    v_mul_f32 v239, v239, v232
    v_accvgpr_write_b32 a32, v236
    v_accvgpr_write_b32 a33, v237
    v_accvgpr_write_b32 a34, v238
    v_accvgpr_write_b32 a35, v239
    v_accvgpr_read_b32 v236, a36
    v_accvgpr_read_b32 v237, a37
    v_accvgpr_read_b32 v238, a38
    v_accvgpr_read_b32 v239, a39
    s_nop 0
    v_mul_f32 v236, v236, v233
    v_mul_f32 v237, v237, v233
    v_mul_f32 v238, v238, v233
    v_mul_f32 v239, v239, v233
    v_accvgpr_write_b32 a36, v236
    v_accvgpr_write_b32 a37, v237
    v_accvgpr_write_b32 a38, v238
    v_accvgpr_write_b32 a39, v239
    v_accvgpr_read_b32 v236, a40
    v_accvgpr_read_b32 v237, a41
    v_accvgpr_read_b32 v238, a42
    v_accvgpr_read_b32 v239, a43
    s_nop 0
    v_mul_f32 v236, v236, v234
    v_mul_f32 v237, v237, v234
    v_mul_f32 v238, v238, v234
    v_mul_f32 v239, v239, v234
    v_accvgpr_write_b32 a40, v236
    v_accvgpr_write_b32 a41, v237
    v_accvgpr_write_b32 a42, v238
    v_accvgpr_write_b32 a43, v239
    v_accvgpr_read_b32 v236, a44
    v_accvgpr_read_b32 v237, a45
    v_accvgpr_read_b32 v238, a46
    v_accvgpr_read_b32 v239, a47
    s_nop 0
    v_mul_f32 v236, v236, v235
    v_mul_f32 v237, v237, v235
    v_mul_f32 v238, v238, v235
    v_mul_f32 v239, v239, v235
    v_accvgpr_write_b32 a44, v236
    v_accvgpr_write_b32 a45, v237
    v_accvgpr_write_b32 a46, v238
    v_accvgpr_write_b32 a47, v239
    v_accvgpr_read_b32 v236, a48
    v_accvgpr_read_b32 v237, a49
    v_accvgpr_read_b32 v238, a50
    v_accvgpr_read_b32 v239, a51
    s_nop 0
    v_mul_f32 v236, v236, v232
    v_mul_f32 v237, v237, v232
    v_mul_f32 v238, v238, v232
    v_mul_f32 v239, v239, v232
    v_accvgpr_write_b32 a48, v236
    v_accvgpr_write_b32 a49, v237
    v_accvgpr_write_b32 a50, v238
    v_accvgpr_write_b32 a51, v239
    v_accvgpr_read_b32 v236, a52
    v_accvgpr_read_b32 v237, a53
    v_accvgpr_read_b32 v238, a54
    v_accvgpr_read_b32 v239, a55
    s_nop 0
    v_mul_f32 v236, v236, v233
    v_mul_f32 v237, v237, v233
    v_mul_f32 v238, v238, v233
    v_mul_f32 v239, v239, v233
    v_accvgpr_write_b32 a52, v236
    v_accvgpr_write_b32 a53, v237
    v_accvgpr_write_b32 a54, v238
    v_accvgpr_write_b32 a55, v239
    v_accvgpr_read_b32 v236, a56
    v_accvgpr_read_b32 v237, a57
    v_accvgpr_read_b32 v238, a58
    v_accvgpr_read_b32 v239, a59
    s_nop 0
    v_mul_f32 v236, v236, v234
    v_mul_f32 v237, v237, v234
    v_mul_f32 v238, v238, v234
    v_mul_f32 v239, v239, v234
    v_accvgpr_write_b32 a56, v236
    v_accvgpr_write_b32 a57, v237
    v_accvgpr_write_b32 a58, v238
    v_accvgpr_write_b32 a59, v239
    v_accvgpr_read_b32 v236, a60
    v_accvgpr_read_b32 v237, a61
    v_accvgpr_read_b32 v238, a62
    v_accvgpr_read_b32 v239, a63
    s_nop 0
    v_mul_f32 v236, v236, v235
    v_mul_f32 v237, v237, v235
    v_mul_f32 v238, v238, v235
    v_mul_f32 v239, v239, v235
    v_accvgpr_write_b32 a60, v236
    v_accvgpr_write_b32 a61, v237
    v_accvgpr_write_b32 a62, v238
    v_accvgpr_write_b32 a63, v239
    v_accvgpr_read_b32 v236, a64
    v_accvgpr_read_b32 v237, a65
    v_accvgpr_read_b32 v238, a66
    v_accvgpr_read_b32 v239, a67
    s_nop 0
    v_mul_f32 v236, v236, v232
    v_mul_f32 v237, v237, v232
    v_mul_f32 v238, v238, v232
    v_mul_f32 v239, v239, v232
    v_accvgpr_write_b32 a64, v236
    v_accvgpr_write_b32 a65, v237
    v_accvgpr_write_b32 a66, v238
    v_accvgpr_write_b32 a67, v239
    v_accvgpr_read_b32 v236, a68
    v_accvgpr_read_b32 v237, a69
    v_accvgpr_read_b32 v238, a70
    v_accvgpr_read_b32 v239, a71
    s_nop 0
    v_mul_f32 v236, v236, v233
    v_mul_f32 v237, v237, v233
    v_mul_f32 v238, v238, v233
    v_mul_f32 v239, v239, v233
    v_accvgpr_write_b32 a68, v236
    v_accvgpr_write_b32 a69, v237
    v_accvgpr_write_b32 a70, v238
    v_accvgpr_write_b32 a71, v239
    v_accvgpr_read_b32 v236, a72
    v_accvgpr_read_b32 v237, a73
    v_accvgpr_read_b32 v238, a74
    v_accvgpr_read_b32 v239, a75
    s_nop 0
    v_mul_f32 v236, v236, v234
    v_mul_f32 v237, v237, v234
    v_mul_f32 v238, v238, v234
    v_mul_f32 v239, v239, v234
    v_accvgpr_write_b32 a72, v236
    v_accvgpr_write_b32 a73, v237
    v_accvgpr_write_b32 a74, v238
    v_accvgpr_write_b32 a75, v239
    v_accvgpr_read_b32 v236, a76
    v_accvgpr_read_b32 v237, a77
    v_accvgpr_read_b32 v238, a78
    v_accvgpr_read_b32 v239, a79
    s_nop 0
    v_mul_f32 v236, v236, v235
    v_mul_f32 v237, v237, v235
    v_mul_f32 v238, v238, v235
    v_mul_f32 v239, v239, v235
    v_accvgpr_write_b32 a76, v236
    v_accvgpr_write_b32 a77, v237
    v_accvgpr_write_b32 a78, v238
    v_accvgpr_write_b32 a79, v239
    v_accvgpr_read_b32 v236, a80
    v_accvgpr_read_b32 v237, a81
    v_accvgpr_read_b32 v238, a82
    v_accvgpr_read_b32 v239, a83
    s_nop 0
    v_mul_f32 v236, v236, v232
    v_mul_f32 v237, v237, v232
    v_mul_f32 v238, v238, v232
    v_mul_f32 v239, v239, v232
    v_accvgpr_write_b32 a80, v236
    v_accvgpr_write_b32 a81, v237
    v_accvgpr_write_b32 a82, v238
    v_accvgpr_write_b32 a83, v239
    v_accvgpr_read_b32 v236, a84
    v_accvgpr_read_b32 v237, a85
    v_accvgpr_read_b32 v238, a86
    v_accvgpr_read_b32 v239, a87
    s_nop 0
    v_mul_f32 v236, v236, v233
    v_mul_f32 v237, v237, v233
    v_mul_f32 v238, v238, v233
    v_mul_f32 v239, v239, v233
    v_accvgpr_write_b32 a84, v236
    v_accvgpr_write_b32 a85, v237
    v_accvgpr_write_b32 a86, v238
    v_accvgpr_write_b32 a87, v239
    v_accvgpr_read_b32 v236, a88
    v_accvgpr_read_b32 v237, a89
    v_accvgpr_read_b32 v238, a90
    v_accvgpr_read_b32 v239, a91
    s_nop 0
    v_mul_f32 v236, v236, v234
    v_mul_f32 v237, v237, v234
    v_mul_f32 v238, v238, v234
    v_mul_f32 v239, v239, v234
    v_accvgpr_write_b32 a88, v236
    v_accvgpr_write_b32 a89, v237
    v_accvgpr_write_b32 a90, v238
    v_accvgpr_write_b32 a91, v239
    v_accvgpr_read_b32 v236, a92
    v_accvgpr_read_b32 v237, a93
    v_accvgpr_read_b32 v238, a94
    v_accvgpr_read_b32 v239, a95
    s_nop 0
    v_mul_f32 v236, v236, v235
    v_mul_f32 v237, v237, v235
    v_mul_f32 v238, v238, v235
    v_mul_f32 v239, v239, v235
    v_accvgpr_write_b32 a92, v236
    v_accvgpr_write_b32 a93, v237
    v_accvgpr_write_b32 a94, v238
    v_accvgpr_write_b32 a95, v239
    v_accvgpr_read_b32 v236, a96
    v_accvgpr_read_b32 v237, a97
    v_accvgpr_read_b32 v238, a98
    v_accvgpr_read_b32 v239, a99
    s_nop 0
    v_mul_f32 v236, v236, v232
    v_mul_f32 v237, v237, v232
    v_mul_f32 v238, v238, v232
    v_mul_f32 v239, v239, v232
    v_accvgpr_write_b32 a96, v236
    v_accvgpr_write_b32 a97, v237
    v_accvgpr_write_b32 a98, v238
    v_accvgpr_write_b32 a99, v239
    v_accvgpr_read_b32 v236, a100
    v_accvgpr_read_b32 v237, a101
    v_accvgpr_read_b32 v238, a102
    v_accvgpr_read_b32 v239, a103
    s_nop 0
    v_mul_f32 v236, v236, v233
    v_mul_f32 v237, v237, v233
    v_mul_f32 v238, v238, v233
    v_mul_f32 v239, v239, v233
    v_accvgpr_write_b32 a100, v236
    v_accvgpr_write_b32 a101, v237
    v_accvgpr_write_b32 a102, v238
    v_accvgpr_write_b32 a103, v239
    v_accvgpr_read_b32 v236, a104
    v_accvgpr_read_b32 v237, a105
    v_accvgpr_read_b32 v238, a106
    v_accvgpr_read_b32 v239, a107
    s_nop 0
    v_mul_f32 v236, v236, v234
    v_mul_f32 v237, v237, v234
    v_mul_f32 v238, v238, v234
    v_mul_f32 v239, v239, v234
    v_accvgpr_write_b32 a104, v236
    v_accvgpr_write_b32 a105, v237
    v_accvgpr_write_b32 a106, v238
    v_accvgpr_write_b32 a107, v239
    v_accvgpr_read_b32 v236, a108
    v_accvgpr_read_b32 v237, a109
    v_accvgpr_read_b32 v238, a110
    v_accvgpr_read_b32 v239, a111
    s_nop 0
    v_mul_f32 v236, v236, v235
    v_mul_f32 v237, v237, v235
    v_mul_f32 v238, v238, v235
    v_mul_f32 v239, v239, v235
    v_accvgpr_write_b32 a108, v236
    v_accvgpr_write_b32 a109, v237
    v_accvgpr_write_b32 a110, v238
    v_accvgpr_write_b32 a111, v239
    v_accvgpr_read_b32 v236, a112
    v_accvgpr_read_b32 v237, a113
    v_accvgpr_read_b32 v238, a114
    v_accvgpr_read_b32 v239, a115
    s_nop 0
    v_mul_f32 v236, v236, v232
    v_mul_f32 v237, v237, v232
    v_mul_f32 v238, v238, v232
    v_mul_f32 v239, v239, v232
    v_accvgpr_write_b32 a112, v236
    v_accvgpr_write_b32 a113, v237
    v_accvgpr_write_b32 a114, v238
    v_accvgpr_write_b32 a115, v239
    v_accvgpr_read_b32 v236, a116
    v_accvgpr_read_b32 v237, a117
    v_accvgpr_read_b32 v238, a118
    v_accvgpr_read_b32 v239, a119
    s_nop 0
    v_mul_f32 v236, v236, v233
    v_mul_f32 v237, v237, v233
    v_mul_f32 v238, v238, v233
    v_mul_f32 v239, v239, v233
    v_accvgpr_write_b32 a116, v236
    v_accvgpr_write_b32 a117, v237
    v_accvgpr_write_b32 a118, v238
    v_accvgpr_write_b32 a119, v239
    v_accvgpr_read_b32 v236, a120
    v_accvgpr_read_b32 v237, a121
    v_accvgpr_read_b32 v238, a122
    v_accvgpr_read_b32 v239, a123
    s_nop 0
    v_mul_f32 v236, v236, v234
    v_mul_f32 v237, v237, v234
    v_mul_f32 v238, v238, v234
    v_mul_f32 v239, v239, v234
    v_accvgpr_write_b32 a120, v236
    v_accvgpr_write_b32 a121, v237
    v_accvgpr_write_b32 a122, v238
    v_accvgpr_write_b32 a123, v239
    v_accvgpr_read_b32 v236, a124
    v_accvgpr_read_b32 v237, a125
    v_accvgpr_read_b32 v238, a126
    v_accvgpr_read_b32 v239, a127
    s_nop 0
    v_mul_f32 v236, v236, v235
    v_mul_f32 v237, v237, v235
    v_mul_f32 v238, v238, v235
    v_mul_f32 v239, v239, v235
    v_accvgpr_write_b32 a124, v236
    v_accvgpr_write_b32 a125, v237
    v_accvgpr_write_b32 a126, v238
    v_accvgpr_write_b32 a127, v239
    v_accvgpr_read_b32 v236, a128
    v_accvgpr_read_b32 v237, a129
    v_accvgpr_read_b32 v238, a130
    v_accvgpr_read_b32 v239, a131
    s_nop 0
    v_mul_f32 v236, v236, v232
    v_mul_f32 v237, v237, v232
    v_mul_f32 v238, v238, v232
    v_mul_f32 v239, v239, v232
    v_accvgpr_write_b32 a128, v236
    v_accvgpr_write_b32 a129, v237
    v_accvgpr_write_b32 a130, v238
    v_accvgpr_write_b32 a131, v239
    v_accvgpr_read_b32 v236, a132
    v_accvgpr_read_b32 v237, a133
    v_accvgpr_read_b32 v238, a134
    v_accvgpr_read_b32 v239, a135
    s_nop 0
    v_mul_f32 v236, v236, v233
    v_mul_f32 v237, v237, v233
    v_mul_f32 v238, v238, v233
    v_mul_f32 v239, v239, v233
    v_accvgpr_write_b32 a132, v236
    v_accvgpr_write_b32 a133, v237
    v_accvgpr_write_b32 a134, v238
    v_accvgpr_write_b32 a135, v239
    v_accvgpr_read_b32 v236, a136
    v_accvgpr_read_b32 v237, a137
    v_accvgpr_read_b32 v238, a138
    v_accvgpr_read_b32 v239, a139
    s_nop 0
    v_mul_f32 v236, v236, v234
    v_mul_f32 v237, v237, v234
    v_mul_f32 v238, v238, v234
    v_mul_f32 v239, v239, v234
    v_accvgpr_write_b32 a136, v236
    v_accvgpr_write_b32 a137, v237
    v_accvgpr_write_b32 a138, v238
    v_accvgpr_write_b32 a139, v239
    v_accvgpr_read_b32 v236, a140
    v_accvgpr_read_b32 v237, a141
    v_accvgpr_read_b32 v238, a142
    v_accvgpr_read_b32 v239, a143
    s_nop 0
    v_mul_f32 v236, v236, v235
    v_mul_f32 v237, v237, v235
    v_mul_f32 v238, v238, v235
    v_mul_f32 v239, v239, v235
    v_accvgpr_write_b32 a140, v236
    v_accvgpr_write_b32 a141, v237
    v_accvgpr_write_b32 a142, v238
    v_accvgpr_write_b32 a143, v239
    v_accvgpr_read_b32 v236, a144
    v_accvgpr_read_b32 v237, a145
    v_accvgpr_read_b32 v238, a146
    v_accvgpr_read_b32 v239, a147
    s_nop 0
    v_mul_f32 v236, v236, v232
    v_mul_f32 v237, v237, v232
    v_mul_f32 v238, v238, v232
    v_mul_f32 v239, v239, v232
    v_accvgpr_write_b32 a144, v236
    v_accvgpr_write_b32 a145, v237
    v_accvgpr_write_b32 a146, v238
    v_accvgpr_write_b32 a147, v239
    v_accvgpr_read_b32 v236, a148
    v_accvgpr_read_b32 v237, a149
    v_accvgpr_read_b32 v238, a150
    v_accvgpr_read_b32 v239, a151
    s_nop 0
    v_mul_f32 v236, v236, v233
    v_mul_f32 v237, v237, v233
    v_mul_f32 v238, v238, v233
    v_mul_f32 v239, v239, v233
    v_accvgpr_write_b32 a148, v236
    v_accvgpr_write_b32 a149, v237
    v_accvgpr_write_b32 a150, v238
    v_accvgpr_write_b32 a151, v239
    v_accvgpr_read_b32 v236, a152
    v_accvgpr_read_b32 v237, a153
    v_accvgpr_read_b32 v238, a154
    v_accvgpr_read_b32 v239, a155
    s_nop 0
    v_mul_f32 v236, v236, v234
    v_mul_f32 v237, v237, v234
    v_mul_f32 v238, v238, v234
    v_mul_f32 v239, v239, v234
    v_accvgpr_write_b32 a152, v236
    v_accvgpr_write_b32 a153, v237
    v_accvgpr_write_b32 a154, v238
    v_accvgpr_write_b32 a155, v239
    v_accvgpr_read_b32 v236, a156
    v_accvgpr_read_b32 v237, a157
    v_accvgpr_read_b32 v238, a158
    v_accvgpr_read_b32 v239, a159
    s_nop 0
    v_mul_f32 v236, v236, v235
    v_mul_f32 v237, v237, v235
    v_mul_f32 v238, v238, v235
    v_mul_f32 v239, v239, v235
    v_accvgpr_write_b32 a156, v236
    v_accvgpr_write_b32 a157, v237
    v_accvgpr_write_b32 a158, v238
    v_accvgpr_write_b32 a159, v239
    v_accvgpr_read_b32 v236, a160
    v_accvgpr_read_b32 v237, a161
    v_accvgpr_read_b32 v238, a162
    v_accvgpr_read_b32 v239, a163
    s_nop 0
    v_mul_f32 v236, v236, v232
    v_mul_f32 v237, v237, v232
    v_mul_f32 v238, v238, v232
    v_mul_f32 v239, v239, v232
    v_accvgpr_write_b32 a160, v236
    v_accvgpr_write_b32 a161, v237
    v_accvgpr_write_b32 a162, v238
    v_accvgpr_write_b32 a163, v239
    v_accvgpr_read_b32 v236, a164
    v_accvgpr_read_b32 v237, a165
    v_accvgpr_read_b32 v238, a166
    v_accvgpr_read_b32 v239, a167
    s_nop 0
    v_mul_f32 v236, v236, v233
    v_mul_f32 v237, v237, v233
    v_mul_f32 v238, v238, v233
    v_mul_f32 v239, v239, v233
    v_accvgpr_write_b32 a164, v236
    v_accvgpr_write_b32 a165, v237
    v_accvgpr_write_b32 a166, v238
    v_accvgpr_write_b32 a167, v239
    v_accvgpr_read_b32 v236, a168
    v_accvgpr_read_b32 v237, a169
    v_accvgpr_read_b32 v238, a170
    v_accvgpr_read_b32 v239, a171
    s_nop 0
    v_mul_f32 v236, v236, v234
    v_mul_f32 v237, v237, v234
    v_mul_f32 v238, v238, v234
    v_mul_f32 v239, v239, v234
    v_accvgpr_write_b32 a168, v236
    v_accvgpr_write_b32 a169, v237
    v_accvgpr_write_b32 a170, v238
    v_accvgpr_write_b32 a171, v239
    v_accvgpr_read_b32 v236, a172
    v_accvgpr_read_b32 v237, a173
    v_accvgpr_read_b32 v238, a174
    v_accvgpr_read_b32 v239, a175
    s_nop 0
    v_mul_f32 v236, v236, v235
    v_mul_f32 v237, v237, v235
    v_mul_f32 v238, v238, v235
    v_mul_f32 v239, v239, v235
    v_accvgpr_write_b32 a172, v236
    v_accvgpr_write_b32 a173, v237
    v_accvgpr_write_b32 a174, v238
    v_accvgpr_write_b32 a175, v239
    v_accvgpr_read_b32 v236, a176
    v_accvgpr_read_b32 v237, a177
    v_accvgpr_read_b32 v238, a178
    v_accvgpr_read_b32 v239, a179
    s_nop 0
    v_mul_f32 v236, v236, v232
    v_mul_f32 v237, v237, v232
    v_mul_f32 v238, v238, v232
    v_mul_f32 v239, v239, v232
    v_accvgpr_write_b32 a176, v236
    v_accvgpr_write_b32 a177, v237
    v_accvgpr_write_b32 a178, v238
    v_accvgpr_write_b32 a179, v239
    v_accvgpr_read_b32 v236, a180
    v_accvgpr_read_b32 v237, a181
    v_accvgpr_read_b32 v238, a182
    v_accvgpr_read_b32 v239, a183
    s_nop 0
    v_mul_f32 v236, v236, v233
    v_mul_f32 v237, v237, v233
    v_mul_f32 v238, v238, v233
    v_mul_f32 v239, v239, v233
    v_accvgpr_write_b32 a180, v236
    v_accvgpr_write_b32 a181, v237
    v_accvgpr_write_b32 a182, v238
    v_accvgpr_write_b32 a183, v239
    v_accvgpr_read_b32 v236, a184
    v_accvgpr_read_b32 v237, a185
    v_accvgpr_read_b32 v238, a186
    v_accvgpr_read_b32 v239, a187
    s_nop 0
    v_mul_f32 v236, v236, v234
    v_mul_f32 v237, v237, v234
    v_mul_f32 v238, v238, v234
    v_mul_f32 v239, v239, v234
    v_accvgpr_write_b32 a184, v236
    v_accvgpr_write_b32 a185, v237
    v_accvgpr_write_b32 a186, v238
    v_accvgpr_write_b32 a187, v239
    v_accvgpr_read_b32 v236, a188
    v_accvgpr_read_b32 v237, a189
    v_accvgpr_read_b32 v238, a190
    v_accvgpr_read_b32 v239, a191
    s_nop 0
    v_mul_f32 v236, v236, v235
    v_mul_f32 v237, v237, v235
    v_mul_f32 v238, v238, v235
    v_mul_f32 v239, v239, v235
    v_accvgpr_write_b32 a188, v236
    v_accvgpr_write_b32 a189, v237
    v_accvgpr_write_b32 a190, v238
    v_accvgpr_write_b32 a191, v239
    v_accvgpr_read_b32 v236, a192
    v_accvgpr_read_b32 v237, a193
    v_accvgpr_read_b32 v238, a194
    v_accvgpr_read_b32 v239, a195
    s_nop 0
    v_mul_f32 v236, v236, v232
    v_mul_f32 v237, v237, v232
    v_mul_f32 v238, v238, v232
    v_mul_f32 v239, v239, v232
    v_accvgpr_write_b32 a192, v236
    v_accvgpr_write_b32 a193, v237
    v_accvgpr_write_b32 a194, v238
    v_accvgpr_write_b32 a195, v239
    v_accvgpr_read_b32 v236, a196
    v_accvgpr_read_b32 v237, a197
    v_accvgpr_read_b32 v238, a198
    v_accvgpr_read_b32 v239, a199
    s_nop 0
    v_mul_f32 v236, v236, v233
    v_mul_f32 v237, v237, v233
    v_mul_f32 v238, v238, v233
    v_mul_f32 v239, v239, v233
    v_accvgpr_write_b32 a196, v236
    v_accvgpr_write_b32 a197, v237
    v_accvgpr_write_b32 a198, v238
    v_accvgpr_write_b32 a199, v239
    v_accvgpr_read_b32 v236, a200
    v_accvgpr_read_b32 v237, a201
    v_accvgpr_read_b32 v238, a202
    v_accvgpr_read_b32 v239, a203
    s_nop 0
    v_mul_f32 v236, v236, v234
    v_mul_f32 v237, v237, v234
    v_mul_f32 v238, v238, v234
    v_mul_f32 v239, v239, v234
    v_accvgpr_write_b32 a200, v236
    v_accvgpr_write_b32 a201, v237
    v_accvgpr_write_b32 a202, v238
    v_accvgpr_write_b32 a203, v239
    v_accvgpr_read_b32 v236, a204
    v_accvgpr_read_b32 v237, a205
    v_accvgpr_read_b32 v238, a206
    v_accvgpr_read_b32 v239, a207
    s_nop 0
    v_mul_f32 v236, v236, v235
    v_mul_f32 v237, v237, v235
    v_mul_f32 v238, v238, v235
    v_mul_f32 v239, v239, v235
    v_accvgpr_write_b32 a204, v236
    v_accvgpr_write_b32 a205, v237
    v_accvgpr_write_b32 a206, v238
    v_accvgpr_write_b32 a207, v239
    v_accvgpr_read_b32 v236, a208
    v_accvgpr_read_b32 v237, a209
    v_accvgpr_read_b32 v238, a210
    v_accvgpr_read_b32 v239, a211
    s_nop 0
    v_mul_f32 v236, v236, v232
    v_mul_f32 v237, v237, v232
    v_mul_f32 v238, v238, v232
    v_mul_f32 v239, v239, v232
    v_accvgpr_write_b32 a208, v236
    v_accvgpr_write_b32 a209, v237
    v_accvgpr_write_b32 a210, v238
    v_accvgpr_write_b32 a211, v239
    v_accvgpr_read_b32 v236, a212
    v_accvgpr_read_b32 v237, a213
    v_accvgpr_read_b32 v238, a214
    v_accvgpr_read_b32 v239, a215
    s_nop 0
    v_mul_f32 v236, v236, v233
    v_mul_f32 v237, v237, v233
    v_mul_f32 v238, v238, v233
    v_mul_f32 v239, v239, v233
    v_accvgpr_write_b32 a212, v236
    v_accvgpr_write_b32 a213, v237
    v_accvgpr_write_b32 a214, v238
    v_accvgpr_write_b32 a215, v239
    v_accvgpr_read_b32 v236, a216
    v_accvgpr_read_b32 v237, a217
    v_accvgpr_read_b32 v238, a218
    v_accvgpr_read_b32 v239, a219
    s_nop 0
    v_mul_f32 v236, v236, v234
    v_mul_f32 v237, v237, v234
    v_mul_f32 v238, v238, v234
    v_mul_f32 v239, v239, v234
    v_accvgpr_write_b32 a216, v236
    v_accvgpr_write_b32 a217, v237
    v_accvgpr_write_b32 a218, v238
    v_accvgpr_write_b32 a219, v239
    v_accvgpr_read_b32 v236, a220
    v_accvgpr_read_b32 v237, a221
    v_accvgpr_read_b32 v238, a222
    v_accvgpr_read_b32 v239, a223
    s_nop 0
    v_mul_f32 v236, v236, v235
    v_mul_f32 v237, v237, v235
    v_mul_f32 v238, v238, v235
    v_mul_f32 v239, v239, v235
    v_accvgpr_write_b32 a220, v236
    v_accvgpr_write_b32 a221, v237
    v_accvgpr_write_b32 a222, v238
    v_accvgpr_write_b32 a223, v239
    v_accvgpr_read_b32 v236, a224
    v_accvgpr_read_b32 v237, a225
    v_accvgpr_read_b32 v238, a226
    v_accvgpr_read_b32 v239, a227
    s_nop 0
    v_mul_f32 v236, v236, v232
    v_mul_f32 v237, v237, v232
    v_mul_f32 v238, v238, v232
    v_mul_f32 v239, v239, v232
    v_accvgpr_write_b32 a224, v236
    v_accvgpr_write_b32 a225, v237
    v_accvgpr_write_b32 a226, v238
    v_accvgpr_write_b32 a227, v239
    v_accvgpr_read_b32 v236, a228
    v_accvgpr_read_b32 v237, a229
    v_accvgpr_read_b32 v238, a230
    v_accvgpr_read_b32 v239, a231
    s_nop 0
    v_mul_f32 v236, v236, v233
    v_mul_f32 v237, v237, v233
    v_mul_f32 v238, v238, v233
    v_mul_f32 v239, v239, v233
    v_accvgpr_write_b32 a228, v236
    v_accvgpr_write_b32 a229, v237
    v_accvgpr_write_b32 a230, v238
    v_accvgpr_write_b32 a231, v239
    v_accvgpr_read_b32 v236, a232
    v_accvgpr_read_b32 v237, a233
    v_accvgpr_read_b32 v238, a234
    v_accvgpr_read_b32 v239, a235
    s_nop 0
    v_mul_f32 v236, v236, v234
    v_mul_f32 v237, v237, v234
    v_mul_f32 v238, v238, v234
    v_mul_f32 v239, v239, v234
    v_accvgpr_write_b32 a232, v236
    v_accvgpr_write_b32 a233, v237
    v_accvgpr_write_b32 a234, v238
    v_accvgpr_write_b32 a235, v239
    v_accvgpr_read_b32 v236, a236
    v_accvgpr_read_b32 v237, a237
    v_accvgpr_read_b32 v238, a238
    v_accvgpr_read_b32 v239, a239
    s_nop 0
    v_mul_f32 v236, v236, v235
    v_mul_f32 v237, v237, v235
    v_mul_f32 v238, v238, v235
    v_mul_f32 v239, v239, v235
    v_accvgpr_write_b32 a236, v236
    v_accvgpr_write_b32 a237, v237
    v_accvgpr_write_b32 a238, v238
    v_accvgpr_write_b32 a239, v239
    v_accvgpr_read_b32 v236, a240
    v_accvgpr_read_b32 v237, a241
    v_accvgpr_read_b32 v238, a242
    v_accvgpr_read_b32 v239, a243
    s_nop 0
    v_mul_f32 v236, v236, v232
    v_mul_f32 v237, v237, v232
    v_mul_f32 v238, v238, v232
    v_mul_f32 v239, v239, v232
    v_accvgpr_write_b32 a240, v236
    v_accvgpr_write_b32 a241, v237
    v_accvgpr_write_b32 a242, v238
    v_accvgpr_write_b32 a243, v239
    v_accvgpr_read_b32 v236, a244
    v_accvgpr_read_b32 v237, a245
    v_accvgpr_read_b32 v238, a246
    v_accvgpr_read_b32 v239, a247
    s_nop 0
    v_mul_f32 v236, v236, v233
    v_mul_f32 v237, v237, v233
    v_mul_f32 v238, v238, v233
    v_mul_f32 v239, v239, v233
    v_accvgpr_write_b32 a244, v236
    v_accvgpr_write_b32 a245, v237
    v_accvgpr_write_b32 a246, v238
    v_accvgpr_write_b32 a247, v239
    v_accvgpr_read_b32 v236, a248
    v_accvgpr_read_b32 v237, a249
    v_accvgpr_read_b32 v238, a250
    v_accvgpr_read_b32 v239, a251
    s_nop 0
    v_mul_f32 v236, v236, v234
    v_mul_f32 v237, v237, v234
    v_mul_f32 v238, v238, v234
    v_mul_f32 v239, v239, v234
    v_accvgpr_write_b32 a248, v236
    v_accvgpr_write_b32 a249, v237
    v_accvgpr_write_b32 a250, v238
    v_accvgpr_write_b32 a251, v239
    v_accvgpr_read_b32 v236, a252
    v_accvgpr_read_b32 v237, a253
    v_accvgpr_read_b32 v238, a254
    v_accvgpr_read_b32 v239, a255
    s_nop 0
    v_mul_f32 v236, v236, v235
    v_mul_f32 v237, v237, v235
    v_mul_f32 v238, v238, v235
    v_mul_f32 v239, v239, v235
    v_accvgpr_write_b32 a252, v236
    v_accvgpr_write_b32 a253, v237
    v_accvgpr_write_b32 a254, v238
    v_accvgpr_write_b32 a255, v239
    v_exp_f32 v232, v128
    v_exp_f32 v233, v129
    v_add_f32 v240, v232, v244
    v_exp_f32 v234, v130
    v_add_f32 v240, v233, v240
    v_exp_f32 v235, v131
    v_add_f32 v240, v234, v240
    v_cvt_pk_bf16_f32 v160, v232, v233
    v_exp_f32 v236, v132
    v_add_f32 v240, v235, v240
    v_exp_f32 v237, v133
    v_add_f32 v241, v236, v245
    v_cvt_pk_bf16_f32 v161, v234, v235
    v_exp_f32 v238, v134
    v_add_f32 v241, v237, v241
    v_exp_f32 v239, v135
    v_add_f32 v241, v238, v241
    v_cvt_pk_bf16_f32 v164, v236, v237
    v_exp_f32 v232, v136
    v_add_f32 v241, v239, v241
    v_exp_f32 v233, v137
    v_add_f32 v242, v232, v246
    v_cvt_pk_bf16_f32 v165, v238, v239
    v_exp_f32 v234, v138
    v_add_f32 v242, v233, v242
    v_exp_f32 v235, v139
    v_add_f32 v242, v234, v242
    v_cvt_pk_bf16_f32 v168, v232, v233
    v_exp_f32 v236, v140
    v_add_f32 v242, v235, v242
    v_exp_f32 v237, v141
    v_add_f32 v243, v236, v247
    v_cvt_pk_bf16_f32 v169, v234, v235
    v_exp_f32 v238, v142
    v_add_f32 v243, v237, v243
    v_exp_f32 v239, v143
    v_add_f32 v243, v238, v243
    v_cvt_pk_bf16_f32 v172, v236, v237
    v_add_f32 v243, v239, v243
    v_cvt_pk_bf16_f32 v173, v238, v239
    v_exp_f32 v232, v144
    v_exp_f32 v233, v145
    v_add_f32 v240, v232, v240
    v_exp_f32 v234, v146
    v_add_f32 v240, v233, v240
    v_exp_f32 v235, v147
    v_add_f32 v240, v234, v240
    v_cvt_pk_bf16_f32 v162, v232, v233
    v_exp_f32 v236, v148
    v_add_f32 v240, v235, v240
    v_exp_f32 v237, v149
    v_add_f32 v241, v236, v241
    v_cvt_pk_bf16_f32 v163, v234, v235
    v_exp_f32 v238, v150
    v_add_f32 v241, v237, v241
    v_exp_f32 v239, v151
    v_add_f32 v241, v238, v241
    v_cvt_pk_bf16_f32 v166, v236, v237
    v_exp_f32 v232, v152
    v_add_f32 v241, v239, v241
    v_exp_f32 v233, v153
    v_add_f32 v242, v232, v242
    v_cvt_pk_bf16_f32 v167, v238, v239
    v_exp_f32 v234, v154
    v_add_f32 v242, v233, v242
    v_exp_f32 v235, v155
    v_add_f32 v242, v234, v242
    v_cvt_pk_bf16_f32 v170, v232, v233
    v_exp_f32 v236, v156
    v_add_f32 v242, v235, v242
    v_exp_f32 v237, v157
    v_add_f32 v243, v236, v243
    v_cvt_pk_bf16_f32 v171, v234, v235
    v_exp_f32 v238, v158
    v_add_f32 v243, v237, v243
    v_exp_f32 v239, v159
    v_add_f32 v243, v238, v243
    v_cvt_pk_bf16_f32 v174, v236, v237
    v_add_f32 v243, v239, v243
    v_cvt_pk_bf16_f32 v175, v238, v239
    s_nop 1
    s_branch L_retA
L_slowB:
    s_nop 7
    s_nop 3
    v_max3_f32 v232, v128, v129, v130
    v_max3_f32 v233, v132, v133, v134
    v_max3_f32 v234, v136, v137, v138
    v_max3_f32 v235, v140, v141, v142
    v_max3_f32 v232, v232, v131, v144
    v_max3_f32 v233, v233, v135, v148
    v_max3_f32 v234, v234, v139, v152
    v_max3_f32 v235, v235, v143, v156
    v_max3_f32 v232, v232, v145, v146
    v_max3_f32 v233, v233, v149, v150
    v_max3_f32 v234, v234, v153, v154
    v_max3_f32 v235, v235, v157, v158
    v_max_f32 v232, v232, v147
    v_max_f32 v233, v233, v151
    v_max_f32 v234, v234, v155
    v_max_f32 v235, v235, v159
    s_nop 0
    v_mov_b32 v236, v232
    v_mov_b32 v237, v233
    v_mov_b32 v238, v234
    v_mov_b32 v239, v235
    v_permlane16_swap_b32 v232, v236
    v_permlane16_swap_b32 v233, v237
    v_permlane16_swap_b32 v234, v238
    v_permlane16_swap_b32 v235, v239
    v_max_f32 v232, v232, v236
    v_max_f32 v233, v233, v237
    v_max_f32 v234, v234, v238
    v_max_f32 v235, v235, v239
    v_mov_b32 v236, v232
    v_mov_b32 v237, v233
    v_mov_b32 v238, v234
    v_mov_b32 v239, v235
    v_permlane32_swap_b32 v232, v236
    v_permlane32_swap_b32 v233, v237
    v_permlane32_swap_b32 v234, v238
    v_permlane32_swap_b32 v235, v239
    v_max_f32 v232, v232, v236
    v_max_f32 v233, v233, v237
    v_max_f32 v234, v234, v238
    v_max_f32 v235, v235, v239
    v_max_f32 v232, 0, v232
    v_max_f32 v233, 0, v233
    v_max_f32 v234, 0, v234
    v_max_f32 v235, 0, v235
    v_sub_f32 v128, v128, v232
    v_sub_f32 v129, v129, v232
    v_sub_f32 v130, v130, v232
    v_sub_f32 v131, v131, v232
    v_sub_f32 v144, v144, v232
    v_sub_f32 v145, v145, v232
    v_sub_f32 v146, v146, v232
    v_sub_f32 v147, v147, v232
    v_sub_f32 v192, v192, v232
    v_sub_f32 v193, v193, v232
    v_sub_f32 v194, v194, v232
    v_sub_f32 v195, v195, v232
    v_sub_f32 v132, v132, v233
    v_sub_f32 v133, v133, v233
    v_sub_f32 v134, v134, v233
    v_sub_f32 v135, v135, v233
    v_sub_f32 v148, v148, v233
    v_sub_f32 v149, v149, v233
    v_sub_f32 v150, v150, v233
    v_sub_f32 v151, v151, v233
    v_sub_f32 v196, v196, v233
    v_sub_f32 v197, v197, v233
    v_sub_f32 v198, v198, v233
    v_sub_f32 v199, v199, v233
    v_sub_f32 v136, v136, v234
    v_sub_f32 v137, v137, v234
    v_sub_f32 v138, v138, v234
    v_sub_f32 v139, v139, v234
    v_sub_f32 v152, v152, v234
    v_sub_f32 v153, v153, v234
    v_sub_f32 v154, v154, v234
    v_sub_f32 v155, v155, v234
    v_sub_f32 v200, v200, v234
    v_sub_f32 v201, v201, v234
    v_sub_f32 v202, v202, v234
    v_sub_f32 v203, v203, v234
    v_sub_f32 v140, v140, v235
    v_sub_f32 v141, v141, v235
    v_sub_f32 v142, v142, v235
    v_sub_f32 v143, v143, v235
    v_sub_f32 v156, v156, v235
    v_sub_f32 v157, v157, v235
    v_sub_f32 v158, v158, v235
    v_sub_f32 v159, v159, v235
    v_sub_f32 v204, v204, v235
    v_sub_f32 v205, v205, v235
    v_sub_f32 v206, v206, v235
    v_sub_f32 v207, v207, v235
    v_exp_f32 v232, -v232
    v_exp_f32 v233, -v233
    v_exp_f32 v234, -v234
    v_exp_f32 v235, -v235
    s_nop 0
    v_mul_f32 v240, v240, v232
    v_mul_f32 v241, v241, v233
    v_mul_f32 v242, v242, v234
    v_mul_f32 v243, v243, v235
    v_accvgpr_read_b32 v236, a0
    v_accvgpr_read_b32 v237, a1
    v_accvgpr_read_b32 v238, a2
    v_accvgpr_read_b32 v239, a3
    s_nop 0
    v_mul_f32 v236, v236, v232
    v_mul_f32 v237, v237, v232
    v_mul_f32 v238, v238, v232
    v_mul_f32 v239, v239, v232
    v_accvgpr_write_b32 a0, v236
    v_accvgpr_write_b32 a1, v237
    v_accvgpr_write_b32 a2, v238
    v_accvgpr_write_b32 a3, v239
    v_accvgpr_read_b32 v236, a4
    v_accvgpr_read_b32 v237, a5
    v_accvgpr_read_b32 v238, a6
    v_accvgpr_read_b32 v239, a7
    s_nop 0
    v_mul_f32 v236, v236, v233
    v_mul_f32 v237, v237, v233
    v_mul_f32 v238, v238, v233
    v_mul_f32 v239, v239, v233
    v_accvgpr_write_b32 a4, v236
    v_accvgpr_write_b32 a5, v237
    v_accvgpr_write_b32 a6, v238
    v_accvgpr_write_b32 a7, v239
    v_accvgpr_read_b32 v236, a8
    v_accvgpr_read_b32 v237, a9
    v_accvgpr_read_b32 v238, a10
    v_accvgpr_read_b32 v239, a11
    s_nop 0
    v_mul_f32 v236, v236, v234
    v_mul_f32 v237, v237, v234
    v_mul_f32 v238, v238, v234
    v_mul_f32 v239, v239, v234
    v_accvgpr_write_b32 a8, v236
    v_accvgpr_write_b32 a9, v237
    v_accvgpr_write_b32 a10, v238
    v_accvgpr_write_b32 a11, v239
    v_accvgpr_read_b32 v236, a12
    v_accvgpr_read_b32 v237, a13
    v_accvgpr_read_b32 v238, a14
    v_accvgpr_read_b32 v239, a15
    s_nop 0
    v_mul_f32 v236, v236, v235
    v_mul_f32 v237, v237, v235
    v_mul_f32 v238, v238, v235
    v_mul_f32 v239, v239, v235
    v_accvgpr_write_b32 a12, v236
    v_accvgpr_write_b32 a13, v237
    v_accvgpr_write_b32 a14, v238
    v_accvgpr_write_b32 a15, v239
    v_accvgpr_read_b32 v236, a16
    v_accvgpr_read_b32 v237, a17
    v_accvgpr_read_b32 v238, a18
    v_accvgpr_read_b32 v239, a19
    s_nop 0
    v_mul_f32 v236, v236, v232
    v_mul_f32 v237, v237, v232
    v_mul_f32 v238, v238, v232
    v_mul_f32 v239, v239, v232
    v_accvgpr_write_b32 a16, v236
    v_accvgpr_write_b32 a17, v237
    v_accvgpr_write_b32 a18, v238
    v_accvgpr_write_b32 a19, v239
    v_accvgpr_read_b32 v236, a20
    v_accvgpr_read_b32 v237, a21
    v_accvgpr_read_b32 v238, a22
    v_accvgpr_read_b32 v239, a23
    s_nop 0
    v_mul_f32 v236, v236, v233
    v_mul_f32 v237, v237, v233
    v_mul_f32 v238, v238, v233
    v_mul_f32 v239, v239, v233
    v_accvgpr_write_b32 a20, v236
    v_accvgpr_write_b32 a21, v237
    v_accvgpr_write_b32 a22, v238
    v_accvgpr_write_b32 a23, v239
    v_accvgpr_read_b32 v236, a24
    v_accvgpr_read_b32 v237, a25
    v_accvgpr_read_b32 v238, a26
    v_accvgpr_read_b32 v239, a27
    s_nop 0
    v_mul_f32 v236, v236, v234
    v_mul_f32 v237, v237, v234
    v_mul_f32 v238, v238, v234
    v_mul_f32 v239, v239, v234
    v_accvgpr_write_b32 a24, v236
    v_accvgpr_write_b32 a25, v237
    v_accvgpr_write_b32 a26, v238
    v_accvgpr_write_b32 a27, v239
    v_accvgpr_read_b32 v236, a28
    v_accvgpr_read_b32 v237, a29
    v_accvgpr_read_b32 v238, a30
    v_accvgpr_read_b32 v239, a31
    s_nop 0
    v_mul_f32 v236, v236, v235
    v_mul_f32 v237, v237, v235
    v_mul_f32 v238, v238, v235
    v_mul_f32 v239, v239, v235
    v_accvgpr_write_b32 a28, v236
    v_accvgpr_write_b32 a29, v237
    v_accvgpr_write_b32 a30, v238
    v_accvgpr_write_b32 a31, v239
    v_accvgpr_read_b32 v236, a32
    v_accvgpr_read_b32 v237, a33
    v_accvgpr_read_b32 v238, a34
    v_accvgpr_read_b32 v239, a35
    s_nop 0
    v_mul_f32 v236, v236, v232
    v_mul_f32 v237, v237, v232
    v_mul_f32 v238, v238, v232
    v_mul_f32 v239, v239, v232
    v_accvgpr_write_b32 a32, v236
    v_accvgpr_write_b32 a33, v237
    v_accvgpr_write_b32 a34, v238
    v_accvgpr_write_b32 a35, v239
    v_accvgpr_read_b32 v236, a36
    v_accvgpr_read_b32 v237, a37
    v_accvgpr_read_b32 v238, a38
    v_accvgpr_read_b32 v239, a39
    s_nop 0
    v_mul_f32 v236, v236, v233
    v_mul_f32 v237, v237, v233
    v_mul_f32 v238, v238, v233
    v_mul_f32 v239, v239, v233
    v_accvgpr_write_b32 a36, v236
    v_accvgpr_write_b32 a37, v237
    v_accvgpr_write_b32 a38, v238
    v_accvgpr_write_b32 a39, v239
    v_accvgpr_read_b32 v236, a40
    v_accvgpr_read_b32 v237, a41
    v_accvgpr_read_b32 v238, a42
    v_accvgpr_read_b32 v239, a43
    s_nop 0
    v_mul_f32 v236, v236, v234
    v_mul_f32 v237, v237, v234
    v_mul_f32 v238, v238, v234
    v_mul_f32 v239, v239, v234
    v_accvgpr_write_b32 a40, v236
    v_accvgpr_write_b32 a41, v237
    v_accvgpr_write_b32 a42, v238
    v_accvgpr_write_b32 a43, v239
    v_accvgpr_read_b32 v236, a44
    v_accvgpr_read_b32 v237, a45
    v_accvgpr_read_b32 v238, a46
    v_accvgpr_read_b32 v239, a47
    s_nop 0
    v_mul_f32 v236, v236, v235
    v_mul_f32 v237, v237, v235
    v_mul_f32 v238, v238, v235
    v_mul_f32 v239, v239, v235
    v_accvgpr_write_b32 a44, v236
    v_accvgpr_write_b32 a45, v237
    v_accvgpr_write_b32 a46, v238
    v_accvgpr_write_b32 a47, v239
    v_accvgpr_read_b32 v236, a48
    v_accvgpr_read_b32 v237, a49
    v_accvgpr_read_b32 v238, a50
    v_accvgpr_read_b32 v239, a51
    s_nop 0
    v_mul_f32 v236, v236, v232
    v_mul_f32 v237, v237, v232
    v_mul_f32 v238, v238, v232
    v_mul_f32 v239, v239, v232
    v_accvgpr_write_b32 a48, v236
    v_accvgpr_write_b32 a49, v237
    v_accvgpr_write_b32 a50, v238
    v_accvgpr_write_b32 a51, v239
    v_accvgpr_read_b32 v236, a52
    v_accvgpr_read_b32 v237, a53
    v_accvgpr_read_b32 v238, a54
    v_accvgpr_read_b32 v239, a55
    s_nop 0
    v_mul_f32 v236, v236, v233
    v_mul_f32 v237, v237, v233
    v_mul_f32 v238, v238, v233
    v_mul_f32 v239, v239, v233
    v_accvgpr_write_b32 a52, v236
    v_accvgpr_write_b32 a53, v237
    v_accvgpr_write_b32 a54, v238
    v_accvgpr_write_b32 a55, v239
    v_accvgpr_read_b32 v236, a56
    v_accvgpr_read_b32 v237, a57
    v_accvgpr_read_b32 v238, a58
    v_accvgpr_read_b32 v239, a59
    s_nop 0
    v_mul_f32 v236, v236, v234
    v_mul_f32 v237, v237, v234
    v_mul_f32 v238, v238, v234
    v_mul_f32 v239, v239, v234
    v_accvgpr_write_b32 a56, v236
    v_accvgpr_write_b32 a57, v237
    v_accvgpr_write_b32 a58, v238
    v_accvgpr_write_b32 a59, v239
    v_accvgpr_read_b32 v236, a60
    v_accvgpr_read_b32 v237, a61
    v_accvgpr_read_b32 v238, a62
    v_accvgpr_read_b32 v239, a63
    s_nop 0
    v_mul_f32 v236, v236, v235
    v_mul_f32 v237, v237, v235
    v_mul_f32 v238, v238, v235
    v_mul_f32 v239, v239, v235
    v_accvgpr_write_b32 a60, v236
    v_accvgpr_write_b32 a61, v237
    v_accvgpr_write_b32 a62, v238
    v_accvgpr_write_b32 a63, v239
    v_accvgpr_read_b32 v236, a64
    v_accvgpr_read_b32 v237, a65
    v_accvgpr_read_b32 v238, a66
    v_accvgpr_read_b32 v239, a67
    s_nop 0
    v_mul_f32 v236, v236, v232
    v_mul_f32 v237, v237, v232
    v_mul_f32 v238, v238, v232
    v_mul_f32 v239, v239, v232
    v_accvgpr_write_b32 a64, v236
    v_accvgpr_write_b32 a65, v237
    v_accvgpr_write_b32 a66, v238
    v_accvgpr_write_b32 a67, v239
    v_accvgpr_read_b32 v236, a68
    v_accvgpr_read_b32 v237, a69
    v_accvgpr_read_b32 v238, a70
    v_accvgpr_read_b32 v239, a71
    s_nop 0
    v_mul_f32 v236, v236, v233
    v_mul_f32 v237, v237, v233
    v_mul_f32 v238, v238, v233
    v_mul_f32 v239, v239, v233
    v_accvgpr_write_b32 a68, v236
    v_accvgpr_write_b32 a69, v237
    v_accvgpr_write_b32 a70, v238
    v_accvgpr_write_b32 a71, v239
    v_accvgpr_read_b32 v236, a72
    v_accvgpr_read_b32 v237, a73
    v_accvgpr_read_b32 v238, a74
    v_accvgpr_read_b32 v239, a75
    s_nop 0
    v_mul_f32 v236, v236, v234
    v_mul_f32 v237, v237, v234
    v_mul_f32 v238, v238, v234
    v_mul_f32 v239, v239, v234
    v_accvgpr_write_b32 a72, v236
    v_accvgpr_write_b32 a73, v237
    v_accvgpr_write_b32 a74, v238
    v_accvgpr_write_b32 a75, v239
    v_accvgpr_read_b32 v236, a76
    v_accvgpr_read_b32 v237, a77
    v_accvgpr_read_b32 v238, a78
    v_accvgpr_read_b32 v239, a79
    s_nop 0
    v_mul_f32 v236, v236, v235
    v_mul_f32 v237, v237, v235
    v_mul_f32 v238, v238, v235
    v_mul_f32 v239, v239, v235
    v_accvgpr_write_b32 a76, v236
    v_accvgpr_write_b32 a77, v237
    v_accvgpr_write_b32 a78, v238
    v_accvgpr_write_b32 a79, v239
    v_accvgpr_read_b32 v236, a80
    v_accvgpr_read_b32 v237, a81
    v_accvgpr_read_b32 v238, a82
    v_accvgpr_read_b32 v239, a83
    s_nop 0
    v_mul_f32 v236, v236, v232
    v_mul_f32 v237, v237, v232
    v_mul_f32 v238, v238, v232
    v_mul_f32 v239, v239, v232
    v_accvgpr_write_b32 a80, v236
    v_accvgpr_write_b32 a81, v237
    v_accvgpr_write_b32 a82, v238
    v_accvgpr_write_b32 a83, v239
    v_accvgpr_read_b32 v236, a84
    v_accvgpr_read_b32 v237, a85
    v_accvgpr_read_b32 v238, a86
    v_accvgpr_read_b32 v239, a87
    s_nop 0
    v_mul_f32 v236, v236, v233
    v_mul_f32 v237, v237, v233
    v_mul_f32 v238, v238, v233
    v_mul_f32 v239, v239, v233
    v_accvgpr_write_b32 a84, v236
    v_accvgpr_write_b32 a85, v237
    v_accvgpr_write_b32 a86, v238
    v_accvgpr_write_b32 a87, v239
    v_accvgpr_read_b32 v236, a88
    v_accvgpr_read_b32 v237, a89
    v_accvgpr_read_b32 v238, a90
    v_accvgpr_read_b32 v239, a91
    s_nop 0
    v_mul_f32 v236, v236, v234
    v_mul_f32 v237, v237, v234
    v_mul_f32 v238, v238, v234
    v_mul_f32 v239, v239, v234
    v_accvgpr_write_b32 a88, v236
    v_accvgpr_write_b32 a89, v237
    v_accvgpr_write_b32 a90, v238
    v_accvgpr_write_b32 a91, v239
    v_accvgpr_read_b32 v236, a92
    v_accvgpr_read_b32 v237, a93
    v_accvgpr_read_b32 v238, a94
    v_accvgpr_read_b32 v239, a95
    s_nop 0
    v_mul_f32 v236, v236, v235
    v_mul_f32 v237, v237, v235
    v_mul_f32 v238, v238, v235
    v_mul_f32 v239, v239, v235
    v_accvgpr_write_b32 a92, v236
    v_accvgpr_write_b32 a93, v237
    v_accvgpr_write_b32 a94, v238
    v_accvgpr_write_b32 a95, v239
    v_accvgpr_read_b32 v236, a96
    v_accvgpr_read_b32 v237, a97
    v_accvgpr_read_b32 v238, a98
    v_accvgpr_read_b32 v239, a99
    s_nop 0
    v_mul_f32 v236, v236, v232
    v_mul_f32 v237, v237, v232
    v_mul_f32 v238, v238, v232
    v_mul_f32 v239, v239, v232
    v_accvgpr_write_b32 a96, v236
    v_accvgpr_write_b32 a97, v237
    v_accvgpr_write_b32 a98, v238
    v_accvgpr_write_b32 a99, v239
    v_accvgpr_read_b32 v236, a100
    v_accvgpr_read_b32 v237, a101
    v_accvgpr_read_b32 v238, a102
    v_accvgpr_read_b32 v239, a103
    s_nop 0
    v_mul_f32 v236, v236, v233
    v_mul_f32 v237, v237, v233
    v_mul_f32 v238, v238, v233
    v_mul_f32 v239, v239, v233
    v_accvgpr_write_b32 a100, v236
    v_accvgpr_write_b32 a101, v237
    v_accvgpr_write_b32 a102, v238
    v_accvgpr_write_b32 a103, v239
    v_accvgpr_read_b32 v236, a104
    v_accvgpr_read_b32 v237, a105
    v_accvgpr_read_b32 v238, a106
    v_accvgpr_read_b32 v239, a107
    s_nop 0
    v_mul_f32 v236, v236, v234
    v_mul_f32 v237, v237, v234
    v_mul_f32 v238, v238, v234
    v_mul_f32 v239, v239, v234
    v_accvgpr_write_b32 a104, v236
    v_accvgpr_write_b32 a105, v237
    v_accvgpr_write_b32 a106, v238
    v_accvgpr_write_b32 a107, v239
    v_accvgpr_read_b32 v236, a108
    v_accvgpr_read_b32 v237, a109
    v_accvgpr_read_b32 v238, a110
    v_accvgpr_read_b32 v239, a111
    s_nop 0
    v_mul_f32 v236, v236, v235
    v_mul_f32 v237, v237, v235
    v_mul_f32 v238, v238, v235
    v_mul_f32 v239, v239, v235
    v_accvgpr_write_b32 a108, v236
    v_accvgpr_write_b32 a109, v237
    v_accvgpr_write_b32 a110, v238
    v_accvgpr_write_b32 a111, v239
    v_accvgpr_read_b32 v236, a112
    v_accvgpr_read_b32 v237, a113
    v_accvgpr_read_b32 v238, a114
    v_accvgpr_read_b32 v239, a115
    s_nop 0
    v_mul_f32 v236, v236, v232
    v_mul_f32 v237, v237, v232
    v_mul_f32 v238, v238, v232
    v_mul_f32 v239, v239, v232
    v_accvgpr_write_b32 a112, v236
    v_accvgpr_write_b32 a113, v237
    v_accvgpr_write_b32 a114, v238
    v_accvgpr_write_b32 a115, v239
    v_accvgpr_read_b32 v236, a116
    v_accvgpr_read_b32 v237, a117
    v_accvgpr_read_b32 v238, a118
    v_accvgpr_read_b32 v239, a119
    s_nop 0
    v_mul_f32 v236, v236, v233
    v_mul_f32 v237, v237, v233
    v_mul_f32 v238, v238, v233
    v_mul_f32 v239, v239, v233
    v_accvgpr_write_b32 a116, v236
    v_accvgpr_write_b32 a117, v237
    v_accvgpr_write_b32 a118, v238
    v_accvgpr_write_b32 a119, v239
    v_accvgpr_read_b32 v236, a120
    v_accvgpr_read_b32 v237, a121
    v_accvgpr_read_b32 v238, a122
    v_accvgpr_read_b32 v239, a123
    s_nop 0
    v_mul_f32 v236, v236, v234
    v_mul_f32 v237, v237, v234
    v_mul_f32 v238, v238, v234
    v_mul_f32 v239, v239, v234
    v_accvgpr_write_b32 a120, v236
    v_accvgpr_write_b32 a121, v237
    v_accvgpr_write_b32 a122, v238
    v_accvgpr_write_b32 a123, v239
    v_accvgpr_read_b32 v236, a124
    v_accvgpr_read_b32 v237, a125
    v_accvgpr_read_b32 v238, a126
    v_accvgpr_read_b32 v239, a127
    s_nop 0
    v_mul_f32 v236, v236, v235
    v_mul_f32 v237, v237, v235
    v_mul_f32 v238, v238, v235
    v_mul_f32 v239, v239, v235
    v_accvgpr_write_b32 a124, v236
    v_accvgpr_write_b32 a125, v237
    v_accvgpr_write_b32 a126, v238
    v_accvgpr_write_b32 a127, v239
    v_accvgpr_read_b32 v236, a128
    v_accvgpr_read_b32 v237, a129
    v_accvgpr_read_b32 v238, a130
    v_accvgpr_read_b32 v239, a131
    s_nop 0
    v_mul_f32 v236, v236, v232
    v_mul_f32 v237, v237, v232
    v_mul_f32 v238, v238, v232
    v_mul_f32 v239, v239, v232
    v_accvgpr_write_b32 a128, v236
    v_accvgpr_write_b32 a129, v237
    v_accvgpr_write_b32 a130, v238
    v_accvgpr_write_b32 a131, v239
    v_accvgpr_read_b32 v236, a132
    v_accvgpr_read_b32 v237, a133
    v_accvgpr_read_b32 v238, a134
    v_accvgpr_read_b32 v239, a135
    s_nop 0
    v_mul_f32 v236, v236, v233
    v_mul_f32 v237, v237, v233
    v_mul_f32 v238, v238, v233
    v_mul_f32 v239, v239, v233
    v_accvgpr_write_b32 a132, v236
    v_accvgpr_write_b32 a133, v237
    v_accvgpr_write_b32 a134, v238
    v_accvgpr_write_b32 a135, v239
    v_accvgpr_read_b32 v236, a136
    v_accvgpr_read_b32 v237, a137
    v_accvgpr_read_b32 v238, a138
    v_accvgpr_read_b32 v239, a139
    s_nop 0
    v_mul_f32 v236, v236, v234
    v_mul_f32 v237, v237, v234
    v_mul_f32 v238, v238, v234
    v_mul_f32 v239, v239, v234
    v_accvgpr_write_b32 a136, v236
    v_accvgpr_write_b32 a137, v237
    v_accvgpr_write_b32 a138, v238
    v_accvgpr_write_b32 a139, v239
    v_accvgpr_read_b32 v236, a140
    v_accvgpr_read_b32 v237, a141
    v_accvgpr_read_b32 v238, a142
    v_accvgpr_read_b32 v239, a143
    s_nop 0
    v_mul_f32 v236, v236, v235
    v_mul_f32 v237, v237, v235
    v_mul_f32 v238, v238, v235
    v_mul_f32 v239, v239, v235
    v_accvgpr_write_b32 a140, v236
    v_accvgpr_write_b32 a141, v237
    v_accvgpr_write_b32 a142, v238
    v_accvgpr_write_b32 a143, v239
    v_accvgpr_read_b32 v236, a144
    v_accvgpr_read_b32 v237, a145
    v_accvgpr_read_b32 v238, a146
    v_accvgpr_read_b32 v239, a147
    s_nop 0
    v_mul_f32 v236, v236, v232
    v_mul_f32 v237, v237, v232
    v_mul_f32 v238, v238, v232
    v_mul_f32 v239, v239, v232
    v_accvgpr_write_b32 a144, v236
    v_accvgpr_write_b32 a145, v237
    v_accvgpr_write_b32 a146, v238
    v_accvgpr_write_b32 a147, v239
    v_accvgpr_read_b32 v236, a148
    v_accvgpr_read_b32 v237, a149
    v_accvgpr_read_b32 v238, a150
    v_accvgpr_read_b32 v239, a151
    s_nop 0
    v_mul_f32 v236, v236, v233
    v_mul_f32 v237, v237, v233
    v_mul_f32 v238, v238, v233
    v_mul_f32 v239, v239, v233
    v_accvgpr_write_b32 a148, v236
    v_accvgpr_write_b32 a149, v237
    v_accvgpr_write_b32 a150, v238
    v_accvgpr_write_b32 a151, v239
    v_accvgpr_read_b32 v236, a152
    v_accvgpr_read_b32 v237, a153
    v_accvgpr_read_b32 v238, a154
    v_accvgpr_read_b32 v239, a155
    s_nop 0
    v_mul_f32 v236, v236, v234
    v_mul_f32 v237, v237, v234
    v_mul_f32 v238, v238, v234
    v_mul_f32 v239, v239, v234
    v_accvgpr_write_b32 a152, v236
    v_accvgpr_write_b32 a153, v237
    v_accvgpr_write_b32 a154, v238
    v_accvgpr_write_b32 a155, v239
    v_accvgpr_read_b32 v236, a156
    v_accvgpr_read_b32 v237, a157
    v_accvgpr_read_b32 v238, a158
    v_accvgpr_read_b32 v239, a159
    s_nop 0
    v_mul_f32 v236, v236, v235
    v_mul_f32 v237, v237, v235
    v_mul_f32 v238, v238, v235
    v_mul_f32 v239, v239, v235
    v_accvgpr_write_b32 a156, v236
    v_accvgpr_write_b32 a157, v237
    v_accvgpr_write_b32 a158, v238
    v_accvgpr_write_b32 a159, v239
    v_accvgpr_read_b32 v236, a160
    v_accvgpr_read_b32 v237, a161
    v_accvgpr_read_b32 v238, a162
    v_accvgpr_read_b32 v239, a163
    s_nop 0
    v_mul_f32 v236, v236, v232
    v_mul_f32 v237, v237, v232
    v_mul_f32 v238, v238, v232
    v_mul_f32 v239, v239, v232
    v_accvgpr_write_b32 a160, v236
    v_accvgpr_write_b32 a161, v237
    v_accvgpr_write_b32 a162, v238
    v_accvgpr_write_b32 a163, v239
    v_accvgpr_read_b32 v236, a164
    v_accvgpr_read_b32 v237, a165
    v_accvgpr_read_b32 v238, a166
    v_accvgpr_read_b32 v239, a167
    s_nop 0
    v_mul_f32 v236, v236, v233
    v_mul_f32 v237, v237, v233
    v_mul_f32 v238, v238, v233
    v_mul_f32 v239, v239, v233
    v_accvgpr_write_b32 a164, v236
    v_accvgpr_write_b32 a165, v237
    v_accvgpr_write_b32 a166, v238
    v_accvgpr_write_b32 a167, v239
    v_accvgpr_read_b32 v236, a168
    v_accvgpr_read_b32 v237, a169
    v_accvgpr_read_b32 v238, a170
    v_accvgpr_read_b32 v239, a171
    s_nop 0
    v_mul_f32 v236, v236, v234
    v_mul_f32 v237, v237, v234
    v_mul_f32 v238, v238, v234
    v_mul_f32 v239, v239, v234
    v_accvgpr_write_b32 a168, v236
    v_accvgpr_write_b32 a169, v237
    v_accvgpr_write_b32 a170, v238
    v_accvgpr_write_b32 a171, v239
    v_accvgpr_read_b32 v236, a172
    v_accvgpr_read_b32 v237, a173
    v_accvgpr_read_b32 v238, a174
    v_accvgpr_read_b32 v239, a175
    s_nop 0
    v_mul_f32 v236, v236, v235
    v_mul_f32 v237, v237, v235
    v_mul_f32 v238, v238, v235
    v_mul_f32 v239, v239, v235
    v_accvgpr_write_b32 a172, v236
    v_accvgpr_write_b32 a173, v237
    v_accvgpr_write_b32 a174, v238
    v_accvgpr_write_b32 a175, v239
    v_accvgpr_read_b32 v236, a176
    v_accvgpr_read_b32 v237, a177
    v_accvgpr_read_b32 v238, a178
    v_accvgpr_read_b32 v239, a179
    s_nop 0
    v_mul_f32 v236, v236, v232
    v_mul_f32 v237, v237, v232
    v_mul_f32 v238, v238, v232
    v_mul_f32 v239, v239, v232
    v_accvgpr_write_b32 a176, v236
    v_accvgpr_write_b32 a177, v237
    v_accvgpr_write_b32 a178, v238
    v_accvgpr_write_b32 a179, v239
    v_accvgpr_read_b32 v236, a180
    v_accvgpr_read_b32 v237, a181
    v_accvgpr_read_b32 v238, a182
    v_accvgpr_read_b32 v239, a183
    s_nop 0
    v_mul_f32 v236, v236, v233
    v_mul_f32 v237, v237, v233
    v_mul_f32 v238, v238, v233
    v_mul_f32 v239, v239, v233
    v_accvgpr_write_b32 a180, v236
    v_accvgpr_write_b32 a181, v237
    v_accvgpr_write_b32 a182, v238
    v_accvgpr_write_b32 a183, v239
    v_accvgpr_read_b32 v236, a184
    v_accvgpr_read_b32 v237, a185
    v_accvgpr_read_b32 v238, a186
    v_accvgpr_read_b32 v239, a187
    s_nop 0
    v_mul_f32 v236, v236, v234
    v_mul_f32 v237, v237, v234
    v_mul_f32 v238, v238, v234
    v_mul_f32 v239, v239, v234
    v_accvgpr_write_b32 a184, v236
    v_accvgpr_write_b32 a185, v237
    v_accvgpr_write_b32 a186, v238
    v_accvgpr_write_b32 a187, v239
    v_accvgpr_read_b32 v236, a188
    v_accvgpr_read_b32 v237, a189
    v_accvgpr_read_b32 v238, a190
    v_accvgpr_read_b32 v239, a191
    s_nop 0
    v_mul_f32 v236, v236, v235
    v_mul_f32 v237, v237, v235
    v_mul_f32 v238, v238, v235
    v_mul_f32 v239, v239, v235
    v_accvgpr_write_b32 a188, v236
    v_accvgpr_write_b32 a189, v237
    v_accvgpr_write_b32 a190, v238
    v_accvgpr_write_b32 a191, v239
    v_accvgpr_read_b32 v236, a192
    v_accvgpr_read_b32 v237, a193
    v_accvgpr_read_b32 v238, a194
    v_accvgpr_read_b32 v239, a195
    s_nop 0
    v_mul_f32 v236, v236, v232
    v_mul_f32 v237, v237, v232
    v_mul_f32 v238, v238, v232
    v_mul_f32 v239, v239, v232
    v_accvgpr_write_b32 a192, v236
    v_accvgpr_write_b32 a193, v237
    v_accvgpr_write_b32 a194, v238
    v_accvgpr_write_b32 a195, v239
    v_accvgpr_read_b32 v236, a196
    v_accvgpr_read_b32 v237, a197
    v_accvgpr_read_b32 v238, a198
    v_accvgpr_read_b32 v239, a199
    s_nop 0
    v_mul_f32 v236, v236, v233
    v_mul_f32 v237, v237, v233
    v_mul_f32 v238, v238, v233
    v_mul_f32 v239, v239, v233
    v_accvgpr_write_b32 a196, v236
    v_accvgpr_write_b32 a197, v237
    v_accvgpr_write_b32 a198, v238
    v_accvgpr_write_b32 a199, v239
    v_accvgpr_read_b32 v236, a200
    v_accvgpr_read_b32 v237, a201
    v_accvgpr_read_b32 v238, a202
    v_accvgpr_read_b32 v239, a203
    s_nop 0
    v_mul_f32 v236, v236, v234
    v_mul_f32 v237, v237, v234
    v_mul_f32 v238, v238, v234
    v_mul_f32 v239, v239, v234
    v_accvgpr_write_b32 a200, v236
    v_accvgpr_write_b32 a201, v237
    v_accvgpr_write_b32 a202, v238
    v_accvgpr_write_b32 a203, v239
    v_accvgpr_read_b32 v236, a204
    v_accvgpr_read_b32 v237, a205
    v_accvgpr_read_b32 v238, a206
    v_accvgpr_read_b32 v239, a207
    s_nop 0
    v_mul_f32 v236, v236, v235
    v_mul_f32 v237, v237, v235
    v_mul_f32 v238, v238, v235
    v_mul_f32 v239, v239, v235
    v_accvgpr_write_b32 a204, v236
    v_accvgpr_write_b32 a205, v237
    v_accvgpr_write_b32 a206, v238
    v_accvgpr_write_b32 a207, v239
    v_accvgpr_read_b32 v236, a208
    v_accvgpr_read_b32 v237, a209
    v_accvgpr_read_b32 v238, a210
    v_accvgpr_read_b32 v239, a211
    s_nop 0
    v_mul_f32 v236, v236, v232
    v_mul_f32 v237, v237, v232
    v_mul_f32 v238, v238, v232
    v_mul_f32 v239, v239, v232
    v_accvgpr_write_b32 a208, v236
    v_accvgpr_write_b32 a209, v237
    v_accvgpr_write_b32 a210, v238
    v_accvgpr_write_b32 a211, v239
    v_accvgpr_read_b32 v236, a212
    v_accvgpr_read_b32 v237, a213
    v_accvgpr_read_b32 v238, a214
    v_accvgpr_read_b32 v239, a215
    s_nop 0
    v_mul_f32 v236, v236, v233
    v_mul_f32 v237, v237, v233
    v_mul_f32 v238, v238, v233
    v_mul_f32 v239, v239, v233
    v_accvgpr_write_b32 a212, v236
    v_accvgpr_write_b32 a213, v237
    v_accvgpr_write_b32 a214, v238
    v_accvgpr_write_b32 a215, v239
    v_accvgpr_read_b32 v236, a216
    v_accvgpr_read_b32 v237, a217
    v_accvgpr_read_b32 v238, a218
    v_accvgpr_read_b32 v239, a219
    s_nop 0
    v_mul_f32 v236, v236, v234
    v_mul_f32 v237, v237, v234
    v_mul_f32 v238, v238, v234
    v_mul_f32 v239, v239, v234
    v_accvgpr_write_b32 a216, v236
    v_accvgpr_write_b32 a217, v237
    v_accvgpr_write_b32 a218, v238
    v_accvgpr_write_b32 a219, v239
    v_accvgpr_read_b32 v236, a220
    v_accvgpr_read_b32 v237, a221
    v_accvgpr_read_b32 v238, a222
    v_accvgpr_read_b32 v239, a223
    s_nop 0
    v_mul_f32 v236, v236, v235
    v_mul_f32 v237, v237, v235
    v_mul_f32 v238, v238, v235
    v_mul_f32 v239, v239, v235
    v_accvgpr_write_b32 a220, v236
    v_accvgpr_write_b32 a221, v237
    v_accvgpr_write_b32 a222, v238
    v_accvgpr_write_b32 a223, v239
    v_accvgpr_read_b32 v236, a224
    v_accvgpr_read_b32 v237, a225
    v_accvgpr_read_b32 v238, a226
    v_accvgpr_read_b32 v239, a227
    s_nop 0
    v_mul_f32 v236, v236, v232
    v_mul_f32 v237, v237, v232
    v_mul_f32 v238, v238, v232
    v_mul_f32 v239, v239, v232
    v_accvgpr_write_b32 a224, v236
    v_accvgpr_write_b32 a225, v237
    v_accvgpr_write_b32 a226, v238
    v_accvgpr_write_b32 a227, v239
    v_accvgpr_read_b32 v236, a228
    v_accvgpr_read_b32 v237, a229
    v_accvgpr_read_b32 v238, a230
    v_accvgpr_read_b32 v239, a231
    s_nop 0
    v_mul_f32 v236, v236, v233
    v_mul_f32 v237, v237, v233
    v_mul_f32 v238, v238, v233
    v_mul_f32 v239, v239, v233
    v_accvgpr_write_b32 a228, v236
    v_accvgpr_write_b32 a229, v237
    v_accvgpr_write_b32 a230, v238
    v_accvgpr_write_b32 a231, v239
    v_accvgpr_read_b32 v236, a232
    v_accvgpr_read_b32 v237, a233
    v_accvgpr_read_b32 v238, a234
    v_accvgpr_read_b32 v239, a235
    s_nop 0
    v_mul_f32 v236, v236, v234
    v_mul_f32 v237, v237, v234
    v_mul_f32 v238, v238, v234
    v_mul_f32 v239, v239, v234
    v_accvgpr_write_b32 a232, v236
    v_accvgpr_write_b32 a233, v237
    v_accvgpr_write_b32 a234, v238
    v_accvgpr_write_b32 a235, v239
    v_accvgpr_read_b32 v236, a236
    v_accvgpr_read_b32 v237, a237
    v_accvgpr_read_b32 v238, a238
    v_accvgpr_read_b32 v239, a239
    s_nop 0
    v_mul_f32 v236, v236, v235
    v_mul_f32 v237, v237, v235
    v_mul_f32 v238, v238, v235
    v_mul_f32 v239, v239, v235
    v_accvgpr_write_b32 a236, v236
    v_accvgpr_write_b32 a237, v237
    v_accvgpr_write_b32 a238, v238
    v_accvgpr_write_b32 a239, v239
    v_accvgpr_read_b32 v236, a240
    v_accvgpr_read_b32 v237, a241
    v_accvgpr_read_b32 v238, a242
    v_accvgpr_read_b32 v239, a243
    s_nop 0
    v_mul_f32 v236, v236, v232
    v_mul_f32 v237, v237, v232
    v_mul_f32 v238, v238, v232
    v_mul_f32 v239, v239, v232
    v_accvgpr_write_b32 a240, v236
    v_accvgpr_write_b32 a241, v237
    v_accvgpr_write_b32 a242, v238
    v_accvgpr_write_b32 a243, v239
    v_accvgpr_read_b32 v236, a244
    v_accvgpr_read_b32 v237, a245
    v_accvgpr_read_b32 v238, a246
    v_accvgpr_read_b32 v239, a247
    s_nop 0
    v_mul_f32 v236, v236, v233
    v_mul_f32 v237, v237, v233
    v_mul_f32 v238, v238, v233
    v_mul_f32 v239, v239, v233
    v_accvgpr_write_b32 a244, v236
    v_accvgpr_write_b32 a245, v237
    v_accvgpr_write_b32 a246, v238
    v_accvgpr_write_b32 a247, v239
    v_accvgpr_read_b32 v236, a248
    v_accvgpr_read_b32 v237, a249
    v_accvgpr_read_b32 v238, a250
    v_accvgpr_read_b32 v239, a251
    s_nop 0
    v_mul_f32 v236, v236, v234
    v_mul_f32 v237, v237, v234
    v_mul_f32 v238, v238, v234
    v_mul_f32 v239, v239, v234
    v_accvgpr_write_b32 a248, v236
    v_accvgpr_write_b32 a249, v237
    v_accvgpr_write_b32 a250, v238
    v_accvgpr_write_b32 a251, v239
    v_accvgpr_read_b32 v236, a252
    v_accvgpr_read_b32 v237, a253
    v_accvgpr_read_b32 v238, a254
    v_accvgpr_read_b32 v239, a255
    s_nop 0
    v_mul_f32 v236, v236, v235
    v_mul_f32 v237, v237, v235
    v_mul_f32 v238, v238, v235
    v_mul_f32 v239, v239, v235
    v_accvgpr_write_b32 a252, v236
    v_accvgpr_write_b32 a253, v237
    v_accvgpr_write_b32 a254, v238
    v_accvgpr_write_b32 a255, v239
    v_exp_f32 v232, v128
    v_exp_f32 v233, v129
    v_add_f32 v244, v232, v240
    v_exp_f32 v234, v130
    v_add_f32 v244, v233, v244
    v_exp_f32 v235, v131
    v_add_f32 v244, v234, v244
    v_cvt_pk_bf16_f32 v176, v232, v233
    v_exp_f32 v236, v132
    v_add_f32 v244, v235, v244
    v_exp_f32 v237, v133
    v_add_f32 v245, v236, v241
    v_cvt_pk_bf16_f32 v177, v234, v235
    v_exp_f32 v238, v134
    v_add_f32 v245, v237, v245
    v_exp_f32 v239, v135
    v_add_f32 v245, v238, v245
    v_cvt_pk_bf16_f32 v180, v236, v237
    v_exp_f32 v232, v136
    v_add_f32 v245, v239, v245
    v_exp_f32 v233, v137
    v_add_f32 v246, v232, v242
    v_cvt_pk_bf16_f32 v181, v238, v239
    v_exp_f32 v234, v138
    v_add_f32 v246, v233, v246
    v_exp_f32 v235, v139
    v_add_f32 v246, v234, v246
    v_cvt_pk_bf16_f32 v184, v232, v233
    v_exp_f32 v236, v140
    v_add_f32 v246, v235, v246
    v_exp_f32 v237, v141
    v_add_f32 v247, v236, v243
    v_cvt_pk_bf16_f32 v185, v234, v235
    v_exp_f32 v238, v142
    v_add_f32 v247, v237, v247
    v_exp_f32 v239, v143
    v_add_f32 v247, v238, v247
    v_cvt_pk_bf16_f32 v188, v236, v237
    v_add_f32 v247, v239, v247
    v_cvt_pk_bf16_f32 v189, v238, v239
    v_exp_f32 v232, v144
    v_exp_f32 v233, v145
    v_add_f32 v244, v232, v244
    v_exp_f32 v234, v146
    v_add_f32 v244, v233, v244
    v_exp_f32 v235, v147
    v_add_f32 v244, v234, v244
    v_cvt_pk_bf16_f32 v178, v232, v233
    v_exp_f32 v236, v148
    v_add_f32 v244, v235, v244
    v_exp_f32 v237, v149
    v_add_f32 v245, v236, v245
    v_cvt_pk_bf16_f32 v179, v234, v235
    v_exp_f32 v238, v150
    v_add_f32 v245, v237, v245
    v_exp_f32 v239, v151
    v_add_f32 v245, v238, v245
    v_cvt_pk_bf16_f32 v182, v236, v237
    v_exp_f32 v232, v152
    v_add_f32 v245, v239, v245
    v_exp_f32 v233, v153
    v_add_f32 v246, v232, v246
    v_cvt_pk_bf16_f32 v183, v238, v239
    v_exp_f32 v234, v154
    v_add_f32 v246, v233, v246
    v_exp_f32 v235, v155
    v_add_f32 v246, v234, v246
    v_cvt_pk_bf16_f32 v186, v232, v233
    v_exp_f32 v236, v156
    v_add_f32 v246, v235, v246
    v_exp_f32 v237, v157
    v_add_f32 v247, v236, v247
    v_cvt_pk_bf16_f32 v187, v234, v235
    v_exp_f32 v238, v158
    v_add_f32 v247, v237, v247
    v_exp_f32 v239, v159
    v_add_f32 v247, v238, v247
    v_cvt_pk_bf16_f32 v190, v236, v237
    v_add_f32 v247, v239, v247
    v_cvt_pk_bf16_f32 v191, v238, v239
    s_nop 1
    s_branch L_retB
.section .rodata,"a"
.p2align 6
.amdhsa_kernel recurrent_scan__gqa_block_cached__mixer_channel_mlp__prompt_kernel
  .amdhsa_next_free_vgpr 512
  .amdhsa_next_free_sgpr 102
  .amdhsa_accum_offset 256
  .amdhsa_group_segment_fixed_size 0
  .amdhsa_kernarg_size 104
  .amdhsa_user_sgpr_count 2
  .amdhsa_user_sgpr_kernarg_segment_ptr 1
  .amdhsa_system_sgpr_workgroup_id_x 1
.end_amdhsa_kernel
.text
```
